```python
import torch

def _softmax(x, axis=-1):
    return torch.softmax(x, dim=axis)

def _gelu(x):
    return torch.nn.functional.gelu(x, approximate='tanh')

def _silu(x):
    return torch.nn.functional.silu(x)

def _sigmoid(x):
    return torch.sigmoid(x)

def _layernorm(x, axis=-1, eps=1e-05):
    m = x.mean(dim=axis, keepdim=True)
    v = x.var(dim=axis, keepdim=True, unbiased=False)
    return (x - m) / torch.sqrt(v + eps)

def _scatter_add(tgt, idx, src, axis=0):
    return tgt.clone().index_add_(axis, idx, src)

def _segment_sum(src, seg, n):
    out = torch.zeros((n,) + src.shape[1:], dtype=src.dtype)
    return out.index_add_(0, seg, src)

def _pad(x, pw):
    flat = tuple((v for pair in reversed(pw) for v in pair))
    return torch.nn.functional.pad(x, flat)
kernel_name = 'recurrent_scan__memory_aug_recurrent_mem_tr__mixer_channel_mlp__prompt'

def setup_inputs():

    _w = lambda a: (lambda t: t.to(torch.bfloat16) if t.is_floating_point() else t)(torch.as_tensor(a))

    def _A_setup():
        B, S, Dm = (1, 2048, 512)
        H, Dh = (32, 128)
        M, seg = (8, 32)
        seg = min(seg, S)
        S = S // seg * seg
        return {'x': _w((lambda *s: torch.randn(*s, dtype=torch.bfloat16) * 0.05)(B, S, Dm)), 'mem0': _w((lambda *s: torch.randn(*s, dtype=torch.bfloat16) * 0.8)(B, M, Dm)), 'Wq': _w((lambda *s: torch.randn(*s, dtype=torch.bfloat16) * 0.8)(Dm, H, Dh) * Dm ** (-0.5)), 'Wk': _w((lambda *s: torch.randn(*s, dtype=torch.bfloat16) * 0.8)(Dm, H, Dh) * Dm ** (-0.5)), 'Wv': _w((lambda *s: torch.randn(*s, dtype=torch.bfloat16) * 0.8)(Dm, H, Dh) * Dm ** (-0.5)), 'Wo': _w((lambda *s: torch.randn(*s, dtype=torch.bfloat16) * 0.8)(H, Dh, Dm) * (H * Dh) ** (-0.5)), 'seg_len': seg}
    _A_in = _A_setup()

    def _B_setup():
        B, S, D, F = (1, 2048, 512, 1792)
        return {'x': _w((lambda *s: torch.randn(*s, dtype=torch.bfloat16) * 0.05)(B, S, D)), 'w1': _w((lambda *s: torch.randn(*s, dtype=torch.bfloat16) * 0.8)(D, F) * D ** (-0.5)), 'b1': _w((lambda *s: torch.randn(*s, dtype=torch.bfloat16) * 0.4)(F)), 'w2': _w((lambda *s: torch.randn(*s, dtype=torch.bfloat16) * 0.2)(F, D) * F ** (-0.5)), 'b2': _w((lambda *s: torch.randn(*s, dtype=torch.bfloat16) * 0.2)(D))}
    _B_in = _B_setup()
    return {'A_x': _A_in['x'], 'A_mem0': _A_in['mem0'], 'A_Wq': _A_in['Wq'], 'A_Wk': _A_in['Wk'], 'A_Wv': _A_in['Wv'], 'A_Wo': _A_in['Wo'], 'A_seg_len': _A_in['seg_len'], 'B_x': _B_in['x'], 'B_w1': _B_in['w1'], 'B_b1': _B_in['b1'], 'B_w2': _B_in['w2'], 'B_b2': _B_in['b2']}

def reference(A_x, A_mem0, A_Wq, A_Wk, A_Wv, A_Wo, A_seg_len, B_x, B_w1, B_b1, B_w2, B_b2):

    def _A_ref(x, mem0, Wq, Wk, Wv, Wo, seg_len):
        B, S, Dm = x.shape
        H, Dh = (Wq.shape[1], Wq.shape[2])
        M = mem0.shape[1]
        scale = Dh ** (-0.5)
        n_seg = S // seg_len
        L = M + seg_len
        idx = torch.arange(L)
        mask = (idx[:, None] < M) | (idx[:, None] >= idx[None, :])
        mem = mem0
        outs = []
        for s in range(n_seg):
            xs = x[:, s * seg_len:(s + 1) * seg_len, :].clone()
            h = torch.concatenate([mem, xs], axis=1)
            q = torch.einsum('btd,dhe->bhte', h, Wq)
            k = torch.einsum('btd,dhe->bhte', h, Wk)
            v = torch.einsum('btd,dhe->bhte', h, Wv)
            scores = torch.einsum('bhqe,bhke->bhqk', q, k) * scale
            scores = torch.where(mask[None, None], scores, -1000000000.0)
            p = _softmax(scores, axis=-1)
            o = torch.einsum('bhqk,bhke->bhqe', p, v)
            o = torch.einsum('bhte,hed->btd', o, Wo)
            mem = o[:, :M, :].clone()
            outs.append(o[:, M:, :])
        return torch.concatenate(outs, axis=1)

    def _B_ref(x, w1, b1, w2, b2):
        y = _layernorm(x, axis=-1)
        h = _gelu(torch.einsum('bsd,df->bsf', y, w1) + b1)
        return torch.einsum('bsf,fd->bsd', h, w2) + b2
    x = A_x
    xn = _layernorm(x, axis=-1)
    s = _A_ref(xn, A_mem0, A_Wq, A_Wk, A_Wv, A_Wo, A_seg_len)
    g = _silu(_B_ref(xn, B_w1, B_b1, B_w2, B_b2))
    return x + s * g
```

```asm
; @launch grid=(256,1,1) block=(256,1,1) lds=163840
.amdgcn_target "amdgcn-amd-amdhsa--gfx950"
.text
.globl recurrent_scan__memory_aug_recurrent_mem_tr__mixer_channel_mlp__prompt_kernel
.p2align 8
.type recurrent_scan__memory_aug_recurrent_mem_tr__mixer_channel_mlp__prompt_kernel,@function
recurrent_scan__memory_aug_recurrent_mem_tr__mixer_channel_mlp__prompt_kernel:
    s_cmp_ge_u32 s2, 256
    s_cbranch_scc1 Lexit
    s_load_dwordx2 s[6:7], s[0:1], 104
    s_load_dwordx2 s[8:9], s[0:1], 112
    v_lshrrev_b32 v1, 6, v0
    s_mov_b32 s10, 0x10000000
    s_mov_b32 s11, 0x20000
    v_readfirstlane_b32 s15, v1
    s_getreg_b32 s14, hwreg(HW_REG_XCC_ID, 0, 3)
    s_sub_u32 s14, s2, s14
    s_add_u32 s14, s14, 3
    s_and_b32 s14, s14, 7
    s_cmp_lg_u32 s15, 3
    s_cbranch_scc1 Lrole
    s_getpc_b64 s[4:5]
Lpc:
    s_lshr_b32 s18, s2, 3
    s_lshl_b32 s18, s18, 12
    v_and_b32 v2, 31, v0
    v_lshlrev_b32 v2, 7, v2
    v_add_u32 v2, s18, v2
    v_min_u32 v2, Lcode_end-Lpc-4, v2
    global_load_dword v99, v2, s[4:5]
    s_cmp_ge_u32 s2, 8
    s_cbranch_scc1 Lrole
    s_add_u32 s18, s14, 1
    v_mov_b32 v2, s18
    v_mov_b32 v3, 0
    s_waitcnt lgkmcnt(0)
    s_mov_b64 exec, 1
    global_atomic_cmpswap v3, v[2:3], s[6:7] offset:32
    s_mov_b64 exec, -1
Lrole:
    s_load_dwordx4 s[40:43], s[0:1], 16
    s_load_dwordx4 s[44:47], s[0:1], 32
    s_load_dwordx2 s[48:49], s[0:1], 8
    s_mov_b32 s17, s15
    s_sub_u32 s3, s2, s14
    s_and_b32 s3, s3, 7
    s_lshr_b32 s16, s2, 3
    s_cmp_eq_u32 s3, 0
    s_cbranch_scc1 Lteam
    s_branch Lwork
Lexit:
    s_endpgm
Lteam:
    s_cmp_eq_u32 s17, 1
    s_cbranch_scc1 Twave_1
    s_cmp_eq_u32 s17, 2
    s_cbranch_scc1 Twave_2
    s_cmp_eq_u32 s17, 3
    s_cbranch_scc1 Twave_3
Twave_0:
    v_and_b32 v100, 63, v0
    v_lshrrev_b32 v102, 1, v100
    v_and_b32 v102, 8, v102
    v_xor_b32 v102, v102, v100
    v_and_b32 v102, 15, v102
    v_lshlrev_b32 v102, 4, v102
    v_lshrrev_b32 v103, 4, v100
    v_lshl_add_u32 v104, v103, 13, v102
    v_lshl_add_u32 v108, v103, 10, v102
    v_xor_b32 v105, 64, v104
    v_xor_b32 v109, 64, v108
    s_mov_b32 s54, 0x400000
    s_mov_b32 s55, 0x20000
    s_mov_b32 s58, 0x400000
    s_mov_b32 s59, 0x20000
    s_mov_b32 s62, 0x400000
    s_mov_b32 s63, 0x20000
    s_mov_b32 s66, 0x400000
    s_mov_b32 s67, 0x20000
    s_lshl_b32 s50, s16, 8
    s_lshl_b32 s51, s16, 17
    s_waitcnt lgkmcnt(0)
    s_mov_b64 s[52:53], s[40:41]
    s_mov_b64 s[56:57], s[42:43]
    s_mov_b64 s[60:61], s[44:45]
    s_mov_b64 s[64:65], s[46:47]
    s_mov_b32 m0, 0
    s_add_u32 s29, s50, 1572864
    buffer_load_dwordx4 v104, s[56:59], s29 offen  lds
    s_mov_b32 m0, 1024
    s_add_u32 s29, s50, 1605632
    buffer_load_dwordx4 v105, s[56:59], s29 offen  lds
    s_mov_b32 m0, 2048
    s_add_u32 s29, s50, 1638400
    buffer_load_dwordx4 v104, s[56:59], s29 offen  lds
    s_mov_b32 m0, 3072
    s_add_u32 s29, s50, 1671168
    buffer_load_dwordx4 v105, s[56:59], s29 offen  lds
    s_mov_b32 m0, 4096
    s_add_u32 s29, s50, 2097152
    buffer_load_dwordx4 v104, s[56:59], s29 offen  lds
    s_mov_b32 m0, 5120
    s_add_u32 s29, s50, 2129920
    buffer_load_dwordx4 v105, s[56:59], s29 offen  lds
    s_mov_b32 m0, 6144
    s_add_u32 s29, s50, 2162688
    buffer_load_dwordx4 v104, s[56:59], s29 offen  lds
    s_mov_b32 m0, 7168
    s_add_u32 s29, s50, 2195456
    buffer_load_dwordx4 v105, s[56:59], s29 offen  lds
    v_mov_b32 v120, 0
    v_bfe_u32 v101, v100, 2, 1
    v_lshl_add_u32 v120, v101, 8, v120
    v_bfe_u32 v101, v100, 4, 2
    v_lshl_add_u32 v120, v101, 10, v120
    v_bfe_u32 v101, v100, 3, 1
    v_lshl_add_u32 v120, v101, 15, v120
    v_bfe_u32 v101, v100, 2, 1
    v_lshl_add_u32 v120, v101, 7, v120
    v_bfe_u32 v101, v100, 4, 1
    v_lshl_add_u32 v120, v101, 6, v120
    v_bfe_u32 v101, v100, 1, 1
    v_lshl_add_u32 v120, v101, 5, v120
    v_bfe_u32 v101, v100, 3, 1
    v_lshl_add_u32 v120, v101, 4, v120
    v_bfe_u32 v101, v100, 0, 1
    v_lshl_add_u32 v120, v101, 3, v120
    v_xor_b32 v120, 0, v120
    v_xor_b32 v121, 16, v120
    v_add_u32 v122, 65536, v120
    v_add_u32 v123, 65536, v121
    v_mov_b32 v124, 0
    v_bfe_u32 v101, v100, 2, 1
    v_lshl_add_u32 v124, v101, 8, v124
    v_bfe_u32 v101, v100, 5, 1
    v_lshl_add_u32 v124, v101, 10, v124
    v_bfe_u32 v101, v100, 4, 1
    v_lshl_add_u32 v124, v101, 11, v124
    v_bfe_u32 v101, v100, 2, 1
    v_lshl_add_u32 v124, v101, 7, v124
    v_bfe_u32 v101, v100, 4, 1
    v_lshl_add_u32 v124, v101, 6, v124
    v_bfe_u32 v101, v100, 3, 1
    v_lshl_add_u32 v124, v101, 5, v124
    v_bfe_u32 v101, v100, 0, 2
    v_lshl_add_u32 v124, v101, 3, v124
    v_xor_b32 v124, 0, v124
    v_add_u32 v125, 65536, v124
    s_mov_b32 m0, 8192
    s_add_u32 s29, s50, 2621440
    buffer_load_dwordx4 v104, s[56:59], s29 offen  lds
    s_mov_b32 m0, 9216
    s_add_u32 s29, s50, 2654208
    buffer_load_dwordx4 v105, s[56:59], s29 offen  lds
    s_mov_b32 m0, 10240
    s_add_u32 s29, s50, 2686976
    buffer_load_dwordx4 v104, s[56:59], s29 offen  lds
    s_mov_b32 m0, 11264
    s_add_u32 s29, s50, 2719744
    buffer_load_dwordx4 v105, s[56:59], s29 offen  lds
    s_waitcnt vmcnt(8)
    s_waitcnt lgkmcnt(0)
    s_barrier
    ds_read_b64_tr_b16 v[144:145], v120 offset:0
    ds_read_b64_tr_b16 v[146:147], v120 offset:512
    ds_read_b64_tr_b16 v[148:149], v122 offset:0
    ds_read_b64_tr_b16 v[150:151], v122 offset:512
    ds_read_b64_tr_b16 v[152:153], v121 offset:0
    ds_read_b64_tr_b16 v[154:155], v121 offset:512
    ds_read_b64_tr_b16 v[156:157], v123 offset:0
    ds_read_b64_tr_b16 v[158:159], v123 offset:512
    s_mov_b32 m0, 12288
    s_add_u32 s29, s50, 3145728
    buffer_load_dwordx4 v104, s[56:59], s29 offen  lds
    s_mov_b32 m0, 13312
    s_add_u32 s29, s50, 3178496
    buffer_load_dwordx4 v105, s[56:59], s29 offen  lds
    s_mov_b32 m0, 14336
    s_add_u32 s29, s50, 3211264
    buffer_load_dwordx4 v104, s[56:59], s29 offen  lds
    s_mov_b32 m0, 15360
    s_add_u32 s29, s50, 3244032
    buffer_load_dwordx4 v105, s[56:59], s29 offen  lds
    v_mov_b32 v103, 0
    v_bfe_u32 v101, v100, 4, 1
    v_lshl_add_u32 v103, v101, 10, v103
    v_bfe_u32 v101, v100, 5, 1
    v_lshl_add_u32 v103, v101, 5, v103
    v_bfe_u32 v101, v100, 0, 2
    v_lshl_add_u32 v103, v101, 2, v103
    s_and_b32 s29, s16, 3
    s_lshl_b32 s29, s29, 11
    s_lshr_b32 s30, s16, 3
    s_lshl_b32 s30, s30, 6
    s_add_u32 s29, s29, s30
    s_and_b32 s30, s16, 4
    s_lshl_b32 s30, s30, 2
    s_add_u32 s29, s29, s30
    v_add_u32 v103, s29, v103
    global_load_dword v110, v103, s[48:49]
    s_waitcnt vmcnt(9)
    s_waitcnt lgkmcnt(0)
    s_barrier
    ds_read_b64_tr_b16 v[160:161], v120 offset:4096
    ds_read_b64_tr_b16 v[162:163], v120 offset:4608
    ds_read_b64_tr_b16 v[164:165], v122 offset:4096
    ds_read_b64_tr_b16 v[166:167], v122 offset:4608
    ds_read_b64_tr_b16 v[168:169], v121 offset:4096
    ds_read_b64_tr_b16 v[170:171], v121 offset:4608
    ds_read_b64_tr_b16 v[172:173], v123 offset:4096
    ds_read_b64_tr_b16 v[174:175], v123 offset:4608
    s_mov_b32 m0, 16384
    s_add_u32 s29, s50, 3670016
    buffer_load_dwordx4 v104, s[56:59], s29 offen  lds
    s_mov_b32 m0, 17408
    s_add_u32 s29, s50, 3702784
    buffer_load_dwordx4 v105, s[56:59], s29 offen  lds
    s_mov_b32 m0, 18432
    s_add_u32 s29, s50, 3735552
    buffer_load_dwordx4 v104, s[56:59], s29 offen  lds
    s_mov_b32 m0, 19456
    s_add_u32 s29, s50, 3768320
    buffer_load_dwordx4 v105, s[56:59], s29 offen  lds
    s_waitcnt vmcnt(9)
    s_waitcnt lgkmcnt(0)
    s_barrier
    ds_read_b64_tr_b16 v[176:177], v120 offset:8192
    ds_read_b64_tr_b16 v[178:179], v120 offset:8704
    ds_read_b64_tr_b16 v[180:181], v122 offset:8192
    ds_read_b64_tr_b16 v[182:183], v122 offset:8704
    ds_read_b64_tr_b16 v[184:185], v121 offset:8192
    ds_read_b64_tr_b16 v[186:187], v121 offset:8704
    ds_read_b64_tr_b16 v[188:189], v123 offset:8192
    ds_read_b64_tr_b16 v[190:191], v123 offset:8704
    s_mov_b32 m0, 20480
    s_add_u32 s29, s50, 0
    buffer_load_dwordx4 v104, s[60:63], s29 offen  lds
    s_mov_b32 m0, 21504
    s_add_u32 s29, s50, 32768
    buffer_load_dwordx4 v105, s[60:63], s29 offen  lds
    s_mov_b32 m0, 22528
    s_add_u32 s29, s50, 65536
    buffer_load_dwordx4 v104, s[60:63], s29 offen  lds
    s_mov_b32 m0, 23552
    s_add_u32 s29, s50, 98304
    buffer_load_dwordx4 v105, s[60:63], s29 offen  lds
    v_mov_b32 v111, 0
    s_mov_b64 exec, 1
    global_load_dword v111, v111, s[6:7] offset:32 sc1
    s_mov_b64 exec, -1
    v_mov_b32 v2, 0
    v_bfe_u32 v101, v100, 0, 6
    v_lshl_add_u32 v2, v101, 4, v2
    s_waitcnt vmcnt(10)
    s_waitcnt lgkmcnt(0)
    s_barrier
    ds_read_b64_tr_b16 v[192:193], v120 offset:12288
    ds_read_b64_tr_b16 v[194:195], v120 offset:12800
    ds_read_b64_tr_b16 v[196:197], v122 offset:12288
    ds_read_b64_tr_b16 v[198:199], v122 offset:12800
    ds_read_b64_tr_b16 v[200:201], v121 offset:12288
    ds_read_b64_tr_b16 v[202:203], v121 offset:12800
    ds_read_b64_tr_b16 v[204:205], v123 offset:12288
    ds_read_b64_tr_b16 v[206:207], v123 offset:12800
    s_mov_b32 m0, 24576
    s_add_u32 s29, s50, 524288
    buffer_load_dwordx4 v104, s[60:63], s29 offen  lds
    s_mov_b32 m0, 25600
    s_add_u32 s29, s50, 557056
    buffer_load_dwordx4 v105, s[60:63], s29 offen  lds
    s_mov_b32 m0, 26624
    s_add_u32 s29, s50, 589824
    buffer_load_dwordx4 v104, s[60:63], s29 offen  lds
    s_mov_b32 m0, 27648
    s_add_u32 s29, s50, 622592
    buffer_load_dwordx4 v105, s[60:63], s29 offen  lds
    v_mov_b32 v4, 139264
    v_bfe_u32 v101, v100, 0, 3
    v_lshl_add_u32 v4, v101, 5, v4
    v_bfe_u32 v101, v100, 4, 2
    v_lshl_add_u32 v4, v101, 3, v4
    v_bfe_u32 v101, v100, 3, 1
    v_lshl_add_u32 v4, v101, 2, v4
    s_waitcnt vmcnt(9)
    s_waitcnt lgkmcnt(0)
    s_barrier
    ds_read_b64_tr_b16 v[208:209], v120 offset:16384
    ds_read_b64_tr_b16 v[210:211], v120 offset:16896
    ds_read_b64_tr_b16 v[212:213], v122 offset:16384
    ds_read_b64_tr_b16 v[214:215], v122 offset:16896
    ds_read_b64_tr_b16 v[216:217], v121 offset:16384
    ds_read_b64_tr_b16 v[218:219], v121 offset:16896
    ds_read_b64_tr_b16 v[220:221], v123 offset:16384
    ds_read_b64_tr_b16 v[222:223], v123 offset:16896
    s_mov_b32 m0, 28672
    s_add_u32 s29, s50, 1048576
    buffer_load_dwordx4 v104, s[60:63], s29 offen  lds
    s_mov_b32 m0, 29696
    s_add_u32 s29, s50, 1081344
    buffer_load_dwordx4 v105, s[60:63], s29 offen  lds
    s_mov_b32 m0, 30720
    s_add_u32 s29, s50, 1114112
    buffer_load_dwordx4 v104, s[60:63], s29 offen  lds
    s_mov_b32 m0, 31744
    s_add_u32 s29, s50, 1146880
    buffer_load_dwordx4 v105, s[60:63], s29 offen  lds
    v_mov_b32 v5, 139264
    v_bfe_u32 v101, v100, 5, 1
    v_lshl_add_u32 v5, v101, 10, v5
    v_bfe_u32 v101, v100, 0, 5
    v_lshl_add_u32 v5, v101, 3, v5
    s_waitcnt vmcnt(9)
    s_waitcnt lgkmcnt(0)
    s_barrier
    ds_read_b64_tr_b16 v[224:225], v120 offset:20480
    ds_read_b64_tr_b16 v[226:227], v120 offset:20992
    ds_read_b64_tr_b16 v[228:229], v122 offset:20480
    ds_read_b64_tr_b16 v[230:231], v122 offset:20992
    ds_read_b64_tr_b16 v[232:233], v121 offset:20480
    ds_read_b64_tr_b16 v[234:235], v121 offset:20992
    ds_read_b64_tr_b16 v[236:237], v123 offset:20480
    ds_read_b64_tr_b16 v[238:239], v123 offset:20992
    s_mov_b32 m0, 0
    s_add_u32 s29, s50, 1572864
    buffer_load_dwordx4 v104, s[60:63], s29 offen  lds
    s_mov_b32 m0, 1024
    s_add_u32 s29, s50, 1605632
    buffer_load_dwordx4 v105, s[60:63], s29 offen  lds
    s_mov_b32 m0, 2048
    s_add_u32 s29, s50, 1638400
    buffer_load_dwordx4 v104, s[60:63], s29 offen  lds
    s_mov_b32 m0, 3072
    s_add_u32 s29, s50, 1671168
    buffer_load_dwordx4 v105, s[60:63], s29 offen  lds
    v_mov_b32 v6, 131072
    v_bfe_u32 v101, v100, 2, 4
    v_lshl_add_u32 v6, v101, 6, v6
    v_bfe_u32 v101, v100, 0, 1
    v_lshl_add_u32 v6, v101, 4, v6
    s_waitcnt vmcnt(8)
    s_waitcnt lgkmcnt(0)
    s_barrier
    ds_read_b64_tr_b16 v[240:241], v120 offset:24576
    ds_read_b64_tr_b16 v[242:243], v120 offset:25088
    ds_read_b64_tr_b16 v[244:245], v122 offset:24576
    ds_read_b64_tr_b16 v[246:247], v122 offset:25088
    ds_read_b64_tr_b16 v[248:249], v121 offset:24576
    ds_read_b64_tr_b16 v[250:251], v121 offset:25088
    ds_read_b64_tr_b16 v[252:253], v123 offset:24576
    ds_read_b64_tr_b16 v[254:255], v123 offset:25088
    s_mov_b32 m0, 4096
    s_add_u32 s29, s50, 2097152
    buffer_load_dwordx4 v104, s[60:63], s29 offen  lds
    s_mov_b32 m0, 5120
    s_add_u32 s29, s50, 2129920
    buffer_load_dwordx4 v105, s[60:63], s29 offen  lds
    s_mov_b32 m0, 6144
    s_add_u32 s29, s50, 2162688
    buffer_load_dwordx4 v104, s[60:63], s29 offen  lds
    s_mov_b32 m0, 7168
    s_add_u32 s29, s50, 2195456
    buffer_load_dwordx4 v105, s[60:63], s29 offen  lds
    s_mov_b32 s5, 0
Lrot_1:
    v_readfirstlane_b32 s4, v111
    s_nop 3
    s_sub_u32 s4, s4, 1
    s_cmp_eq_u32 s4, s14
    s_cbranch_scc1 Lrot_1_ok
    s_cmp_lt_u32 s4, 8
    s_cbranch_scc0 Lrot_1_again
    s_mov_b32 s14, s4
    s_waitcnt vmcnt(0) lgkmcnt(0)
    s_barrier
    s_branch Lrole
Lrot_1_again:
    v_mov_b32 v111, 0
    s_mov_b64 exec, 1
    global_load_dword v111, v111, s[6:7] offset:32 sc1
    s_mov_b64 exec, -1
    s_waitcnt vmcnt(0)
    s_add_u32 s5, s5, 1
    s_cmp_lt_u32 s5, 400000
    s_cbranch_scc1 Lrot_1
Lrot_1_ok:
    v_mov_b32 v12, 143360
    v_bfe_u32 v101, v100, 0, 4
    v_lshl_add_u32 v12, v101, 4, v12
    v_bfe_u32 v101, v100, 4, 2
    v_lshl_add_u32 v12, v101, 2, v12
    s_waitcnt vmcnt(8)
    s_waitcnt lgkmcnt(0)
    s_barrier
    ds_read_b64_tr_b16 a[0:1], v120 offset:28672
    ds_read_b64_tr_b16 a[2:3], v120 offset:29184
    ds_read_b64_tr_b16 a[4:5], v122 offset:28672
    ds_read_b64_tr_b16 a[6:7], v122 offset:29184
    ds_read_b64_tr_b16 a[8:9], v121 offset:28672
    ds_read_b64_tr_b16 a[10:11], v121 offset:29184
    ds_read_b64_tr_b16 a[12:13], v123 offset:28672
    ds_read_b64_tr_b16 a[14:15], v123 offset:29184
    s_mov_b32 m0, 8192
    s_add_u32 s29, s50, 2621440
    buffer_load_dwordx4 v104, s[60:63], s29 offen  lds
    s_mov_b32 m0, 9216
    s_add_u32 s29, s50, 2654208
    buffer_load_dwordx4 v105, s[60:63], s29 offen  lds
    s_mov_b32 m0, 10240
    s_add_u32 s29, s50, 2686976
    buffer_load_dwordx4 v104, s[60:63], s29 offen  lds
    s_mov_b32 m0, 11264
    s_add_u32 s29, s50, 2719744
    buffer_load_dwordx4 v105, s[60:63], s29 offen  lds
    v_mov_b32 v7, 131072
    v_bfe_u32 v101, v100, 3, 1
    v_lshl_add_u32 v7, v101, 15, v7
    v_bfe_u32 v101, v100, 4, 2
    v_lshl_add_u32 v7, v101, 13, v7
    v_bfe_u32 v101, v100, 0, 3
    v_lshl_add_u32 v7, v101, 3, v7
    v_mov_b32 v103, 0
    v_bfe_u32 v101, v100, 3, 1
    v_lshl_add_u32 v103, v101, 2, v103
    v_bfe_u32 v101, v100, 4, 2
    v_lshl_add_u32 v103, v101, 0, v103
    v_mul_u32_u24 v103, 0, v103
    v_add_u32 v103, s16, v103
    v_and_b32 v103, 31, v103
    v_lshl_add_u32 v7, v103, 6, v7
    s_waitcnt vmcnt(8)
    s_waitcnt lgkmcnt(0)
    s_barrier
    ds_read_b64_tr_b16 a[16:17], v120 offset:0
    ds_read_b64_tr_b16 a[18:19], v120 offset:512
    ds_read_b64_tr_b16 a[20:21], v122 offset:0
    ds_read_b64_tr_b16 a[22:23], v122 offset:512
    ds_read_b64_tr_b16 a[24:25], v121 offset:0
    ds_read_b64_tr_b16 a[26:27], v121 offset:512
    ds_read_b64_tr_b16 a[28:29], v123 offset:0
    ds_read_b64_tr_b16 a[30:31], v123 offset:512
    s_mov_b32 m0, 12288
    s_add_u32 s29, s50, 3145728
    buffer_load_dwordx4 v104, s[60:63], s29 offen  lds
    s_mov_b32 m0, 13312
    s_add_u32 s29, s50, 3178496
    buffer_load_dwordx4 v105, s[60:63], s29 offen  lds
    s_mov_b32 m0, 14336
    s_add_u32 s29, s50, 3211264
    buffer_load_dwordx4 v104, s[60:63], s29 offen  lds
    s_mov_b32 m0, 15360
    s_add_u32 s29, s50, 3244032
    buffer_load_dwordx4 v105, s[60:63], s29 offen  lds
    v_mov_b32 v1, 131072
    v_bfe_u32 v101, v100, 0, 6
    v_lshl_add_u32 v1, v101, 4, v1
    v_mov_b32 v112, -1
    v_mov_b32 v113, -1
    v_mov_b32 v114, -1
    v_mov_b32 v115, -1
    s_lshl_b32 s22, s16, 13
    s_add_u32 s22, s22, 52428800
    s_xor_b32 s23, s22, 262144
    buffer_store_dwordx4 v[112:115], v1, s[8:11], s22 offen offset:0 sc1
    buffer_store_dwordx4 v[112:115], v1, s[8:11], s22 offen offset:1024 sc1
    buffer_store_dwordx4 v[112:115], v1, s[8:11], s23 offen offset:0 sc1
    buffer_store_dwordx4 v[112:115], v1, s[8:11], s23 offen offset:1024 sc1
    s_waitcnt vmcnt(12)
    s_waitcnt lgkmcnt(0)
    s_barrier
    ds_read_b64_tr_b16 a[32:33], v120 offset:4096
    ds_read_b64_tr_b16 a[34:35], v120 offset:4608
    ds_read_b64_tr_b16 a[36:37], v122 offset:4096
    ds_read_b64_tr_b16 a[38:39], v122 offset:4608
    ds_read_b64_tr_b16 a[40:41], v121 offset:4096
    ds_read_b64_tr_b16 a[42:43], v121 offset:4608
    ds_read_b64_tr_b16 a[44:45], v123 offset:4096
    ds_read_b64_tr_b16 a[46:47], v123 offset:4608
    s_mov_b32 m0, 16384
    s_add_u32 s29, s50, 3670016
    buffer_load_dwordx4 v104, s[60:63], s29 offen  lds
    s_mov_b32 m0, 17408
    s_add_u32 s29, s50, 3702784
    buffer_load_dwordx4 v105, s[60:63], s29 offen  lds
    s_mov_b32 m0, 18432
    s_add_u32 s29, s50, 3735552
    buffer_load_dwordx4 v104, s[60:63], s29 offen  lds
    s_mov_b32 m0, 19456
    s_add_u32 s29, s50, 3768320
    buffer_load_dwordx4 v105, s[60:63], s29 offen  lds
    v_mov_b32 v8, 0
    v_bfe_u32 v101, v100, 4, 2
    v_lshl_add_u32 v8, v101, 4, v8
    v_bfe_u32 v101, v100, 0, 2
    v_lshl_add_u32 v8, v101, 2, v8
    v_bfe_u32 v101, v100, 2, 1
    v_lshl_add_u32 v8, v101, 30, v8
    v_bfe_u32 v101, v100, 3, 1
    v_lshlrev_b32 v101, 30, v101
    v_or_b32 v8, v101, v8
    s_lshl_b32 s24, s16, 6
    s_add_u32 s24, s24, 53084160
    s_add_u32 s29, s24, 8192
    buffer_store_dword v112, v8, s[8:11], s29 offen sc1
    s_add_u32 s29, s24, 16384
    buffer_store_dword v112, v8, s[8:11], s29 offen sc1
    s_add_u32 s29, s24, 24576
    buffer_store_dword v112, v8, s[8:11], s29 offen sc1
    buffer_store_dword v110, v8, s[8:11], s24 offen sc1
    s_waitcnt vmcnt(16)
    s_waitcnt lgkmcnt(0)
    s_barrier
    ds_read_b64_tr_b16 a[48:49], v120 offset:8192
    ds_read_b64_tr_b16 a[50:51], v120 offset:8704
    ds_read_b64_tr_b16 a[52:53], v122 offset:8192
    ds_read_b64_tr_b16 a[54:55], v122 offset:8704
    ds_read_b64_tr_b16 a[56:57], v121 offset:8192
    ds_read_b64_tr_b16 a[58:59], v121 offset:8704
    ds_read_b64_tr_b16 a[60:61], v123 offset:8192
    ds_read_b64_tr_b16 a[62:63], v123 offset:8704
    s_mov_b32 m0, 20480
    s_add_u32 s29, s50, 2097152
    buffer_load_dwordx4 v104, s[52:55], s29 offen  lds
    s_mov_b32 m0, 21504
    s_add_u32 s29, s50, 2129920
    buffer_load_dwordx4 v105, s[52:55], s29 offen  lds
    s_mov_b32 m0, 22528
    s_add_u32 s29, s50, 2162688
    buffer_load_dwordx4 v104, s[52:55], s29 offen  lds
    s_mov_b32 m0, 23552
    s_add_u32 s29, s50, 2195456
    buffer_load_dwordx4 v105, s[52:55], s29 offen  lds
    v_mov_b32 v3, 0
    v_bfe_u32 v101, v100, 4, 2
    v_lshl_add_u32 v3, v101, 9, v3
    v_bfe_u32 v101, v100, 3, 1
    v_lshl_add_u32 v3, v101, 8, v3
    v_bfe_u32 v101, v100, 0, 3
    v_lshl_add_u32 v3, v101, 4, v3
    s_waitcnt vmcnt(16)
    s_waitcnt lgkmcnt(0)
    s_barrier
    ds_read_b64_tr_b16 a[64:65], v120 offset:12288
    ds_read_b64_tr_b16 a[66:67], v120 offset:12800
    ds_read_b64_tr_b16 a[68:69], v122 offset:12288
    ds_read_b64_tr_b16 a[70:71], v122 offset:12800
    ds_read_b64_tr_b16 a[72:73], v121 offset:12288
    ds_read_b64_tr_b16 a[74:75], v121 offset:12800
    ds_read_b64_tr_b16 a[76:77], v123 offset:12288
    ds_read_b64_tr_b16 a[78:79], v123 offset:12800
    s_mov_b32 m0, 24576
    s_add_u32 s29, s50, 2621440
    buffer_load_dwordx4 v104, s[52:55], s29 offen  lds
    s_mov_b32 m0, 25600
    s_add_u32 s29, s50, 2654208
    buffer_load_dwordx4 v105, s[52:55], s29 offen  lds
    s_mov_b32 m0, 26624
    s_add_u32 s29, s50, 2686976
    buffer_load_dwordx4 v104, s[52:55], s29 offen  lds
    s_mov_b32 m0, 27648
    s_add_u32 s29, s50, 2719744
    buffer_load_dwordx4 v105, s[52:55], s29 offen  lds
    v_mov_b32 v9, 0
    v_bfe_u32 v101, v100, 5, 1
    v_lshl_add_u32 v9, v101, 12, v9
    v_bfe_u32 v101, v100, 4, 1
    v_lshl_add_u32 v9, v101, 10, v9
    v_bfe_u32 v101, v100, 0, 4
    v_lshl_add_u32 v9, v101, 4, v9
    s_waitcnt vmcnt(12)
    s_waitcnt lgkmcnt(0)
    s_barrier
    ds_read_b64_tr_b16 a[80:81], v120 offset:16384
    ds_read_b64_tr_b16 a[82:83], v120 offset:16896
    ds_read_b64_tr_b16 a[84:85], v122 offset:16384
    ds_read_b64_tr_b16 a[86:87], v122 offset:16896
    ds_read_b64_tr_b16 a[88:89], v121 offset:16384
    ds_read_b64_tr_b16 a[90:91], v121 offset:16896
    ds_read_b64_tr_b16 a[92:93], v123 offset:16384
    ds_read_b64_tr_b16 a[94:95], v123 offset:16896
    s_mov_b32 m0, 28672
    s_add_u32 s29, s50, 3145728
    buffer_load_dwordx4 v104, s[52:55], s29 offen  lds
    s_mov_b32 m0, 29696
    s_add_u32 s29, s50, 3178496
    buffer_load_dwordx4 v105, s[52:55], s29 offen  lds
    s_mov_b32 m0, 30720
    s_add_u32 s29, s50, 3211264
    buffer_load_dwordx4 v104, s[52:55], s29 offen  lds
    s_mov_b32 m0, 31744
    s_add_u32 s29, s50, 3244032
    buffer_load_dwordx4 v105, s[52:55], s29 offen  lds
    v_mov_b32 v103, 0
    v_bfe_u32 v101, v100, 0, 2
    v_lshl_add_u32 v103, v101, 2, v103
    v_bfe_u32 v101, v100, 2, 2
    v_lshl_add_u32 v103, v101, 0, v103
    v_and_b32 v102, 1, v103
    v_lshlrev_b32 v102, 4, v102
    v_mov_b32 v101, 0x3f80
    v_lshlrev_b32 v102, v102, v101
    v_lshrrev_b32 v103, 1, v103
    v_cmp_eq_u32 vcc, 0, v103
    s_nop 1
    v_cndmask_b32 v112, 0, v102, vcc
    v_cmp_eq_u32 vcc, 1, v103
    s_nop 1
    v_cndmask_b32 v113, 0, v102, vcc
    v_cmp_eq_u32 vcc, 2, v103
    s_nop 1
    v_cndmask_b32 v114, 0, v102, vcc
    v_cmp_eq_u32 vcc, 3, v103
    s_nop 1
    v_cndmask_b32 v115, 0, v102, vcc
    ds_write_b128 v1, v[112:115] offset:13312
    v_bfe_u32 v101, v100, 1, 1
    v_mul_u32_u24 v101, 0xaaaa, v101
    v_add_u32 v0, 0x4444, v101
    s_waitcnt vmcnt(8)
    s_waitcnt lgkmcnt(0)
    s_barrier
    ds_read_b64_tr_b16 a[96:97], v120 offset:20480
    ds_read_b64_tr_b16 a[98:99], v120 offset:20992
    ds_read_b64_tr_b16 a[100:101], v122 offset:20480
    ds_read_b64_tr_b16 a[102:103], v122 offset:20992
    ds_read_b64_tr_b16 a[104:105], v121 offset:20480
    ds_read_b64_tr_b16 a[106:107], v121 offset:20992
    ds_read_b64_tr_b16 a[108:109], v123 offset:20480
    ds_read_b64_tr_b16 a[110:111], v123 offset:20992
    s_mov_b32 m0, 0
    s_add_u32 s29, s50, 3670016
    buffer_load_dwordx4 v104, s[52:55], s29 offen  lds
    s_mov_b32 m0, 1024
    s_add_u32 s29, s50, 3702784
    buffer_load_dwordx4 v105, s[52:55], s29 offen  lds
    s_mov_b32 m0, 2048
    s_add_u32 s29, s50, 3735552
    buffer_load_dwordx4 v104, s[52:55], s29 offen  lds
    s_mov_b32 m0, 3072
    s_add_u32 s29, s50, 3768320
    buffer_load_dwordx4 v105, s[52:55], s29 offen  lds
    s_lshl_b32 s18, s16, 14
    s_add_u32 s18, s18, 4096
    s_add_u32 s19, s24, 7733248
    v_mov_b32 v14, v110
    s_mov_b32 s20, 52428800
    s_mov_b32 s17, 0
    s_mov_b32 s28, 0
    s_mov_b32 s32, 0x3e0293ee
    s_mov_b32 s42, 0x3f803f80
    s_mov_b32 s44, 0x3f003f00
    s_mov_b32 s48, 0x33333333
    s_mov_b32 s43, 0x3f803f80
    s_mov_b32 s45, 0x3f003f00
    s_mov_b32 s49, 0x33333333
    s_mov_b32 s34, 0x21800000
    s_mov_b32 s35, 0x3c000000
    s_waitcnt vmcnt(8)
    s_waitcnt lgkmcnt(0)
    s_barrier
    ds_read_b64_tr_b16 a[112:113], v120 offset:24576
    ds_read_b64_tr_b16 a[114:115], v120 offset:25088
    ds_read_b64_tr_b16 a[116:117], v122 offset:24576
    ds_read_b64_tr_b16 a[118:119], v122 offset:25088
    ds_read_b64_tr_b16 a[120:121], v121 offset:24576
    ds_read_b64_tr_b16 a[122:123], v121 offset:25088
    ds_read_b64_tr_b16 a[124:125], v123 offset:24576
    ds_read_b64_tr_b16 a[126:127], v123 offset:25088
    s_mov_b32 m0, 4096
    s_add_u32 s29, s51, 0
    buffer_load_dwordx4 v108, s[64:67], s29 offen  lds
    s_mov_b32 m0, 5120
    s_add_u32 s29, s51, 4096
    buffer_load_dwordx4 v108, s[64:67], s29 offen  lds
    s_mov_b32 m0, 6144
    s_add_u32 s29, s51, 8192
    buffer_load_dwordx4 v109, s[64:67], s29 offen  lds
    s_mov_b32 m0, 7168
    s_add_u32 s29, s51, 12288
    buffer_load_dwordx4 v109, s[64:67], s29 offen  lds
    v_mov_b32 v126, 131072
    v_bfe_u32 v101, v100, 2, 4
    v_lshl_add_u32 v126, v101, 5, v126
    v_bfe_u32 v101, v100, 0, 1
    v_lshl_add_u32 v126, v101, 4, v126
    v_bfe_u32 v101, v100, 1, 1
    v_lshl_add_u32 v126, v101, 3, v126
    s_waitcnt vmcnt(8)
    s_waitcnt lgkmcnt(0)
    s_barrier
    ds_read_b64_tr_b16 a[128:129], v120 offset:28672
    ds_read_b64_tr_b16 a[130:131], v120 offset:29184
    ds_read_b64_tr_b16 a[132:133], v122 offset:28672
    ds_read_b64_tr_b16 a[134:135], v122 offset:29184
    ds_read_b64_tr_b16 a[136:137], v121 offset:28672
    ds_read_b64_tr_b16 a[138:139], v121 offset:29184
    ds_read_b64_tr_b16 a[140:141], v123 offset:28672
    ds_read_b64_tr_b16 a[142:143], v123 offset:29184
    s_mov_b32 m0, 8192
    s_add_u32 s29, s51, 65536
    buffer_load_dwordx4 v108, s[64:67], s29 offen  lds
    s_mov_b32 m0, 9216
    s_add_u32 s29, s51, 69632
    buffer_load_dwordx4 v108, s[64:67], s29 offen  lds
    s_mov_b32 m0, 10240
    s_add_u32 s29, s51, 73728
    buffer_load_dwordx4 v109, s[64:67], s29 offen  lds
    s_mov_b32 m0, 11264
    s_add_u32 s29, s51, 77824
    buffer_load_dwordx4 v109, s[64:67], s29 offen  lds
    v_mov_b32 v127, 131072
    v_bfe_u32 v101, v100, 2, 4
    v_lshl_add_u32 v127, v101, 5, v127
    v_bfe_u32 v101, v100, 0, 1
    v_lshl_add_u32 v127, v101, 4, v127
    s_waitcnt vmcnt(8)
    s_waitcnt lgkmcnt(0)
    s_barrier
    ds_read_b64_tr_b16 a[144:145], v120 offset:0
    ds_read_b64_tr_b16 a[146:147], v120 offset:512
    ds_read_b64_tr_b16 a[148:149], v122 offset:0
    ds_read_b64_tr_b16 a[150:151], v122 offset:512
    ds_read_b64_tr_b16 a[152:153], v121 offset:0
    ds_read_b64_tr_b16 a[154:155], v121 offset:512
    ds_read_b64_tr_b16 a[156:157], v123 offset:0
    ds_read_b64_tr_b16 a[158:159], v123 offset:512
    s_mov_b32 m0, 12288
    s_add_u32 s29, s51, 256
    buffer_load_dwordx4 v108, s[64:67], s29 offen  lds
    s_mov_b32 m0, 13312
    s_add_u32 s29, s51, 4352
    buffer_load_dwordx4 v108, s[64:67], s29 offen  lds
    s_mov_b32 m0, 14336
    s_add_u32 s29, s51, 8448
    buffer_load_dwordx4 v109, s[64:67], s29 offen  lds
    s_mov_b32 m0, 15360
    s_add_u32 s29, s51, 12544
    buffer_load_dwordx4 v109, s[64:67], s29 offen  lds
    s_waitcnt vmcnt(8)
    s_waitcnt lgkmcnt(0)
    s_barrier
    s_getreg_b32 s36, hwreg(HW_REG_XCC_ID, 0, 3)
    s_lshl_b32 s36, s36, 3
    s_lshl_b64 s[36:37], 1, s36
    v_mov_b32 v116, s36
    v_mov_b32 v117, s37
    v_mov_b32 v118, 0
    s_mov_b64 exec, 1
    global_atomic_add_x2 v118, v[116:117], s[6:7]
    s_mov_b64 exec, -1
    ds_read_b64_tr_b16 a[160:161], v124 offset:4096
    ds_read_b64_tr_b16 a[162:163], v124 offset:4608
    ds_read_b64_tr_b16 a[164:165], v124 offset:36864
    ds_read_b64_tr_b16 a[166:167], v124 offset:37376
    ds_read_b64_tr_b16 a[168:169], v125 offset:4096
    ds_read_b64_tr_b16 a[170:171], v125 offset:4608
    ds_read_b64_tr_b16 a[172:173], v125 offset:36864
    ds_read_b64_tr_b16 a[174:175], v125 offset:37376
    s_mov_b32 m0, 16384
    s_add_u32 s29, s51, 65792
    buffer_load_dwordx4 v108, s[64:67], s29 offen  lds
    s_mov_b32 m0, 17408
    s_add_u32 s29, s51, 69888
    buffer_load_dwordx4 v108, s[64:67], s29 offen  lds
    s_mov_b32 m0, 18432
    s_add_u32 s29, s51, 73984
    buffer_load_dwordx4 v109, s[64:67], s29 offen  lds
    s_mov_b32 m0, 19456
    s_add_u32 s29, s51, 78080
    buffer_load_dwordx4 v109, s[64:67], s29 offen  lds
    s_waitcnt vmcnt(9)
    s_waitcnt lgkmcnt(0)
    s_barrier
    ds_read_b64_tr_b16 a[176:177], v124 offset:8192
    ds_read_b64_tr_b16 a[178:179], v124 offset:8704
    ds_read_b64_tr_b16 a[180:181], v124 offset:40960
    ds_read_b64_tr_b16 a[182:183], v124 offset:41472
    ds_read_b64_tr_b16 a[184:185], v125 offset:8192
    ds_read_b64_tr_b16 a[186:187], v125 offset:8704
    ds_read_b64_tr_b16 a[188:189], v125 offset:40960
    ds_read_b64_tr_b16 a[190:191], v125 offset:41472
    s_mov_b32 m0, 20480
    s_add_u32 s29, s51, 512
    buffer_load_dwordx4 v108, s[64:67], s29 offen  lds
    s_mov_b32 m0, 21504
    s_add_u32 s29, s51, 4608
    buffer_load_dwordx4 v108, s[64:67], s29 offen  lds
    s_mov_b32 m0, 22528
    s_add_u32 s29, s51, 8704
    buffer_load_dwordx4 v109, s[64:67], s29 offen  lds
    s_mov_b32 m0, 23552
    s_add_u32 s29, s51, 12800
    buffer_load_dwordx4 v109, s[64:67], s29 offen  lds
    s_waitcnt vmcnt(9)
    s_waitcnt lgkmcnt(0)
    s_barrier
    ds_read_b64_tr_b16 a[192:193], v124 offset:12288
    ds_read_b64_tr_b16 a[194:195], v124 offset:12800
    ds_read_b64_tr_b16 a[196:197], v124 offset:45056
    ds_read_b64_tr_b16 a[198:199], v124 offset:45568
    ds_read_b64_tr_b16 a[200:201], v125 offset:12288
    ds_read_b64_tr_b16 a[202:203], v125 offset:12800
    ds_read_b64_tr_b16 a[204:205], v125 offset:45056
    ds_read_b64_tr_b16 a[206:207], v125 offset:45568
    s_mov_b32 m0, 24576
    s_add_u32 s29, s51, 66048
    buffer_load_dwordx4 v108, s[64:67], s29 offen  lds
    s_mov_b32 m0, 25600
    s_add_u32 s29, s51, 70144
    buffer_load_dwordx4 v108, s[64:67], s29 offen  lds
    s_mov_b32 m0, 26624
    s_add_u32 s29, s51, 74240
    buffer_load_dwordx4 v109, s[64:67], s29 offen  lds
    s_mov_b32 m0, 27648
    s_add_u32 s29, s51, 78336
    buffer_load_dwordx4 v109, s[64:67], s29 offen  lds
    s_waitcnt vmcnt(8)
    s_waitcnt lgkmcnt(0)
    s_barrier
    ds_read_b64_tr_b16 a[208:209], v124 offset:16384
    ds_read_b64_tr_b16 a[210:211], v124 offset:16896
    ds_read_b64_tr_b16 a[212:213], v124 offset:49152
    ds_read_b64_tr_b16 a[214:215], v124 offset:49664
    ds_read_b64_tr_b16 a[216:217], v125 offset:16384
    ds_read_b64_tr_b16 a[218:219], v125 offset:16896
    ds_read_b64_tr_b16 a[220:221], v125 offset:49152
    ds_read_b64_tr_b16 a[222:223], v125 offset:49664
    s_mov_b32 m0, 28672
    s_add_u32 s29, s50, 1572864
    buffer_load_dwordx4 v104, s[52:55], s29 offen  lds
    s_mov_b32 m0, 29696
    s_add_u32 s29, s50, 1605632
    buffer_load_dwordx4 v105, s[52:55], s29 offen  lds
    s_mov_b32 m0, 30720
    s_add_u32 s29, s50, 1638400
    buffer_load_dwordx4 v104, s[52:55], s29 offen  lds
    s_mov_b32 m0, 31744
    s_add_u32 s29, s50, 1671168
    buffer_load_dwordx4 v105, s[52:55], s29 offen  lds
    v_mov_b32 v118, 0
    s_mov_b64 exec, 1
    global_load_dwordx2 v[114:115], v118, s[6:7] offset:128 sc1
    s_mov_b64 exec, -1
    s_waitcnt vmcnt(9)
    s_waitcnt lgkmcnt(0)
    s_barrier
    ds_read_b64_tr_b16 a[224:225], v124 offset:20480
    ds_read_b64_tr_b16 a[226:227], v124 offset:20992
    ds_read_b64_tr_b16 a[228:229], v124 offset:53248
    ds_read_b64_tr_b16 a[230:231], v124 offset:53760
    ds_read_b64_tr_b16 a[232:233], v125 offset:20480
    ds_read_b64_tr_b16 a[234:235], v125 offset:20992
    ds_read_b64_tr_b16 a[236:237], v125 offset:53248
    ds_read_b64_tr_b16 a[238:239], v125 offset:53760
    s_mov_b32 m0, 0
    s_add_u32 s29, s50, 0
    buffer_load_dwordx4 v104, s[52:55], s29 offen  lds
    s_mov_b32 m0, 1024
    s_add_u32 s29, s50, 32768
    buffer_load_dwordx4 v105, s[52:55], s29 offen  lds
    s_mov_b32 m0, 2048
    s_add_u32 s29, s50, 65536
    buffer_load_dwordx4 v104, s[52:55], s29 offen  lds
    s_mov_b32 m0, 3072
    s_add_u32 s29, s50, 98304
    buffer_load_dwordx4 v105, s[52:55], s29 offen  lds
    s_waitcnt vmcnt(9)
    s_waitcnt lgkmcnt(0)
    s_barrier
    ds_read_b64_tr_b16 a[240:241], v124 offset:24576
    ds_read_b64_tr_b16 a[242:243], v124 offset:25088
    ds_read_b64_tr_b16 a[244:245], v124 offset:57344
    ds_read_b64_tr_b16 a[246:247], v124 offset:57856
    ds_read_b64_tr_b16 a[248:249], v125 offset:24576
    ds_read_b64_tr_b16 a[250:251], v125 offset:25088
    ds_read_b64_tr_b16 a[252:253], v125 offset:57344
    ds_read_b64_tr_b16 a[254:255], v125 offset:57856
    s_mov_b32 m0, 4096
    s_add_u32 s29, s50, 524288
    buffer_load_dwordx4 v104, s[52:55], s29 offen  lds
    s_mov_b32 m0, 5120
    s_add_u32 s29, s50, 557056
    buffer_load_dwordx4 v105, s[52:55], s29 offen  lds
    s_mov_b32 m0, 6144
    s_add_u32 s29, s50, 589824
    buffer_load_dwordx4 v104, s[52:55], s29 offen  lds
    s_mov_b32 m0, 7168
    s_add_u32 s29, s50, 622592
    buffer_load_dwordx4 v105, s[52:55], s29 offen  lds
    s_waitcnt vmcnt(9)
    s_waitcnt lgkmcnt(0)
    s_barrier
    ds_read_b64_tr_b16 v[32:33], v120 offset:28672
    ds_read_b64_tr_b16 v[34:35], v120 offset:29184
    ds_read_b64_tr_b16 v[36:37], v122 offset:28672
    ds_read_b64_tr_b16 v[38:39], v122 offset:29184
    ds_read_b64_tr_b16 v[40:41], v121 offset:28672
    ds_read_b64_tr_b16 v[42:43], v121 offset:29184
    ds_read_b64_tr_b16 v[44:45], v123 offset:28672
    ds_read_b64_tr_b16 v[46:47], v123 offset:29184
    s_mov_b32 m0, 8192
    s_add_u32 s29, s50, 1048576
    buffer_load_dwordx4 v104, s[52:55], s29 offen  lds
    s_mov_b32 m0, 9216
    s_add_u32 s29, s50, 1081344
    buffer_load_dwordx4 v105, s[52:55], s29 offen  lds
    s_mov_b32 m0, 10240
    s_add_u32 s29, s50, 1114112
    buffer_load_dwordx4 v104, s[52:55], s29 offen  lds
    s_mov_b32 m0, 11264
    s_add_u32 s29, s50, 1146880
    buffer_load_dwordx4 v105, s[52:55], s29 offen  lds
    s_waitcnt vmcnt(8)
    s_waitcnt lgkmcnt(0)
    s_barrier
    ds_read_b64_tr_b16 v[16:17], v120 offset:0
    ds_read_b64_tr_b16 v[18:19], v120 offset:512
    ds_read_b64_tr_b16 v[20:21], v122 offset:0
    ds_read_b64_tr_b16 v[22:23], v122 offset:512
    ds_read_b64_tr_b16 v[24:25], v121 offset:0
    ds_read_b64_tr_b16 v[26:27], v121 offset:512
    ds_read_b64_tr_b16 v[28:29], v123 offset:0
    ds_read_b64_tr_b16 v[30:31], v123 offset:512
    ds_write_b128 v1, v[32:35] offset:16384
    ds_write_b128 v1, v[36:39] offset:17408
    ds_write_b128 v1, v[40:43] offset:18432
    ds_write_b128 v1, v[44:47] offset:19456
    s_mov_b32 m0, 12288
    s_add_u32 s29, s50, 0
    buffer_load_dwordx4 v104, s[56:59], s29 offen  lds
    s_mov_b32 m0, 13312
    s_add_u32 s29, s50, 32768
    buffer_load_dwordx4 v105, s[56:59], s29 offen  lds
    s_mov_b32 m0, 14336
    s_add_u32 s29, s50, 65536
    buffer_load_dwordx4 v104, s[56:59], s29 offen  lds
    s_mov_b32 m0, 15360
    s_add_u32 s29, s50, 98304
    buffer_load_dwordx4 v105, s[56:59], s29 offen  lds
    s_waitcnt vmcnt(8)
    s_waitcnt lgkmcnt(0)
    s_barrier
    ds_read_b64_tr_b16 v[32:33], v120 offset:4096
    ds_read_b64_tr_b16 v[34:35], v120 offset:4608
    ds_read_b64_tr_b16 v[36:37], v122 offset:4096
    ds_read_b64_tr_b16 v[38:39], v122 offset:4608
    ds_read_b64_tr_b16 v[40:41], v121 offset:4096
    ds_read_b64_tr_b16 v[42:43], v121 offset:4608
    ds_read_b64_tr_b16 v[44:45], v123 offset:4096
    ds_read_b64_tr_b16 v[46:47], v123 offset:4608
    ds_write_b128 v2, v[16:19] offset:0
    ds_write_b128 v2, v[20:23] offset:1024
    ds_write_b128 v2, v[24:27] offset:2048
    ds_write_b128 v2, v[28:31] offset:3072
    s_mov_b32 m0, 16384
    s_add_u32 s29, s50, 524288
    buffer_load_dwordx4 v104, s[56:59], s29 offen  lds
    s_mov_b32 m0, 17408
    s_add_u32 s29, s50, 557056
    buffer_load_dwordx4 v105, s[56:59], s29 offen  lds
    s_mov_b32 m0, 18432
    s_add_u32 s29, s50, 589824
    buffer_load_dwordx4 v104, s[56:59], s29 offen  lds
    s_mov_b32 m0, 19456
    s_add_u32 s29, s50, 622592
    buffer_load_dwordx4 v105, s[56:59], s29 offen  lds
    s_mov_b32 s27, 0
Tln_0:
    v_and_b32 v114, v114, v115
    s_nop 0
    v_readfirstlane_b32 s39, v114
    s_nop 3
    s_cmp_eq_u32 s39, -1
    s_cbranch_scc1 Tlnd_0
    v_mov_b32 v118, 0
    s_mov_b64 exec, 1
    global_load_dwordx2 v[114:115], v118, s[6:7] offset:128 sc1
    s_mov_b64 exec, -1
    s_waitcnt vmcnt(0)
    s_add_u32 s27, s27, 1
    s_cmp_lt_u32 s27, 400000
    s_cbranch_scc1 Tln_0
Tlnd_0:
    s_waitcnt vmcnt(8)
    s_waitcnt lgkmcnt(0)
    s_barrier
    ds_read_b64_tr_b16 v[16:17], v120 offset:8192
    ds_read_b64_tr_b16 v[18:19], v120 offset:8704
    ds_read_b64_tr_b16 v[20:21], v122 offset:8192
    ds_read_b64_tr_b16 v[22:23], v122 offset:8704
    ds_read_b64_tr_b16 v[24:25], v121 offset:8192
    ds_read_b64_tr_b16 v[26:27], v121 offset:8704
    ds_read_b64_tr_b16 v[28:29], v123 offset:8192
    ds_read_b64_tr_b16 v[30:31], v123 offset:8704
    ds_write_b128 v2, v[32:35] offset:4096
    ds_write_b128 v2, v[36:39] offset:5120
    ds_write_b128 v2, v[40:43] offset:6144
    ds_write_b128 v2, v[44:47] offset:7168
    s_mov_b32 m0, 20480
    s_add_u32 s29, s50, 1048576
    buffer_load_dwordx4 v104, s[56:59], s29 offen  lds
    s_mov_b32 m0, 21504
    s_add_u32 s29, s50, 1081344
    buffer_load_dwordx4 v105, s[56:59], s29 offen  lds
    s_mov_b32 m0, 22528
    s_add_u32 s29, s50, 1114112
    buffer_load_dwordx4 v104, s[56:59], s29 offen  lds
    s_mov_b32 m0, 23552
    s_add_u32 s29, s50, 1146880
    buffer_load_dwordx4 v105, s[56:59], s29 offen  lds
    v_mov_b32 v118, 0
    v_lshlrev_b32 v119, 12, v100
    s_lshl_b32 s38, s16, 7
    s_add_u32 s38, s38, 58720260
    s_mov_b64 exec, 1
    global_load_dwordx2 v[116:117], v118, s[6:7] sc1
    s_mov_b64 exec, 3
    buffer_load_dword v113, v119, s[8:11], s38 offen sc1
    s_mov_b64 exec, -1
    s_waitcnt vmcnt(10)
    s_waitcnt lgkmcnt(0)
    s_barrier
    ds_read_b64_tr_b16 v[32:33], v120 offset:12288
    ds_read_b64_tr_b16 v[34:35], v120 offset:12800
    ds_read_b64_tr_b16 v[36:37], v122 offset:12288
    ds_read_b64_tr_b16 v[38:39], v122 offset:12800
    ds_read_b64_tr_b16 v[40:41], v121 offset:12288
    ds_read_b64_tr_b16 v[42:43], v121 offset:12800
    ds_read_b64_tr_b16 v[44:45], v123 offset:12288
    ds_read_b64_tr_b16 v[46:47], v123 offset:12800
    ds_write_b128 v2, v[16:19] offset:8192
    ds_write_b128 v2, v[20:23] offset:9216
    ds_write_b128 v2, v[24:27] offset:10240
    ds_write_b128 v2, v[28:31] offset:11264
    s_mov_b32 m0, 24576
    s_add_u32 s29, s51, 768
    buffer_load_dwordx4 v108, s[64:67], s29 offen  lds
    s_mov_b32 m0, 25600
    s_add_u32 s29, s51, 4864
    buffer_load_dwordx4 v108, s[64:67], s29 offen  lds
    s_mov_b32 m0, 26624
    s_add_u32 s29, s51, 8960
    buffer_load_dwordx4 v109, s[64:67], s29 offen  lds
    s_mov_b32 m0, 27648
    s_add_u32 s29, s51, 13056
    buffer_load_dwordx4 v109, s[64:67], s29 offen  lds
    s_waitcnt vmcnt(10)
    s_waitcnt lgkmcnt(0)
    s_barrier
    ds_read_b64_tr_b16 v[16:17], v120 offset:16384
    ds_read_b64_tr_b16 v[18:19], v120 offset:16896
    ds_read_b64_tr_b16 v[20:21], v122 offset:16384
    ds_read_b64_tr_b16 v[22:23], v122 offset:16896
    ds_read_b64_tr_b16 v[24:25], v121 offset:16384
    ds_read_b64_tr_b16 v[26:27], v121 offset:16896
    ds_read_b64_tr_b16 v[28:29], v123 offset:16384
    ds_read_b64_tr_b16 v[30:31], v123 offset:16896
    ds_write_b128 v2, v[32:35] offset:12288
    ds_write_b128 v2, v[36:39] offset:13312
    ds_write_b128 v2, v[40:43] offset:14336
    ds_write_b128 v2, v[44:47] offset:15360
    s_mov_b32 m0, 28672
    s_add_u32 s29, s51, 66304
    buffer_load_dwordx4 v108, s[64:67], s29 offen  lds
    s_mov_b32 m0, 29696
    s_add_u32 s29, s51, 70400
    buffer_load_dwordx4 v108, s[64:67], s29 offen  lds
    s_mov_b32 m0, 30720
    s_add_u32 s29, s51, 74496
    buffer_load_dwordx4 v109, s[64:67], s29 offen  lds
    s_mov_b32 m0, 31744
    s_add_u32 s29, s51, 78592
    buffer_load_dwordx4 v109, s[64:67], s29 offen  lds
    s_waitcnt vmcnt(10)
    s_waitcnt lgkmcnt(0)
    s_barrier
    ds_read_b64_tr_b16 v[32:33], v120 offset:20480
    ds_read_b64_tr_b16 v[34:35], v120 offset:20992
    ds_read_b64_tr_b16 v[36:37], v122 offset:20480
    ds_read_b64_tr_b16 v[38:39], v122 offset:20992
    ds_read_b64_tr_b16 v[40:41], v121 offset:20480
    ds_read_b64_tr_b16 v[42:43], v121 offset:20992
    ds_read_b64_tr_b16 v[44:45], v123 offset:20480
    ds_read_b64_tr_b16 v[46:47], v123 offset:20992
    ds_write_b128 v2, v[16:19] offset:16384
    ds_write_b128 v2, v[20:23] offset:17408
    ds_write_b128 v2, v[24:27] offset:18432
    ds_write_b128 v2, v[28:31] offset:19456
    s_mov_b32 s27, 0
    s_waitcnt vmcnt(8)
Tmeet_0:
    v_sad_u8 v112, v116, 0, 0
    v_sad_u8 v112, v117, 0, v112
    v_cmp_eq_u32 vcc, 1, v113
    v_readfirstlane_b32 s40, v112
    v_readfirstlane_b32 s36, v116
    v_readfirstlane_b32 s37, v117
    s_nop 3
    s_xor_b32 s40, s40, 32
    s_andn2_b32 s39, 3, vcc_lo
    s_or_b32 s40, s40, s39
    s_cbranch_scc0 Tmet_0
    v_mov_b32 v118, 0
    v_lshlrev_b32 v119, 12, v100
    s_lshl_b32 s38, s16, 7
    s_add_u32 s38, s38, 58720260
    s_mov_b64 exec, 1
    global_load_dwordx2 v[116:117], v118, s[6:7] sc1
    s_mov_b64 exec, 3
    buffer_load_dword v113, v119, s[8:11], s38 offen sc1
    s_mov_b64 exec, -1
    s_waitcnt vmcnt(0)
    s_add_u32 s27, s27, 1
    s_cmp_lt_u32 s27, 400000
    s_cbranch_scc1 Tmeet_0
Tmet_0:
    s_getreg_b32 s38, hwreg(HW_REG_XCC_ID, 0, 3)
    s_lshl_b32 s38, s38, 3
    s_lshl_b64 s[38:39], 32, s38
    s_cmp_eq_u64 s[36:37], s[38:39]
    s_cselect_b32 s41, 1, 0
    s_add_u32 s33, s18, 8192
    buffer_load_dwordx4 v[128:131], v9, s[8:11], s18 offen sc1
    buffer_load_dwordx4 v[132:135], v9, s[8:11], s33 offen sc1
    buffer_load_dwordx4 v[136:139], v3, s[8:11], s18 offen offset:2048 sc1
    buffer_load_dwordx4 v[140:143], v3, s[8:11], s18 offen offset:2176 sc1
    v_and_b32 v112, 15, v100
    v_lshlrev_b32 v112, 7, v112
    v_lshrrev_b32 v113, 4, v100
    v_lshl_add_u32 v114, v113, 13, v112
    s_mov_b32 s38, 53084160
    buffer_load_dword v114, v114, s[8:11], s38 offen sc1
    v_and_b32 v113, 1, v113
    v_lshl_add_u32 v115, v113, 18, v112
    s_add_u32 s38, s22, 131072
    buffer_load_dword v115, v115, s[8:11], s38 offen sc1
    s_waitcnt vmcnt(10)
    s_waitcnt lgkmcnt(0)
    s_barrier
    ds_read_b64_tr_b16 v[16:17], v124 offset:24576
    ds_read_b64_tr_b16 v[18:19], v124 offset:25088
    ds_read_b64_tr_b16 v[20:21], v124 offset:57344
    ds_read_b64_tr_b16 v[22:23], v124 offset:57856
    ds_read_b64_tr_b16 v[24:25], v125 offset:24576
    ds_read_b64_tr_b16 v[26:27], v125 offset:25088
    ds_read_b64_tr_b16 v[28:29], v125 offset:57344
    ds_read_b64_tr_b16 v[30:31], v125 offset:57856
    ds_write_b128 v2, v[32:35] offset:20480
    ds_write_b128 v2, v[36:39] offset:21504
    ds_write_b128 v2, v[40:43] offset:22528
    ds_write_b128 v2, v[44:47] offset:23552
    s_waitcnt vmcnt(6)
    s_waitcnt lgkmcnt(0)
    s_barrier
    ds_read_b64_tr_b16 v[32:33], v124 offset:28672
    ds_read_b64_tr_b16 v[34:35], v124 offset:29184
    ds_read_b64_tr_b16 v[36:37], v124 offset:61440
    ds_read_b64_tr_b16 v[38:39], v124 offset:61952
    ds_read_b64_tr_b16 v[40:41], v125 offset:28672
    ds_read_b64_tr_b16 v[42:43], v125 offset:29184
    ds_read_b64_tr_b16 v[44:45], v125 offset:61440
    ds_read_b64_tr_b16 v[46:47], v125 offset:61952
    ds_write_b128 v2, v[16:19] offset:24576
    ds_write_b128 v2, v[20:23] offset:25600
    ds_write_b128 v2, v[24:27] offset:26624
    ds_write_b128 v2, v[28:31] offset:27648
    s_waitcnt lgkmcnt(0)
    s_barrier
    ds_write_b128 v2, v[32:35] offset:28672
    ds_write_b128 v2, v[36:39] offset:29696
    ds_write_b128 v2, v[40:43] offset:30720
    ds_write_b128 v2, v[44:47] offset:31744
    s_waitcnt lgkmcnt(0)
    s_waitcnt vmcnt(0)
    s_cmp_eq_u32 s41, 0
    s_cbranch_scc1 Tslow_0
Tfast_0:
    s_mov_b32 s27, 0
    s_mov_b32 s46, 0
    v_mov_b32 v13, -1
    v_mov_b64 v[122:123], s[42:43]
    v_mov_b64 v[124:125], s[42:43]
    v_mov_b64 v[120:121], s[44:45]
    s_mov_b32 s26, 52953088
    s_add_u32 s21, s20, 4096
    s_lshl_b32 s54, s16, 7
    s_add_u32 s54, s54, 58720260
    s_add_u32 s51, s54, 4096
    s_add_u32 s18, s18, 524288
    s_add_u32 s33, s18, 8192
    s_add_u32 s51, s51, 4096
    v_mov_b64 v[72:73], v[128:129]
    ds_read_b128 v[32:35], v2 offset:0
    v_mov_b64 v[74:75], v[130:131]
    ds_read_b128 v[36:39], v2 offset:1024
    v_mov_b64 v[76:77], v[132:133]
    ds_read_b128 v[88:91], v2 offset:6144
    v_mov_b64 v[78:79], v[134:135]
    ds_read_b128 v[92:95], v2 offset:7168
    v_mov_b64 v[80:81], v[136:137]
    ds_read_b128 v[96:99], v2 offset:8192
    v_mov_b64 v[82:83], v[138:139]
    ds_read_b128 v[100:103], v2 offset:9216
    v_mov_b64 v[84:85], v[140:141]
    ds_read_b128 v[104:107], v2 offset:10240
    v_mov_b64 v[86:87], v[142:143]
    ds_read_b128 v[108:111], v2 offset:11264
    v_mov_b64 v[48:49], 0
    ds_read_b128 v[112:115], v1 offset:16384
    v_mov_b64 v[50:51], 0
    ds_read_b128 v[116:119], v1 offset:17408
    v_mov_b64 v[52:53], 0
    ds_read_b128 v[64:67], v1 offset:18432
    v_mov_b64 v[54:55], 0
    ds_read_b128 v[68:71], v1 offset:19456
    v_mov_b64 v[56:57], 0
    ds_read_b128 v[128:131], v2 offset:2048
    v_mov_b64 v[58:59], 0
    ds_read_b128 v[132:135], v2 offset:3072
    v_mov_b64 v[60:61], 0
    ds_read_b128 v[136:139], v2 offset:4096
    v_mov_b64 v[62:63], 0
    ds_read_b128 v[140:143], v2 offset:5120
    s_branch Tstep_0
.p2align 6
Tstep_0:
    buffer_load_dwordx4 v[40:43], v1, s[8:11], s26 offen offset:0 sc1
    buffer_load_dwordx4 v[44:47], v1, s[8:11], s26 offen offset:1024 sc1
    s_waitcnt vmcnt(1)
    v_max3_u32 v11, v40, v41, v42
    v_max_u32 v11, v11, v43
    ds_write_b128 v1, v[40:43] offset:0
    s_waitcnt vmcnt(0)
    v_max3_u32 v11, v11, v44, v45
    v_max3_u32 v11, v11, v46, v47
    v_cmp_eq_u32 vcc, -1, v11
    ds_write_b128 v1, v[44:47] offset:1024
    s_cbranch_vccnz Tr2_0
Tok2_0:
    s_waitcnt lgkmcnt(0)
    s_barrier
    ds_read_b128 v[16:19], v1 offset:0
    ds_read_b128 v[20:23], v1 offset:1024
    buffer_store_dword v14, v8, s[8:11], s19 offen sc1
    s_barrier
    ds_read_b128 v[24:27], v1 offset:2048
    ds_read_b128 v[28:31], v1 offset:3072
    s_waitcnt lgkmcnt(3)
    v_smfmac_f32_16x16x64_bf16 v[48:51], v[16:19], v[32:39], v0
    ds_read_b128 v[32:35], v1 offset:4096
    v_smfmac_f32_16x16x64_bf16 v[52:55], v[16:19], v[128:135], v0
    ds_read_b128 v[36:39], v1 offset:5120
    s_waitcnt lgkmcnt(4)
    v_smfmac_f32_16x16x64_bf16 v[48:51], v[20:23], v[136:143], v0
    buffer_load_dwordx4 v[128:131], v9, s[8:11], s18 offen sc1
    v_smfmac_f32_16x16x64_bf16 v[52:55], v[20:23], v[88:95], v0
    ds_read_b128 v[40:43], v1 offset:6144
    s_waitcnt lgkmcnt(4)
    v_smfmac_f32_16x16x64_bf16 v[48:51], v[24:27], v[96:103], v0
    ds_read_b128 v[44:47], v1 offset:7168
    s_waitcnt lgkmcnt(3)
    v_smfmac_f32_16x16x64_bf16 v[48:51], v[28:31], v[112:119], v0
    buffer_load_dwordx4 v[132:135], v9, s[8:11], s33 offen sc1
    v_smfmac_f32_16x16x64_bf16 v[48:51], v[32:35], a[96:103], v0
    ds_read_b128 v[88:91], v2 offset:12288
    s_waitcnt lgkmcnt(3)
    v_smfmac_f32_16x16x64_bf16 v[48:51], v[36:39], a[112:119], v0
    buffer_load_dwordx4 v[136:139], v3, s[8:11], s18 offen offset:2048 sc1
    s_waitcnt lgkmcnt(2)
    v_smfmac_f32_16x16x64_bf16 v[48:51], v[40:43], a[128:135], v0
    ds_read_b128 v[92:95], v2 offset:13312
    s_waitcnt lgkmcnt(2)
    v_smfmac_f32_16x16x64_bf16 v[48:51], v[44:47], a[144:151], v0
    buffer_load_dwordx4 v[140:143], v3, s[8:11], s18 offen offset:2176 sc1
    v_smfmac_f32_16x16x64_bf16 v[52:55], v[24:27], v[104:111], v0
    s_nop 1
    s_waitcnt lgkmcnt(1)
    v_smfmac_f32_16x16x64_bf16 v[52:55], v[28:31], v[64:71], v0
    s_nop 1
    v_add_f32 v48, v48, v50
    v_smfmac_f32_16x16x64_bf16 v[52:55], v[32:35], a[104:111], v0
    ds_read_b128 v[96:99], v2 offset:16384
    v_add_f32 v49, v49, v51
    v_smfmac_f32_16x16x64_bf16 v[52:55], v[36:39], a[120:127], v0
    ds_read_b128 v[100:103], v2 offset:17408
    v_mul_f32 v48, s32, v48
    v_smfmac_f32_16x16x64_bf16 v[52:55], v[40:43], a[136:143], v0
    ds_read_b128 v[104:107], v2 offset:20480
    v_mul_f32 v49, s32, v49
    v_smfmac_f32_16x16x64_bf16 v[52:55], v[44:47], a[152:159], v0
    s_nop 0
    s_waitcnt lgkmcnt(3)
    v_cvt_pk_bf16_f32 v48, v48, v49
    v_smfmac_f32_16x16x64_bf16 v[56:59], v[28:31], v[144:151], v0
    ds_write_b32 v4, v48 offset:0
    v_smfmac_f32_16x16x64_bf16 v[56:59], v[32:35], v[160:167], v0
    buffer_load_dword v10, off, s[8:11], s51 sc1
    s_nop 0
    v_add_f32 v52, v52, v54
    v_smfmac_f32_16x16x64_bf16 v[56:59], v[16:19], v[88:95], v0
    ds_read_b128 v[108:111], v2 offset:21504
    s_waitcnt lgkmcnt(2)
    v_add_f32 v53, v53, v55
    v_mul_f32 v52, s32, v52
    v_smfmac_f32_16x16x64_bf16 v[56:59], v[20:23], v[96:103], v0
    ds_read_b128 v[112:115], v2 offset:14336
    v_mul_f32 v53, s32, v53
    v_smfmac_f32_16x16x64_bf16 v[56:59], v[36:39], v[176:183], v0
    ds_read_b128 v[116:119], v2 offset:15360
    v_cvt_pk_bf16_f32 v52, v52, v53
    v_smfmac_f32_16x16x64_bf16 v[56:59], v[40:43], v[192:199], v0
    ds_write_b32 v4, v52 offset:256
    v_smfmac_f32_16x16x64_bf16 v[56:59], v[44:47], v[208:215], v0
    ds_read_b128 v[88:91], v2 offset:18432
    s_waitcnt lgkmcnt(4)
    v_smfmac_f32_16x16x64_bf16 v[56:59], v[24:27], v[104:111], v0
    ds_read_b128 v[92:95], v2 offset:19456
    s_waitcnt lgkmcnt(4)
    v_smfmac_f32_16x16x64_bf16 v[60:63], v[28:31], v[152:159], v0
    ds_read_b128 v[96:99], v2 offset:22528
    ds_read_b128 v[100:103], v2 offset:23552
    v_smfmac_f32_16x16x64_bf16 v[60:63], v[32:35], v[168:175], v0
    s_waitcnt lgkmcnt(4)
    s_barrier
    v_smfmac_f32_16x16x64_bf16 v[60:63], v[36:39], v[184:191], v0
    ds_read_b64_tr_b16 v[104:105], v5 offset:0
    v_add_f32 v56, v56, v58
    v_smfmac_f32_16x16x64_bf16 v[60:63], v[40:43], v[200:207], v0
    ds_read_b64_tr_b16 v[106:107], v5 offset:256
    v_add_f32 v57, v57, v59
    v_smfmac_f32_16x16x64_bf16 v[60:63], v[44:47], v[216:223], v0
    ds_read_b64_tr_b16 v[108:109], v5 offset:2048
    v_cvt_pk_bf16_f32 v56, v56, v57
    v_smfmac_f32_16x16x64_bf16 v[60:63], v[16:19], v[112:119], v0
    ds_read_b64_tr_b16 v[110:111], v5 offset:2304
    s_waitcnt lgkmcnt(4)
    v_mov_b64 v[64:65], 0
    v_smfmac_f32_16x16x64_bf16 v[60:63], v[20:23], v[88:95], v0
    ds_write_b32 v4, v56 offset:512
    v_smfmac_f32_16x16x64_bf16 v[60:63], v[24:27], v[96:103], v0
    s_waitcnt lgkmcnt(3)
    v_mov_b64 v[66:67], 0
    v_mfma_f32_16x16x32_bf16 v[48:51], v[72:75], v[104:107], 0
    s_waitcnt lgkmcnt(1)
    v_mov_b64 v[68:69], 0
    v_mov_b64 v[70:71], 0
    v_mfma_f32_16x16x32_bf16 v[48:51], v[76:79], v[108:111], v[48:51]
    s_nop 0
    v_add_f32 v60, v60, v62
    v_add_f32 v61, v61, v63
    v_cvt_pk_bf16_f32 v60, v60, v61
    v_smfmac_f32_16x16x64_bf16 v[64:67], v[28:31], a[16:23], v0
    ds_write_b32 v4, v60 offset:768
    v_smfmac_f32_16x16x64_bf16 v[64:67], v[24:27], a[0:7], v0
    s_waitcnt lgkmcnt(1)
    v_add_f32_dpp v48, v50, v48 quad_perm:[2,3,0,1] row_mask:0xf bank_mask:0xf
    v_smfmac_f32_16x16x64_bf16 v[64:67], v[20:23], v[240:247], v0
    v_add_f32_dpp v49, v51, v49 quad_perm:[2,3,0,1] row_mask:0xf bank_mask:0xf
    v_smfmac_f32_16x16x64_bf16 v[64:67], v[16:19], v[224:231], v0
    v_exp_f32 v50, v48
    v_smfmac_f32_16x16x64_bf16 v[64:67], v[32:35], a[32:39], v0
    s_waitcnt lgkmcnt(0)
    s_barrier
    v_smfmac_f32_16x16x64_bf16 v[64:67], v[36:39], a[48:55], v0
    ds_read_b64_tr_b16 v[112:113], v5 offset:512
    v_exp_f32 v51, v49
    v_smfmac_f32_16x16x64_bf16 v[64:67], v[40:43], a[64:71], v0
    ds_read_b64_tr_b16 v[114:115], v5 offset:768
    v_cvt_pk_bf16_f32 v50, v50, v51
    v_smfmac_f32_16x16x64_bf16 v[64:67], v[44:47], a[80:87], v0
    ds_read_b64_tr_b16 v[116:117], v5 offset:2560
    v_smfmac_f32_16x16x64_bf16 v[68:71], v[28:31], a[24:31], v0
    ds_read_b64_tr_b16 v[118:119], v5 offset:2816
    v_smfmac_f32_16x16x64_bf16 v[68:71], v[24:27], a[8:15], v0
    ds_write_b32 v12, v50
    s_waitcnt lgkmcnt(3)
    v_mfma_f32_16x16x32_bf16 v[52:55], v[112:115], v[104:107], 0
    s_nop 0
    v_cvt_pk_bf16_f32 v60, v64, v65
    v_cvt_pk_bf16_f32 v61, v66, v67
    v_smfmac_f32_16x16x64_bf16 v[68:71], v[20:23], v[248:255], v0
    s_waitcnt lgkmcnt(1)
    v_mov_b64 v[30:31], 0
    v_mfma_f32_16x16x32_bf16 v[52:55], v[116:119], v[108:111], v[52:55]
    s_nop 0
    v_mov_b64 v[26:27], 0
    v_mov_b64 v[24:25], 0
    v_smfmac_f32_16x16x64_bf16 v[68:71], v[16:19], v[232:239], v0
    s_waitcnt lgkmcnt(0)
    s_barrier
    v_smfmac_f32_16x16x64_bf16 v[68:71], v[32:35], a[40:47], v0
    ds_read_b128 v[56:59], v6 offset:12288
    v_add_f32_dpp v52, v54, v52 quad_perm:[2,3,0,1] row_mask:0xf bank_mask:0xf
    v_smfmac_f32_16x16x64_bf16 v[68:71], v[36:39], a[56:63], v0
    ds_read_b128 v[104:107], v2 offset:24576
    v_add_f32_dpp v53, v55, v53 quad_perm:[2,3,0,1] row_mask:0xf bank_mask:0xf
    v_smfmac_f32_16x16x64_bf16 v[68:71], v[40:43], a[72:79], v0
    ds_read_b128 v[108:111], v2 offset:25600
    v_exp_f32_dpp v54, v52 quad_perm:[0,1,0,1] row_mask:0xf bank_mask:0xf
    v_smfmac_f32_16x16x64_bf16 v[68:71], v[44:47], a[88:95], v0
    s_nop 0
    s_waitcnt lgkmcnt(2)
    v_exp_f32_dpp v55, v53 quad_perm:[0,1,0,1] row_mask:0xf bank_mask:0xf
Tsm_0:
    v_mfma_f32_16x16x32_bf16 v[88:91], v[122:125], v[56:59], 0
    v_cvt_pk_bf16_f32 v28, v54, v55
    v_cvt_pk_bf16_f32 v29, v54, v55
    v_mfma_f32_16x16x32_bf16 v[96:99], v[80:83], v[56:59], 0
    s_nop 0
    v_cvt_pk_bf16_f32 v62, v68, v69
    v_cvt_pk_bf16_f32 v63, v70, v71
    v_mfma_f32_16x16x32_bf16 v[88:91], v[120:123], v[28:31], v[88:91]
    s_nop 0
    v_mov_b64 v[16:17], 0
    v_mov_b64 v[18:19], 0
    v_mfma_f32_16x16x32_bf16 v[96:99], v[60:63], v[28:31], v[96:99]
    s_nop 0
    v_mov_b64 v[20:21], 0
    v_mov_b64 v[22:23], 0
    v_mfma_f32_16x16x32_bf16 v[100:103], v[84:87], v[56:59], 0
    s_nop 0
    v_rcp_f32 v14, v88
    v_mfma_f32_16x16x32_bf16 v[100:103], v[60:63], v[26:29], v[100:103]
    s_nop 0
    v_mul_f32 v96, v96, v14
    v_mul_f32 v97, v97, v14
    v_mul_f32 v98, v98, v14
    v_mul_f32 v99, v99, v14
    v_subrev_u32 v11, s34, v88
    v_cmp_le_u32 vcc, s35, v11
    s_not_b64 exec, s[48:49]
    v_pk_mul_f32 v[96:97], v[100:101], v[14:15] op_sel_hi:[1,0]
    v_pk_mul_f32 v[98:99], v[102:103], v[14:15] op_sel_hi:[1,0]
    s_mov_b64 exec, -1
    v_cvt_pk_bf16_f32 v96, v96, v97
    v_cvt_pk_bf16_f32 v97, v98, v99
    ds_write_b64 v126, v[96:97]
    v_mov_b32_dpp v32, v96 quad_perm:[0,1,0,1] row_mask:0xf bank_mask:0xf
    v_mov_b32_dpp v33, v97 quad_perm:[0,1,0,1] row_mask:0xf bank_mask:0xf
    v_mov_b32_dpp v34, v96 quad_perm:[2,3,2,3] row_mask:0xf bank_mask:0xf
    v_mov_b32_dpp v35, v97 quad_perm:[2,3,2,3] row_mask:0xf bank_mask:0xf
    v_mov_b64 v[28:29], 0
    s_cbranch_vccnz Tmx_0
Tmxd_0:
    v_smfmac_f32_16x16x64_bf16 v[16:19], v[32:35], a[160:167], v0
    s_waitcnt lgkmcnt(0)
    s_barrier
    ds_read_b128 v[36:39], v127 offset:512
    v_smfmac_f32_16x16x64_bf16 v[20:23], v[32:35], a[192:199], v0
    ds_read_b128 v[40:43], v127 offset:1024
    v_smfmac_f32_16x16x64_bf16 v[24:27], v[32:35], a[224:231], v0
    ds_read_b128 v[44:47], v127 offset:1536
    v_smfmac_f32_16x16x64_bf16 v[28:31], v[32:35], v[104:111], v0
    ds_read_b128 v[112:115], v2 offset:26624
    s_waitcnt lgkmcnt(3)
    v_smfmac_f32_16x16x64_bf16 v[16:19], v[36:39], a[168:175], v0
    ds_read_b128 v[116:119], v2 offset:27648
    s_waitcnt lgkmcnt(3)
    v_smfmac_f32_16x16x64_bf16 v[16:19], v[40:43], a[176:183], v0
    ds_read_b128 v[48:51], v2 offset:28672
    s_waitcnt lgkmcnt(3)
    v_smfmac_f32_16x16x64_bf16 v[16:19], v[44:47], a[184:191], v0
    s_nop 0
    ds_read_b128 v[56:59], v2 offset:30720
    v_smfmac_f32_16x16x64_bf16 v[20:23], v[36:39], a[200:207], v0
    s_nop 0
    ds_read_b128 v[52:55], v2 offset:29696
    v_smfmac_f32_16x16x64_bf16 v[20:23], v[40:43], a[208:215], v0
    s_nop 1
    v_cvt_pk_bf16_f32 v16, v16, v17
    v_cvt_pk_bf16_f32 v17, v18, v19
    v_and_or_b32 v16, v16, -2, s46
    v_smfmac_f32_16x16x64_bf16 v[20:23], v[44:47], a[216:223], v0
    buffer_store_dwordx2 v[16:17], v7, s[8:11], s20 offen offset:0
    v_smfmac_f32_16x16x64_bf16 v[24:27], v[36:39], a[232:239], v0
    s_nop 0
    ds_read_b128 v[60:63], v2 offset:31744
    v_smfmac_f32_16x16x64_bf16 v[24:27], v[40:43], a[240:247], v0
    s_nop 1
    s_nop 0
    v_cvt_pk_bf16_f32 v20, v20, v21
    v_cvt_pk_bf16_f32 v21, v22, v23
    v_and_or_b32 v20, v20, -2, s46
    v_smfmac_f32_16x16x64_bf16 v[24:27], v[44:47], a[248:255], v0
    buffer_store_dwordx2 v[20:21], v7, s[8:11], s20 offen offset:2048
    s_waitcnt lgkmcnt(4)
    v_smfmac_f32_16x16x64_bf16 v[28:31], v[36:39], v[112:119], v0
    s_nop 0
    s_waitcnt lgkmcnt(1)
    v_smfmac_f32_16x16x64_bf16 v[28:31], v[40:43], v[48:55], v0
    s_nop 1
    v_cvt_pk_bf16_f32 v24, v24, v25
    v_cvt_pk_bf16_f32 v25, v26, v27
    s_waitcnt lgkmcnt(0)
    v_and_or_b32 v24, v24, -2, s46
    v_smfmac_f32_16x16x64_bf16 v[28:31], v[44:47], v[56:63], v0
    buffer_store_dwordx2 v[24:25], v7, s[8:11], s21 offen offset:0
    s_nop 6
    v_cvt_pk_bf16_f32 v28, v28, v29
    v_cvt_pk_bf16_f32 v29, v30, v31
    v_and_or_b32 v28, v28, -2, s46
    buffer_store_dwordx2 v[28:29], v7, s[8:11], s21 offen offset:2048
    s_barrier
    ds_read_b128 v[16:19], v1 offset:13312
    s_waitcnt vmcnt(8)
    v_mov_b64 v[72:73], v[128:129]
    ds_read_b128 v[32:35], v2 offset:0
    s_add_u32 s17, s17, 1
    v_mov_b64 v[74:75], v[130:131]
    ds_read_b128 v[36:39], v2 offset:1024
    s_and_b32 s29, s17, 3
    s_waitcnt vmcnt(7)
    v_mov_b64 v[76:77], v[132:133]
    ds_read_b128 v[88:91], v2 offset:6144
    s_lshl_b32 s29, s29, 13
    v_mov_b64 v[78:79], v[134:135]
    ds_read_b128 v[92:95], v2 offset:7168
    s_add_u32 s30, s24, s29
    s_waitcnt vmcnt(6)
    v_mov_b64 v[80:81], v[136:137]
    ds_read_b128 v[96:99], v2 offset:8192
    s_add_u32 s26, s29, 52953088
    s_nop 3
    buffer_load_dwordx4 v[40:43], v1, s[8:11], s22 offen offset:0 sc1
    buffer_load_dwordx4 v[44:47], v1, s[8:11], s22 offen offset:1024 sc1
    v_mov_b64 v[82:83], v[138:139]
    ds_read_b128 v[100:103], v2 offset:9216
    s_xor_b32 s25, s30, 16384
    s_waitcnt vmcnt(7)
    v_mov_b64 v[84:85], v[140:141]
    ds_read_b128 v[104:107], v2 offset:10240
    s_xor_b32 s20, s20, 262144
    v_mov_b64 v[86:87], v[142:143]
    ds_read_b128 v[108:111], v2 offset:11264
    s_add_u32 s21, s20, 4096
    v_mov_b64 v[48:49], 0
    ds_read_b128 v[112:115], v1 offset:16384
    s_add_u32 s19, s19, 8192
    v_mov_b64 v[50:51], 0
    ds_read_b128 v[116:119], v1 offset:17408
    s_cmp_ge_u32 s17, 62
    s_cselect_b32 s35, 0, s35
    s_cselect_b32 s18, 0x40000000, s18
    v_mov_b64 v[52:53], 0
    ds_read_b128 v[64:67], v1 offset:18432
    s_add_u32 s18, s18, 524288
    v_mov_b64 v[54:55], 0
    ds_read_b128 v[68:71], v1 offset:19456
    s_add_u32 s33, s18, 8192
    v_mov_b64 v[56:57], 0
    ds_read_b128 v[128:131], v2 offset:2048
    s_add_u32 s51, s51, 4096
    s_waitcnt lgkmcnt(13)
    s_waitcnt vmcnt(1)
    v_mfma_f32_16x16x32_bf16 v[20:23], v[16:19], v[40:43], 0
    v_bitop3_b32 v11, v40, v42, s46 bitop3:0x7e
    s_waitcnt vmcnt(0)
    v_mfma_f32_16x16x32_bf16 v[20:23], v[16:19], v[44:47], v[20:23]
    v_bitop3_b32 v15, v44, v46, s46 bitop3:0x7e
    v_bitop3_b32 v11, v11, v15, 1 bitop3:0xa8
    v_cmp_ne_u32 vcc, 0, v11
    s_nop 4
    v_add_f32_dpp v20, v20, v20 row_ror:4 row_mask:0xf bank_mask:0xf
    v_add_f32_dpp v21, v21, v21 row_ror:4 row_mask:0xf bank_mask:0xf
    s_cbranch_vccnz Tr1_0
Tok1_0:
    v_add_f32_dpp v20, v20, v20 row_ror:8 row_mask:0xf bank_mask:0xf
    v_add_f32_dpp v21, v21, v21 row_ror:8 row_mask:0xf bank_mask:0xf
    v_cvt_pk_bf16_f32 v14, v20, v21
    buffer_store_dword v14, v8, s[8:11], s30 offen
    buffer_store_dword v13, v8, s[8:11], s25 offen
    v_readfirstlane_b32 s52, v10
    s_xor_b32 s22, s22, 262144
    s_bfe_u32 s46, s17, 0x10001
    v_mov_b64 v[58:59], 0
    ds_read_b128 v[132:135], v2 offset:3072
    v_mov_b64 v[60:61], 0
    ds_read_b128 v[136:139], v2 offset:4096
    v_mov_b64 v[62:63], 0
    ds_read_b128 v[140:143], v2 offset:5120
    s_cmp_lg_u32 s52, 1
    s_cbranch_scc1 Tkv2_0
Tkv2d_0:
    s_nop 15
    s_nop 10
    s_branch Tstep_0
Tkv2_0:
    s_add_u32 s29, s17, 1
    s_cmp_ge_u32 s29, 63
    s_cbranch_scc1 Tkv2d_0
    s_lshl_b32 s36, s29, 12
    s_add_u32 s36, s36, s54
    buffer_load_dword v11, off, s[8:11], s36 sc1
    s_waitcnt vmcnt(0)
    v_cmp_ne_u32 vcc, 1, v11
    s_cbranch_vccz Tkv2d_0
    s_add_u32 s27, s27, 1
    s_cmp_lt_u32 s27, 400000
    s_cbranch_scc1 Tkv2_0
    s_branch Tkv2d_0
Tr2_0:
    buffer_load_dwordx4 v[40:43], v1, s[8:11], s26 offen offset:0 sc1
    buffer_load_dwordx4 v[44:47], v1, s[8:11], s26 offen offset:1024 sc1
    s_waitcnt vmcnt(1)
    v_max3_u32 v11, v40, v41, v42
    v_max_u32 v11, v11, v43
    ds_write_b128 v1, v[40:43] offset:0
    s_waitcnt vmcnt(0)
    v_max3_u32 v11, v11, v44, v45
    v_max3_u32 v11, v11, v46, v47
    v_cmp_eq_u32 vcc, -1, v11
    ds_write_b128 v1, v[44:47] offset:1024
    s_cbranch_vccz Tok2_0
    buffer_load_dwordx4 v[40:43], v1, s[8:11], s26 offen offset:0 sc1
    buffer_load_dwordx4 v[44:47], v1, s[8:11], s26 offen offset:1024 sc1
    s_waitcnt vmcnt(1)
    v_max3_u32 v11, v40, v41, v42
    v_max_u32 v11, v11, v43
    ds_write_b128 v1, v[40:43] offset:0
    s_waitcnt vmcnt(0)
    v_max3_u32 v11, v11, v44, v45
    v_max3_u32 v11, v11, v46, v47
    v_cmp_eq_u32 vcc, -1, v11
    ds_write_b128 v1, v[44:47] offset:1024
    s_cbranch_vccz Tok2_0
    s_add_u32 s27, s27, 1
    s_cmp_lt_u32 s27, 400000
    s_cbranch_scc1 Tr2_0
    s_mov_b32 s28, 1
    s_branch Tok2_0
Tr1_0:
    buffer_load_dwordx4 v[40:43], v1, s[8:11], s22 offen offset:0 sc1
    buffer_load_dwordx4 v[44:47], v1, s[8:11], s22 offen offset:1024 sc1
    s_waitcnt vmcnt(1)
    v_mfma_f32_16x16x32_bf16 v[20:23], v[16:19], v[40:43], 0
    v_bitop3_b32 v11, v40, v42, s46 bitop3:0x7e
    s_waitcnt vmcnt(0)
    v_mfma_f32_16x16x32_bf16 v[20:23], v[16:19], v[44:47], v[20:23]
    v_bitop3_b32 v15, v44, v46, s46 bitop3:0x7e
    v_bitop3_b32 v11, v11, v15, 1 bitop3:0xa8
    v_cmp_ne_u32 vcc, 0, v11
    s_nop 4
    v_add_f32_dpp v20, v20, v20 row_ror:4 row_mask:0xf bank_mask:0xf
    v_add_f32_dpp v21, v21, v21 row_ror:4 row_mask:0xf bank_mask:0xf
    s_cbranch_vccz Tok1_0
    s_add_u32 s27, s27, 1
    s_cmp_lt_u32 s27, 400000
    s_cbranch_scc1 Tr1_0
    s_mov_b32 s28, 1
    s_waitcnt vmcnt(0)
    s_branch Tok1_0
Tmx_0:
    s_nop 7
    s_waitcnt lgkmcnt(0)
    s_cmp_lg_u32 s35, 0
    s_cbranch_scc1 Tmx2_0
    ds_read_b64_tr_b16 v[40:41], v5 offset:512
    v_pk_add_f32 v[44:45], v[64:65], v[66:67]
    v_pk_add_f32 v[46:47], v[68:69], v[70:71]
    v_cvt_pk_bf16_f32 v42, v44, v45
    v_cvt_pk_bf16_f32 v43, v46, v47
    s_and_b32 s29, s17, 1
    s_lshl_b32 s29, s29, 5
    s_add_u32 s29, s29, s16
    s_lshl_b32 s29, s29, 12
    s_add_u32 s29, s29, 61734912
    s_waitcnt lgkmcnt(0)
    buffer_store_dwordx4 v[40:43], v1, s[8:11], s29 offen sc1
    s_cmp_eq_u32 s17, 63
    s_cbranch_scc1 Tend_0
    s_mov_b32 s35, 0x3c000000
    v_cmp_le_u32 vcc, s35, v11
    s_nop 4
    s_and_b64 vcc, vcc, s[48:49]
    s_cbranch_scc0 Tmxd_0
Tmx2_0:
    v_max3_f32 v14, v48, v49, v52
    v_max_f32 v14, v14, v53
    v_mov_b32 v15, v14
    s_nop 1
    v_permlane16_swap_b32 v14, v15
    v_max_f32 v14, v14, v15
    v_mov_b32 v15, v14
    s_nop 1
    v_permlane32_swap_b32 v14, v15
    v_max_f32 v14, v14, v15
    ds_write_b32 v1, v14 offset:14336
    s_waitcnt lgkmcnt(0)
    s_barrier
    ds_read_b128 v[88:91], v1 offset:14336
    s_waitcnt lgkmcnt(0)
    v_max3_f32 v14, v88, v89, v90
    v_max_f32 v14, v14, v91
    v_cmp_neq_f32 vcc, 0, v14
    v_mov_b32 v11, 0x1f8
    v_cmp_class_f32 s[36:37], v14, v11
    s_nop 4
    s_and_b64 vcc, vcc, s[36:37]
    s_and_b64 vcc, vcc, s[48:49]
    s_cbranch_scc0 Tmxd_0
    v_cndmask_b32 v14, 0, v14, vcc
    v_sub_f32 v48, v48, v14
    v_sub_f32 v49, v49, v14
    v_sub_f32 v52, v52, v14
    v_sub_f32 v53, v53, v14
    v_exp_f32 v50, v48
    v_exp_f32 v51, v49
    s_nop 0
    v_cvt_pk_bf16_f32 v50, v50, v51
    ds_write_b32 v12, v50
    v_exp_f32_dpp v54, v52 quad_perm:[0,1,0,1] row_mask:0xf bank_mask:0xf
    v_exp_f32_dpp v55, v53 quad_perm:[0,1,0,1] row_mask:0xf bank_mask:0xf
    s_waitcnt lgkmcnt(0)
    s_barrier
    ds_read_b128 v[56:59], v6 offset:12288
    s_waitcnt lgkmcnt(0)
    s_branch Tsm_0
Tend_0:
    s_cmp_lg_u32 s16, 0
    s_cbranch_scc1 Tnwb_0
    s_waitcnt vmcnt(0)
    buffer_wbl2 sc1
    s_waitcnt vmcnt(0)
Tnwb_0:
    s_endpgm
Tslow_0:
    s_mov_b32 s27, 0
    s_mov_b32 s46, 0
    v_mov_b32 v13, -1
    v_mov_b64 v[122:123], s[42:43]
    v_mov_b64 v[124:125], s[42:43]
    v_mov_b64 v[120:121], s[44:45]
    s_mov_b32 s26, 52953088
    s_add_u32 s21, s20, 4096
    s_lshl_b32 s54, s16, 7
    s_add_u32 s54, s54, 58720260
    s_add_u32 s51, s54, 4096
    s_add_u32 s18, s18, 524288
    s_add_u32 s33, s18, 8192
    s_add_u32 s51, s51, 4096
    v_mov_b64 v[72:73], v[128:129]
    ds_read_b128 v[32:35], v2 offset:0
    v_mov_b64 v[74:75], v[130:131]
    ds_read_b128 v[36:39], v2 offset:1024
    v_mov_b64 v[76:77], v[132:133]
    ds_read_b128 v[88:91], v2 offset:6144
    v_mov_b64 v[78:79], v[134:135]
    ds_read_b128 v[92:95], v2 offset:7168
    v_mov_b64 v[80:81], v[136:137]
    ds_read_b128 v[96:99], v2 offset:8192
    v_mov_b64 v[82:83], v[138:139]
    ds_read_b128 v[100:103], v2 offset:9216
    v_mov_b64 v[84:85], v[140:141]
    ds_read_b128 v[104:107], v2 offset:10240
    v_mov_b64 v[86:87], v[142:143]
    ds_read_b128 v[108:111], v2 offset:11264
    v_mov_b64 v[48:49], 0
    ds_read_b128 v[112:115], v1 offset:16384
    v_mov_b64 v[50:51], 0
    ds_read_b128 v[116:119], v1 offset:17408
    v_mov_b64 v[52:53], 0
    ds_read_b128 v[64:67], v1 offset:18432
    v_mov_b64 v[54:55], 0
    ds_read_b128 v[68:71], v1 offset:19456
    v_mov_b64 v[56:57], 0
    ds_read_b128 v[128:131], v2 offset:2048
    v_mov_b64 v[58:59], 0
    ds_read_b128 v[132:135], v2 offset:3072
    v_mov_b64 v[60:61], 0
    ds_read_b128 v[136:139], v2 offset:4096
    v_mov_b64 v[62:63], 0
    ds_read_b128 v[140:143], v2 offset:5120
    s_branch Tstep_0sc1
.p2align 6
Tstep_0sc1:
    buffer_load_dwordx4 v[40:43], v1, s[8:11], s26 offen offset:0 sc1
    buffer_load_dwordx4 v[44:47], v1, s[8:11], s26 offen offset:1024 sc1
    s_waitcnt vmcnt(1)
    v_max3_u32 v11, v40, v41, v42
    v_max_u32 v11, v11, v43
    ds_write_b128 v1, v[40:43] offset:0
    s_waitcnt vmcnt(0)
    v_max3_u32 v11, v11, v44, v45
    v_max3_u32 v11, v11, v46, v47
    v_cmp_eq_u32 vcc, -1, v11
    ds_write_b128 v1, v[44:47] offset:1024
    s_cbranch_vccnz Tr2_0sc1
Tok2_0sc1:
    s_waitcnt lgkmcnt(0)
    s_barrier
    ds_read_b128 v[16:19], v1 offset:0
    ds_read_b128 v[20:23], v1 offset:1024
    buffer_store_dword v14, v8, s[8:11], s19 offen sc1
    s_barrier
    ds_read_b128 v[24:27], v1 offset:2048
    ds_read_b128 v[28:31], v1 offset:3072
    s_waitcnt lgkmcnt(3)
    v_smfmac_f32_16x16x64_bf16 v[48:51], v[16:19], v[32:39], v0
    ds_read_b128 v[32:35], v1 offset:4096
    v_smfmac_f32_16x16x64_bf16 v[52:55], v[16:19], v[128:135], v0
    ds_read_b128 v[36:39], v1 offset:5120
    s_waitcnt lgkmcnt(4)
    v_smfmac_f32_16x16x64_bf16 v[48:51], v[20:23], v[136:143], v0
    buffer_load_dwordx4 v[128:131], v9, s[8:11], s18 offen sc1
    v_smfmac_f32_16x16x64_bf16 v[52:55], v[20:23], v[88:95], v0
    ds_read_b128 v[40:43], v1 offset:6144
    s_waitcnt lgkmcnt(4)
    v_smfmac_f32_16x16x64_bf16 v[48:51], v[24:27], v[96:103], v0
    ds_read_b128 v[44:47], v1 offset:7168
    s_waitcnt lgkmcnt(3)
    v_smfmac_f32_16x16x64_bf16 v[48:51], v[28:31], v[112:119], v0
    buffer_load_dwordx4 v[132:135], v9, s[8:11], s33 offen sc1
    v_smfmac_f32_16x16x64_bf16 v[48:51], v[32:35], a[96:103], v0
    ds_read_b128 v[88:91], v2 offset:12288
    s_waitcnt lgkmcnt(3)
    v_smfmac_f32_16x16x64_bf16 v[48:51], v[36:39], a[112:119], v0
    buffer_load_dwordx4 v[136:139], v3, s[8:11], s18 offen offset:2048 sc1
    s_waitcnt lgkmcnt(2)
    v_smfmac_f32_16x16x64_bf16 v[48:51], v[40:43], a[128:135], v0
    ds_read_b128 v[92:95], v2 offset:13312
    s_waitcnt lgkmcnt(2)
    v_smfmac_f32_16x16x64_bf16 v[48:51], v[44:47], a[144:151], v0
    buffer_load_dwordx4 v[140:143], v3, s[8:11], s18 offen offset:2176 sc1
    v_smfmac_f32_16x16x64_bf16 v[52:55], v[24:27], v[104:111], v0
    s_nop 1
    s_waitcnt lgkmcnt(1)
    v_smfmac_f32_16x16x64_bf16 v[52:55], v[28:31], v[64:71], v0
    s_nop 1
    v_add_f32 v48, v48, v50
    v_smfmac_f32_16x16x64_bf16 v[52:55], v[32:35], a[104:111], v0
    ds_read_b128 v[96:99], v2 offset:16384
    v_add_f32 v49, v49, v51
    v_smfmac_f32_16x16x64_bf16 v[52:55], v[36:39], a[120:127], v0
    ds_read_b128 v[100:103], v2 offset:17408
    v_mul_f32 v48, s32, v48
    v_smfmac_f32_16x16x64_bf16 v[52:55], v[40:43], a[136:143], v0
    ds_read_b128 v[104:107], v2 offset:20480
    v_mul_f32 v49, s32, v49
    v_smfmac_f32_16x16x64_bf16 v[52:55], v[44:47], a[152:159], v0
    s_nop 0
    s_waitcnt lgkmcnt(3)
    v_cvt_pk_bf16_f32 v48, v48, v49
    v_smfmac_f32_16x16x64_bf16 v[56:59], v[28:31], v[144:151], v0
    ds_write_b32 v4, v48 offset:0
    v_smfmac_f32_16x16x64_bf16 v[56:59], v[32:35], v[160:167], v0
    buffer_load_dword v10, off, s[8:11], s51 sc1
    s_nop 0
    v_add_f32 v52, v52, v54
    v_smfmac_f32_16x16x64_bf16 v[56:59], v[16:19], v[88:95], v0
    ds_read_b128 v[108:111], v2 offset:21504
    s_waitcnt lgkmcnt(2)
    v_add_f32 v53, v53, v55
    v_mul_f32 v52, s32, v52
    v_smfmac_f32_16x16x64_bf16 v[56:59], v[20:23], v[96:103], v0
    ds_read_b128 v[112:115], v2 offset:14336
    v_mul_f32 v53, s32, v53
    v_smfmac_f32_16x16x64_bf16 v[56:59], v[36:39], v[176:183], v0
    ds_read_b128 v[116:119], v2 offset:15360
    v_cvt_pk_bf16_f32 v52, v52, v53
    v_smfmac_f32_16x16x64_bf16 v[56:59], v[40:43], v[192:199], v0
    ds_write_b32 v4, v52 offset:256
    v_smfmac_f32_16x16x64_bf16 v[56:59], v[44:47], v[208:215], v0
    ds_read_b128 v[88:91], v2 offset:18432
    s_waitcnt lgkmcnt(4)
    v_smfmac_f32_16x16x64_bf16 v[56:59], v[24:27], v[104:111], v0
    ds_read_b128 v[92:95], v2 offset:19456
    s_waitcnt lgkmcnt(4)
    v_smfmac_f32_16x16x64_bf16 v[60:63], v[28:31], v[152:159], v0
    ds_read_b128 v[96:99], v2 offset:22528
    ds_read_b128 v[100:103], v2 offset:23552
    v_smfmac_f32_16x16x64_bf16 v[60:63], v[32:35], v[168:175], v0
    s_waitcnt lgkmcnt(4)
    s_barrier
    v_smfmac_f32_16x16x64_bf16 v[60:63], v[36:39], v[184:191], v0
    ds_read_b64_tr_b16 v[104:105], v5 offset:0
    v_add_f32 v56, v56, v58
    v_smfmac_f32_16x16x64_bf16 v[60:63], v[40:43], v[200:207], v0
    ds_read_b64_tr_b16 v[106:107], v5 offset:256
    v_add_f32 v57, v57, v59
    v_smfmac_f32_16x16x64_bf16 v[60:63], v[44:47], v[216:223], v0
    ds_read_b64_tr_b16 v[108:109], v5 offset:2048
    v_cvt_pk_bf16_f32 v56, v56, v57
    v_smfmac_f32_16x16x64_bf16 v[60:63], v[16:19], v[112:119], v0
    ds_read_b64_tr_b16 v[110:111], v5 offset:2304
    s_waitcnt lgkmcnt(4)
    v_mov_b64 v[64:65], 0
    v_smfmac_f32_16x16x64_bf16 v[60:63], v[20:23], v[88:95], v0
    ds_write_b32 v4, v56 offset:512
    v_smfmac_f32_16x16x64_bf16 v[60:63], v[24:27], v[96:103], v0
    s_waitcnt lgkmcnt(3)
    v_mov_b64 v[66:67], 0
    v_mfma_f32_16x16x32_bf16 v[48:51], v[72:75], v[104:107], 0
    s_waitcnt lgkmcnt(1)
    v_mov_b64 v[68:69], 0
    v_mov_b64 v[70:71], 0
    v_mfma_f32_16x16x32_bf16 v[48:51], v[76:79], v[108:111], v[48:51]
    s_nop 0
    v_add_f32 v60, v60, v62
    v_add_f32 v61, v61, v63
    v_cvt_pk_bf16_f32 v60, v60, v61
    v_smfmac_f32_16x16x64_bf16 v[64:67], v[28:31], a[16:23], v0
    ds_write_b32 v4, v60 offset:768
    v_smfmac_f32_16x16x64_bf16 v[64:67], v[24:27], a[0:7], v0
    s_waitcnt lgkmcnt(1)
    v_add_f32_dpp v48, v50, v48 quad_perm:[2,3,0,1] row_mask:0xf bank_mask:0xf
    v_smfmac_f32_16x16x64_bf16 v[64:67], v[20:23], v[240:247], v0
    v_add_f32_dpp v49, v51, v49 quad_perm:[2,3,0,1] row_mask:0xf bank_mask:0xf
    v_smfmac_f32_16x16x64_bf16 v[64:67], v[16:19], v[224:231], v0
    v_exp_f32 v50, v48
    v_smfmac_f32_16x16x64_bf16 v[64:67], v[32:35], a[32:39], v0
    s_waitcnt lgkmcnt(0)
    s_barrier
    v_smfmac_f32_16x16x64_bf16 v[64:67], v[36:39], a[48:55], v0
    ds_read_b64_tr_b16 v[112:113], v5 offset:512
    v_exp_f32 v51, v49
    v_smfmac_f32_16x16x64_bf16 v[64:67], v[40:43], a[64:71], v0
    ds_read_b64_tr_b16 v[114:115], v5 offset:768
    v_cvt_pk_bf16_f32 v50, v50, v51
    v_smfmac_f32_16x16x64_bf16 v[64:67], v[44:47], a[80:87], v0
    ds_read_b64_tr_b16 v[116:117], v5 offset:2560
    v_smfmac_f32_16x16x64_bf16 v[68:71], v[28:31], a[24:31], v0
    ds_read_b64_tr_b16 v[118:119], v5 offset:2816
    v_smfmac_f32_16x16x64_bf16 v[68:71], v[24:27], a[8:15], v0
    ds_write_b32 v12, v50
    s_waitcnt lgkmcnt(3)
    v_mfma_f32_16x16x32_bf16 v[52:55], v[112:115], v[104:107], 0
    s_nop 0
    v_cvt_pk_bf16_f32 v60, v64, v65
    v_cvt_pk_bf16_f32 v61, v66, v67
    v_smfmac_f32_16x16x64_bf16 v[68:71], v[20:23], v[248:255], v0
    s_waitcnt lgkmcnt(1)
    v_mov_b64 v[30:31], 0
    v_mfma_f32_16x16x32_bf16 v[52:55], v[116:119], v[108:111], v[52:55]
    s_nop 0
    v_mov_b64 v[26:27], 0
    v_mov_b64 v[24:25], 0
    v_smfmac_f32_16x16x64_bf16 v[68:71], v[16:19], v[232:239], v0
    s_waitcnt lgkmcnt(0)
    s_barrier
    v_smfmac_f32_16x16x64_bf16 v[68:71], v[32:35], a[40:47], v0
    ds_read_b128 v[56:59], v6 offset:12288
    v_add_f32_dpp v52, v54, v52 quad_perm:[2,3,0,1] row_mask:0xf bank_mask:0xf
    v_smfmac_f32_16x16x64_bf16 v[68:71], v[36:39], a[56:63], v0
    ds_read_b128 v[104:107], v2 offset:24576
    v_add_f32_dpp v53, v55, v53 quad_perm:[2,3,0,1] row_mask:0xf bank_mask:0xf
    v_smfmac_f32_16x16x64_bf16 v[68:71], v[40:43], a[72:79], v0
    ds_read_b128 v[108:111], v2 offset:25600
    v_exp_f32_dpp v54, v52 quad_perm:[0,1,0,1] row_mask:0xf bank_mask:0xf
    v_smfmac_f32_16x16x64_bf16 v[68:71], v[44:47], a[88:95], v0
    s_nop 0
    s_waitcnt lgkmcnt(2)
    v_exp_f32_dpp v55, v53 quad_perm:[0,1,0,1] row_mask:0xf bank_mask:0xf
Tsm_0sc1:
    v_mfma_f32_16x16x32_bf16 v[88:91], v[122:125], v[56:59], 0
    v_cvt_pk_bf16_f32 v28, v54, v55
    v_cvt_pk_bf16_f32 v29, v54, v55
    v_mfma_f32_16x16x32_bf16 v[96:99], v[80:83], v[56:59], 0
    s_nop 0
    v_cvt_pk_bf16_f32 v62, v68, v69
    v_cvt_pk_bf16_f32 v63, v70, v71
    v_mfma_f32_16x16x32_bf16 v[88:91], v[120:123], v[28:31], v[88:91]
    s_nop 0
    v_mov_b64 v[16:17], 0
    v_mov_b64 v[18:19], 0
    v_mfma_f32_16x16x32_bf16 v[96:99], v[60:63], v[28:31], v[96:99]
    s_nop 0
    v_mov_b64 v[20:21], 0
    v_mov_b64 v[22:23], 0
    v_mfma_f32_16x16x32_bf16 v[100:103], v[84:87], v[56:59], 0
    s_nop 0
    v_rcp_f32 v14, v88
    v_mfma_f32_16x16x32_bf16 v[100:103], v[60:63], v[26:29], v[100:103]
    s_nop 0
    v_mul_f32 v96, v96, v14
    v_mul_f32 v97, v97, v14
    v_mul_f32 v98, v98, v14
    v_mul_f32 v99, v99, v14
    v_subrev_u32 v11, s34, v88
    v_cmp_le_u32 vcc, s35, v11
    s_not_b64 exec, s[48:49]
    v_pk_mul_f32 v[96:97], v[100:101], v[14:15] op_sel_hi:[1,0]
    v_pk_mul_f32 v[98:99], v[102:103], v[14:15] op_sel_hi:[1,0]
    s_mov_b64 exec, -1
    v_cvt_pk_bf16_f32 v96, v96, v97
    v_cvt_pk_bf16_f32 v97, v98, v99
    ds_write_b64 v126, v[96:97]
    v_mov_b32_dpp v32, v96 quad_perm:[0,1,0,1] row_mask:0xf bank_mask:0xf
    v_mov_b32_dpp v33, v97 quad_perm:[0,1,0,1] row_mask:0xf bank_mask:0xf
    v_mov_b32_dpp v34, v96 quad_perm:[2,3,2,3] row_mask:0xf bank_mask:0xf
    v_mov_b32_dpp v35, v97 quad_perm:[2,3,2,3] row_mask:0xf bank_mask:0xf
    v_mov_b64 v[28:29], 0
    s_cbranch_vccnz Tmx_0sc1
Tmxd_0sc1:
    v_smfmac_f32_16x16x64_bf16 v[16:19], v[32:35], a[160:167], v0
    s_waitcnt lgkmcnt(0)
    s_barrier
    ds_read_b128 v[36:39], v127 offset:512
    v_smfmac_f32_16x16x64_bf16 v[20:23], v[32:35], a[192:199], v0
    ds_read_b128 v[40:43], v127 offset:1024
    v_smfmac_f32_16x16x64_bf16 v[24:27], v[32:35], a[224:231], v0
    ds_read_b128 v[44:47], v127 offset:1536
    v_smfmac_f32_16x16x64_bf16 v[28:31], v[32:35], v[104:111], v0
    ds_read_b128 v[112:115], v2 offset:26624
    s_waitcnt lgkmcnt(3)
    v_smfmac_f32_16x16x64_bf16 v[16:19], v[36:39], a[168:175], v0
    ds_read_b128 v[116:119], v2 offset:27648
    s_waitcnt lgkmcnt(3)
    v_smfmac_f32_16x16x64_bf16 v[16:19], v[40:43], a[176:183], v0
    ds_read_b128 v[48:51], v2 offset:28672
    s_waitcnt lgkmcnt(3)
    v_smfmac_f32_16x16x64_bf16 v[16:19], v[44:47], a[184:191], v0
    s_nop 0
    ds_read_b128 v[56:59], v2 offset:30720
    v_smfmac_f32_16x16x64_bf16 v[20:23], v[36:39], a[200:207], v0
    s_nop 0
    ds_read_b128 v[52:55], v2 offset:29696
    v_smfmac_f32_16x16x64_bf16 v[20:23], v[40:43], a[208:215], v0
    s_nop 1
    v_cvt_pk_bf16_f32 v16, v16, v17
    v_cvt_pk_bf16_f32 v17, v18, v19
    v_and_or_b32 v16, v16, -2, s46
    v_smfmac_f32_16x16x64_bf16 v[20:23], v[44:47], a[216:223], v0
    buffer_store_dwordx2 v[16:17], v7, s[8:11], s20 offen offset:0 sc1
    v_smfmac_f32_16x16x64_bf16 v[24:27], v[36:39], a[232:239], v0
    s_nop 0
    ds_read_b128 v[60:63], v2 offset:31744
    v_smfmac_f32_16x16x64_bf16 v[24:27], v[40:43], a[240:247], v0
    s_nop 1
    s_nop 0
    v_cvt_pk_bf16_f32 v20, v20, v21
    v_cvt_pk_bf16_f32 v21, v22, v23
    v_and_or_b32 v20, v20, -2, s46
    v_smfmac_f32_16x16x64_bf16 v[24:27], v[44:47], a[248:255], v0
    buffer_store_dwordx2 v[20:21], v7, s[8:11], s20 offen offset:2048 sc1
    s_waitcnt lgkmcnt(4)
    v_smfmac_f32_16x16x64_bf16 v[28:31], v[36:39], v[112:119], v0
    s_nop 0
    s_waitcnt lgkmcnt(1)
    v_smfmac_f32_16x16x64_bf16 v[28:31], v[40:43], v[48:55], v0
    s_nop 1
    v_cvt_pk_bf16_f32 v24, v24, v25
    v_cvt_pk_bf16_f32 v25, v26, v27
    s_waitcnt lgkmcnt(0)
    v_and_or_b32 v24, v24, -2, s46
    v_smfmac_f32_16x16x64_bf16 v[28:31], v[44:47], v[56:63], v0
    buffer_store_dwordx2 v[24:25], v7, s[8:11], s21 offen offset:0 sc1
    s_nop 6
    v_cvt_pk_bf16_f32 v28, v28, v29
    v_cvt_pk_bf16_f32 v29, v30, v31
    v_and_or_b32 v28, v28, -2, s46
    buffer_store_dwordx2 v[28:29], v7, s[8:11], s21 offen offset:2048 sc1
    s_barrier
    ds_read_b128 v[16:19], v1 offset:13312
    s_waitcnt vmcnt(8)
    v_mov_b64 v[72:73], v[128:129]
    ds_read_b128 v[32:35], v2 offset:0
    s_add_u32 s17, s17, 1
    v_mov_b64 v[74:75], v[130:131]
    ds_read_b128 v[36:39], v2 offset:1024
    s_and_b32 s29, s17, 3
    s_waitcnt vmcnt(7)
    v_mov_b64 v[76:77], v[132:133]
    ds_read_b128 v[88:91], v2 offset:6144
    s_lshl_b32 s29, s29, 13
    v_mov_b64 v[78:79], v[134:135]
    ds_read_b128 v[92:95], v2 offset:7168
    s_add_u32 s30, s24, s29
    s_waitcnt vmcnt(6)
    v_mov_b64 v[80:81], v[136:137]
    ds_read_b128 v[96:99], v2 offset:8192
    s_add_u32 s26, s29, 52953088
    s_nop 3
    buffer_load_dwordx4 v[40:43], v1, s[8:11], s22 offen offset:0 sc1
    buffer_load_dwordx4 v[44:47], v1, s[8:11], s22 offen offset:1024 sc1
    v_mov_b64 v[82:83], v[138:139]
    ds_read_b128 v[100:103], v2 offset:9216
    s_xor_b32 s25, s30, 16384
    s_waitcnt vmcnt(7)
    v_mov_b64 v[84:85], v[140:141]
    ds_read_b128 v[104:107], v2 offset:10240
    s_xor_b32 s20, s20, 262144
    v_mov_b64 v[86:87], v[142:143]
    ds_read_b128 v[108:111], v2 offset:11264
    s_add_u32 s21, s20, 4096
    v_mov_b64 v[48:49], 0
    ds_read_b128 v[112:115], v1 offset:16384
    s_add_u32 s19, s19, 8192
    v_mov_b64 v[50:51], 0
    ds_read_b128 v[116:119], v1 offset:17408
    s_cmp_ge_u32 s17, 62
    s_cselect_b32 s35, 0, s35
    s_cselect_b32 s18, 0x40000000, s18
    v_mov_b64 v[52:53], 0
    ds_read_b128 v[64:67], v1 offset:18432
    s_add_u32 s18, s18, 524288
    v_mov_b64 v[54:55], 0
    ds_read_b128 v[68:71], v1 offset:19456
    s_add_u32 s33, s18, 8192
    v_mov_b64 v[56:57], 0
    ds_read_b128 v[128:131], v2 offset:2048
    s_add_u32 s51, s51, 4096
    s_waitcnt lgkmcnt(13)
    s_waitcnt vmcnt(1)
    v_mfma_f32_16x16x32_bf16 v[20:23], v[16:19], v[40:43], 0
    v_bitop3_b32 v11, v40, v42, s46 bitop3:0x7e
    s_waitcnt vmcnt(0)
    v_mfma_f32_16x16x32_bf16 v[20:23], v[16:19], v[44:47], v[20:23]
    v_bitop3_b32 v15, v44, v46, s46 bitop3:0x7e
    v_bitop3_b32 v11, v11, v15, 1 bitop3:0xa8
    v_cmp_ne_u32 vcc, 0, v11
    s_nop 4
    v_add_f32_dpp v20, v20, v20 row_ror:4 row_mask:0xf bank_mask:0xf
    v_add_f32_dpp v21, v21, v21 row_ror:4 row_mask:0xf bank_mask:0xf
    s_cbranch_vccnz Tr1_0sc1
Tok1_0sc1:
    v_add_f32_dpp v20, v20, v20 row_ror:8 row_mask:0xf bank_mask:0xf
    v_add_f32_dpp v21, v21, v21 row_ror:8 row_mask:0xf bank_mask:0xf
    v_cvt_pk_bf16_f32 v14, v20, v21
    buffer_store_dword v14, v8, s[8:11], s30 offen sc1
    buffer_store_dword v13, v8, s[8:11], s25 offen sc1
    v_readfirstlane_b32 s52, v10
    s_xor_b32 s22, s22, 262144
    s_bfe_u32 s46, s17, 0x10001
    v_mov_b64 v[58:59], 0
    ds_read_b128 v[132:135], v2 offset:3072
    v_mov_b64 v[60:61], 0
    ds_read_b128 v[136:139], v2 offset:4096
    v_mov_b64 v[62:63], 0
    ds_read_b128 v[140:143], v2 offset:5120
    s_cmp_lg_u32 s52, 1
    s_cbranch_scc1 Tkv2_0sc1
Tkv2d_0sc1:
    s_nop 15
    s_nop 10
    s_branch Tstep_0sc1
Tkv2_0sc1:
    s_add_u32 s29, s17, 1
    s_cmp_ge_u32 s29, 63
    s_cbranch_scc1 Tkv2d_0sc1
    s_lshl_b32 s36, s29, 12
    s_add_u32 s36, s36, s54
    buffer_load_dword v11, off, s[8:11], s36 sc1
    s_waitcnt vmcnt(0)
    v_cmp_ne_u32 vcc, 1, v11
    s_cbranch_vccz Tkv2d_0sc1
    s_add_u32 s27, s27, 1
    s_cmp_lt_u32 s27, 400000
    s_cbranch_scc1 Tkv2_0sc1
    s_branch Tkv2d_0sc1
Tr2_0sc1:
    buffer_load_dwordx4 v[40:43], v1, s[8:11], s26 offen offset:0 sc1
    buffer_load_dwordx4 v[44:47], v1, s[8:11], s26 offen offset:1024 sc1
    s_waitcnt vmcnt(1)
    v_max3_u32 v11, v40, v41, v42
    v_max_u32 v11, v11, v43
    ds_write_b128 v1, v[40:43] offset:0
    s_waitcnt vmcnt(0)
    v_max3_u32 v11, v11, v44, v45
    v_max3_u32 v11, v11, v46, v47
    v_cmp_eq_u32 vcc, -1, v11
    ds_write_b128 v1, v[44:47] offset:1024
    s_cbranch_vccz Tok2_0sc1
    buffer_load_dwordx4 v[40:43], v1, s[8:11], s26 offen offset:0 sc1
    buffer_load_dwordx4 v[44:47], v1, s[8:11], s26 offen offset:1024 sc1
    s_waitcnt vmcnt(1)
    v_max3_u32 v11, v40, v41, v42
    v_max_u32 v11, v11, v43
    ds_write_b128 v1, v[40:43] offset:0
    s_waitcnt vmcnt(0)
    v_max3_u32 v11, v11, v44, v45
    v_max3_u32 v11, v11, v46, v47
    v_cmp_eq_u32 vcc, -1, v11
    ds_write_b128 v1, v[44:47] offset:1024
    s_cbranch_vccz Tok2_0sc1
    s_add_u32 s27, s27, 1
    s_cmp_lt_u32 s27, 400000
    s_cbranch_scc1 Tr2_0sc1
    s_mov_b32 s28, 1
    s_branch Tok2_0sc1
Tr1_0sc1:
    buffer_load_dwordx4 v[40:43], v1, s[8:11], s22 offen offset:0 sc1
    buffer_load_dwordx4 v[44:47], v1, s[8:11], s22 offen offset:1024 sc1
    s_waitcnt vmcnt(1)
    v_mfma_f32_16x16x32_bf16 v[20:23], v[16:19], v[40:43], 0
    v_bitop3_b32 v11, v40, v42, s46 bitop3:0x7e
    s_waitcnt vmcnt(0)
    v_mfma_f32_16x16x32_bf16 v[20:23], v[16:19], v[44:47], v[20:23]
    v_bitop3_b32 v15, v44, v46, s46 bitop3:0x7e
    v_bitop3_b32 v11, v11, v15, 1 bitop3:0xa8
    v_cmp_ne_u32 vcc, 0, v11
    s_nop 4
    v_add_f32_dpp v20, v20, v20 row_ror:4 row_mask:0xf bank_mask:0xf
    v_add_f32_dpp v21, v21, v21 row_ror:4 row_mask:0xf bank_mask:0xf
    s_cbranch_vccz Tok1_0sc1
    s_add_u32 s27, s27, 1
    s_cmp_lt_u32 s27, 400000
    s_cbranch_scc1 Tr1_0sc1
    s_mov_b32 s28, 1
    s_waitcnt vmcnt(0)
    s_branch Tok1_0sc1
Tmx_0sc1:
    s_nop 7
    s_waitcnt lgkmcnt(0)
    s_cmp_lg_u32 s35, 0
    s_cbranch_scc1 Tmx2_0sc1
    ds_read_b64_tr_b16 v[40:41], v5 offset:512
    v_pk_add_f32 v[44:45], v[64:65], v[66:67]
    v_pk_add_f32 v[46:47], v[68:69], v[70:71]
    v_cvt_pk_bf16_f32 v42, v44, v45
    v_cvt_pk_bf16_f32 v43, v46, v47
    s_and_b32 s29, s17, 1
    s_lshl_b32 s29, s29, 5
    s_add_u32 s29, s29, s16
    s_lshl_b32 s29, s29, 12
    s_add_u32 s29, s29, 61734912
    s_waitcnt lgkmcnt(0)
    buffer_store_dwordx4 v[40:43], v1, s[8:11], s29 offen sc1
    s_cmp_eq_u32 s17, 63
    s_cbranch_scc1 Tend_0sc1
    s_mov_b32 s35, 0x3c000000
    v_cmp_le_u32 vcc, s35, v11
    s_nop 4
    s_and_b64 vcc, vcc, s[48:49]
    s_cbranch_scc0 Tmxd_0sc1
Tmx2_0sc1:
    v_max3_f32 v14, v48, v49, v52
    v_max_f32 v14, v14, v53
    v_mov_b32 v15, v14
    s_nop 1
    v_permlane16_swap_b32 v14, v15
    v_max_f32 v14, v14, v15
    v_mov_b32 v15, v14
    s_nop 1
    v_permlane32_swap_b32 v14, v15
    v_max_f32 v14, v14, v15
    ds_write_b32 v1, v14 offset:14336
    s_waitcnt lgkmcnt(0)
    s_barrier
    ds_read_b128 v[88:91], v1 offset:14336
    s_waitcnt lgkmcnt(0)
    v_max3_f32 v14, v88, v89, v90
    v_max_f32 v14, v14, v91
    v_cmp_neq_f32 vcc, 0, v14
    v_mov_b32 v11, 0x1f8
    v_cmp_class_f32 s[36:37], v14, v11
    s_nop 4
    s_and_b64 vcc, vcc, s[36:37]
    s_and_b64 vcc, vcc, s[48:49]
    s_cbranch_scc0 Tmxd_0sc1
    v_cndmask_b32 v14, 0, v14, vcc
    v_sub_f32 v48, v48, v14
    v_sub_f32 v49, v49, v14
    v_sub_f32 v52, v52, v14
    v_sub_f32 v53, v53, v14
    v_exp_f32 v50, v48
    v_exp_f32 v51, v49
    s_nop 0
    v_cvt_pk_bf16_f32 v50, v50, v51
    ds_write_b32 v12, v50
    v_exp_f32_dpp v54, v52 quad_perm:[0,1,0,1] row_mask:0xf bank_mask:0xf
    v_exp_f32_dpp v55, v53 quad_perm:[0,1,0,1] row_mask:0xf bank_mask:0xf
    s_waitcnt lgkmcnt(0)
    s_barrier
    ds_read_b128 v[56:59], v6 offset:12288
    s_waitcnt lgkmcnt(0)
    s_branch Tsm_0sc1
Tend_0sc1:
    s_cmp_lg_u32 s16, 0
    s_cbranch_scc1 Tnwb_0sc1
    s_waitcnt vmcnt(0)
    buffer_wbl2 sc1
    s_waitcnt vmcnt(0)
Tnwb_0sc1:
    s_endpgm
Twave_1:
    v_and_b32 v100, 63, v0
    v_lshrrev_b32 v102, 1, v100
    v_and_b32 v102, 8, v102
    v_xor_b32 v102, v102, v100
    v_and_b32 v102, 15, v102
    v_lshlrev_b32 v102, 4, v102
    v_lshrrev_b32 v103, 4, v100
    v_lshl_add_u32 v104, v103, 13, v102
    v_lshl_add_u32 v108, v103, 10, v102
    v_xor_b32 v104, 16, v104
    v_xor_b32 v105, 64, v104
    v_xor_b32 v109, 64, v108
    s_mov_b32 s54, 0x400000
    s_mov_b32 s55, 0x20000
    s_mov_b32 s58, 0x400000
    s_mov_b32 s59, 0x20000
    s_mov_b32 s62, 0x400000
    s_mov_b32 s63, 0x20000
    s_mov_b32 s66, 0x400000
    s_mov_b32 s67, 0x20000
    s_lshl_b32 s50, s16, 8
    s_lshl_b32 s51, s16, 17
    s_waitcnt lgkmcnt(0)
    s_mov_b64 s[52:53], s[40:41]
    s_mov_b64 s[56:57], s[42:43]
    s_mov_b64 s[60:61], s[44:45]
    s_mov_b64 s[64:65], s[46:47]
    s_mov_b32 m0, 32768
    s_add_u32 s29, s50, 1703936
    buffer_load_dwordx4 v104, s[56:59], s29 offen  lds
    s_mov_b32 m0, 33792
    s_add_u32 s29, s50, 1736704
    buffer_load_dwordx4 v105, s[56:59], s29 offen  lds
    s_mov_b32 m0, 34816
    s_add_u32 s29, s50, 1769472
    buffer_load_dwordx4 v104, s[56:59], s29 offen  lds
    s_mov_b32 m0, 35840
    s_add_u32 s29, s50, 1802240
    buffer_load_dwordx4 v105, s[56:59], s29 offen  lds
    s_mov_b32 m0, 36864
    s_add_u32 s29, s50, 2228224
    buffer_load_dwordx4 v104, s[56:59], s29 offen  lds
    s_mov_b32 m0, 37888
    s_add_u32 s29, s50, 2260992
    buffer_load_dwordx4 v105, s[56:59], s29 offen  lds
    s_mov_b32 m0, 38912
    s_add_u32 s29, s50, 2293760
    buffer_load_dwordx4 v104, s[56:59], s29 offen  lds
    s_mov_b32 m0, 39936
    s_add_u32 s29, s50, 2326528
    buffer_load_dwordx4 v105, s[56:59], s29 offen  lds
    v_mov_b32 v120, 0
    v_bfe_u32 v101, v100, 2, 1
    v_lshl_add_u32 v120, v101, 8, v120
    v_bfe_u32 v101, v100, 4, 2
    v_lshl_add_u32 v120, v101, 10, v120
    v_bfe_u32 v101, v100, 3, 1
    v_lshl_add_u32 v120, v101, 15, v120
    v_bfe_u32 v101, v100, 2, 1
    v_lshl_add_u32 v120, v101, 7, v120
    v_bfe_u32 v101, v100, 4, 1
    v_lshl_add_u32 v120, v101, 6, v120
    v_bfe_u32 v101, v100, 1, 1
    v_lshl_add_u32 v120, v101, 5, v120
    v_bfe_u32 v101, v100, 3, 1
    v_lshl_add_u32 v120, v101, 4, v120
    v_bfe_u32 v101, v100, 0, 1
    v_lshl_add_u32 v120, v101, 3, v120
    v_xor_b32 v120, 64, v120
    v_xor_b32 v121, 16, v120
    v_add_u32 v122, 65536, v120
    v_add_u32 v123, 65536, v121
    v_mov_b32 v124, 0
    v_bfe_u32 v101, v100, 2, 1
    v_lshl_add_u32 v124, v101, 8, v124
    v_bfe_u32 v101, v100, 5, 1
    v_lshl_add_u32 v124, v101, 10, v124
    v_bfe_u32 v101, v100, 4, 1
    v_lshl_add_u32 v124, v101, 11, v124
    v_bfe_u32 v101, v100, 2, 1
    v_lshl_add_u32 v124, v101, 7, v124
    v_bfe_u32 v101, v100, 4, 1
    v_lshl_add_u32 v124, v101, 6, v124
    v_bfe_u32 v101, v100, 3, 1
    v_lshl_add_u32 v124, v101, 5, v124
    v_bfe_u32 v101, v100, 0, 2
    v_lshl_add_u32 v124, v101, 3, v124
    v_xor_b32 v124, 64, v124
    v_add_u32 v125, 65536, v124
    s_mov_b32 m0, 40960
    s_add_u32 s29, s50, 2752512
    buffer_load_dwordx4 v104, s[56:59], s29 offen  lds
    s_mov_b32 m0, 41984
    s_add_u32 s29, s50, 2785280
    buffer_load_dwordx4 v105, s[56:59], s29 offen  lds
    s_mov_b32 m0, 43008
    s_add_u32 s29, s50, 2818048
    buffer_load_dwordx4 v104, s[56:59], s29 offen  lds
    s_mov_b32 m0, 44032
    s_add_u32 s29, s50, 2850816
    buffer_load_dwordx4 v105, s[56:59], s29 offen  lds
    s_waitcnt vmcnt(8)
    s_waitcnt lgkmcnt(0)
    s_barrier
    ds_read_b64_tr_b16 v[144:145], v120 offset:0
    ds_read_b64_tr_b16 v[146:147], v120 offset:512
    ds_read_b64_tr_b16 v[148:149], v122 offset:0
    ds_read_b64_tr_b16 v[150:151], v122 offset:512
    ds_read_b64_tr_b16 v[152:153], v121 offset:0
    ds_read_b64_tr_b16 v[154:155], v121 offset:512
    ds_read_b64_tr_b16 v[156:157], v123 offset:0
    ds_read_b64_tr_b16 v[158:159], v123 offset:512
    s_mov_b32 m0, 45056
    s_add_u32 s29, s50, 3276800
    buffer_load_dwordx4 v104, s[56:59], s29 offen  lds
    s_mov_b32 m0, 46080
    s_add_u32 s29, s50, 3309568
    buffer_load_dwordx4 v105, s[56:59], s29 offen  lds
    s_mov_b32 m0, 47104
    s_add_u32 s29, s50, 3342336
    buffer_load_dwordx4 v104, s[56:59], s29 offen  lds
    s_mov_b32 m0, 48128
    s_add_u32 s29, s50, 3375104
    buffer_load_dwordx4 v105, s[56:59], s29 offen  lds
    v_mov_b32 v103, 256
    v_bfe_u32 v101, v100, 4, 1
    v_lshl_add_u32 v103, v101, 10, v103
    v_bfe_u32 v101, v100, 5, 1
    v_lshl_add_u32 v103, v101, 5, v103
    v_bfe_u32 v101, v100, 0, 2
    v_lshl_add_u32 v103, v101, 2, v103
    s_and_b32 s29, s16, 3
    s_lshl_b32 s29, s29, 11
    s_lshr_b32 s30, s16, 3
    s_lshl_b32 s30, s30, 6
    s_add_u32 s29, s29, s30
    s_and_b32 s30, s16, 4
    s_lshl_b32 s30, s30, 2
    s_add_u32 s29, s29, s30
    v_add_u32 v103, s29, v103
    global_load_dword v110, v103, s[48:49]
    s_waitcnt vmcnt(9)
    s_waitcnt lgkmcnt(0)
    s_barrier
    ds_read_b64_tr_b16 v[160:161], v120 offset:4096
    ds_read_b64_tr_b16 v[162:163], v120 offset:4608
    ds_read_b64_tr_b16 v[164:165], v122 offset:4096
    ds_read_b64_tr_b16 v[166:167], v122 offset:4608
    ds_read_b64_tr_b16 v[168:169], v121 offset:4096
    ds_read_b64_tr_b16 v[170:171], v121 offset:4608
    ds_read_b64_tr_b16 v[172:173], v123 offset:4096
    ds_read_b64_tr_b16 v[174:175], v123 offset:4608
    s_mov_b32 m0, 49152
    s_add_u32 s29, s50, 3801088
    buffer_load_dwordx4 v104, s[56:59], s29 offen  lds
    s_mov_b32 m0, 50176
    s_add_u32 s29, s50, 3833856
    buffer_load_dwordx4 v105, s[56:59], s29 offen  lds
    s_mov_b32 m0, 51200
    s_add_u32 s29, s50, 3866624
    buffer_load_dwordx4 v104, s[56:59], s29 offen  lds
    s_mov_b32 m0, 52224
    s_add_u32 s29, s50, 3899392
    buffer_load_dwordx4 v105, s[56:59], s29 offen  lds
    s_waitcnt vmcnt(9)
    s_waitcnt lgkmcnt(0)
    s_barrier
    ds_read_b64_tr_b16 v[176:177], v120 offset:8192
    ds_read_b64_tr_b16 v[178:179], v120 offset:8704
    ds_read_b64_tr_b16 v[180:181], v122 offset:8192
    ds_read_b64_tr_b16 v[182:183], v122 offset:8704
    ds_read_b64_tr_b16 v[184:185], v121 offset:8192
    ds_read_b64_tr_b16 v[186:187], v121 offset:8704
    ds_read_b64_tr_b16 v[188:189], v123 offset:8192
    ds_read_b64_tr_b16 v[190:191], v123 offset:8704
    s_mov_b32 m0, 53248
    s_add_u32 s29, s50, 131072
    buffer_load_dwordx4 v104, s[60:63], s29 offen  lds
    s_mov_b32 m0, 54272
    s_add_u32 s29, s50, 163840
    buffer_load_dwordx4 v105, s[60:63], s29 offen  lds
    s_mov_b32 m0, 55296
    s_add_u32 s29, s50, 196608
    buffer_load_dwordx4 v104, s[60:63], s29 offen  lds
    s_mov_b32 m0, 56320
    s_add_u32 s29, s50, 229376
    buffer_load_dwordx4 v105, s[60:63], s29 offen  lds
    v_mov_b32 v111, 0
    s_mov_b64 exec, 1
    global_load_dword v111, v111, s[6:7] offset:32 sc1
    s_mov_b64 exec, -1
    v_mov_b32 v2, 32768
    v_bfe_u32 v101, v100, 0, 6
    v_lshl_add_u32 v2, v101, 4, v2
    s_waitcnt vmcnt(10)
    s_waitcnt lgkmcnt(0)
    s_barrier
    ds_read_b64_tr_b16 v[192:193], v120 offset:12288
    ds_read_b64_tr_b16 v[194:195], v120 offset:12800
    ds_read_b64_tr_b16 v[196:197], v122 offset:12288
    ds_read_b64_tr_b16 v[198:199], v122 offset:12800
    ds_read_b64_tr_b16 v[200:201], v121 offset:12288
    ds_read_b64_tr_b16 v[202:203], v121 offset:12800
    ds_read_b64_tr_b16 v[204:205], v123 offset:12288
    ds_read_b64_tr_b16 v[206:207], v123 offset:12800
    s_mov_b32 m0, 57344
    s_add_u32 s29, s50, 655360
    buffer_load_dwordx4 v104, s[60:63], s29 offen  lds
    s_mov_b32 m0, 58368
    s_add_u32 s29, s50, 688128
    buffer_load_dwordx4 v105, s[60:63], s29 offen  lds
    s_mov_b32 m0, 59392
    s_add_u32 s29, s50, 720896
    buffer_load_dwordx4 v104, s[60:63], s29 offen  lds
    s_mov_b32 m0, 60416
    s_add_u32 s29, s50, 753664
    buffer_load_dwordx4 v105, s[60:63], s29 offen  lds
    v_mov_b32 v4, 140288
    v_bfe_u32 v101, v100, 0, 3
    v_lshl_add_u32 v4, v101, 5, v4
    v_bfe_u32 v101, v100, 4, 2
    v_lshl_add_u32 v4, v101, 3, v4
    v_bfe_u32 v101, v100, 3, 1
    v_lshl_add_u32 v4, v101, 2, v4
    s_waitcnt vmcnt(9)
    s_waitcnt lgkmcnt(0)
    s_barrier
    ds_read_b64_tr_b16 v[208:209], v120 offset:16384
    ds_read_b64_tr_b16 v[210:211], v120 offset:16896
    ds_read_b64_tr_b16 v[212:213], v122 offset:16384
    ds_read_b64_tr_b16 v[214:215], v122 offset:16896
    ds_read_b64_tr_b16 v[216:217], v121 offset:16384
    ds_read_b64_tr_b16 v[218:219], v121 offset:16896
    ds_read_b64_tr_b16 v[220:221], v123 offset:16384
    ds_read_b64_tr_b16 v[222:223], v123 offset:16896
    s_mov_b32 m0, 61440
    s_add_u32 s29, s50, 1179648
    buffer_load_dwordx4 v104, s[60:63], s29 offen  lds
    s_mov_b32 m0, 62464
    s_add_u32 s29, s50, 1212416
    buffer_load_dwordx4 v105, s[60:63], s29 offen  lds
    s_mov_b32 m0, 63488
    s_add_u32 s29, s50, 1245184
    buffer_load_dwordx4 v104, s[60:63], s29 offen  lds
    s_mov_b32 m0, 64512
    s_add_u32 s29, s50, 1277952
    buffer_load_dwordx4 v105, s[60:63], s29 offen  lds
    v_mov_b32 v5, 139264
    v_bfe_u32 v101, v100, 5, 1
    v_lshl_add_u32 v5, v101, 10, v5
    v_bfe_u32 v101, v100, 0, 5
    v_lshl_add_u32 v5, v101, 3, v5
    s_waitcnt vmcnt(9)
    s_waitcnt lgkmcnt(0)
    s_barrier
    ds_read_b64_tr_b16 v[224:225], v120 offset:20480
    ds_read_b64_tr_b16 v[226:227], v120 offset:20992
    ds_read_b64_tr_b16 v[228:229], v122 offset:20480
    ds_read_b64_tr_b16 v[230:231], v122 offset:20992
    ds_read_b64_tr_b16 v[232:233], v121 offset:20480
    ds_read_b64_tr_b16 v[234:235], v121 offset:20992
    ds_read_b64_tr_b16 v[236:237], v123 offset:20480
    ds_read_b64_tr_b16 v[238:239], v123 offset:20992
    s_mov_b32 m0, 32768
    s_add_u32 s29, s50, 1703936
    buffer_load_dwordx4 v104, s[60:63], s29 offen  lds
    s_mov_b32 m0, 33792
    s_add_u32 s29, s50, 1736704
    buffer_load_dwordx4 v105, s[60:63], s29 offen  lds
    s_mov_b32 m0, 34816
    s_add_u32 s29, s50, 1769472
    buffer_load_dwordx4 v104, s[60:63], s29 offen  lds
    s_mov_b32 m0, 35840
    s_add_u32 s29, s50, 1802240
    buffer_load_dwordx4 v105, s[60:63], s29 offen  lds
    v_mov_b32 v6, 131072
    v_bfe_u32 v101, v100, 2, 4
    v_lshl_add_u32 v6, v101, 6, v6
    v_bfe_u32 v101, v100, 0, 1
    v_lshl_add_u32 v6, v101, 4, v6
    s_waitcnt vmcnt(8)
    s_waitcnt lgkmcnt(0)
    s_barrier
    ds_read_b64_tr_b16 v[240:241], v120 offset:24576
    ds_read_b64_tr_b16 v[242:243], v120 offset:25088
    ds_read_b64_tr_b16 v[244:245], v122 offset:24576
    ds_read_b64_tr_b16 v[246:247], v122 offset:25088
    ds_read_b64_tr_b16 v[248:249], v121 offset:24576
    ds_read_b64_tr_b16 v[250:251], v121 offset:25088
    ds_read_b64_tr_b16 v[252:253], v123 offset:24576
    ds_read_b64_tr_b16 v[254:255], v123 offset:25088
    s_mov_b32 m0, 36864
    s_add_u32 s29, s50, 2228224
    buffer_load_dwordx4 v104, s[60:63], s29 offen  lds
    s_mov_b32 m0, 37888
    s_add_u32 s29, s50, 2260992
    buffer_load_dwordx4 v105, s[60:63], s29 offen  lds
    s_mov_b32 m0, 38912
    s_add_u32 s29, s50, 2293760
    buffer_load_dwordx4 v104, s[60:63], s29 offen  lds
    s_mov_b32 m0, 39936
    s_add_u32 s29, s50, 2326528
    buffer_load_dwordx4 v105, s[60:63], s29 offen  lds
    s_mov_b32 s5, 0
Lrot_2:
    v_readfirstlane_b32 s4, v111
    s_nop 3
    s_sub_u32 s4, s4, 1
    s_cmp_eq_u32 s4, s14
    s_cbranch_scc1 Lrot_2_ok
    s_cmp_lt_u32 s4, 8
    s_cbranch_scc0 Lrot_2_again
    s_mov_b32 s14, s4
    s_waitcnt vmcnt(0) lgkmcnt(0)
    s_barrier
    s_branch Lrole
Lrot_2_again:
    v_mov_b32 v111, 0
    s_mov_b64 exec, 1
    global_load_dword v111, v111, s[6:7] offset:32 sc1
    s_mov_b64 exec, -1
    s_waitcnt vmcnt(0)
    s_add_u32 s5, s5, 1
    s_cmp_lt_u32 s5, 400000
    s_cbranch_scc1 Lrot_2
Lrot_2_ok:
    v_mov_b32 v12, 143616
    v_bfe_u32 v101, v100, 0, 4
    v_lshl_add_u32 v12, v101, 4, v12
    v_bfe_u32 v101, v100, 4, 2
    v_lshl_add_u32 v12, v101, 2, v12
    s_waitcnt vmcnt(8)
    s_waitcnt lgkmcnt(0)
    s_barrier
    ds_read_b64_tr_b16 a[0:1], v120 offset:28672
    ds_read_b64_tr_b16 a[2:3], v120 offset:29184
    ds_read_b64_tr_b16 a[4:5], v122 offset:28672
    ds_read_b64_tr_b16 a[6:7], v122 offset:29184
    ds_read_b64_tr_b16 a[8:9], v121 offset:28672
    ds_read_b64_tr_b16 a[10:11], v121 offset:29184
    ds_read_b64_tr_b16 a[12:13], v123 offset:28672
    ds_read_b64_tr_b16 a[14:15], v123 offset:29184
    s_mov_b32 m0, 40960
    s_add_u32 s29, s50, 2752512
    buffer_load_dwordx4 v104, s[60:63], s29 offen  lds
    s_mov_b32 m0, 41984
    s_add_u32 s29, s50, 2785280
    buffer_load_dwordx4 v105, s[60:63], s29 offen  lds
    s_mov_b32 m0, 43008
    s_add_u32 s29, s50, 2818048
    buffer_load_dwordx4 v104, s[60:63], s29 offen  lds
    s_mov_b32 m0, 44032
    s_add_u32 s29, s50, 2850816
    buffer_load_dwordx4 v105, s[60:63], s29 offen  lds
    v_mov_b32 v7, 131072
    v_bfe_u32 v101, v100, 3, 1
    v_lshl_add_u32 v7, v101, 15, v7
    v_bfe_u32 v101, v100, 4, 2
    v_lshl_add_u32 v7, v101, 13, v7
    v_bfe_u32 v101, v100, 0, 3
    v_lshl_add_u32 v7, v101, 3, v7
    v_mov_b32 v103, 8
    v_bfe_u32 v101, v100, 3, 1
    v_lshl_add_u32 v103, v101, 2, v103
    v_bfe_u32 v101, v100, 4, 2
    v_lshl_add_u32 v103, v101, 0, v103
    v_mul_u32_u24 v103, 0, v103
    v_add_u32 v103, s16, v103
    v_and_b32 v103, 31, v103
    v_lshl_add_u32 v7, v103, 6, v7
    s_waitcnt vmcnt(8)
    s_waitcnt lgkmcnt(0)
    s_barrier
    ds_read_b64_tr_b16 a[16:17], v120 offset:0
    ds_read_b64_tr_b16 a[18:19], v120 offset:512
    ds_read_b64_tr_b16 a[20:21], v122 offset:0
    ds_read_b64_tr_b16 a[22:23], v122 offset:512
    ds_read_b64_tr_b16 a[24:25], v121 offset:0
    ds_read_b64_tr_b16 a[26:27], v121 offset:512
    ds_read_b64_tr_b16 a[28:29], v123 offset:0
    ds_read_b64_tr_b16 a[30:31], v123 offset:512
    s_mov_b32 m0, 45056
    s_add_u32 s29, s50, 3276800
    buffer_load_dwordx4 v104, s[60:63], s29 offen  lds
    s_mov_b32 m0, 46080
    s_add_u32 s29, s50, 3309568
    buffer_load_dwordx4 v105, s[60:63], s29 offen  lds
    s_mov_b32 m0, 47104
    s_add_u32 s29, s50, 3342336
    buffer_load_dwordx4 v104, s[60:63], s29 offen  lds
    s_mov_b32 m0, 48128
    s_add_u32 s29, s50, 3375104
    buffer_load_dwordx4 v105, s[60:63], s29 offen  lds
    v_mov_b32 v1, 131072
    v_bfe_u32 v101, v100, 0, 6
    v_lshl_add_u32 v1, v101, 4, v1
    v_mov_b32 v112, -1
    v_mov_b32 v113, -1
    v_mov_b32 v114, -1
    v_mov_b32 v115, -1
    s_lshl_b32 s22, s16, 13
    s_add_u32 s22, s22, 52430848
    s_xor_b32 s23, s22, 262144
    buffer_store_dwordx4 v[112:115], v1, s[8:11], s22 offen offset:0 sc1
    buffer_store_dwordx4 v[112:115], v1, s[8:11], s22 offen offset:1024 sc1
    buffer_store_dwordx4 v[112:115], v1, s[8:11], s23 offen offset:0 sc1
    buffer_store_dwordx4 v[112:115], v1, s[8:11], s23 offen offset:1024 sc1
    s_waitcnt vmcnt(12)
    s_waitcnt lgkmcnt(0)
    s_barrier
    ds_read_b64_tr_b16 a[32:33], v120 offset:4096
    ds_read_b64_tr_b16 a[34:35], v120 offset:4608
    ds_read_b64_tr_b16 a[36:37], v122 offset:4096
    ds_read_b64_tr_b16 a[38:39], v122 offset:4608
    ds_read_b64_tr_b16 a[40:41], v121 offset:4096
    ds_read_b64_tr_b16 a[42:43], v121 offset:4608
    ds_read_b64_tr_b16 a[44:45], v123 offset:4096
    ds_read_b64_tr_b16 a[46:47], v123 offset:4608
    s_mov_b32 m0, 49152
    s_add_u32 s29, s50, 3801088
    buffer_load_dwordx4 v104, s[60:63], s29 offen  lds
    s_mov_b32 m0, 50176
    s_add_u32 s29, s50, 3833856
    buffer_load_dwordx4 v105, s[60:63], s29 offen  lds
    s_mov_b32 m0, 51200
    s_add_u32 s29, s50, 3866624
    buffer_load_dwordx4 v104, s[60:63], s29 offen  lds
    s_mov_b32 m0, 52224
    s_add_u32 s29, s50, 3899392
    buffer_load_dwordx4 v105, s[60:63], s29 offen  lds
    v_mov_b32 v8, 0
    v_bfe_u32 v101, v100, 4, 2
    v_lshl_add_u32 v8, v101, 4, v8
    v_bfe_u32 v101, v100, 0, 2
    v_lshl_add_u32 v8, v101, 2, v8
    v_bfe_u32 v101, v100, 2, 1
    v_lshl_add_u32 v8, v101, 30, v8
    v_bfe_u32 v101, v100, 3, 1
    v_lshlrev_b32 v101, 30, v101
    v_or_b32 v8, v101, v8
    s_lshl_b32 s24, s16, 6
    s_add_u32 s24, s24, 53086208
    s_add_u32 s29, s24, 8192
    buffer_store_dword v112, v8, s[8:11], s29 offen sc1
    s_add_u32 s29, s24, 16384
    buffer_store_dword v112, v8, s[8:11], s29 offen sc1
    s_add_u32 s29, s24, 24576
    buffer_store_dword v112, v8, s[8:11], s29 offen sc1
    buffer_store_dword v110, v8, s[8:11], s24 offen sc1
    s_waitcnt vmcnt(16)
    s_waitcnt lgkmcnt(0)
    s_barrier
    ds_read_b64_tr_b16 a[48:49], v120 offset:8192
    ds_read_b64_tr_b16 a[50:51], v120 offset:8704
    ds_read_b64_tr_b16 a[52:53], v122 offset:8192
    ds_read_b64_tr_b16 a[54:55], v122 offset:8704
    ds_read_b64_tr_b16 a[56:57], v121 offset:8192
    ds_read_b64_tr_b16 a[58:59], v121 offset:8704
    ds_read_b64_tr_b16 a[60:61], v123 offset:8192
    ds_read_b64_tr_b16 a[62:63], v123 offset:8704
    s_mov_b32 m0, 53248
    s_add_u32 s29, s50, 2228224
    buffer_load_dwordx4 v104, s[52:55], s29 offen  lds
    s_mov_b32 m0, 54272
    s_add_u32 s29, s50, 2260992
    buffer_load_dwordx4 v105, s[52:55], s29 offen  lds
    s_mov_b32 m0, 55296
    s_add_u32 s29, s50, 2293760
    buffer_load_dwordx4 v104, s[52:55], s29 offen  lds
    s_mov_b32 m0, 56320
    s_add_u32 s29, s50, 2326528
    buffer_load_dwordx4 v105, s[52:55], s29 offen  lds
    v_mov_b32 v3, 4096
    v_bfe_u32 v101, v100, 4, 2
    v_lshl_add_u32 v3, v101, 9, v3
    v_bfe_u32 v101, v100, 3, 1
    v_lshl_add_u32 v3, v101, 8, v3
    v_bfe_u32 v101, v100, 0, 3
    v_lshl_add_u32 v3, v101, 4, v3
    s_waitcnt vmcnt(16)
    s_waitcnt lgkmcnt(0)
    s_barrier
    ds_read_b64_tr_b16 a[64:65], v120 offset:12288
    ds_read_b64_tr_b16 a[66:67], v120 offset:12800
    ds_read_b64_tr_b16 a[68:69], v122 offset:12288
    ds_read_b64_tr_b16 a[70:71], v122 offset:12800
    ds_read_b64_tr_b16 a[72:73], v121 offset:12288
    ds_read_b64_tr_b16 a[74:75], v121 offset:12800
    ds_read_b64_tr_b16 a[76:77], v123 offset:12288
    ds_read_b64_tr_b16 a[78:79], v123 offset:12800
    s_mov_b32 m0, 57344
    s_add_u32 s29, s50, 2752512
    buffer_load_dwordx4 v104, s[52:55], s29 offen  lds
    s_mov_b32 m0, 58368
    s_add_u32 s29, s50, 2785280
    buffer_load_dwordx4 v105, s[52:55], s29 offen  lds
    s_mov_b32 m0, 59392
    s_add_u32 s29, s50, 2818048
    buffer_load_dwordx4 v104, s[52:55], s29 offen  lds
    s_mov_b32 m0, 60416
    s_add_u32 s29, s50, 2850816
    buffer_load_dwordx4 v105, s[52:55], s29 offen  lds
    v_mov_b32 v9, 256
    v_bfe_u32 v101, v100, 5, 1
    v_lshl_add_u32 v9, v101, 12, v9
    v_bfe_u32 v101, v100, 4, 1
    v_lshl_add_u32 v9, v101, 10, v9
    v_bfe_u32 v101, v100, 0, 4
    v_lshl_add_u32 v9, v101, 4, v9
    s_waitcnt vmcnt(12)
    s_waitcnt lgkmcnt(0)
    s_barrier
    ds_read_b64_tr_b16 a[80:81], v120 offset:16384
    ds_read_b64_tr_b16 a[82:83], v120 offset:16896
    ds_read_b64_tr_b16 a[84:85], v122 offset:16384
    ds_read_b64_tr_b16 a[86:87], v122 offset:16896
    ds_read_b64_tr_b16 a[88:89], v121 offset:16384
    ds_read_b64_tr_b16 a[90:91], v121 offset:16896
    ds_read_b64_tr_b16 a[92:93], v123 offset:16384
    ds_read_b64_tr_b16 a[94:95], v123 offset:16896
    s_mov_b32 m0, 61440
    s_add_u32 s29, s50, 3276800
    buffer_load_dwordx4 v104, s[52:55], s29 offen  lds
    s_mov_b32 m0, 62464
    s_add_u32 s29, s50, 3309568
    buffer_load_dwordx4 v105, s[52:55], s29 offen  lds
    s_mov_b32 m0, 63488
    s_add_u32 s29, s50, 3342336
    buffer_load_dwordx4 v104, s[52:55], s29 offen  lds
    s_mov_b32 m0, 64512
    s_add_u32 s29, s50, 3375104
    buffer_load_dwordx4 v105, s[52:55], s29 offen  lds
    v_mov_b32 v103, 0
    v_bfe_u32 v101, v100, 0, 2
    v_lshl_add_u32 v103, v101, 2, v103
    v_bfe_u32 v101, v100, 2, 2
    v_lshl_add_u32 v103, v101, 0, v103
    v_and_b32 v102, 1, v103
    v_lshlrev_b32 v102, 4, v102
    v_mov_b32 v101, 0x3f80
    v_lshlrev_b32 v102, v102, v101
    v_lshrrev_b32 v103, 1, v103
    v_cmp_eq_u32 vcc, 0, v103
    s_nop 1
    v_cndmask_b32 v112, 0, v102, vcc
    v_cmp_eq_u32 vcc, 1, v103
    s_nop 1
    v_cndmask_b32 v113, 0, v102, vcc
    v_cmp_eq_u32 vcc, 2, v103
    s_nop 1
    v_cndmask_b32 v114, 0, v102, vcc
    v_cmp_eq_u32 vcc, 3, v103
    s_nop 1
    v_cndmask_b32 v115, 0, v102, vcc
    ds_write_b128 v1, v[112:115] offset:13312
    v_bfe_u32 v101, v100, 1, 1
    v_mul_u32_u24 v101, 0xaaaa, v101
    v_add_u32 v0, 0x4444, v101
    s_waitcnt vmcnt(8)
    s_waitcnt lgkmcnt(0)
    s_barrier
    ds_read_b64_tr_b16 a[96:97], v120 offset:20480
    ds_read_b64_tr_b16 a[98:99], v120 offset:20992
    ds_read_b64_tr_b16 a[100:101], v122 offset:20480
    ds_read_b64_tr_b16 a[102:103], v122 offset:20992
    ds_read_b64_tr_b16 a[104:105], v121 offset:20480
    ds_read_b64_tr_b16 a[106:107], v121 offset:20992
    ds_read_b64_tr_b16 a[108:109], v123 offset:20480
    ds_read_b64_tr_b16 a[110:111], v123 offset:20992
    s_mov_b32 m0, 32768
    s_add_u32 s29, s50, 3801088
    buffer_load_dwordx4 v104, s[52:55], s29 offen  lds
    s_mov_b32 m0, 33792
    s_add_u32 s29, s50, 3833856
    buffer_load_dwordx4 v105, s[52:55], s29 offen  lds
    s_mov_b32 m0, 34816
    s_add_u32 s29, s50, 3866624
    buffer_load_dwordx4 v104, s[52:55], s29 offen  lds
    s_mov_b32 m0, 35840
    s_add_u32 s29, s50, 3899392
    buffer_load_dwordx4 v105, s[52:55], s29 offen  lds
    s_lshl_b32 s18, s16, 14
    s_add_u32 s18, s18, 4096
    s_add_u32 s19, s24, 7733248
    v_mov_b32 v14, v110
    s_mov_b32 s20, 52494336
    s_mov_b32 s17, 0
    s_mov_b32 s28, 0
    s_mov_b32 s32, 0x3e0293ee
    s_mov_b32 s42, 0x3f803f80
    s_mov_b32 s44, 0x3f003f00
    s_mov_b32 s48, 0x33333333
    s_mov_b32 s43, 0x3f803f80
    s_mov_b32 s45, 0x3f003f00
    s_mov_b32 s49, 0x33333333
    s_mov_b32 s34, 0x21800000
    s_mov_b32 s35, 0x3c000000
    s_waitcnt vmcnt(8)
    s_waitcnt lgkmcnt(0)
    s_barrier
    ds_read_b64_tr_b16 a[112:113], v120 offset:24576
    ds_read_b64_tr_b16 a[114:115], v120 offset:25088
    ds_read_b64_tr_b16 a[116:117], v122 offset:24576
    ds_read_b64_tr_b16 a[118:119], v122 offset:25088
    ds_read_b64_tr_b16 a[120:121], v121 offset:24576
    ds_read_b64_tr_b16 a[122:123], v121 offset:25088
    ds_read_b64_tr_b16 a[124:125], v123 offset:24576
    ds_read_b64_tr_b16 a[126:127], v123 offset:25088
    s_mov_b32 m0, 36864
    s_add_u32 s29, s51, 16384
    buffer_load_dwordx4 v108, s[64:67], s29 offen  lds
    s_mov_b32 m0, 37888
    s_add_u32 s29, s51, 20480
    buffer_load_dwordx4 v108, s[64:67], s29 offen  lds
    s_mov_b32 m0, 38912
    s_add_u32 s29, s51, 24576
    buffer_load_dwordx4 v109, s[64:67], s29 offen  lds
    s_mov_b32 m0, 39936
    s_add_u32 s29, s51, 28672
    buffer_load_dwordx4 v109, s[64:67], s29 offen  lds
    v_mov_b32 v126, 131584
    v_bfe_u32 v101, v100, 2, 4
    v_lshl_add_u32 v126, v101, 5, v126
    v_bfe_u32 v101, v100, 0, 1
    v_lshl_add_u32 v126, v101, 4, v126
    v_bfe_u32 v101, v100, 1, 1
    v_lshl_add_u32 v126, v101, 3, v126
    s_waitcnt vmcnt(8)
    s_waitcnt lgkmcnt(0)
    s_barrier
    ds_read_b64_tr_b16 a[128:129], v120 offset:28672
    ds_read_b64_tr_b16 a[130:131], v120 offset:29184
    ds_read_b64_tr_b16 a[132:133], v122 offset:28672
    ds_read_b64_tr_b16 a[134:135], v122 offset:29184
    ds_read_b64_tr_b16 a[136:137], v121 offset:28672
    ds_read_b64_tr_b16 a[138:139], v121 offset:29184
    ds_read_b64_tr_b16 a[140:141], v123 offset:28672
    ds_read_b64_tr_b16 a[142:143], v123 offset:29184
    s_mov_b32 m0, 40960
    s_add_u32 s29, s51, 81920
    buffer_load_dwordx4 v108, s[64:67], s29 offen  lds
    s_mov_b32 m0, 41984
    s_add_u32 s29, s51, 86016
    buffer_load_dwordx4 v108, s[64:67], s29 offen  lds
    s_mov_b32 m0, 43008
    s_add_u32 s29, s51, 90112
    buffer_load_dwordx4 v109, s[64:67], s29 offen  lds
    s_mov_b32 m0, 44032
    s_add_u32 s29, s51, 94208
    buffer_load_dwordx4 v109, s[64:67], s29 offen  lds
    v_mov_b32 v127, 131072
    v_bfe_u32 v101, v100, 2, 4
    v_lshl_add_u32 v127, v101, 5, v127
    v_bfe_u32 v101, v100, 0, 1
    v_lshl_add_u32 v127, v101, 4, v127
    s_waitcnt vmcnt(8)
    s_waitcnt lgkmcnt(0)
    s_barrier
    ds_read_b64_tr_b16 a[144:145], v120 offset:0
    ds_read_b64_tr_b16 a[146:147], v120 offset:512
    ds_read_b64_tr_b16 a[148:149], v122 offset:0
    ds_read_b64_tr_b16 a[150:151], v122 offset:512
    ds_read_b64_tr_b16 a[152:153], v121 offset:0
    ds_read_b64_tr_b16 a[154:155], v121 offset:512
    ds_read_b64_tr_b16 a[156:157], v123 offset:0
    ds_read_b64_tr_b16 a[158:159], v123 offset:512
    s_mov_b32 m0, 45056
    s_add_u32 s29, s51, 16640
    buffer_load_dwordx4 v108, s[64:67], s29 offen  lds
    s_mov_b32 m0, 46080
    s_add_u32 s29, s51, 20736
    buffer_load_dwordx4 v108, s[64:67], s29 offen  lds
    s_mov_b32 m0, 47104
    s_add_u32 s29, s51, 24832
    buffer_load_dwordx4 v109, s[64:67], s29 offen  lds
    s_mov_b32 m0, 48128
    s_add_u32 s29, s51, 28928
    buffer_load_dwordx4 v109, s[64:67], s29 offen  lds
    s_waitcnt vmcnt(8)
    s_waitcnt lgkmcnt(0)
    s_barrier
    ds_read_b64_tr_b16 a[160:161], v124 offset:4096
    ds_read_b64_tr_b16 a[162:163], v124 offset:4608
    ds_read_b64_tr_b16 a[164:165], v124 offset:36864
    ds_read_b64_tr_b16 a[166:167], v124 offset:37376
    ds_read_b64_tr_b16 a[168:169], v125 offset:4096
    ds_read_b64_tr_b16 a[170:171], v125 offset:4608
    ds_read_b64_tr_b16 a[172:173], v125 offset:36864
    ds_read_b64_tr_b16 a[174:175], v125 offset:37376
    s_mov_b32 m0, 49152
    s_add_u32 s29, s51, 82176
    buffer_load_dwordx4 v108, s[64:67], s29 offen  lds
    s_mov_b32 m0, 50176
    s_add_u32 s29, s51, 86272
    buffer_load_dwordx4 v108, s[64:67], s29 offen  lds
    s_mov_b32 m0, 51200
    s_add_u32 s29, s51, 90368
    buffer_load_dwordx4 v109, s[64:67], s29 offen  lds
    s_mov_b32 m0, 52224
    s_add_u32 s29, s51, 94464
    buffer_load_dwordx4 v109, s[64:67], s29 offen  lds
    s_waitcnt vmcnt(8)
    s_waitcnt lgkmcnt(0)
    s_barrier
    ds_read_b64_tr_b16 a[176:177], v124 offset:8192
    ds_read_b64_tr_b16 a[178:179], v124 offset:8704
    ds_read_b64_tr_b16 a[180:181], v124 offset:40960
    ds_read_b64_tr_b16 a[182:183], v124 offset:41472
    ds_read_b64_tr_b16 a[184:185], v125 offset:8192
    ds_read_b64_tr_b16 a[186:187], v125 offset:8704
    ds_read_b64_tr_b16 a[188:189], v125 offset:40960
    ds_read_b64_tr_b16 a[190:191], v125 offset:41472
    s_mov_b32 m0, 53248
    s_add_u32 s29, s51, 16896
    buffer_load_dwordx4 v108, s[64:67], s29 offen  lds
    s_mov_b32 m0, 54272
    s_add_u32 s29, s51, 20992
    buffer_load_dwordx4 v108, s[64:67], s29 offen  lds
    s_mov_b32 m0, 55296
    s_add_u32 s29, s51, 25088
    buffer_load_dwordx4 v109, s[64:67], s29 offen  lds
    s_mov_b32 m0, 56320
    s_add_u32 s29, s51, 29184
    buffer_load_dwordx4 v109, s[64:67], s29 offen  lds
    s_waitcnt vmcnt(8)
    s_waitcnt lgkmcnt(0)
    s_barrier
    ds_read_b64_tr_b16 a[192:193], v124 offset:12288
    ds_read_b64_tr_b16 a[194:195], v124 offset:12800
    ds_read_b64_tr_b16 a[196:197], v124 offset:45056
    ds_read_b64_tr_b16 a[198:199], v124 offset:45568
    ds_read_b64_tr_b16 a[200:201], v125 offset:12288
    ds_read_b64_tr_b16 a[202:203], v125 offset:12800
    ds_read_b64_tr_b16 a[204:205], v125 offset:45056
    ds_read_b64_tr_b16 a[206:207], v125 offset:45568
    s_mov_b32 m0, 57344
    s_add_u32 s29, s51, 82432
    buffer_load_dwordx4 v108, s[64:67], s29 offen  lds
    s_mov_b32 m0, 58368
    s_add_u32 s29, s51, 86528
    buffer_load_dwordx4 v108, s[64:67], s29 offen  lds
    s_mov_b32 m0, 59392
    s_add_u32 s29, s51, 90624
    buffer_load_dwordx4 v109, s[64:67], s29 offen  lds
    s_mov_b32 m0, 60416
    s_add_u32 s29, s51, 94720
    buffer_load_dwordx4 v109, s[64:67], s29 offen  lds
    s_waitcnt vmcnt(8)
    s_waitcnt lgkmcnt(0)
    s_barrier
    ds_read_b64_tr_b16 a[208:209], v124 offset:16384
    ds_read_b64_tr_b16 a[210:211], v124 offset:16896
    ds_read_b64_tr_b16 a[212:213], v124 offset:49152
    ds_read_b64_tr_b16 a[214:215], v124 offset:49664
    ds_read_b64_tr_b16 a[216:217], v125 offset:16384
    ds_read_b64_tr_b16 a[218:219], v125 offset:16896
    ds_read_b64_tr_b16 a[220:221], v125 offset:49152
    ds_read_b64_tr_b16 a[222:223], v125 offset:49664
    s_mov_b32 m0, 61440
    s_add_u32 s29, s50, 1703936
    buffer_load_dwordx4 v104, s[52:55], s29 offen  lds
    s_mov_b32 m0, 62464
    s_add_u32 s29, s50, 1736704
    buffer_load_dwordx4 v105, s[52:55], s29 offen  lds
    s_mov_b32 m0, 63488
    s_add_u32 s29, s50, 1769472
    buffer_load_dwordx4 v104, s[52:55], s29 offen  lds
    s_mov_b32 m0, 64512
    s_add_u32 s29, s50, 1802240
    buffer_load_dwordx4 v105, s[52:55], s29 offen  lds
    v_mov_b32 v118, 0
    s_mov_b64 exec, 1
    global_load_dwordx2 v[114:115], v118, s[6:7] offset:128 sc1
    s_mov_b64 exec, -1
    s_waitcnt vmcnt(9)
    s_waitcnt lgkmcnt(0)
    s_barrier
    ds_read_b64_tr_b16 a[224:225], v124 offset:20480
    ds_read_b64_tr_b16 a[226:227], v124 offset:20992
    ds_read_b64_tr_b16 a[228:229], v124 offset:53248
    ds_read_b64_tr_b16 a[230:231], v124 offset:53760
    ds_read_b64_tr_b16 a[232:233], v125 offset:20480
    ds_read_b64_tr_b16 a[234:235], v125 offset:20992
    ds_read_b64_tr_b16 a[236:237], v125 offset:53248
    ds_read_b64_tr_b16 a[238:239], v125 offset:53760
    s_mov_b32 m0, 32768
    s_add_u32 s29, s50, 131072
    buffer_load_dwordx4 v104, s[52:55], s29 offen  lds
    s_mov_b32 m0, 33792
    s_add_u32 s29, s50, 163840
    buffer_load_dwordx4 v105, s[52:55], s29 offen  lds
    s_mov_b32 m0, 34816
    s_add_u32 s29, s50, 196608
    buffer_load_dwordx4 v104, s[52:55], s29 offen  lds
    s_mov_b32 m0, 35840
    s_add_u32 s29, s50, 229376
    buffer_load_dwordx4 v105, s[52:55], s29 offen  lds
    s_waitcnt vmcnt(9)
    s_waitcnt lgkmcnt(0)
    s_barrier
    ds_read_b64_tr_b16 a[240:241], v124 offset:24576
    ds_read_b64_tr_b16 a[242:243], v124 offset:25088
    ds_read_b64_tr_b16 a[244:245], v124 offset:57344
    ds_read_b64_tr_b16 a[246:247], v124 offset:57856
    ds_read_b64_tr_b16 a[248:249], v125 offset:24576
    ds_read_b64_tr_b16 a[250:251], v125 offset:25088
    ds_read_b64_tr_b16 a[252:253], v125 offset:57344
    ds_read_b64_tr_b16 a[254:255], v125 offset:57856
    s_mov_b32 m0, 36864
    s_add_u32 s29, s50, 655360
    buffer_load_dwordx4 v104, s[52:55], s29 offen  lds
    s_mov_b32 m0, 37888
    s_add_u32 s29, s50, 688128
    buffer_load_dwordx4 v105, s[52:55], s29 offen  lds
    s_mov_b32 m0, 38912
    s_add_u32 s29, s50, 720896
    buffer_load_dwordx4 v104, s[52:55], s29 offen  lds
    s_mov_b32 m0, 39936
    s_add_u32 s29, s50, 753664
    buffer_load_dwordx4 v105, s[52:55], s29 offen  lds
    s_waitcnt vmcnt(9)
    s_waitcnt lgkmcnt(0)
    s_barrier
    ds_read_b64_tr_b16 v[32:33], v120 offset:28672
    ds_read_b64_tr_b16 v[34:35], v120 offset:29184
    ds_read_b64_tr_b16 v[36:37], v122 offset:28672
    ds_read_b64_tr_b16 v[38:39], v122 offset:29184
    ds_read_b64_tr_b16 v[40:41], v121 offset:28672
    ds_read_b64_tr_b16 v[42:43], v121 offset:29184
    ds_read_b64_tr_b16 v[44:45], v123 offset:28672
    ds_read_b64_tr_b16 v[46:47], v123 offset:29184
    s_mov_b32 m0, 40960
    s_add_u32 s29, s50, 1179648
    buffer_load_dwordx4 v104, s[52:55], s29 offen  lds
    s_mov_b32 m0, 41984
    s_add_u32 s29, s50, 1212416
    buffer_load_dwordx4 v105, s[52:55], s29 offen  lds
    s_mov_b32 m0, 43008
    s_add_u32 s29, s50, 1245184
    buffer_load_dwordx4 v104, s[52:55], s29 offen  lds
    s_mov_b32 m0, 44032
    s_add_u32 s29, s50, 1277952
    buffer_load_dwordx4 v105, s[52:55], s29 offen  lds
    s_waitcnt vmcnt(8)
    s_waitcnt lgkmcnt(0)
    s_barrier
    ds_read_b64_tr_b16 v[16:17], v120 offset:0
    ds_read_b64_tr_b16 v[18:19], v120 offset:512
    ds_read_b64_tr_b16 v[20:21], v122 offset:0
    ds_read_b64_tr_b16 v[22:23], v122 offset:512
    ds_read_b64_tr_b16 v[24:25], v121 offset:0
    ds_read_b64_tr_b16 v[26:27], v121 offset:512
    ds_read_b64_tr_b16 v[28:29], v123 offset:0
    ds_read_b64_tr_b16 v[30:31], v123 offset:512
    ds_write_b128 v1, v[32:35] offset:20480
    ds_write_b128 v1, v[36:39] offset:21504
    ds_write_b128 v1, v[40:43] offset:22528
    ds_write_b128 v1, v[44:47] offset:23552
    s_mov_b32 m0, 45056
    s_add_u32 s29, s50, 131072
    buffer_load_dwordx4 v104, s[56:59], s29 offen  lds
    s_mov_b32 m0, 46080
    s_add_u32 s29, s50, 163840
    buffer_load_dwordx4 v105, s[56:59], s29 offen  lds
    s_mov_b32 m0, 47104
    s_add_u32 s29, s50, 196608
    buffer_load_dwordx4 v104, s[56:59], s29 offen  lds
    s_mov_b32 m0, 48128
    s_add_u32 s29, s50, 229376
    buffer_load_dwordx4 v105, s[56:59], s29 offen  lds
    s_waitcnt vmcnt(8)
    s_waitcnt lgkmcnt(0)
    s_barrier
    ds_read_b64_tr_b16 v[32:33], v120 offset:4096
    ds_read_b64_tr_b16 v[34:35], v120 offset:4608
    ds_read_b64_tr_b16 v[36:37], v122 offset:4096
    ds_read_b64_tr_b16 v[38:39], v122 offset:4608
    ds_read_b64_tr_b16 v[40:41], v121 offset:4096
    ds_read_b64_tr_b16 v[42:43], v121 offset:4608
    ds_read_b64_tr_b16 v[44:45], v123 offset:4096
    ds_read_b64_tr_b16 v[46:47], v123 offset:4608
    ds_write_b128 v2, v[16:19] offset:0
    ds_write_b128 v2, v[20:23] offset:1024
    ds_write_b128 v2, v[24:27] offset:2048
    ds_write_b128 v2, v[28:31] offset:3072
    s_mov_b32 m0, 49152
    s_add_u32 s29, s50, 655360
    buffer_load_dwordx4 v104, s[56:59], s29 offen  lds
    s_mov_b32 m0, 50176
    s_add_u32 s29, s50, 688128
    buffer_load_dwordx4 v105, s[56:59], s29 offen  lds
    s_mov_b32 m0, 51200
    s_add_u32 s29, s50, 720896
    buffer_load_dwordx4 v104, s[56:59], s29 offen  lds
    s_mov_b32 m0, 52224
    s_add_u32 s29, s50, 753664
    buffer_load_dwordx4 v105, s[56:59], s29 offen  lds
    s_mov_b32 s27, 0
Tln_1:
    v_and_b32 v114, v114, v115
    s_nop 0
    v_readfirstlane_b32 s39, v114
    s_nop 3
    s_cmp_eq_u32 s39, -1
    s_cbranch_scc1 Tlnd_1
    v_mov_b32 v118, 0
    s_mov_b64 exec, 1
    global_load_dwordx2 v[114:115], v118, s[6:7] offset:128 sc1
    s_mov_b64 exec, -1
    s_waitcnt vmcnt(0)
    s_add_u32 s27, s27, 1
    s_cmp_lt_u32 s27, 400000
    s_cbranch_scc1 Tln_1
Tlnd_1:
    s_waitcnt vmcnt(8)
    s_waitcnt lgkmcnt(0)
    s_barrier
    ds_read_b64_tr_b16 v[16:17], v120 offset:8192
    ds_read_b64_tr_b16 v[18:19], v120 offset:8704
    ds_read_b64_tr_b16 v[20:21], v122 offset:8192
    ds_read_b64_tr_b16 v[22:23], v122 offset:8704
    ds_read_b64_tr_b16 v[24:25], v121 offset:8192
    ds_read_b64_tr_b16 v[26:27], v121 offset:8704
    ds_read_b64_tr_b16 v[28:29], v123 offset:8192
    ds_read_b64_tr_b16 v[30:31], v123 offset:8704
    ds_write_b128 v2, v[32:35] offset:4096
    ds_write_b128 v2, v[36:39] offset:5120
    ds_write_b128 v2, v[40:43] offset:6144
    ds_write_b128 v2, v[44:47] offset:7168
    s_mov_b32 m0, 53248
    s_add_u32 s29, s50, 1179648
    buffer_load_dwordx4 v104, s[56:59], s29 offen  lds
    s_mov_b32 m0, 54272
    s_add_u32 s29, s50, 1212416
    buffer_load_dwordx4 v105, s[56:59], s29 offen  lds
    s_mov_b32 m0, 55296
    s_add_u32 s29, s50, 1245184
    buffer_load_dwordx4 v104, s[56:59], s29 offen  lds
    s_mov_b32 m0, 56320
    s_add_u32 s29, s50, 1277952
    buffer_load_dwordx4 v105, s[56:59], s29 offen  lds
    v_mov_b32 v118, 0
    v_lshlrev_b32 v119, 12, v100
    s_lshl_b32 s38, s16, 7
    s_add_u32 s38, s38, 58720260
    s_mov_b64 exec, 1
    global_load_dwordx2 v[116:117], v118, s[6:7] sc1
    s_mov_b64 exec, 3
    buffer_load_dword v113, v119, s[8:11], s38 offen sc1
    s_mov_b64 exec, -1
    s_waitcnt vmcnt(10)
    s_waitcnt lgkmcnt(0)
    s_barrier
    ds_read_b64_tr_b16 v[32:33], v120 offset:12288
    ds_read_b64_tr_b16 v[34:35], v120 offset:12800
    ds_read_b64_tr_b16 v[36:37], v122 offset:12288
    ds_read_b64_tr_b16 v[38:39], v122 offset:12800
    ds_read_b64_tr_b16 v[40:41], v121 offset:12288
    ds_read_b64_tr_b16 v[42:43], v121 offset:12800
    ds_read_b64_tr_b16 v[44:45], v123 offset:12288
    ds_read_b64_tr_b16 v[46:47], v123 offset:12800
    ds_write_b128 v2, v[16:19] offset:8192
    ds_write_b128 v2, v[20:23] offset:9216
    ds_write_b128 v2, v[24:27] offset:10240
    ds_write_b128 v2, v[28:31] offset:11264
    s_mov_b32 m0, 57344
    s_add_u32 s29, s51, 17152
    buffer_load_dwordx4 v108, s[64:67], s29 offen  lds
    s_mov_b32 m0, 58368
    s_add_u32 s29, s51, 21248
    buffer_load_dwordx4 v108, s[64:67], s29 offen  lds
    s_mov_b32 m0, 59392
    s_add_u32 s29, s51, 25344
    buffer_load_dwordx4 v109, s[64:67], s29 offen  lds
    s_mov_b32 m0, 60416
    s_add_u32 s29, s51, 29440
    buffer_load_dwordx4 v109, s[64:67], s29 offen  lds
    s_waitcnt vmcnt(10)
    s_waitcnt lgkmcnt(0)
    s_barrier
    ds_read_b64_tr_b16 v[16:17], v120 offset:16384
    ds_read_b64_tr_b16 v[18:19], v120 offset:16896
    ds_read_b64_tr_b16 v[20:21], v122 offset:16384
    ds_read_b64_tr_b16 v[22:23], v122 offset:16896
    ds_read_b64_tr_b16 v[24:25], v121 offset:16384
    ds_read_b64_tr_b16 v[26:27], v121 offset:16896
    ds_read_b64_tr_b16 v[28:29], v123 offset:16384
    ds_read_b64_tr_b16 v[30:31], v123 offset:16896
    ds_write_b128 v2, v[32:35] offset:12288
    ds_write_b128 v2, v[36:39] offset:13312
    ds_write_b128 v2, v[40:43] offset:14336
    ds_write_b128 v2, v[44:47] offset:15360
    s_mov_b32 m0, 61440
    s_add_u32 s29, s51, 82688
    buffer_load_dwordx4 v108, s[64:67], s29 offen  lds
    s_mov_b32 m0, 62464
    s_add_u32 s29, s51, 86784
    buffer_load_dwordx4 v108, s[64:67], s29 offen  lds
    s_mov_b32 m0, 63488
    s_add_u32 s29, s51, 90880
    buffer_load_dwordx4 v109, s[64:67], s29 offen  lds
    s_mov_b32 m0, 64512
    s_add_u32 s29, s51, 94976
    buffer_load_dwordx4 v109, s[64:67], s29 offen  lds
    s_waitcnt vmcnt(10)
    s_waitcnt lgkmcnt(0)
    s_barrier
    ds_read_b64_tr_b16 v[32:33], v120 offset:20480
    ds_read_b64_tr_b16 v[34:35], v120 offset:20992
    ds_read_b64_tr_b16 v[36:37], v122 offset:20480
    ds_read_b64_tr_b16 v[38:39], v122 offset:20992
    ds_read_b64_tr_b16 v[40:41], v121 offset:20480
    ds_read_b64_tr_b16 v[42:43], v121 offset:20992
    ds_read_b64_tr_b16 v[44:45], v123 offset:20480
    ds_read_b64_tr_b16 v[46:47], v123 offset:20992
    ds_write_b128 v2, v[16:19] offset:16384
    ds_write_b128 v2, v[20:23] offset:17408
    ds_write_b128 v2, v[24:27] offset:18432
    ds_write_b128 v2, v[28:31] offset:19456
    s_mov_b32 s27, 0
    s_waitcnt vmcnt(8)
Tmeet_1:
    v_sad_u8 v112, v116, 0, 0
    v_sad_u8 v112, v117, 0, v112
    v_cmp_eq_u32 vcc, 1, v113
    v_readfirstlane_b32 s40, v112
    v_readfirstlane_b32 s36, v116
    v_readfirstlane_b32 s37, v117
    s_nop 3
    s_xor_b32 s40, s40, 32
    s_andn2_b32 s39, 3, vcc_lo
    s_or_b32 s40, s40, s39
    s_cbranch_scc0 Tmet_1
    v_mov_b32 v118, 0
    v_lshlrev_b32 v119, 12, v100
    s_lshl_b32 s38, s16, 7
    s_add_u32 s38, s38, 58720260
    s_mov_b64 exec, 1
    global_load_dwordx2 v[116:117], v118, s[6:7] sc1
    s_mov_b64 exec, 3
    buffer_load_dword v113, v119, s[8:11], s38 offen sc1
    s_mov_b64 exec, -1
    s_waitcnt vmcnt(0)
    s_add_u32 s27, s27, 1
    s_cmp_lt_u32 s27, 400000
    s_cbranch_scc1 Tmeet_1
Tmet_1:
    s_getreg_b32 s38, hwreg(HW_REG_XCC_ID, 0, 3)
    s_lshl_b32 s38, s38, 3
    s_lshl_b64 s[38:39], 32, s38
    s_cmp_eq_u64 s[36:37], s[38:39]
    s_cselect_b32 s41, 1, 0
    s_add_u32 s33, s18, 8192
    buffer_load_dwordx4 v[128:131], v9, s[8:11], s18 offen sc1
    buffer_load_dwordx4 v[132:135], v9, s[8:11], s33 offen sc1
    buffer_load_dwordx4 v[136:139], v3, s[8:11], s18 offen offset:2048 sc1
    buffer_load_dwordx4 v[140:143], v3, s[8:11], s18 offen offset:2176 sc1
    v_and_b32 v112, 15, v100
    v_lshlrev_b32 v112, 7, v112
    v_lshrrev_b32 v113, 4, v100
    v_lshl_add_u32 v114, v113, 13, v112
    s_mov_b32 s38, 53086208
    buffer_load_dword v114, v114, s[8:11], s38 offen sc1
    v_and_b32 v113, 1, v113
    v_lshl_add_u32 v115, v113, 18, v112
    s_add_u32 s38, s22, 131072
    buffer_load_dword v115, v115, s[8:11], s38 offen sc1
    s_waitcnt vmcnt(10)
    s_waitcnt lgkmcnt(0)
    s_barrier
    ds_read_b64_tr_b16 v[16:17], v124 offset:24576
    ds_read_b64_tr_b16 v[18:19], v124 offset:25088
    ds_read_b64_tr_b16 v[20:21], v124 offset:57344
    ds_read_b64_tr_b16 v[22:23], v124 offset:57856
    ds_read_b64_tr_b16 v[24:25], v125 offset:24576
    ds_read_b64_tr_b16 v[26:27], v125 offset:25088
    ds_read_b64_tr_b16 v[28:29], v125 offset:57344
    ds_read_b64_tr_b16 v[30:31], v125 offset:57856
    ds_write_b128 v2, v[32:35] offset:20480
    ds_write_b128 v2, v[36:39] offset:21504
    ds_write_b128 v2, v[40:43] offset:22528
    ds_write_b128 v2, v[44:47] offset:23552
    s_waitcnt vmcnt(6)
    s_waitcnt lgkmcnt(0)
    s_barrier
    ds_read_b64_tr_b16 v[32:33], v124 offset:28672
    ds_read_b64_tr_b16 v[34:35], v124 offset:29184
    ds_read_b64_tr_b16 v[36:37], v124 offset:61440
    ds_read_b64_tr_b16 v[38:39], v124 offset:61952
    ds_read_b64_tr_b16 v[40:41], v125 offset:28672
    ds_read_b64_tr_b16 v[42:43], v125 offset:29184
    ds_read_b64_tr_b16 v[44:45], v125 offset:61440
    ds_read_b64_tr_b16 v[46:47], v125 offset:61952
    ds_write_b128 v2, v[16:19] offset:24576
    ds_write_b128 v2, v[20:23] offset:25600
    ds_write_b128 v2, v[24:27] offset:26624
    ds_write_b128 v2, v[28:31] offset:27648
    s_waitcnt lgkmcnt(0)
    s_barrier
    ds_write_b128 v2, v[32:35] offset:28672
    ds_write_b128 v2, v[36:39] offset:29696
    ds_write_b128 v2, v[40:43] offset:30720
    ds_write_b128 v2, v[44:47] offset:31744
    s_waitcnt lgkmcnt(0)
    s_waitcnt vmcnt(0)
    s_cmp_eq_u32 s41, 0
    s_cbranch_scc1 Tslow_1
Tfast_1:
    s_mov_b32 s27, 0
    s_mov_b32 s46, 0
    v_mov_b32 v13, -1
    v_mov_b64 v[122:123], s[42:43]
    v_mov_b64 v[124:125], s[42:43]
    v_mov_b64 v[120:121], s[44:45]
    s_mov_b32 s26, 52955136
    s_add_u32 s21, s20, 4096
    s_lshl_b32 s54, s16, 7
    s_add_u32 s54, s54, 58720260
    s_add_u32 s51, s54, 4096
    s_add_u32 s18, s18, 524288
    s_add_u32 s33, s18, 8192
    s_add_u32 s51, s51, 4096
    v_mov_b64 v[72:73], v[128:129]
    ds_read_b128 v[32:35], v2 offset:0
    v_mov_b64 v[74:75], v[130:131]
    ds_read_b128 v[36:39], v2 offset:1024
    v_mov_b64 v[76:77], v[132:133]
    ds_read_b128 v[88:91], v2 offset:6144
    v_mov_b64 v[78:79], v[134:135]
    ds_read_b128 v[92:95], v2 offset:7168
    v_mov_b64 v[80:81], v[136:137]
    ds_read_b128 v[96:99], v2 offset:8192
    v_mov_b64 v[82:83], v[138:139]
    ds_read_b128 v[100:103], v2 offset:9216
    v_mov_b64 v[84:85], v[140:141]
    ds_read_b128 v[104:107], v2 offset:10240
    v_mov_b64 v[86:87], v[142:143]
    ds_read_b128 v[108:111], v2 offset:11264
    v_mov_b64 v[48:49], 0
    ds_read_b128 v[112:115], v1 offset:20480
    v_mov_b64 v[50:51], 0
    ds_read_b128 v[116:119], v1 offset:21504
    v_mov_b64 v[52:53], 0
    ds_read_b128 v[64:67], v1 offset:22528
    v_mov_b64 v[54:55], 0
    ds_read_b128 v[68:71], v1 offset:23552
    v_mov_b64 v[56:57], 0
    ds_read_b128 v[128:131], v2 offset:2048
    v_mov_b64 v[58:59], 0
    ds_read_b128 v[132:135], v2 offset:3072
    v_mov_b64 v[60:61], 0
    ds_read_b128 v[136:139], v2 offset:4096
    v_mov_b64 v[62:63], 0
    ds_read_b128 v[140:143], v2 offset:5120
    s_branch Tstep_1
.p2align 6
Tstep_1:
    buffer_load_dwordx4 v[40:43], v1, s[8:11], s26 offen offset:0 sc1
    buffer_load_dwordx4 v[44:47], v1, s[8:11], s26 offen offset:1024 sc1
    s_waitcnt vmcnt(1)
    v_max3_u32 v11, v40, v41, v42
    v_max_u32 v11, v11, v43
    ds_write_b128 v1, v[40:43] offset:2048
    s_waitcnt vmcnt(0)
    v_max3_u32 v11, v11, v44, v45
    v_max3_u32 v11, v11, v46, v47
    v_cmp_eq_u32 vcc, -1, v11
    ds_write_b128 v1, v[44:47] offset:3072
    s_cbranch_vccnz Tr2_1
Tok2_1:
    s_barrier
    ds_read_b128 v[16:19], v1 offset:0
    ds_read_b128 v[20:23], v1 offset:1024
    buffer_store_dword v14, v8, s[8:11], s19 offen sc1
    s_waitcnt lgkmcnt(2)
    s_barrier
    ds_read_b128 v[24:27], v1 offset:2048
    ds_read_b128 v[28:31], v1 offset:3072
    s_waitcnt lgkmcnt(3)
    v_smfmac_f32_16x16x64_bf16 v[48:51], v[16:19], v[32:39], v0
    ds_read_b128 v[32:35], v1 offset:4096
    v_smfmac_f32_16x16x64_bf16 v[52:55], v[16:19], v[128:135], v0
    ds_read_b128 v[36:39], v1 offset:5120
    s_waitcnt lgkmcnt(4)
    v_smfmac_f32_16x16x64_bf16 v[48:51], v[20:23], v[136:143], v0
    buffer_load_dwordx4 v[128:131], v9, s[8:11], s18 offen sc1
    v_smfmac_f32_16x16x64_bf16 v[52:55], v[20:23], v[88:95], v0
    ds_read_b128 v[40:43], v1 offset:6144
    s_waitcnt lgkmcnt(4)
    v_smfmac_f32_16x16x64_bf16 v[48:51], v[24:27], v[96:103], v0
    ds_read_b128 v[44:47], v1 offset:7168
    s_waitcnt lgkmcnt(3)
    v_smfmac_f32_16x16x64_bf16 v[48:51], v[28:31], v[112:119], v0
    buffer_load_dwordx4 v[132:135], v9, s[8:11], s33 offen sc1
    v_smfmac_f32_16x16x64_bf16 v[48:51], v[32:35], a[96:103], v0
    ds_read_b128 v[88:91], v2 offset:12288
    s_waitcnt lgkmcnt(3)
    v_smfmac_f32_16x16x64_bf16 v[48:51], v[36:39], a[112:119], v0
    buffer_load_dwordx4 v[136:139], v3, s[8:11], s18 offen offset:2048 sc1
    s_waitcnt lgkmcnt(2)
    v_smfmac_f32_16x16x64_bf16 v[48:51], v[40:43], a[128:135], v0
    ds_read_b128 v[92:95], v2 offset:13312
    s_waitcnt lgkmcnt(2)
    v_smfmac_f32_16x16x64_bf16 v[48:51], v[44:47], a[144:151], v0
    buffer_load_dwordx4 v[140:143], v3, s[8:11], s18 offen offset:2176 sc1
    v_smfmac_f32_16x16x64_bf16 v[52:55], v[24:27], v[104:111], v0
    s_nop 1
    s_waitcnt lgkmcnt(1)
    v_smfmac_f32_16x16x64_bf16 v[52:55], v[28:31], v[64:71], v0
    s_nop 1
    v_add_f32 v48, v48, v50
    v_smfmac_f32_16x16x64_bf16 v[52:55], v[32:35], a[104:111], v0
    ds_read_b128 v[96:99], v2 offset:16384
    v_add_f32 v49, v49, v51
    v_smfmac_f32_16x16x64_bf16 v[52:55], v[36:39], a[120:127], v0
    ds_read_b128 v[100:103], v2 offset:17408
    v_mul_f32 v48, s32, v48
    v_smfmac_f32_16x16x64_bf16 v[52:55], v[40:43], a[136:143], v0
    ds_read_b128 v[104:107], v2 offset:20480
    v_mul_f32 v49, s32, v49
    v_smfmac_f32_16x16x64_bf16 v[52:55], v[44:47], a[152:159], v0
    s_nop 0
    s_waitcnt lgkmcnt(3)
    v_cvt_pk_bf16_f32 v48, v48, v49
    v_smfmac_f32_16x16x64_bf16 v[56:59], v[28:31], v[144:151], v0
    ds_write_b32 v4, v48 offset:0
    v_smfmac_f32_16x16x64_bf16 v[56:59], v[32:35], v[160:167], v0
    s_waitcnt lgkmcnt(2)
    s_nop 0
    v_add_f32 v52, v52, v54
    v_smfmac_f32_16x16x64_bf16 v[56:59], v[16:19], v[88:95], v0
    ds_read_b128 v[108:111], v2 offset:21504
    v_add_f32 v53, v53, v55
    v_mul_f32 v52, s32, v52
    v_smfmac_f32_16x16x64_bf16 v[56:59], v[20:23], v[96:103], v0
    ds_read_b128 v[112:115], v2 offset:14336
    v_mul_f32 v53, s32, v53
    v_smfmac_f32_16x16x64_bf16 v[56:59], v[36:39], v[176:183], v0
    ds_read_b128 v[116:119], v2 offset:15360
    v_cvt_pk_bf16_f32 v52, v52, v53
    v_smfmac_f32_16x16x64_bf16 v[56:59], v[40:43], v[192:199], v0
    ds_write_b32 v4, v52 offset:256
    v_smfmac_f32_16x16x64_bf16 v[56:59], v[44:47], v[208:215], v0
    ds_read_b128 v[88:91], v2 offset:18432
    s_waitcnt lgkmcnt(4)
    v_smfmac_f32_16x16x64_bf16 v[56:59], v[24:27], v[104:111], v0
    ds_read_b128 v[92:95], v2 offset:19456
    s_waitcnt lgkmcnt(4)
    v_smfmac_f32_16x16x64_bf16 v[60:63], v[28:31], v[152:159], v0
    ds_read_b128 v[96:99], v2 offset:22528
    ds_read_b128 v[100:103], v2 offset:23552
    v_smfmac_f32_16x16x64_bf16 v[60:63], v[32:35], v[168:175], v0
    s_waitcnt lgkmcnt(4)
    s_barrier
    v_smfmac_f32_16x16x64_bf16 v[60:63], v[36:39], v[184:191], v0
    ds_read_b64_tr_b16 v[104:105], v5 offset:0
    v_add_f32 v56, v56, v58
    v_smfmac_f32_16x16x64_bf16 v[60:63], v[40:43], v[200:207], v0
    ds_read_b64_tr_b16 v[106:107], v5 offset:256
    v_add_f32 v57, v57, v59
    v_smfmac_f32_16x16x64_bf16 v[60:63], v[44:47], v[216:223], v0
    ds_read_b64_tr_b16 v[108:109], v5 offset:2048
    v_cvt_pk_bf16_f32 v56, v56, v57
    v_smfmac_f32_16x16x64_bf16 v[60:63], v[16:19], v[112:119], v0
    ds_read_b64_tr_b16 v[110:111], v5 offset:2304
    s_waitcnt lgkmcnt(4)
    v_mov_b64 v[64:65], 0
    v_smfmac_f32_16x16x64_bf16 v[60:63], v[20:23], v[88:95], v0
    ds_write_b32 v4, v56 offset:512
    v_smfmac_f32_16x16x64_bf16 v[60:63], v[24:27], v[96:103], v0
    s_waitcnt lgkmcnt(3)
    v_mov_b64 v[66:67], 0
    v_mfma_f32_16x16x32_bf16 v[48:51], v[72:75], v[104:107], 0
    s_waitcnt lgkmcnt(1)
    v_mov_b64 v[68:69], 0
    v_mov_b64 v[70:71], 0
    v_mfma_f32_16x16x32_bf16 v[48:51], v[76:79], v[108:111], v[48:51]
    s_nop 0
    v_add_f32 v60, v60, v62
    v_add_f32 v61, v61, v63
    v_cvt_pk_bf16_f32 v60, v60, v61
    v_smfmac_f32_16x16x64_bf16 v[64:67], v[28:31], a[16:23], v0
    ds_write_b32 v4, v60 offset:768
    v_smfmac_f32_16x16x64_bf16 v[64:67], v[24:27], a[0:7], v0
    s_waitcnt lgkmcnt(1)
    v_add_f32_dpp v48, v50, v48 quad_perm:[2,3,0,1] row_mask:0xf bank_mask:0xf
    v_smfmac_f32_16x16x64_bf16 v[64:67], v[20:23], v[240:247], v0
    v_add_f32_dpp v49, v51, v49 quad_perm:[2,3,0,1] row_mask:0xf bank_mask:0xf
    v_smfmac_f32_16x16x64_bf16 v[64:67], v[16:19], v[224:231], v0
    v_exp_f32 v50, v48
    v_smfmac_f32_16x16x64_bf16 v[64:67], v[32:35], a[32:39], v0
    s_waitcnt lgkmcnt(0)
    s_barrier
    v_smfmac_f32_16x16x64_bf16 v[64:67], v[36:39], a[48:55], v0
    ds_read_b64_tr_b16 v[112:113], v5 offset:512
    v_exp_f32 v51, v49
    v_smfmac_f32_16x16x64_bf16 v[64:67], v[40:43], a[64:71], v0
    ds_read_b64_tr_b16 v[114:115], v5 offset:768
    v_cvt_pk_bf16_f32 v50, v50, v51
    v_smfmac_f32_16x16x64_bf16 v[64:67], v[44:47], a[80:87], v0
    ds_read_b64_tr_b16 v[116:117], v5 offset:2560
    v_smfmac_f32_16x16x64_bf16 v[68:71], v[28:31], a[24:31], v0
    ds_read_b64_tr_b16 v[118:119], v5 offset:2816
    v_smfmac_f32_16x16x64_bf16 v[68:71], v[24:27], a[8:15], v0
    ds_write_b32 v12, v50
    s_waitcnt lgkmcnt(3)
    v_mfma_f32_16x16x32_bf16 v[52:55], v[112:115], v[104:107], 0
    s_nop 0
    v_cvt_pk_bf16_f32 v60, v64, v65
    v_cvt_pk_bf16_f32 v61, v66, v67
    v_smfmac_f32_16x16x64_bf16 v[68:71], v[20:23], v[248:255], v0
    s_waitcnt lgkmcnt(1)
    v_mov_b64 v[30:31], 0
    v_mfma_f32_16x16x32_bf16 v[52:55], v[116:119], v[108:111], v[52:55]
    s_nop 0
    v_mov_b64 v[26:27], 0
    v_mov_b64 v[24:25], 0
    v_smfmac_f32_16x16x64_bf16 v[68:71], v[16:19], v[232:239], v0
    s_waitcnt lgkmcnt(0)
    s_barrier
    v_smfmac_f32_16x16x64_bf16 v[68:71], v[32:35], a[40:47], v0
    ds_read_b128 v[56:59], v6 offset:12288
    v_add_f32_dpp v52, v54, v52 quad_perm:[2,3,0,1] row_mask:0xf bank_mask:0xf
    v_smfmac_f32_16x16x64_bf16 v[68:71], v[36:39], a[56:63], v0
    ds_read_b128 v[104:107], v2 offset:26624
    v_add_f32_dpp v53, v55, v53 quad_perm:[2,3,0,1] row_mask:0xf bank_mask:0xf
    v_smfmac_f32_16x16x64_bf16 v[68:71], v[40:43], a[72:79], v0
    ds_read_b128 v[108:111], v2 offset:27648
    v_exp_f32_dpp v54, v52 quad_perm:[0,1,0,1] row_mask:0xf bank_mask:0xf
    v_smfmac_f32_16x16x64_bf16 v[68:71], v[44:47], a[88:95], v0
    s_nop 0
    s_waitcnt lgkmcnt(2)
    v_exp_f32_dpp v55, v53 quad_perm:[0,1,0,1] row_mask:0xf bank_mask:0xf
Tsm_1:
    v_mfma_f32_16x16x32_bf16 v[88:91], v[122:125], v[56:59], 0
    v_cvt_pk_bf16_f32 v28, v54, v55
    v_cvt_pk_bf16_f32 v29, v54, v55
    v_mfma_f32_16x16x32_bf16 v[96:99], v[80:83], v[56:59], 0
    s_nop 0
    v_cvt_pk_bf16_f32 v62, v68, v69
    v_cvt_pk_bf16_f32 v63, v70, v71
    v_mfma_f32_16x16x32_bf16 v[88:91], v[120:123], v[28:31], v[88:91]
    s_nop 0
    v_mov_b64 v[16:17], 0
    v_mov_b64 v[18:19], 0
    v_mfma_f32_16x16x32_bf16 v[96:99], v[60:63], v[28:31], v[96:99]
    s_nop 0
    v_mov_b64 v[20:21], 0
    v_mov_b64 v[22:23], 0
    v_mfma_f32_16x16x32_bf16 v[100:103], v[84:87], v[56:59], 0
    s_nop 0
    v_rcp_f32 v14, v88
    v_mfma_f32_16x16x32_bf16 v[100:103], v[60:63], v[26:29], v[100:103]
    s_nop 0
    v_mul_f32 v96, v96, v14
    v_mul_f32 v97, v97, v14
    v_mul_f32 v98, v98, v14
    v_mul_f32 v99, v99, v14
    v_subrev_u32 v11, s34, v88
    v_cmp_le_u32 vcc, s35, v11
    s_not_b64 exec, s[48:49]
    v_pk_mul_f32 v[96:97], v[100:101], v[14:15] op_sel_hi:[1,0]
    v_pk_mul_f32 v[98:99], v[102:103], v[14:15] op_sel_hi:[1,0]
    s_mov_b64 exec, -1
    v_cvt_pk_bf16_f32 v96, v96, v97
    v_cvt_pk_bf16_f32 v97, v98, v99
    ds_write_b64 v126, v[96:97]
    v_mov_b32_dpp v32, v96 quad_perm:[0,1,0,1] row_mask:0xf bank_mask:0xf
    v_mov_b32_dpp v33, v97 quad_perm:[0,1,0,1] row_mask:0xf bank_mask:0xf
    v_mov_b32_dpp v34, v96 quad_perm:[2,3,2,3] row_mask:0xf bank_mask:0xf
    v_mov_b32_dpp v35, v97 quad_perm:[2,3,2,3] row_mask:0xf bank_mask:0xf
    v_mov_b64 v[28:29], 0
    s_cbranch_vccnz Tmx_1
Tmxd_1:
    v_smfmac_f32_16x16x64_bf16 v[16:19], v[32:35], a[168:175], v0
    s_waitcnt lgkmcnt(0)
    s_barrier
    ds_read_b128 v[36:39], v127 offset:1024
    v_smfmac_f32_16x16x64_bf16 v[20:23], v[32:35], a[200:207], v0
    ds_read_b128 v[40:43], v127 offset:1536
    v_smfmac_f32_16x16x64_bf16 v[24:27], v[32:35], a[232:239], v0
    ds_read_b128 v[44:47], v127 offset:0
    v_smfmac_f32_16x16x64_bf16 v[28:31], v[32:35], v[104:111], v0
    ds_read_b128 v[112:115], v2 offset:28672
    s_waitcnt lgkmcnt(3)
    v_smfmac_f32_16x16x64_bf16 v[16:19], v[36:39], a[176:183], v0
    ds_read_b128 v[116:119], v2 offset:29696
    s_waitcnt lgkmcnt(3)
    v_smfmac_f32_16x16x64_bf16 v[16:19], v[40:43], a[184:191], v0
    ds_read_b128 v[48:51], v2 offset:30720
    s_waitcnt lgkmcnt(3)
    v_smfmac_f32_16x16x64_bf16 v[16:19], v[44:47], a[160:167], v0
    s_nop 0
    ds_read_b128 v[56:59], v2 offset:24576
    v_smfmac_f32_16x16x64_bf16 v[20:23], v[36:39], a[208:215], v0
    s_nop 0
    ds_read_b128 v[52:55], v2 offset:31744
    v_smfmac_f32_16x16x64_bf16 v[20:23], v[40:43], a[216:223], v0
    s_nop 1
    v_cvt_pk_bf16_f32 v16, v16, v17
    v_cvt_pk_bf16_f32 v17, v18, v19
    v_and_or_b32 v16, v16, -2, s46
    v_smfmac_f32_16x16x64_bf16 v[20:23], v[44:47], a[192:199], v0
    buffer_store_dwordx2 v[16:17], v7, s[8:11], s20 offen offset:0
    v_smfmac_f32_16x16x64_bf16 v[24:27], v[36:39], a[240:247], v0
    s_nop 0
    ds_read_b128 v[60:63], v2 offset:25600
    v_smfmac_f32_16x16x64_bf16 v[24:27], v[40:43], a[248:255], v0
    s_nop 1
    s_nop 0
    v_cvt_pk_bf16_f32 v20, v20, v21
    v_cvt_pk_bf16_f32 v21, v22, v23
    v_and_or_b32 v20, v20, -2, s46
    v_smfmac_f32_16x16x64_bf16 v[24:27], v[44:47], a[224:231], v0
    buffer_store_dwordx2 v[20:21], v7, s[8:11], s20 offen offset:2048
    s_waitcnt lgkmcnt(4)
    v_smfmac_f32_16x16x64_bf16 v[28:31], v[36:39], v[112:119], v0
    s_nop 0
    s_waitcnt lgkmcnt(1)
    v_smfmac_f32_16x16x64_bf16 v[28:31], v[40:43], v[48:55], v0
    s_nop 1
    v_cvt_pk_bf16_f32 v24, v24, v25
    v_cvt_pk_bf16_f32 v25, v26, v27
    s_waitcnt lgkmcnt(0)
    v_and_or_b32 v24, v24, -2, s46
    v_smfmac_f32_16x16x64_bf16 v[28:31], v[44:47], v[56:63], v0
    buffer_store_dwordx2 v[24:25], v7, s[8:11], s21 offen offset:0
    s_nop 6
    v_cvt_pk_bf16_f32 v28, v28, v29
    v_cvt_pk_bf16_f32 v29, v30, v31
    v_and_or_b32 v28, v28, -2, s46
    buffer_store_dwordx2 v[28:29], v7, s[8:11], s21 offen offset:2048
    s_barrier
    ds_read_b128 v[16:19], v1 offset:13312
    s_waitcnt vmcnt(7)
    v_mov_b64 v[72:73], v[128:129]
    ds_read_b128 v[32:35], v2 offset:0
    s_add_u32 s17, s17, 1
    v_mov_b64 v[74:75], v[130:131]
    ds_read_b128 v[36:39], v2 offset:1024
    s_and_b32 s29, s17, 3
    s_waitcnt vmcnt(6)
    v_mov_b64 v[76:77], v[132:133]
    ds_read_b128 v[88:91], v2 offset:6144
    s_lshl_b32 s29, s29, 13
    v_mov_b64 v[78:79], v[134:135]
    ds_read_b128 v[92:95], v2 offset:7168
    s_add_u32 s30, s24, s29
    s_waitcnt vmcnt(5)
    v_mov_b64 v[80:81], v[136:137]
    ds_read_b128 v[96:99], v2 offset:8192
    s_add_u32 s26, s29, 52955136
    v_mov_b64 v[82:83], v[138:139]
    ds_read_b128 v[100:103], v2 offset:9216
    s_xor_b32 s25, s30, 16384
    s_waitcnt vmcnt(4)
    v_mov_b64 v[84:85], v[140:141]
    ds_read_b128 v[104:107], v2 offset:10240
    s_xor_b32 s20, s20, 262144
    s_nop 9
    buffer_load_dwordx4 v[40:43], v1, s[8:11], s22 offen offset:0 sc1
    buffer_load_dwordx4 v[44:47], v1, s[8:11], s22 offen offset:1024 sc1
    v_mov_b64 v[86:87], v[142:143]
    ds_read_b128 v[108:111], v2 offset:11264
    s_add_u32 s21, s20, 4096
    v_mov_b64 v[48:49], 0
    ds_read_b128 v[112:115], v1 offset:20480
    s_add_u32 s19, s19, 8192
    v_mov_b64 v[50:51], 0
    ds_read_b128 v[116:119], v1 offset:21504
    s_cmp_ge_u32 s17, 62
    s_cselect_b32 s35, 0, s35
    s_cselect_b32 s18, 0x40000000, s18
    s_waitcnt lgkmcnt(10)
    s_waitcnt vmcnt(1)
    v_mfma_f32_16x16x32_bf16 v[20:23], v[16:19], v[40:43], 0
    v_bitop3_b32 v11, v40, v42, s46 bitop3:0x7e
    s_waitcnt vmcnt(0)
    v_mfma_f32_16x16x32_bf16 v[20:23], v[16:19], v[44:47], v[20:23]
    v_bitop3_b32 v15, v44, v46, s46 bitop3:0x7e
    v_bitop3_b32 v11, v11, v15, 1 bitop3:0xa8
    v_cmp_ne_u32 vcc, 0, v11
    s_nop 4
    v_add_f32_dpp v20, v20, v20 row_ror:4 row_mask:0xf bank_mask:0xf
    v_add_f32_dpp v21, v21, v21 row_ror:4 row_mask:0xf bank_mask:0xf
    s_cbranch_vccnz Tr1_1
Tok1_1:
    v_add_f32_dpp v20, v20, v20 row_ror:8 row_mask:0xf bank_mask:0xf
    v_add_f32_dpp v21, v21, v21 row_ror:8 row_mask:0xf bank_mask:0xf
    v_cvt_pk_bf16_f32 v14, v20, v21
    buffer_store_dword v14, v8, s[8:11], s30 offen
    buffer_store_dword v13, v8, s[8:11], s25 offen
    s_xor_b32 s22, s22, 262144
    s_bfe_u32 s46, s17, 0x10001
    v_mov_b64 v[52:53], 0
    ds_read_b128 v[64:67], v1 offset:22528
    s_add_u32 s18, s18, 524288
    v_mov_b64 v[54:55], 0
    ds_read_b128 v[68:71], v1 offset:23552
    s_add_u32 s33, s18, 8192
    v_mov_b64 v[56:57], 0
    ds_read_b128 v[128:131], v2 offset:2048
    s_add_u32 s51, s51, 4096
    v_mov_b64 v[58:59], 0
    ds_read_b128 v[132:135], v2 offset:3072
    v_mov_b64 v[60:61], 0
    ds_read_b128 v[136:139], v2 offset:4096
    v_mov_b64 v[62:63], 0
    ds_read_b128 v[140:143], v2 offset:5120
    s_nop 15
    s_branch Tstep_1
Tr2_1:
    buffer_load_dwordx4 v[40:43], v1, s[8:11], s26 offen offset:0 sc1
    buffer_load_dwordx4 v[44:47], v1, s[8:11], s26 offen offset:1024 sc1
    s_waitcnt vmcnt(1)
    v_max3_u32 v11, v40, v41, v42
    v_max_u32 v11, v11, v43
    ds_write_b128 v1, v[40:43] offset:2048
    s_waitcnt vmcnt(0)
    v_max3_u32 v11, v11, v44, v45
    v_max3_u32 v11, v11, v46, v47
    v_cmp_eq_u32 vcc, -1, v11
    ds_write_b128 v1, v[44:47] offset:3072
    s_cbranch_vccz Tok2_1
    buffer_load_dwordx4 v[40:43], v1, s[8:11], s26 offen offset:0 sc1
    buffer_load_dwordx4 v[44:47], v1, s[8:11], s26 offen offset:1024 sc1
    s_waitcnt vmcnt(1)
    v_max3_u32 v11, v40, v41, v42
    v_max_u32 v11, v11, v43
    ds_write_b128 v1, v[40:43] offset:2048
    s_waitcnt vmcnt(0)
    v_max3_u32 v11, v11, v44, v45
    v_max3_u32 v11, v11, v46, v47
    v_cmp_eq_u32 vcc, -1, v11
    ds_write_b128 v1, v[44:47] offset:3072
    s_cbranch_vccz Tok2_1
    s_add_u32 s27, s27, 1
    s_cmp_lt_u32 s27, 400000
    s_cbranch_scc1 Tr2_1
    s_mov_b32 s28, 1
    s_branch Tok2_1
Tr1_1:
    buffer_load_dwordx4 v[40:43], v1, s[8:11], s22 offen offset:0 sc1
    buffer_load_dwordx4 v[44:47], v1, s[8:11], s22 offen offset:1024 sc1
    s_waitcnt vmcnt(1)
    v_mfma_f32_16x16x32_bf16 v[20:23], v[16:19], v[40:43], 0
    v_bitop3_b32 v11, v40, v42, s46 bitop3:0x7e
    s_waitcnt vmcnt(0)
    v_mfma_f32_16x16x32_bf16 v[20:23], v[16:19], v[44:47], v[20:23]
    v_bitop3_b32 v15, v44, v46, s46 bitop3:0x7e
    v_bitop3_b32 v11, v11, v15, 1 bitop3:0xa8
    v_cmp_ne_u32 vcc, 0, v11
    s_nop 4
    v_add_f32_dpp v20, v20, v20 row_ror:4 row_mask:0xf bank_mask:0xf
    v_add_f32_dpp v21, v21, v21 row_ror:4 row_mask:0xf bank_mask:0xf
    s_cbranch_vccz Tok1_1
    s_add_u32 s27, s27, 1
    s_cmp_lt_u32 s27, 400000
    s_cbranch_scc1 Tr1_1
    s_mov_b32 s28, 1
    s_waitcnt vmcnt(0)
    s_branch Tok1_1
Tmx_1:
    s_nop 7
    s_waitcnt lgkmcnt(0)
    s_cmp_lg_u32 s35, 0
    s_cbranch_scc1 Tmx2_1
    ds_read_b64_tr_b16 v[40:41], v5 offset:768
    v_pk_add_f32 v[44:45], v[64:65], v[66:67]
    v_pk_add_f32 v[46:47], v[68:69], v[70:71]
    v_cvt_pk_bf16_f32 v42, v44, v45
    v_cvt_pk_bf16_f32 v43, v46, v47
    s_and_b32 s29, s17, 1
    s_lshl_b32 s29, s29, 5
    s_add_u32 s29, s29, s16
    s_lshl_b32 s29, s29, 12
    s_add_u32 s29, s29, 61735936
    s_waitcnt lgkmcnt(0)
    buffer_store_dwordx4 v[40:43], v1, s[8:11], s29 offen sc1
    s_cmp_eq_u32 s17, 63
    s_cbranch_scc1 Tend_1
    s_mov_b32 s35, 0x3c000000
    v_cmp_le_u32 vcc, s35, v11
    s_nop 4
    s_and_b64 vcc, vcc, s[48:49]
    s_cbranch_scc0 Tmxd_1
Tmx2_1:
    v_max3_f32 v14, v48, v49, v52
    v_max_f32 v14, v14, v53
    v_mov_b32 v15, v14
    s_nop 1
    v_permlane16_swap_b32 v14, v15
    v_max_f32 v14, v14, v15
    v_mov_b32 v15, v14
    s_nop 1
    v_permlane32_swap_b32 v14, v15
    v_max_f32 v14, v14, v15
    ds_write_b32 v1, v14 offset:14340
    s_waitcnt lgkmcnt(0)
    s_barrier
    ds_read_b128 v[88:91], v1 offset:14336
    s_waitcnt lgkmcnt(0)
    v_max3_f32 v14, v88, v89, v90
    v_max_f32 v14, v14, v91
    v_cmp_neq_f32 vcc, 0, v14
    v_mov_b32 v11, 0x1f8
    v_cmp_class_f32 s[36:37], v14, v11
    s_nop 4
    s_and_b64 vcc, vcc, s[36:37]
    s_and_b64 vcc, vcc, s[48:49]
    s_cbranch_scc0 Tmxd_1
    v_cndmask_b32 v14, 0, v14, vcc
    v_sub_f32 v48, v48, v14
    v_sub_f32 v49, v49, v14
    v_sub_f32 v52, v52, v14
    v_sub_f32 v53, v53, v14
    v_exp_f32 v50, v48
    v_exp_f32 v51, v49
    s_nop 0
    v_cvt_pk_bf16_f32 v50, v50, v51
    ds_write_b32 v12, v50
    v_exp_f32_dpp v54, v52 quad_perm:[0,1,0,1] row_mask:0xf bank_mask:0xf
    v_exp_f32_dpp v55, v53 quad_perm:[0,1,0,1] row_mask:0xf bank_mask:0xf
    s_waitcnt lgkmcnt(0)
    s_barrier
    ds_read_b128 v[56:59], v6 offset:12288
    s_waitcnt lgkmcnt(0)
    s_branch Tsm_1
Tend_1:
    s_endpgm
Tslow_1:
    s_mov_b32 s27, 0
    s_mov_b32 s46, 0
    v_mov_b32 v13, -1
    v_mov_b64 v[122:123], s[42:43]
    v_mov_b64 v[124:125], s[42:43]
    v_mov_b64 v[120:121], s[44:45]
    s_mov_b32 s26, 52955136
    s_add_u32 s21, s20, 4096
    s_lshl_b32 s54, s16, 7
    s_add_u32 s54, s54, 58720260
    s_add_u32 s51, s54, 4096
    s_add_u32 s18, s18, 524288
    s_add_u32 s33, s18, 8192
    s_add_u32 s51, s51, 4096
    v_mov_b64 v[72:73], v[128:129]
    ds_read_b128 v[32:35], v2 offset:0
    v_mov_b64 v[74:75], v[130:131]
    ds_read_b128 v[36:39], v2 offset:1024
    v_mov_b64 v[76:77], v[132:133]
    ds_read_b128 v[88:91], v2 offset:6144
    v_mov_b64 v[78:79], v[134:135]
    ds_read_b128 v[92:95], v2 offset:7168
    v_mov_b64 v[80:81], v[136:137]
    ds_read_b128 v[96:99], v2 offset:8192
    v_mov_b64 v[82:83], v[138:139]
    ds_read_b128 v[100:103], v2 offset:9216
    v_mov_b64 v[84:85], v[140:141]
    ds_read_b128 v[104:107], v2 offset:10240
    v_mov_b64 v[86:87], v[142:143]
    ds_read_b128 v[108:111], v2 offset:11264
    v_mov_b64 v[48:49], 0
    ds_read_b128 v[112:115], v1 offset:20480
    v_mov_b64 v[50:51], 0
    ds_read_b128 v[116:119], v1 offset:21504
    v_mov_b64 v[52:53], 0
    ds_read_b128 v[64:67], v1 offset:22528
    v_mov_b64 v[54:55], 0
    ds_read_b128 v[68:71], v1 offset:23552
    v_mov_b64 v[56:57], 0
    ds_read_b128 v[128:131], v2 offset:2048
    v_mov_b64 v[58:59], 0
    ds_read_b128 v[132:135], v2 offset:3072
    v_mov_b64 v[60:61], 0
    ds_read_b128 v[136:139], v2 offset:4096
    v_mov_b64 v[62:63], 0
    ds_read_b128 v[140:143], v2 offset:5120
    s_branch Tstep_1sc1
.p2align 6
Tstep_1sc1:
    buffer_load_dwordx4 v[40:43], v1, s[8:11], s26 offen offset:0 sc1
    buffer_load_dwordx4 v[44:47], v1, s[8:11], s26 offen offset:1024 sc1
    s_waitcnt vmcnt(1)
    v_max3_u32 v11, v40, v41, v42
    v_max_u32 v11, v11, v43
    ds_write_b128 v1, v[40:43] offset:2048
    s_waitcnt vmcnt(0)
    v_max3_u32 v11, v11, v44, v45
    v_max3_u32 v11, v11, v46, v47
    v_cmp_eq_u32 vcc, -1, v11
    ds_write_b128 v1, v[44:47] offset:3072
    s_cbranch_vccnz Tr2_1sc1
Tok2_1sc1:
    s_barrier
    ds_read_b128 v[16:19], v1 offset:0
    ds_read_b128 v[20:23], v1 offset:1024
    buffer_store_dword v14, v8, s[8:11], s19 offen sc1
    s_waitcnt lgkmcnt(2)
    s_barrier
    ds_read_b128 v[24:27], v1 offset:2048
    ds_read_b128 v[28:31], v1 offset:3072
    s_waitcnt lgkmcnt(3)
    v_smfmac_f32_16x16x64_bf16 v[48:51], v[16:19], v[32:39], v0
    ds_read_b128 v[32:35], v1 offset:4096
    v_smfmac_f32_16x16x64_bf16 v[52:55], v[16:19], v[128:135], v0
    ds_read_b128 v[36:39], v1 offset:5120
    s_waitcnt lgkmcnt(4)
    v_smfmac_f32_16x16x64_bf16 v[48:51], v[20:23], v[136:143], v0
    buffer_load_dwordx4 v[128:131], v9, s[8:11], s18 offen sc1
    v_smfmac_f32_16x16x64_bf16 v[52:55], v[20:23], v[88:95], v0
    ds_read_b128 v[40:43], v1 offset:6144
    s_waitcnt lgkmcnt(4)
    v_smfmac_f32_16x16x64_bf16 v[48:51], v[24:27], v[96:103], v0
    ds_read_b128 v[44:47], v1 offset:7168
    s_waitcnt lgkmcnt(3)
    v_smfmac_f32_16x16x64_bf16 v[48:51], v[28:31], v[112:119], v0
    buffer_load_dwordx4 v[132:135], v9, s[8:11], s33 offen sc1
    v_smfmac_f32_16x16x64_bf16 v[48:51], v[32:35], a[96:103], v0
    ds_read_b128 v[88:91], v2 offset:12288
    s_waitcnt lgkmcnt(3)
    v_smfmac_f32_16x16x64_bf16 v[48:51], v[36:39], a[112:119], v0
    buffer_load_dwordx4 v[136:139], v3, s[8:11], s18 offen offset:2048 sc1
    s_waitcnt lgkmcnt(2)
    v_smfmac_f32_16x16x64_bf16 v[48:51], v[40:43], a[128:135], v0
    ds_read_b128 v[92:95], v2 offset:13312
    s_waitcnt lgkmcnt(2)
    v_smfmac_f32_16x16x64_bf16 v[48:51], v[44:47], a[144:151], v0
    buffer_load_dwordx4 v[140:143], v3, s[8:11], s18 offen offset:2176 sc1
    v_smfmac_f32_16x16x64_bf16 v[52:55], v[24:27], v[104:111], v0
    s_nop 1
    s_waitcnt lgkmcnt(1)
    v_smfmac_f32_16x16x64_bf16 v[52:55], v[28:31], v[64:71], v0
    s_nop 1
    v_add_f32 v48, v48, v50
    v_smfmac_f32_16x16x64_bf16 v[52:55], v[32:35], a[104:111], v0
    ds_read_b128 v[96:99], v2 offset:16384
    v_add_f32 v49, v49, v51
    v_smfmac_f32_16x16x64_bf16 v[52:55], v[36:39], a[120:127], v0
    ds_read_b128 v[100:103], v2 offset:17408
    v_mul_f32 v48, s32, v48
    v_smfmac_f32_16x16x64_bf16 v[52:55], v[40:43], a[136:143], v0
    ds_read_b128 v[104:107], v2 offset:20480
    v_mul_f32 v49, s32, v49
    v_smfmac_f32_16x16x64_bf16 v[52:55], v[44:47], a[152:159], v0
    s_nop 0
    s_waitcnt lgkmcnt(3)
    v_cvt_pk_bf16_f32 v48, v48, v49
    v_smfmac_f32_16x16x64_bf16 v[56:59], v[28:31], v[144:151], v0
    ds_write_b32 v4, v48 offset:0
    v_smfmac_f32_16x16x64_bf16 v[56:59], v[32:35], v[160:167], v0
    s_waitcnt lgkmcnt(2)
    s_nop 0
    v_add_f32 v52, v52, v54
    v_smfmac_f32_16x16x64_bf16 v[56:59], v[16:19], v[88:95], v0
    ds_read_b128 v[108:111], v2 offset:21504
    v_add_f32 v53, v53, v55
    v_mul_f32 v52, s32, v52
    v_smfmac_f32_16x16x64_bf16 v[56:59], v[20:23], v[96:103], v0
    ds_read_b128 v[112:115], v2 offset:14336
    v_mul_f32 v53, s32, v53
    v_smfmac_f32_16x16x64_bf16 v[56:59], v[36:39], v[176:183], v0
    ds_read_b128 v[116:119], v2 offset:15360
    v_cvt_pk_bf16_f32 v52, v52, v53
    v_smfmac_f32_16x16x64_bf16 v[56:59], v[40:43], v[192:199], v0
    ds_write_b32 v4, v52 offset:256
    v_smfmac_f32_16x16x64_bf16 v[56:59], v[44:47], v[208:215], v0
    ds_read_b128 v[88:91], v2 offset:18432
    s_waitcnt lgkmcnt(4)
    v_smfmac_f32_16x16x64_bf16 v[56:59], v[24:27], v[104:111], v0
    ds_read_b128 v[92:95], v2 offset:19456
    s_waitcnt lgkmcnt(4)
    v_smfmac_f32_16x16x64_bf16 v[60:63], v[28:31], v[152:159], v0
    ds_read_b128 v[96:99], v2 offset:22528
    ds_read_b128 v[100:103], v2 offset:23552
    v_smfmac_f32_16x16x64_bf16 v[60:63], v[32:35], v[168:175], v0
    s_waitcnt lgkmcnt(4)
    s_barrier
    v_smfmac_f32_16x16x64_bf16 v[60:63], v[36:39], v[184:191], v0
    ds_read_b64_tr_b16 v[104:105], v5 offset:0
    v_add_f32 v56, v56, v58
    v_smfmac_f32_16x16x64_bf16 v[60:63], v[40:43], v[200:207], v0
    ds_read_b64_tr_b16 v[106:107], v5 offset:256
    v_add_f32 v57, v57, v59
    v_smfmac_f32_16x16x64_bf16 v[60:63], v[44:47], v[216:223], v0
    ds_read_b64_tr_b16 v[108:109], v5 offset:2048
    v_cvt_pk_bf16_f32 v56, v56, v57
    v_smfmac_f32_16x16x64_bf16 v[60:63], v[16:19], v[112:119], v0
    ds_read_b64_tr_b16 v[110:111], v5 offset:2304
    s_waitcnt lgkmcnt(4)
    v_mov_b64 v[64:65], 0
    v_smfmac_f32_16x16x64_bf16 v[60:63], v[20:23], v[88:95], v0
    ds_write_b32 v4, v56 offset:512
    v_smfmac_f32_16x16x64_bf16 v[60:63], v[24:27], v[96:103], v0
    s_waitcnt lgkmcnt(3)
    v_mov_b64 v[66:67], 0
    v_mfma_f32_16x16x32_bf16 v[48:51], v[72:75], v[104:107], 0
    s_waitcnt lgkmcnt(1)
    v_mov_b64 v[68:69], 0
    v_mov_b64 v[70:71], 0
    v_mfma_f32_16x16x32_bf16 v[48:51], v[76:79], v[108:111], v[48:51]
    s_nop 0
    v_add_f32 v60, v60, v62
    v_add_f32 v61, v61, v63
    v_cvt_pk_bf16_f32 v60, v60, v61
    v_smfmac_f32_16x16x64_bf16 v[64:67], v[28:31], a[16:23], v0
    ds_write_b32 v4, v60 offset:768
    v_smfmac_f32_16x16x64_bf16 v[64:67], v[24:27], a[0:7], v0
    s_waitcnt lgkmcnt(1)
    v_add_f32_dpp v48, v50, v48 quad_perm:[2,3,0,1] row_mask:0xf bank_mask:0xf
    v_smfmac_f32_16x16x64_bf16 v[64:67], v[20:23], v[240:247], v0
    v_add_f32_dpp v49, v51, v49 quad_perm:[2,3,0,1] row_mask:0xf bank_mask:0xf
    v_smfmac_f32_16x16x64_bf16 v[64:67], v[16:19], v[224:231], v0
    v_exp_f32 v50, v48
    v_smfmac_f32_16x16x64_bf16 v[64:67], v[32:35], a[32:39], v0
    s_waitcnt lgkmcnt(0)
    s_barrier
    v_smfmac_f32_16x16x64_bf16 v[64:67], v[36:39], a[48:55], v0
    ds_read_b64_tr_b16 v[112:113], v5 offset:512
    v_exp_f32 v51, v49
    v_smfmac_f32_16x16x64_bf16 v[64:67], v[40:43], a[64:71], v0
    ds_read_b64_tr_b16 v[114:115], v5 offset:768
    v_cvt_pk_bf16_f32 v50, v50, v51
    v_smfmac_f32_16x16x64_bf16 v[64:67], v[44:47], a[80:87], v0
    ds_read_b64_tr_b16 v[116:117], v5 offset:2560
    v_smfmac_f32_16x16x64_bf16 v[68:71], v[28:31], a[24:31], v0
    ds_read_b64_tr_b16 v[118:119], v5 offset:2816
    v_smfmac_f32_16x16x64_bf16 v[68:71], v[24:27], a[8:15], v0
    ds_write_b32 v12, v50
    s_waitcnt lgkmcnt(3)
    v_mfma_f32_16x16x32_bf16 v[52:55], v[112:115], v[104:107], 0
    s_nop 0
    v_cvt_pk_bf16_f32 v60, v64, v65
    v_cvt_pk_bf16_f32 v61, v66, v67
    v_smfmac_f32_16x16x64_bf16 v[68:71], v[20:23], v[248:255], v0
    s_waitcnt lgkmcnt(1)
    v_mov_b64 v[30:31], 0
    v_mfma_f32_16x16x32_bf16 v[52:55], v[116:119], v[108:111], v[52:55]
    s_nop 0
    v_mov_b64 v[26:27], 0
    v_mov_b64 v[24:25], 0
    v_smfmac_f32_16x16x64_bf16 v[68:71], v[16:19], v[232:239], v0
    s_waitcnt lgkmcnt(0)
    s_barrier
    v_smfmac_f32_16x16x64_bf16 v[68:71], v[32:35], a[40:47], v0
    ds_read_b128 v[56:59], v6 offset:12288
    v_add_f32_dpp v52, v54, v52 quad_perm:[2,3,0,1] row_mask:0xf bank_mask:0xf
    v_smfmac_f32_16x16x64_bf16 v[68:71], v[36:39], a[56:63], v0
    ds_read_b128 v[104:107], v2 offset:26624
    v_add_f32_dpp v53, v55, v53 quad_perm:[2,3,0,1] row_mask:0xf bank_mask:0xf
    v_smfmac_f32_16x16x64_bf16 v[68:71], v[40:43], a[72:79], v0
    ds_read_b128 v[108:111], v2 offset:27648
    v_exp_f32_dpp v54, v52 quad_perm:[0,1,0,1] row_mask:0xf bank_mask:0xf
    v_smfmac_f32_16x16x64_bf16 v[68:71], v[44:47], a[88:95], v0
    s_nop 0
    s_waitcnt lgkmcnt(2)
    v_exp_f32_dpp v55, v53 quad_perm:[0,1,0,1] row_mask:0xf bank_mask:0xf
Tsm_1sc1:
    v_mfma_f32_16x16x32_bf16 v[88:91], v[122:125], v[56:59], 0
    v_cvt_pk_bf16_f32 v28, v54, v55
    v_cvt_pk_bf16_f32 v29, v54, v55
    v_mfma_f32_16x16x32_bf16 v[96:99], v[80:83], v[56:59], 0
    s_nop 0
    v_cvt_pk_bf16_f32 v62, v68, v69
    v_cvt_pk_bf16_f32 v63, v70, v71
    v_mfma_f32_16x16x32_bf16 v[88:91], v[120:123], v[28:31], v[88:91]
    s_nop 0
    v_mov_b64 v[16:17], 0
    v_mov_b64 v[18:19], 0
    v_mfma_f32_16x16x32_bf16 v[96:99], v[60:63], v[28:31], v[96:99]
    s_nop 0
    v_mov_b64 v[20:21], 0
    v_mov_b64 v[22:23], 0
    v_mfma_f32_16x16x32_bf16 v[100:103], v[84:87], v[56:59], 0
    s_nop 0
    v_rcp_f32 v14, v88
    v_mfma_f32_16x16x32_bf16 v[100:103], v[60:63], v[26:29], v[100:103]
    s_nop 0
    v_mul_f32 v96, v96, v14
    v_mul_f32 v97, v97, v14
    v_mul_f32 v98, v98, v14
    v_mul_f32 v99, v99, v14
    v_subrev_u32 v11, s34, v88
    v_cmp_le_u32 vcc, s35, v11
    s_not_b64 exec, s[48:49]
    v_pk_mul_f32 v[96:97], v[100:101], v[14:15] op_sel_hi:[1,0]
    v_pk_mul_f32 v[98:99], v[102:103], v[14:15] op_sel_hi:[1,0]
    s_mov_b64 exec, -1
    v_cvt_pk_bf16_f32 v96, v96, v97
    v_cvt_pk_bf16_f32 v97, v98, v99
    ds_write_b64 v126, v[96:97]
    v_mov_b32_dpp v32, v96 quad_perm:[0,1,0,1] row_mask:0xf bank_mask:0xf
    v_mov_b32_dpp v33, v97 quad_perm:[0,1,0,1] row_mask:0xf bank_mask:0xf
    v_mov_b32_dpp v34, v96 quad_perm:[2,3,2,3] row_mask:0xf bank_mask:0xf
    v_mov_b32_dpp v35, v97 quad_perm:[2,3,2,3] row_mask:0xf bank_mask:0xf
    v_mov_b64 v[28:29], 0
    s_cbranch_vccnz Tmx_1sc1
Tmxd_1sc1:
    v_smfmac_f32_16x16x64_bf16 v[16:19], v[32:35], a[168:175], v0
    s_waitcnt lgkmcnt(0)
    s_barrier
    ds_read_b128 v[36:39], v127 offset:1024
    v_smfmac_f32_16x16x64_bf16 v[20:23], v[32:35], a[200:207], v0
    ds_read_b128 v[40:43], v127 offset:1536
    v_smfmac_f32_16x16x64_bf16 v[24:27], v[32:35], a[232:239], v0
    ds_read_b128 v[44:47], v127 offset:0
    v_smfmac_f32_16x16x64_bf16 v[28:31], v[32:35], v[104:111], v0
    ds_read_b128 v[112:115], v2 offset:28672
    s_waitcnt lgkmcnt(3)
    v_smfmac_f32_16x16x64_bf16 v[16:19], v[36:39], a[176:183], v0
    ds_read_b128 v[116:119], v2 offset:29696
    s_waitcnt lgkmcnt(3)
    v_smfmac_f32_16x16x64_bf16 v[16:19], v[40:43], a[184:191], v0
    ds_read_b128 v[48:51], v2 offset:30720
    s_waitcnt lgkmcnt(3)
    v_smfmac_f32_16x16x64_bf16 v[16:19], v[44:47], a[160:167], v0
    s_nop 0
    ds_read_b128 v[56:59], v2 offset:24576
    v_smfmac_f32_16x16x64_bf16 v[20:23], v[36:39], a[208:215], v0
    s_nop 0
    ds_read_b128 v[52:55], v2 offset:31744
    v_smfmac_f32_16x16x64_bf16 v[20:23], v[40:43], a[216:223], v0
    s_nop 1
    v_cvt_pk_bf16_f32 v16, v16, v17
    v_cvt_pk_bf16_f32 v17, v18, v19
    v_and_or_b32 v16, v16, -2, s46
    v_smfmac_f32_16x16x64_bf16 v[20:23], v[44:47], a[192:199], v0
    buffer_store_dwordx2 v[16:17], v7, s[8:11], s20 offen offset:0 sc1
    v_smfmac_f32_16x16x64_bf16 v[24:27], v[36:39], a[240:247], v0
    s_nop 0
    ds_read_b128 v[60:63], v2 offset:25600
    v_smfmac_f32_16x16x64_bf16 v[24:27], v[40:43], a[248:255], v0
    s_nop 1
    s_nop 0
    v_cvt_pk_bf16_f32 v20, v20, v21
    v_cvt_pk_bf16_f32 v21, v22, v23
    v_and_or_b32 v20, v20, -2, s46
    v_smfmac_f32_16x16x64_bf16 v[24:27], v[44:47], a[224:231], v0
    buffer_store_dwordx2 v[20:21], v7, s[8:11], s20 offen offset:2048 sc1
    s_waitcnt lgkmcnt(4)
    v_smfmac_f32_16x16x64_bf16 v[28:31], v[36:39], v[112:119], v0
    s_nop 0
    s_waitcnt lgkmcnt(1)
    v_smfmac_f32_16x16x64_bf16 v[28:31], v[40:43], v[48:55], v0
    s_nop 1
    v_cvt_pk_bf16_f32 v24, v24, v25
    v_cvt_pk_bf16_f32 v25, v26, v27
    s_waitcnt lgkmcnt(0)
    v_and_or_b32 v24, v24, -2, s46
    v_smfmac_f32_16x16x64_bf16 v[28:31], v[44:47], v[56:63], v0
    buffer_store_dwordx2 v[24:25], v7, s[8:11], s21 offen offset:0 sc1
    s_nop 6
    v_cvt_pk_bf16_f32 v28, v28, v29
    v_cvt_pk_bf16_f32 v29, v30, v31
    v_and_or_b32 v28, v28, -2, s46
    buffer_store_dwordx2 v[28:29], v7, s[8:11], s21 offen offset:2048 sc1
    s_barrier
    ds_read_b128 v[16:19], v1 offset:13312
    s_waitcnt vmcnt(7)
    v_mov_b64 v[72:73], v[128:129]
    ds_read_b128 v[32:35], v2 offset:0
    s_add_u32 s17, s17, 1
    v_mov_b64 v[74:75], v[130:131]
    ds_read_b128 v[36:39], v2 offset:1024
    s_and_b32 s29, s17, 3
    s_waitcnt vmcnt(6)
    v_mov_b64 v[76:77], v[132:133]
    ds_read_b128 v[88:91], v2 offset:6144
    s_lshl_b32 s29, s29, 13
    v_mov_b64 v[78:79], v[134:135]
    ds_read_b128 v[92:95], v2 offset:7168
    s_add_u32 s30, s24, s29
    s_waitcnt vmcnt(5)
    v_mov_b64 v[80:81], v[136:137]
    ds_read_b128 v[96:99], v2 offset:8192
    s_add_u32 s26, s29, 52955136
    v_mov_b64 v[82:83], v[138:139]
    ds_read_b128 v[100:103], v2 offset:9216
    s_xor_b32 s25, s30, 16384
    s_waitcnt vmcnt(4)
    v_mov_b64 v[84:85], v[140:141]
    ds_read_b128 v[104:107], v2 offset:10240
    s_xor_b32 s20, s20, 262144
    s_nop 9
    buffer_load_dwordx4 v[40:43], v1, s[8:11], s22 offen offset:0 sc1
    buffer_load_dwordx4 v[44:47], v1, s[8:11], s22 offen offset:1024 sc1
    v_mov_b64 v[86:87], v[142:143]
    ds_read_b128 v[108:111], v2 offset:11264
    s_add_u32 s21, s20, 4096
    v_mov_b64 v[48:49], 0
    ds_read_b128 v[112:115], v1 offset:20480
    s_add_u32 s19, s19, 8192
    v_mov_b64 v[50:51], 0
    ds_read_b128 v[116:119], v1 offset:21504
    s_cmp_ge_u32 s17, 62
    s_cselect_b32 s35, 0, s35
    s_cselect_b32 s18, 0x40000000, s18
    s_waitcnt lgkmcnt(10)
    s_waitcnt vmcnt(1)
    v_mfma_f32_16x16x32_bf16 v[20:23], v[16:19], v[40:43], 0
    v_bitop3_b32 v11, v40, v42, s46 bitop3:0x7e
    s_waitcnt vmcnt(0)
    v_mfma_f32_16x16x32_bf16 v[20:23], v[16:19], v[44:47], v[20:23]
    v_bitop3_b32 v15, v44, v46, s46 bitop3:0x7e
    v_bitop3_b32 v11, v11, v15, 1 bitop3:0xa8
    v_cmp_ne_u32 vcc, 0, v11
    s_nop 4
    v_add_f32_dpp v20, v20, v20 row_ror:4 row_mask:0xf bank_mask:0xf
    v_add_f32_dpp v21, v21, v21 row_ror:4 row_mask:0xf bank_mask:0xf
    s_cbranch_vccnz Tr1_1sc1
Tok1_1sc1:
    v_add_f32_dpp v20, v20, v20 row_ror:8 row_mask:0xf bank_mask:0xf
    v_add_f32_dpp v21, v21, v21 row_ror:8 row_mask:0xf bank_mask:0xf
    v_cvt_pk_bf16_f32 v14, v20, v21
    buffer_store_dword v14, v8, s[8:11], s30 offen sc1
    buffer_store_dword v13, v8, s[8:11], s25 offen sc1
    s_xor_b32 s22, s22, 262144
    s_bfe_u32 s46, s17, 0x10001
    v_mov_b64 v[52:53], 0
    ds_read_b128 v[64:67], v1 offset:22528
    s_add_u32 s18, s18, 524288
    v_mov_b64 v[54:55], 0
    ds_read_b128 v[68:71], v1 offset:23552
    s_add_u32 s33, s18, 8192
    v_mov_b64 v[56:57], 0
    ds_read_b128 v[128:131], v2 offset:2048
    s_add_u32 s51, s51, 4096
    v_mov_b64 v[58:59], 0
    ds_read_b128 v[132:135], v2 offset:3072
    v_mov_b64 v[60:61], 0
    ds_read_b128 v[136:139], v2 offset:4096
    v_mov_b64 v[62:63], 0
    ds_read_b128 v[140:143], v2 offset:5120
    s_nop 15
    s_branch Tstep_1sc1
Tr2_1sc1:
    buffer_load_dwordx4 v[40:43], v1, s[8:11], s26 offen offset:0 sc1
    buffer_load_dwordx4 v[44:47], v1, s[8:11], s26 offen offset:1024 sc1
    s_waitcnt vmcnt(1)
    v_max3_u32 v11, v40, v41, v42
    v_max_u32 v11, v11, v43
    ds_write_b128 v1, v[40:43] offset:2048
    s_waitcnt vmcnt(0)
    v_max3_u32 v11, v11, v44, v45
    v_max3_u32 v11, v11, v46, v47
    v_cmp_eq_u32 vcc, -1, v11
    ds_write_b128 v1, v[44:47] offset:3072
    s_cbranch_vccz Tok2_1sc1
    buffer_load_dwordx4 v[40:43], v1, s[8:11], s26 offen offset:0 sc1
    buffer_load_dwordx4 v[44:47], v1, s[8:11], s26 offen offset:1024 sc1
    s_waitcnt vmcnt(1)
    v_max3_u32 v11, v40, v41, v42
    v_max_u32 v11, v11, v43
    ds_write_b128 v1, v[40:43] offset:2048
    s_waitcnt vmcnt(0)
    v_max3_u32 v11, v11, v44, v45
    v_max3_u32 v11, v11, v46, v47
    v_cmp_eq_u32 vcc, -1, v11
    ds_write_b128 v1, v[44:47] offset:3072
    s_cbranch_vccz Tok2_1sc1
    s_add_u32 s27, s27, 1
    s_cmp_lt_u32 s27, 400000
    s_cbranch_scc1 Tr2_1sc1
    s_mov_b32 s28, 1
    s_branch Tok2_1sc1
Tr1_1sc1:
    buffer_load_dwordx4 v[40:43], v1, s[8:11], s22 offen offset:0 sc1
    buffer_load_dwordx4 v[44:47], v1, s[8:11], s22 offen offset:1024 sc1
    s_waitcnt vmcnt(1)
    v_mfma_f32_16x16x32_bf16 v[20:23], v[16:19], v[40:43], 0
    v_bitop3_b32 v11, v40, v42, s46 bitop3:0x7e
    s_waitcnt vmcnt(0)
    v_mfma_f32_16x16x32_bf16 v[20:23], v[16:19], v[44:47], v[20:23]
    v_bitop3_b32 v15, v44, v46, s46 bitop3:0x7e
    v_bitop3_b32 v11, v11, v15, 1 bitop3:0xa8
    v_cmp_ne_u32 vcc, 0, v11
    s_nop 4
    v_add_f32_dpp v20, v20, v20 row_ror:4 row_mask:0xf bank_mask:0xf
    v_add_f32_dpp v21, v21, v21 row_ror:4 row_mask:0xf bank_mask:0xf
    s_cbranch_vccz Tok1_1sc1
    s_add_u32 s27, s27, 1
    s_cmp_lt_u32 s27, 400000
    s_cbranch_scc1 Tr1_1sc1
    s_mov_b32 s28, 1
    s_waitcnt vmcnt(0)
    s_branch Tok1_1sc1
Tmx_1sc1:
    s_nop 7
    s_waitcnt lgkmcnt(0)
    s_cmp_lg_u32 s35, 0
    s_cbranch_scc1 Tmx2_1sc1
    ds_read_b64_tr_b16 v[40:41], v5 offset:768
    v_pk_add_f32 v[44:45], v[64:65], v[66:67]
    v_pk_add_f32 v[46:47], v[68:69], v[70:71]
    v_cvt_pk_bf16_f32 v42, v44, v45
    v_cvt_pk_bf16_f32 v43, v46, v47
    s_and_b32 s29, s17, 1
    s_lshl_b32 s29, s29, 5
    s_add_u32 s29, s29, s16
    s_lshl_b32 s29, s29, 12
    s_add_u32 s29, s29, 61735936
    s_waitcnt lgkmcnt(0)
    buffer_store_dwordx4 v[40:43], v1, s[8:11], s29 offen sc1
    s_cmp_eq_u32 s17, 63
    s_cbranch_scc1 Tend_1sc1
    s_mov_b32 s35, 0x3c000000
    v_cmp_le_u32 vcc, s35, v11
    s_nop 4
    s_and_b64 vcc, vcc, s[48:49]
    s_cbranch_scc0 Tmxd_1sc1
Tmx2_1sc1:
    v_max3_f32 v14, v48, v49, v52
    v_max_f32 v14, v14, v53
    v_mov_b32 v15, v14
    s_nop 1
    v_permlane16_swap_b32 v14, v15
    v_max_f32 v14, v14, v15
    v_mov_b32 v15, v14
    s_nop 1
    v_permlane32_swap_b32 v14, v15
    v_max_f32 v14, v14, v15
    ds_write_b32 v1, v14 offset:14340
    s_waitcnt lgkmcnt(0)
    s_barrier
    ds_read_b128 v[88:91], v1 offset:14336
    s_waitcnt lgkmcnt(0)
    v_max3_f32 v14, v88, v89, v90
    v_max_f32 v14, v14, v91
    v_cmp_neq_f32 vcc, 0, v14
    v_mov_b32 v11, 0x1f8
    v_cmp_class_f32 s[36:37], v14, v11
    s_nop 4
    s_and_b64 vcc, vcc, s[36:37]
    s_and_b64 vcc, vcc, s[48:49]
    s_cbranch_scc0 Tmxd_1sc1
    v_cndmask_b32 v14, 0, v14, vcc
    v_sub_f32 v48, v48, v14
    v_sub_f32 v49, v49, v14
    v_sub_f32 v52, v52, v14
    v_sub_f32 v53, v53, v14
    v_exp_f32 v50, v48
    v_exp_f32 v51, v49
    s_nop 0
    v_cvt_pk_bf16_f32 v50, v50, v51
    ds_write_b32 v12, v50
    v_exp_f32_dpp v54, v52 quad_perm:[0,1,0,1] row_mask:0xf bank_mask:0xf
    v_exp_f32_dpp v55, v53 quad_perm:[0,1,0,1] row_mask:0xf bank_mask:0xf
    s_waitcnt lgkmcnt(0)
    s_barrier
    ds_read_b128 v[56:59], v6 offset:12288
    s_waitcnt lgkmcnt(0)
    s_branch Tsm_1sc1
Tend_1sc1:
    s_endpgm
Twave_2:
    v_and_b32 v100, 63, v0
    v_lshrrev_b32 v102, 1, v100
    v_and_b32 v102, 8, v102
    v_xor_b32 v102, v102, v100
    v_and_b32 v102, 15, v102
    v_lshlrev_b32 v102, 4, v102
    v_lshrrev_b32 v103, 4, v100
    v_lshl_add_u32 v104, v103, 13, v102
    v_lshl_add_u32 v108, v103, 10, v102
    v_xor_b32 v105, 64, v104
    v_xor_b32 v109, 64, v108
    s_mov_b32 s54, 0x400000
    s_mov_b32 s55, 0x20000
    s_mov_b32 s58, 0x400000
    s_mov_b32 s59, 0x20000
    s_mov_b32 s62, 0x400000
    s_mov_b32 s63, 0x20000
    s_mov_b32 s66, 0x400000
    s_mov_b32 s67, 0x20000
    s_lshl_b32 s50, s16, 8
    s_lshl_b32 s51, s16, 17
    s_waitcnt lgkmcnt(0)
    s_mov_b64 s[52:53], s[40:41]
    s_mov_b64 s[56:57], s[42:43]
    s_mov_b64 s[60:61], s[44:45]
    s_mov_b64 s[64:65], s[46:47]
    s_mov_b32 m0, 65536
    s_add_u32 s29, s50, 1835008
    buffer_load_dwordx4 v104, s[56:59], s29 offen  lds
    s_mov_b32 m0, 66560
    s_add_u32 s29, s50, 1867776
    buffer_load_dwordx4 v105, s[56:59], s29 offen  lds
    s_mov_b32 m0, 67584
    s_add_u32 s29, s50, 1900544
    buffer_load_dwordx4 v104, s[56:59], s29 offen  lds
    s_mov_b32 m0, 68608
    s_add_u32 s29, s50, 1933312
    buffer_load_dwordx4 v105, s[56:59], s29 offen  lds
    s_mov_b32 m0, 69632
    s_add_u32 s29, s50, 2359296
    buffer_load_dwordx4 v104, s[56:59], s29 offen  lds
    s_mov_b32 m0, 70656
    s_add_u32 s29, s50, 2392064
    buffer_load_dwordx4 v105, s[56:59], s29 offen  lds
    s_mov_b32 m0, 71680
    s_add_u32 s29, s50, 2424832
    buffer_load_dwordx4 v104, s[56:59], s29 offen  lds
    s_mov_b32 m0, 72704
    s_add_u32 s29, s50, 2457600
    buffer_load_dwordx4 v105, s[56:59], s29 offen  lds
    v_mov_b32 v120, 0
    v_bfe_u32 v101, v100, 2, 1
    v_lshl_add_u32 v120, v101, 8, v120
    v_bfe_u32 v101, v100, 4, 2
    v_lshl_add_u32 v120, v101, 10, v120
    v_bfe_u32 v101, v100, 3, 1
    v_lshl_add_u32 v120, v101, 15, v120
    v_bfe_u32 v101, v100, 2, 1
    v_lshl_add_u32 v120, v101, 7, v120
    v_bfe_u32 v101, v100, 4, 1
    v_lshl_add_u32 v120, v101, 6, v120
    v_bfe_u32 v101, v100, 1, 1
    v_lshl_add_u32 v120, v101, 5, v120
    v_bfe_u32 v101, v100, 3, 1
    v_lshl_add_u32 v120, v101, 4, v120
    v_bfe_u32 v101, v100, 0, 1
    v_lshl_add_u32 v120, v101, 3, v120
    v_xor_b32 v120, 128, v120
    v_xor_b32 v121, 16, v120
    v_add_u32 v122, 65536, v120
    v_add_u32 v123, 65536, v121
    v_mov_b32 v124, 0
    v_bfe_u32 v101, v100, 2, 1
    v_lshl_add_u32 v124, v101, 8, v124
    v_bfe_u32 v101, v100, 5, 1
    v_lshl_add_u32 v124, v101, 10, v124
    v_bfe_u32 v101, v100, 4, 1
    v_lshl_add_u32 v124, v101, 11, v124
    v_bfe_u32 v101, v100, 2, 1
    v_lshl_add_u32 v124, v101, 7, v124
    v_bfe_u32 v101, v100, 4, 1
    v_lshl_add_u32 v124, v101, 6, v124
    v_bfe_u32 v101, v100, 3, 1
    v_lshl_add_u32 v124, v101, 5, v124
    v_bfe_u32 v101, v100, 0, 2
    v_lshl_add_u32 v124, v101, 3, v124
    v_xor_b32 v124, 128, v124
    v_add_u32 v125, 65536, v124
    s_mov_b32 m0, 73728
    s_add_u32 s29, s50, 2883584
    buffer_load_dwordx4 v104, s[56:59], s29 offen  lds
    s_mov_b32 m0, 74752
    s_add_u32 s29, s50, 2916352
    buffer_load_dwordx4 v105, s[56:59], s29 offen  lds
    s_mov_b32 m0, 75776
    s_add_u32 s29, s50, 2949120
    buffer_load_dwordx4 v104, s[56:59], s29 offen  lds
    s_mov_b32 m0, 76800
    s_add_u32 s29, s50, 2981888
    buffer_load_dwordx4 v105, s[56:59], s29 offen  lds
    s_waitcnt vmcnt(8)
    s_waitcnt lgkmcnt(0)
    s_barrier
    ds_read_b64_tr_b16 v[144:145], v120 offset:0
    ds_read_b64_tr_b16 v[146:147], v120 offset:512
    ds_read_b64_tr_b16 v[148:149], v122 offset:0
    ds_read_b64_tr_b16 v[150:151], v122 offset:512
    ds_read_b64_tr_b16 v[152:153], v121 offset:0
    ds_read_b64_tr_b16 v[154:155], v121 offset:512
    ds_read_b64_tr_b16 v[156:157], v123 offset:0
    ds_read_b64_tr_b16 v[158:159], v123 offset:512
    s_mov_b32 m0, 77824
    s_add_u32 s29, s50, 3407872
    buffer_load_dwordx4 v104, s[56:59], s29 offen  lds
    s_mov_b32 m0, 78848
    s_add_u32 s29, s50, 3440640
    buffer_load_dwordx4 v105, s[56:59], s29 offen  lds
    s_mov_b32 m0, 79872
    s_add_u32 s29, s50, 3473408
    buffer_load_dwordx4 v104, s[56:59], s29 offen  lds
    s_mov_b32 m0, 80896
    s_add_u32 s29, s50, 3506176
    buffer_load_dwordx4 v105, s[56:59], s29 offen  lds
    v_mov_b32 v103, 512
    v_bfe_u32 v101, v100, 4, 1
    v_lshl_add_u32 v103, v101, 10, v103
    v_bfe_u32 v101, v100, 5, 1
    v_lshl_add_u32 v103, v101, 5, v103
    v_bfe_u32 v101, v100, 0, 2
    v_lshl_add_u32 v103, v101, 2, v103
    s_and_b32 s29, s16, 3
    s_lshl_b32 s29, s29, 11
    s_lshr_b32 s30, s16, 3
    s_lshl_b32 s30, s30, 6
    s_add_u32 s29, s29, s30
    s_and_b32 s30, s16, 4
    s_lshl_b32 s30, s30, 2
    s_add_u32 s29, s29, s30
    v_add_u32 v103, s29, v103
    global_load_dword v110, v103, s[48:49]
    s_waitcnt vmcnt(9)
    s_waitcnt lgkmcnt(0)
    s_barrier
    ds_read_b64_tr_b16 v[160:161], v120 offset:4096
    ds_read_b64_tr_b16 v[162:163], v120 offset:4608
    ds_read_b64_tr_b16 v[164:165], v122 offset:4096
    ds_read_b64_tr_b16 v[166:167], v122 offset:4608
    ds_read_b64_tr_b16 v[168:169], v121 offset:4096
    ds_read_b64_tr_b16 v[170:171], v121 offset:4608
    ds_read_b64_tr_b16 v[172:173], v123 offset:4096
    ds_read_b64_tr_b16 v[174:175], v123 offset:4608
    s_mov_b32 m0, 81920
    s_add_u32 s29, s50, 3932160
    buffer_load_dwordx4 v104, s[56:59], s29 offen  lds
    s_mov_b32 m0, 82944
    s_add_u32 s29, s50, 3964928
    buffer_load_dwordx4 v105, s[56:59], s29 offen  lds
    s_mov_b32 m0, 83968
    s_add_u32 s29, s50, 3997696
    buffer_load_dwordx4 v104, s[56:59], s29 offen  lds
    s_mov_b32 m0, 84992
    s_add_u32 s29, s50, 4030464
    buffer_load_dwordx4 v105, s[56:59], s29 offen  lds
    s_waitcnt vmcnt(9)
    s_waitcnt lgkmcnt(0)
    s_barrier
    ds_read_b64_tr_b16 v[176:177], v120 offset:8192
    ds_read_b64_tr_b16 v[178:179], v120 offset:8704
    ds_read_b64_tr_b16 v[180:181], v122 offset:8192
    ds_read_b64_tr_b16 v[182:183], v122 offset:8704
    ds_read_b64_tr_b16 v[184:185], v121 offset:8192
    ds_read_b64_tr_b16 v[186:187], v121 offset:8704
    ds_read_b64_tr_b16 v[188:189], v123 offset:8192
    ds_read_b64_tr_b16 v[190:191], v123 offset:8704
    s_mov_b32 m0, 86016
    s_add_u32 s29, s50, 262144
    buffer_load_dwordx4 v104, s[60:63], s29 offen  lds
    s_mov_b32 m0, 87040
    s_add_u32 s29, s50, 294912
    buffer_load_dwordx4 v105, s[60:63], s29 offen  lds
    s_mov_b32 m0, 88064
    s_add_u32 s29, s50, 327680
    buffer_load_dwordx4 v104, s[60:63], s29 offen  lds
    s_mov_b32 m0, 89088
    s_add_u32 s29, s50, 360448
    buffer_load_dwordx4 v105, s[60:63], s29 offen  lds
    v_mov_b32 v111, 0
    s_mov_b64 exec, 1
    global_load_dword v111, v111, s[6:7] offset:32 sc1
    s_mov_b64 exec, -1
    v_mov_b32 v2, 65536
    v_bfe_u32 v101, v100, 0, 6
    v_lshl_add_u32 v2, v101, 4, v2
    s_waitcnt vmcnt(10)
    s_waitcnt lgkmcnt(0)
    s_barrier
    ds_read_b64_tr_b16 v[192:193], v120 offset:12288
    ds_read_b64_tr_b16 v[194:195], v120 offset:12800
    ds_read_b64_tr_b16 v[196:197], v122 offset:12288
    ds_read_b64_tr_b16 v[198:199], v122 offset:12800
    ds_read_b64_tr_b16 v[200:201], v121 offset:12288
    ds_read_b64_tr_b16 v[202:203], v121 offset:12800
    ds_read_b64_tr_b16 v[204:205], v123 offset:12288
    ds_read_b64_tr_b16 v[206:207], v123 offset:12800
    s_mov_b32 m0, 90112
    s_add_u32 s29, s50, 786432
    buffer_load_dwordx4 v104, s[60:63], s29 offen  lds
    s_mov_b32 m0, 91136
    s_add_u32 s29, s50, 819200
    buffer_load_dwordx4 v105, s[60:63], s29 offen  lds
    s_mov_b32 m0, 92160
    s_add_u32 s29, s50, 851968
    buffer_load_dwordx4 v104, s[60:63], s29 offen  lds
    s_mov_b32 m0, 93184
    s_add_u32 s29, s50, 884736
    buffer_load_dwordx4 v105, s[60:63], s29 offen  lds
    v_mov_b32 v4, 141312
    v_bfe_u32 v101, v100, 0, 3
    v_lshl_add_u32 v4, v101, 5, v4
    v_bfe_u32 v101, v100, 4, 2
    v_lshl_add_u32 v4, v101, 3, v4
    v_bfe_u32 v101, v100, 3, 1
    v_lshl_add_u32 v4, v101, 2, v4
    s_waitcnt vmcnt(9)
    s_waitcnt lgkmcnt(0)
    s_barrier
    ds_read_b64_tr_b16 v[208:209], v120 offset:16384
    ds_read_b64_tr_b16 v[210:211], v120 offset:16896
    ds_read_b64_tr_b16 v[212:213], v122 offset:16384
    ds_read_b64_tr_b16 v[214:215], v122 offset:16896
    ds_read_b64_tr_b16 v[216:217], v121 offset:16384
    ds_read_b64_tr_b16 v[218:219], v121 offset:16896
    ds_read_b64_tr_b16 v[220:221], v123 offset:16384
    ds_read_b64_tr_b16 v[222:223], v123 offset:16896
    s_mov_b32 m0, 94208
    s_add_u32 s29, s50, 1310720
    buffer_load_dwordx4 v104, s[60:63], s29 offen  lds
    s_mov_b32 m0, 95232
    s_add_u32 s29, s50, 1343488
    buffer_load_dwordx4 v105, s[60:63], s29 offen  lds
    s_mov_b32 m0, 96256
    s_add_u32 s29, s50, 1376256
    buffer_load_dwordx4 v104, s[60:63], s29 offen  lds
    s_mov_b32 m0, 97280
    s_add_u32 s29, s50, 1409024
    buffer_load_dwordx4 v105, s[60:63], s29 offen  lds
    v_mov_b32 v5, 139264
    v_bfe_u32 v101, v100, 5, 1
    v_lshl_add_u32 v5, v101, 10, v5
    v_bfe_u32 v101, v100, 0, 5
    v_lshl_add_u32 v5, v101, 3, v5
    s_waitcnt vmcnt(9)
    s_waitcnt lgkmcnt(0)
    s_barrier
    ds_read_b64_tr_b16 v[224:225], v120 offset:20480
    ds_read_b64_tr_b16 v[226:227], v120 offset:20992
    ds_read_b64_tr_b16 v[228:229], v122 offset:20480
    ds_read_b64_tr_b16 v[230:231], v122 offset:20992
    ds_read_b64_tr_b16 v[232:233], v121 offset:20480
    ds_read_b64_tr_b16 v[234:235], v121 offset:20992
    ds_read_b64_tr_b16 v[236:237], v123 offset:20480
    ds_read_b64_tr_b16 v[238:239], v123 offset:20992
    s_mov_b32 m0, 65536
    s_add_u32 s29, s50, 1835008
    buffer_load_dwordx4 v104, s[60:63], s29 offen  lds
    s_mov_b32 m0, 66560
    s_add_u32 s29, s50, 1867776
    buffer_load_dwordx4 v105, s[60:63], s29 offen  lds
    s_mov_b32 m0, 67584
    s_add_u32 s29, s50, 1900544
    buffer_load_dwordx4 v104, s[60:63], s29 offen  lds
    s_mov_b32 m0, 68608
    s_add_u32 s29, s50, 1933312
    buffer_load_dwordx4 v105, s[60:63], s29 offen  lds
    v_mov_b32 v6, 131072
    v_bfe_u32 v101, v100, 2, 4
    v_lshl_add_u32 v6, v101, 6, v6
    v_bfe_u32 v101, v100, 0, 1
    v_lshl_add_u32 v6, v101, 4, v6
    s_waitcnt vmcnt(8)
    s_waitcnt lgkmcnt(0)
    s_barrier
    ds_read_b64_tr_b16 v[240:241], v120 offset:24576
    ds_read_b64_tr_b16 v[242:243], v120 offset:25088
    ds_read_b64_tr_b16 v[244:245], v122 offset:24576
    ds_read_b64_tr_b16 v[246:247], v122 offset:25088
    ds_read_b64_tr_b16 v[248:249], v121 offset:24576
    ds_read_b64_tr_b16 v[250:251], v121 offset:25088
    ds_read_b64_tr_b16 v[252:253], v123 offset:24576
    ds_read_b64_tr_b16 v[254:255], v123 offset:25088
    s_mov_b32 m0, 69632
    s_add_u32 s29, s50, 2359296
    buffer_load_dwordx4 v104, s[60:63], s29 offen  lds
    s_mov_b32 m0, 70656
    s_add_u32 s29, s50, 2392064
    buffer_load_dwordx4 v105, s[60:63], s29 offen  lds
    s_mov_b32 m0, 71680
    s_add_u32 s29, s50, 2424832
    buffer_load_dwordx4 v104, s[60:63], s29 offen  lds
    s_mov_b32 m0, 72704
    s_add_u32 s29, s50, 2457600
    buffer_load_dwordx4 v105, s[60:63], s29 offen  lds
    s_mov_b32 s5, 0
Lrot_3:
    v_readfirstlane_b32 s4, v111
    s_nop 3
    s_sub_u32 s4, s4, 1
    s_cmp_eq_u32 s4, s14
    s_cbranch_scc1 Lrot_3_ok
    s_cmp_lt_u32 s4, 8
    s_cbranch_scc0 Lrot_3_again
    s_mov_b32 s14, s4
    s_waitcnt vmcnt(0) lgkmcnt(0)
    s_barrier
    s_branch Lrole
Lrot_3_again:
    v_mov_b32 v111, 0
    s_mov_b64 exec, 1
    global_load_dword v111, v111, s[6:7] offset:32 sc1
    s_mov_b64 exec, -1
    s_waitcnt vmcnt(0)
    s_add_u32 s5, s5, 1
    s_cmp_lt_u32 s5, 400000
    s_cbranch_scc1 Lrot_3
Lrot_3_ok:
    v_mov_b32 v12, 143872
    v_bfe_u32 v101, v100, 0, 4
    v_lshl_add_u32 v12, v101, 4, v12
    v_bfe_u32 v101, v100, 4, 2
    v_lshl_add_u32 v12, v101, 2, v12
    s_waitcnt vmcnt(8)
    s_waitcnt lgkmcnt(0)
    s_barrier
    ds_read_b64_tr_b16 a[0:1], v120 offset:28672
    ds_read_b64_tr_b16 a[2:3], v120 offset:29184
    ds_read_b64_tr_b16 a[4:5], v122 offset:28672
    ds_read_b64_tr_b16 a[6:7], v122 offset:29184
    ds_read_b64_tr_b16 a[8:9], v121 offset:28672
    ds_read_b64_tr_b16 a[10:11], v121 offset:29184
    ds_read_b64_tr_b16 a[12:13], v123 offset:28672
    ds_read_b64_tr_b16 a[14:15], v123 offset:29184
    s_mov_b32 m0, 73728
    s_add_u32 s29, s50, 2883584
    buffer_load_dwordx4 v104, s[60:63], s29 offen  lds
    s_mov_b32 m0, 74752
    s_add_u32 s29, s50, 2916352
    buffer_load_dwordx4 v105, s[60:63], s29 offen  lds
    s_mov_b32 m0, 75776
    s_add_u32 s29, s50, 2949120
    buffer_load_dwordx4 v104, s[60:63], s29 offen  lds
    s_mov_b32 m0, 76800
    s_add_u32 s29, s50, 2981888
    buffer_load_dwordx4 v105, s[60:63], s29 offen  lds
    v_mov_b32 v7, 131072
    v_bfe_u32 v101, v100, 3, 1
    v_lshl_add_u32 v7, v101, 15, v7
    v_bfe_u32 v101, v100, 4, 2
    v_lshl_add_u32 v7, v101, 13, v7
    v_bfe_u32 v101, v100, 0, 3
    v_lshl_add_u32 v7, v101, 3, v7
    v_mov_b32 v103, 16
    v_bfe_u32 v101, v100, 3, 1
    v_lshl_add_u32 v103, v101, 2, v103
    v_bfe_u32 v101, v100, 4, 2
    v_lshl_add_u32 v103, v101, 0, v103
    v_mul_u32_u24 v103, 0, v103
    v_add_u32 v103, s16, v103
    v_and_b32 v103, 31, v103
    v_lshl_add_u32 v7, v103, 6, v7
    s_waitcnt vmcnt(8)
    s_waitcnt lgkmcnt(0)
    s_barrier
    ds_read_b64_tr_b16 a[16:17], v120 offset:0
    ds_read_b64_tr_b16 a[18:19], v120 offset:512
    ds_read_b64_tr_b16 a[20:21], v122 offset:0
    ds_read_b64_tr_b16 a[22:23], v122 offset:512
    ds_read_b64_tr_b16 a[24:25], v121 offset:0
    ds_read_b64_tr_b16 a[26:27], v121 offset:512
    ds_read_b64_tr_b16 a[28:29], v123 offset:0
    ds_read_b64_tr_b16 a[30:31], v123 offset:512
    s_mov_b32 m0, 77824
    s_add_u32 s29, s50, 3407872
    buffer_load_dwordx4 v104, s[60:63], s29 offen  lds
    s_mov_b32 m0, 78848
    s_add_u32 s29, s50, 3440640
    buffer_load_dwordx4 v105, s[60:63], s29 offen  lds
    s_mov_b32 m0, 79872
    s_add_u32 s29, s50, 3473408
    buffer_load_dwordx4 v104, s[60:63], s29 offen  lds
    s_mov_b32 m0, 80896
    s_add_u32 s29, s50, 3506176
    buffer_load_dwordx4 v105, s[60:63], s29 offen  lds
    v_mov_b32 v1, 131072
    v_bfe_u32 v101, v100, 0, 6
    v_lshl_add_u32 v1, v101, 4, v1
    v_mov_b32 v112, -1
    v_mov_b32 v113, -1
    v_mov_b32 v114, -1
    v_mov_b32 v115, -1
    s_lshl_b32 s22, s16, 13
    s_add_u32 s22, s22, 52432896
    s_xor_b32 s23, s22, 262144
    buffer_store_dwordx4 v[112:115], v1, s[8:11], s22 offen offset:0 sc1
    buffer_store_dwordx4 v[112:115], v1, s[8:11], s22 offen offset:1024 sc1
    buffer_store_dwordx4 v[112:115], v1, s[8:11], s23 offen offset:0 sc1
    buffer_store_dwordx4 v[112:115], v1, s[8:11], s23 offen offset:1024 sc1
    s_waitcnt vmcnt(12)
    s_waitcnt lgkmcnt(0)
    s_barrier
    ds_read_b64_tr_b16 a[32:33], v120 offset:4096
    ds_read_b64_tr_b16 a[34:35], v120 offset:4608
    ds_read_b64_tr_b16 a[36:37], v122 offset:4096
    ds_read_b64_tr_b16 a[38:39], v122 offset:4608
    ds_read_b64_tr_b16 a[40:41], v121 offset:4096
    ds_read_b64_tr_b16 a[42:43], v121 offset:4608
    ds_read_b64_tr_b16 a[44:45], v123 offset:4096
    ds_read_b64_tr_b16 a[46:47], v123 offset:4608
    s_mov_b32 m0, 81920
    s_add_u32 s29, s50, 3932160
    buffer_load_dwordx4 v104, s[60:63], s29 offen  lds
    s_mov_b32 m0, 82944
    s_add_u32 s29, s50, 3964928
    buffer_load_dwordx4 v105, s[60:63], s29 offen  lds
    s_mov_b32 m0, 83968
    s_add_u32 s29, s50, 3997696
    buffer_load_dwordx4 v104, s[60:63], s29 offen  lds
    s_mov_b32 m0, 84992
    s_add_u32 s29, s50, 4030464
    buffer_load_dwordx4 v105, s[60:63], s29 offen  lds
    v_mov_b32 v8, 0
    v_bfe_u32 v101, v100, 4, 2
    v_lshl_add_u32 v8, v101, 4, v8
    v_bfe_u32 v101, v100, 0, 2
    v_lshl_add_u32 v8, v101, 2, v8
    v_bfe_u32 v101, v100, 2, 1
    v_lshl_add_u32 v8, v101, 30, v8
    v_bfe_u32 v101, v100, 3, 1
    v_lshlrev_b32 v101, 30, v101
    v_or_b32 v8, v101, v8
    s_lshl_b32 s24, s16, 6
    s_add_u32 s24, s24, 53088256
    s_add_u32 s29, s24, 8192
    buffer_store_dword v112, v8, s[8:11], s29 offen sc1
    s_add_u32 s29, s24, 16384
    buffer_store_dword v112, v8, s[8:11], s29 offen sc1
    s_add_u32 s29, s24, 24576
    buffer_store_dword v112, v8, s[8:11], s29 offen sc1
    buffer_store_dword v110, v8, s[8:11], s24 offen sc1
    s_waitcnt vmcnt(16)
    s_waitcnt lgkmcnt(0)
    s_barrier
    ds_read_b64_tr_b16 a[48:49], v120 offset:8192
    ds_read_b64_tr_b16 a[50:51], v120 offset:8704
    ds_read_b64_tr_b16 a[52:53], v122 offset:8192
    ds_read_b64_tr_b16 a[54:55], v122 offset:8704
    ds_read_b64_tr_b16 a[56:57], v121 offset:8192
    ds_read_b64_tr_b16 a[58:59], v121 offset:8704
    ds_read_b64_tr_b16 a[60:61], v123 offset:8192
    ds_read_b64_tr_b16 a[62:63], v123 offset:8704
    s_mov_b32 m0, 86016
    s_add_u32 s29, s50, 2359296
    buffer_load_dwordx4 v104, s[52:55], s29 offen  lds
    s_mov_b32 m0, 87040
    s_add_u32 s29, s50, 2392064
    buffer_load_dwordx4 v105, s[52:55], s29 offen  lds
    s_mov_b32 m0, 88064
    s_add_u32 s29, s50, 2424832
    buffer_load_dwordx4 v104, s[52:55], s29 offen  lds
    s_mov_b32 m0, 89088
    s_add_u32 s29, s50, 2457600
    buffer_load_dwordx4 v105, s[52:55], s29 offen  lds
    v_mov_b32 v3, 8192
    v_bfe_u32 v101, v100, 4, 2
    v_lshl_add_u32 v3, v101, 9, v3
    v_bfe_u32 v101, v100, 3, 1
    v_lshl_add_u32 v3, v101, 8, v3
    v_bfe_u32 v101, v100, 0, 3
    v_lshl_add_u32 v3, v101, 4, v3
    s_waitcnt vmcnt(16)
    s_waitcnt lgkmcnt(0)
    s_barrier
    ds_read_b64_tr_b16 a[64:65], v120 offset:12288
    ds_read_b64_tr_b16 a[66:67], v120 offset:12800
    ds_read_b64_tr_b16 a[68:69], v122 offset:12288
    ds_read_b64_tr_b16 a[70:71], v122 offset:12800
    ds_read_b64_tr_b16 a[72:73], v121 offset:12288
    ds_read_b64_tr_b16 a[74:75], v121 offset:12800
    ds_read_b64_tr_b16 a[76:77], v123 offset:12288
    ds_read_b64_tr_b16 a[78:79], v123 offset:12800
    s_mov_b32 m0, 90112
    s_add_u32 s29, s50, 2883584
    buffer_load_dwordx4 v104, s[52:55], s29 offen  lds
    s_mov_b32 m0, 91136
    s_add_u32 s29, s50, 2916352
    buffer_load_dwordx4 v105, s[52:55], s29 offen  lds
    s_mov_b32 m0, 92160
    s_add_u32 s29, s50, 2949120
    buffer_load_dwordx4 v104, s[52:55], s29 offen  lds
    s_mov_b32 m0, 93184
    s_add_u32 s29, s50, 2981888
    buffer_load_dwordx4 v105, s[52:55], s29 offen  lds
    v_mov_b32 v9, 512
    v_bfe_u32 v101, v100, 5, 1
    v_lshl_add_u32 v9, v101, 12, v9
    v_bfe_u32 v101, v100, 4, 1
    v_lshl_add_u32 v9, v101, 10, v9
    v_bfe_u32 v101, v100, 0, 4
    v_lshl_add_u32 v9, v101, 4, v9
    s_waitcnt vmcnt(12)
    s_waitcnt lgkmcnt(0)
    s_barrier
    ds_read_b64_tr_b16 a[80:81], v120 offset:16384
    ds_read_b64_tr_b16 a[82:83], v120 offset:16896
    ds_read_b64_tr_b16 a[84:85], v122 offset:16384
    ds_read_b64_tr_b16 a[86:87], v122 offset:16896
    ds_read_b64_tr_b16 a[88:89], v121 offset:16384
    ds_read_b64_tr_b16 a[90:91], v121 offset:16896
    ds_read_b64_tr_b16 a[92:93], v123 offset:16384
    ds_read_b64_tr_b16 a[94:95], v123 offset:16896
    s_mov_b32 m0, 94208
    s_add_u32 s29, s50, 3407872
    buffer_load_dwordx4 v104, s[52:55], s29 offen  lds
    s_mov_b32 m0, 95232
    s_add_u32 s29, s50, 3440640
    buffer_load_dwordx4 v105, s[52:55], s29 offen  lds
    s_mov_b32 m0, 96256
    s_add_u32 s29, s50, 3473408
    buffer_load_dwordx4 v104, s[52:55], s29 offen  lds
    s_mov_b32 m0, 97280
    s_add_u32 s29, s50, 3506176
    buffer_load_dwordx4 v105, s[52:55], s29 offen  lds
    v_mov_b32 v103, 0
    v_bfe_u32 v101, v100, 0, 2
    v_lshl_add_u32 v103, v101, 2, v103
    v_bfe_u32 v101, v100, 2, 2
    v_lshl_add_u32 v103, v101, 0, v103
    v_and_b32 v102, 1, v103
    v_lshlrev_b32 v102, 4, v102
    v_mov_b32 v101, 0x3f80
    v_lshlrev_b32 v102, v102, v101
    v_lshrrev_b32 v103, 1, v103
    v_cmp_eq_u32 vcc, 0, v103
    s_nop 1
    v_cndmask_b32 v112, 0, v102, vcc
    v_cmp_eq_u32 vcc, 1, v103
    s_nop 1
    v_cndmask_b32 v113, 0, v102, vcc
    v_cmp_eq_u32 vcc, 2, v103
    s_nop 1
    v_cndmask_b32 v114, 0, v102, vcc
    v_cmp_eq_u32 vcc, 3, v103
    s_nop 1
    v_cndmask_b32 v115, 0, v102, vcc
    ds_write_b128 v1, v[112:115] offset:13312
    v_bfe_u32 v101, v100, 1, 1
    v_mul_u32_u24 v101, 0xaaaa, v101
    v_add_u32 v0, 0x4444, v101
    s_waitcnt vmcnt(8)
    s_waitcnt lgkmcnt(0)
    s_barrier
    ds_read_b64_tr_b16 a[96:97], v120 offset:20480
    ds_read_b64_tr_b16 a[98:99], v120 offset:20992
    ds_read_b64_tr_b16 a[100:101], v122 offset:20480
    ds_read_b64_tr_b16 a[102:103], v122 offset:20992
    ds_read_b64_tr_b16 a[104:105], v121 offset:20480
    ds_read_b64_tr_b16 a[106:107], v121 offset:20992
    ds_read_b64_tr_b16 a[108:109], v123 offset:20480
    ds_read_b64_tr_b16 a[110:111], v123 offset:20992
    s_mov_b32 m0, 65536
    s_add_u32 s29, s50, 3932160
    buffer_load_dwordx4 v104, s[52:55], s29 offen  lds
    s_mov_b32 m0, 66560
    s_add_u32 s29, s50, 3964928
    buffer_load_dwordx4 v105, s[52:55], s29 offen  lds
    s_mov_b32 m0, 67584
    s_add_u32 s29, s50, 3997696
    buffer_load_dwordx4 v104, s[52:55], s29 offen  lds
    s_mov_b32 m0, 68608
    s_add_u32 s29, s50, 4030464
    buffer_load_dwordx4 v105, s[52:55], s29 offen  lds
    s_lshl_b32 s18, s16, 14
    s_add_u32 s18, s18, 4096
    s_add_u32 s19, s24, 7733248
    v_mov_b32 v14, v110
    s_mov_b32 s20, 52559872
    s_mov_b32 s17, 0
    s_mov_b32 s28, 0
    s_mov_b32 s32, 0x3e0293ee
    s_mov_b32 s42, 0x3f803f80
    s_mov_b32 s44, 0x3f003f00
    s_mov_b32 s48, 0x33333333
    s_mov_b32 s43, 0x3f803f80
    s_mov_b32 s45, 0x3f003f00
    s_mov_b32 s49, 0x33333333
    s_mov_b32 s34, 0x21800000
    s_mov_b32 s35, 0x3c000000
    s_waitcnt vmcnt(8)
    s_waitcnt lgkmcnt(0)
    s_barrier
    ds_read_b64_tr_b16 a[112:113], v120 offset:24576
    ds_read_b64_tr_b16 a[114:115], v120 offset:25088
    ds_read_b64_tr_b16 a[116:117], v122 offset:24576
    ds_read_b64_tr_b16 a[118:119], v122 offset:25088
    ds_read_b64_tr_b16 a[120:121], v121 offset:24576
    ds_read_b64_tr_b16 a[122:123], v121 offset:25088
    ds_read_b64_tr_b16 a[124:125], v123 offset:24576
    ds_read_b64_tr_b16 a[126:127], v123 offset:25088
    s_mov_b32 m0, 69632
    s_add_u32 s29, s51, 32768
    buffer_load_dwordx4 v108, s[64:67], s29 offen  lds
    s_mov_b32 m0, 70656
    s_add_u32 s29, s51, 36864
    buffer_load_dwordx4 v108, s[64:67], s29 offen  lds
    s_mov_b32 m0, 71680
    s_add_u32 s29, s51, 40960
    buffer_load_dwordx4 v109, s[64:67], s29 offen  lds
    s_mov_b32 m0, 72704
    s_add_u32 s29, s51, 45056
    buffer_load_dwordx4 v109, s[64:67], s29 offen  lds
    v_mov_b32 v126, 132096
    v_bfe_u32 v101, v100, 2, 4
    v_lshl_add_u32 v126, v101, 5, v126
    v_bfe_u32 v101, v100, 0, 1
    v_lshl_add_u32 v126, v101, 4, v126
    v_bfe_u32 v101, v100, 1, 1
    v_lshl_add_u32 v126, v101, 3, v126
    s_waitcnt vmcnt(8)
    s_waitcnt lgkmcnt(0)
    s_barrier
    ds_read_b64_tr_b16 a[128:129], v120 offset:28672
    ds_read_b64_tr_b16 a[130:131], v120 offset:29184
    ds_read_b64_tr_b16 a[132:133], v122 offset:28672
    ds_read_b64_tr_b16 a[134:135], v122 offset:29184
    ds_read_b64_tr_b16 a[136:137], v121 offset:28672
    ds_read_b64_tr_b16 a[138:139], v121 offset:29184
    ds_read_b64_tr_b16 a[140:141], v123 offset:28672
    ds_read_b64_tr_b16 a[142:143], v123 offset:29184
    s_mov_b32 m0, 73728
    s_add_u32 s29, s51, 98304
    buffer_load_dwordx4 v108, s[64:67], s29 offen  lds
    s_mov_b32 m0, 74752
    s_add_u32 s29, s51, 102400
    buffer_load_dwordx4 v108, s[64:67], s29 offen  lds
    s_mov_b32 m0, 75776
    s_add_u32 s29, s51, 106496
    buffer_load_dwordx4 v109, s[64:67], s29 offen  lds
    s_mov_b32 m0, 76800
    s_add_u32 s29, s51, 110592
    buffer_load_dwordx4 v109, s[64:67], s29 offen  lds
    v_mov_b32 v127, 131072
    v_bfe_u32 v101, v100, 2, 4
    v_lshl_add_u32 v127, v101, 5, v127
    v_bfe_u32 v101, v100, 0, 1
    v_lshl_add_u32 v127, v101, 4, v127
    s_waitcnt vmcnt(8)
    s_waitcnt lgkmcnt(0)
    s_barrier
    ds_read_b64_tr_b16 a[144:145], v120 offset:0
    ds_read_b64_tr_b16 a[146:147], v120 offset:512
    ds_read_b64_tr_b16 a[148:149], v122 offset:0
    ds_read_b64_tr_b16 a[150:151], v122 offset:512
    ds_read_b64_tr_b16 a[152:153], v121 offset:0
    ds_read_b64_tr_b16 a[154:155], v121 offset:512
    ds_read_b64_tr_b16 a[156:157], v123 offset:0
    ds_read_b64_tr_b16 a[158:159], v123 offset:512
    s_mov_b32 m0, 77824
    s_add_u32 s29, s51, 33024
    buffer_load_dwordx4 v108, s[64:67], s29 offen  lds
    s_mov_b32 m0, 78848
    s_add_u32 s29, s51, 37120
    buffer_load_dwordx4 v108, s[64:67], s29 offen  lds
    s_mov_b32 m0, 79872
    s_add_u32 s29, s51, 41216
    buffer_load_dwordx4 v109, s[64:67], s29 offen  lds
    s_mov_b32 m0, 80896
    s_add_u32 s29, s51, 45312
    buffer_load_dwordx4 v109, s[64:67], s29 offen  lds
    s_waitcnt vmcnt(8)
    s_waitcnt lgkmcnt(0)
    s_barrier
    ds_read_b64_tr_b16 a[160:161], v124 offset:4096
    ds_read_b64_tr_b16 a[162:163], v124 offset:4608
    ds_read_b64_tr_b16 a[164:165], v124 offset:36864
    ds_read_b64_tr_b16 a[166:167], v124 offset:37376
    ds_read_b64_tr_b16 a[168:169], v125 offset:4096
    ds_read_b64_tr_b16 a[170:171], v125 offset:4608
    ds_read_b64_tr_b16 a[172:173], v125 offset:36864
    ds_read_b64_tr_b16 a[174:175], v125 offset:37376
    s_mov_b32 m0, 81920
    s_add_u32 s29, s51, 98560
    buffer_load_dwordx4 v108, s[64:67], s29 offen  lds
    s_mov_b32 m0, 82944
    s_add_u32 s29, s51, 102656
    buffer_load_dwordx4 v108, s[64:67], s29 offen  lds
    s_mov_b32 m0, 83968
    s_add_u32 s29, s51, 106752
    buffer_load_dwordx4 v109, s[64:67], s29 offen  lds
    s_mov_b32 m0, 84992
    s_add_u32 s29, s51, 110848
    buffer_load_dwordx4 v109, s[64:67], s29 offen  lds
    s_waitcnt vmcnt(8)
    s_waitcnt lgkmcnt(0)
    s_barrier
    ds_read_b64_tr_b16 a[176:177], v124 offset:8192
    ds_read_b64_tr_b16 a[178:179], v124 offset:8704
    ds_read_b64_tr_b16 a[180:181], v124 offset:40960
    ds_read_b64_tr_b16 a[182:183], v124 offset:41472
    ds_read_b64_tr_b16 a[184:185], v125 offset:8192
    ds_read_b64_tr_b16 a[186:187], v125 offset:8704
    ds_read_b64_tr_b16 a[188:189], v125 offset:40960
    ds_read_b64_tr_b16 a[190:191], v125 offset:41472
    s_mov_b32 m0, 86016
    s_add_u32 s29, s51, 33280
    buffer_load_dwordx4 v108, s[64:67], s29 offen  lds
    s_mov_b32 m0, 87040
    s_add_u32 s29, s51, 37376
    buffer_load_dwordx4 v108, s[64:67], s29 offen  lds
    s_mov_b32 m0, 88064
    s_add_u32 s29, s51, 41472
    buffer_load_dwordx4 v109, s[64:67], s29 offen  lds
    s_mov_b32 m0, 89088
    s_add_u32 s29, s51, 45568
    buffer_load_dwordx4 v109, s[64:67], s29 offen  lds
    s_waitcnt vmcnt(8)
    s_waitcnt lgkmcnt(0)
    s_barrier
    ds_read_b64_tr_b16 a[192:193], v124 offset:12288
    ds_read_b64_tr_b16 a[194:195], v124 offset:12800
    ds_read_b64_tr_b16 a[196:197], v124 offset:45056
    ds_read_b64_tr_b16 a[198:199], v124 offset:45568
    ds_read_b64_tr_b16 a[200:201], v125 offset:12288
    ds_read_b64_tr_b16 a[202:203], v125 offset:12800
    ds_read_b64_tr_b16 a[204:205], v125 offset:45056
    ds_read_b64_tr_b16 a[206:207], v125 offset:45568
    s_mov_b32 m0, 90112
    s_add_u32 s29, s51, 98816
    buffer_load_dwordx4 v108, s[64:67], s29 offen  lds
    s_mov_b32 m0, 91136
    s_add_u32 s29, s51, 102912
    buffer_load_dwordx4 v108, s[64:67], s29 offen  lds
    s_mov_b32 m0, 92160
    s_add_u32 s29, s51, 107008
    buffer_load_dwordx4 v109, s[64:67], s29 offen  lds
    s_mov_b32 m0, 93184
    s_add_u32 s29, s51, 111104
    buffer_load_dwordx4 v109, s[64:67], s29 offen  lds
    s_waitcnt vmcnt(8)
    s_waitcnt lgkmcnt(0)
    s_barrier
    ds_read_b64_tr_b16 a[208:209], v124 offset:16384
    ds_read_b64_tr_b16 a[210:211], v124 offset:16896
    ds_read_b64_tr_b16 a[212:213], v124 offset:49152
    ds_read_b64_tr_b16 a[214:215], v124 offset:49664
    ds_read_b64_tr_b16 a[216:217], v125 offset:16384
    ds_read_b64_tr_b16 a[218:219], v125 offset:16896
    ds_read_b64_tr_b16 a[220:221], v125 offset:49152
    ds_read_b64_tr_b16 a[222:223], v125 offset:49664
    s_mov_b32 m0, 94208
    s_add_u32 s29, s50, 1835008
    buffer_load_dwordx4 v104, s[52:55], s29 offen  lds
    s_mov_b32 m0, 95232
    s_add_u32 s29, s50, 1867776
    buffer_load_dwordx4 v105, s[52:55], s29 offen  lds
    s_mov_b32 m0, 96256
    s_add_u32 s29, s50, 1900544
    buffer_load_dwordx4 v104, s[52:55], s29 offen  lds
    s_mov_b32 m0, 97280
    s_add_u32 s29, s50, 1933312
    buffer_load_dwordx4 v105, s[52:55], s29 offen  lds
    v_mov_b32 v118, 0
    s_mov_b64 exec, 1
    global_load_dwordx2 v[114:115], v118, s[6:7] offset:128 sc1
    s_mov_b64 exec, -1
    s_waitcnt vmcnt(9)
    s_waitcnt lgkmcnt(0)
    s_barrier
    ds_read_b64_tr_b16 a[224:225], v124 offset:20480
    ds_read_b64_tr_b16 a[226:227], v124 offset:20992
    ds_read_b64_tr_b16 a[228:229], v124 offset:53248
    ds_read_b64_tr_b16 a[230:231], v124 offset:53760
    ds_read_b64_tr_b16 a[232:233], v125 offset:20480
    ds_read_b64_tr_b16 a[234:235], v125 offset:20992
    ds_read_b64_tr_b16 a[236:237], v125 offset:53248
    ds_read_b64_tr_b16 a[238:239], v125 offset:53760
    s_mov_b32 m0, 65536
    s_add_u32 s29, s50, 262144
    buffer_load_dwordx4 v104, s[52:55], s29 offen  lds
    s_mov_b32 m0, 66560
    s_add_u32 s29, s50, 294912
    buffer_load_dwordx4 v105, s[52:55], s29 offen  lds
    s_mov_b32 m0, 67584
    s_add_u32 s29, s50, 327680
    buffer_load_dwordx4 v104, s[52:55], s29 offen  lds
    s_mov_b32 m0, 68608
    s_add_u32 s29, s50, 360448
    buffer_load_dwordx4 v105, s[52:55], s29 offen  lds
    s_waitcnt vmcnt(9)
    s_waitcnt lgkmcnt(0)
    s_barrier
    ds_read_b64_tr_b16 a[240:241], v124 offset:24576
    ds_read_b64_tr_b16 a[242:243], v124 offset:25088
    ds_read_b64_tr_b16 a[244:245], v124 offset:57344
    ds_read_b64_tr_b16 a[246:247], v124 offset:57856
    ds_read_b64_tr_b16 a[248:249], v125 offset:24576
    ds_read_b64_tr_b16 a[250:251], v125 offset:25088
    ds_read_b64_tr_b16 a[252:253], v125 offset:57344
    ds_read_b64_tr_b16 a[254:255], v125 offset:57856
    s_mov_b32 m0, 69632
    s_add_u32 s29, s50, 786432
    buffer_load_dwordx4 v104, s[52:55], s29 offen  lds
    s_mov_b32 m0, 70656
    s_add_u32 s29, s50, 819200
    buffer_load_dwordx4 v105, s[52:55], s29 offen  lds
    s_mov_b32 m0, 71680
    s_add_u32 s29, s50, 851968
    buffer_load_dwordx4 v104, s[52:55], s29 offen  lds
    s_mov_b32 m0, 72704
    s_add_u32 s29, s50, 884736
    buffer_load_dwordx4 v105, s[52:55], s29 offen  lds
    s_waitcnt vmcnt(9)
    s_waitcnt lgkmcnt(0)
    s_barrier
    ds_read_b64_tr_b16 v[32:33], v120 offset:28672
    ds_read_b64_tr_b16 v[34:35], v120 offset:29184
    ds_read_b64_tr_b16 v[36:37], v122 offset:28672
    ds_read_b64_tr_b16 v[38:39], v122 offset:29184
    ds_read_b64_tr_b16 v[40:41], v121 offset:28672
    ds_read_b64_tr_b16 v[42:43], v121 offset:29184
    ds_read_b64_tr_b16 v[44:45], v123 offset:28672
    ds_read_b64_tr_b16 v[46:47], v123 offset:29184
    s_mov_b32 m0, 73728
    s_add_u32 s29, s50, 1310720
    buffer_load_dwordx4 v104, s[52:55], s29 offen  lds
    s_mov_b32 m0, 74752
    s_add_u32 s29, s50, 1343488
    buffer_load_dwordx4 v105, s[52:55], s29 offen  lds
    s_mov_b32 m0, 75776
    s_add_u32 s29, s50, 1376256
    buffer_load_dwordx4 v104, s[52:55], s29 offen  lds
    s_mov_b32 m0, 76800
    s_add_u32 s29, s50, 1409024
    buffer_load_dwordx4 v105, s[52:55], s29 offen  lds
    s_waitcnt vmcnt(8)
    s_waitcnt lgkmcnt(0)
    s_barrier
    ds_read_b64_tr_b16 v[16:17], v120 offset:0
    ds_read_b64_tr_b16 v[18:19], v120 offset:512
    ds_read_b64_tr_b16 v[20:21], v122 offset:0
    ds_read_b64_tr_b16 v[22:23], v122 offset:512
    ds_read_b64_tr_b16 v[24:25], v121 offset:0
    ds_read_b64_tr_b16 v[26:27], v121 offset:512
    ds_read_b64_tr_b16 v[28:29], v123 offset:0
    ds_read_b64_tr_b16 v[30:31], v123 offset:512
    ds_write_b128 v1, v[32:35] offset:24576
    ds_write_b128 v1, v[36:39] offset:25600
    ds_write_b128 v1, v[40:43] offset:26624
    ds_write_b128 v1, v[44:47] offset:27648
    s_mov_b32 m0, 77824
    s_add_u32 s29, s50, 262144
    buffer_load_dwordx4 v104, s[56:59], s29 offen  lds
    s_mov_b32 m0, 78848
    s_add_u32 s29, s50, 294912
    buffer_load_dwordx4 v105, s[56:59], s29 offen  lds
    s_mov_b32 m0, 79872
    s_add_u32 s29, s50, 327680
    buffer_load_dwordx4 v104, s[56:59], s29 offen  lds
    s_mov_b32 m0, 80896
    s_add_u32 s29, s50, 360448
    buffer_load_dwordx4 v105, s[56:59], s29 offen  lds
    s_waitcnt vmcnt(8)
    s_waitcnt lgkmcnt(0)
    s_barrier
    ds_read_b64_tr_b16 v[32:33], v120 offset:4096
    ds_read_b64_tr_b16 v[34:35], v120 offset:4608
    ds_read_b64_tr_b16 v[36:37], v122 offset:4096
    ds_read_b64_tr_b16 v[38:39], v122 offset:4608
    ds_read_b64_tr_b16 v[40:41], v121 offset:4096
    ds_read_b64_tr_b16 v[42:43], v121 offset:4608
    ds_read_b64_tr_b16 v[44:45], v123 offset:4096
    ds_read_b64_tr_b16 v[46:47], v123 offset:4608
    ds_write_b128 v2, v[16:19] offset:0
    ds_write_b128 v2, v[20:23] offset:1024
    ds_write_b128 v2, v[24:27] offset:2048
    ds_write_b128 v2, v[28:31] offset:3072
    s_mov_b32 m0, 81920
    s_add_u32 s29, s50, 786432
    buffer_load_dwordx4 v104, s[56:59], s29 offen  lds
    s_mov_b32 m0, 82944
    s_add_u32 s29, s50, 819200
    buffer_load_dwordx4 v105, s[56:59], s29 offen  lds
    s_mov_b32 m0, 83968
    s_add_u32 s29, s50, 851968
    buffer_load_dwordx4 v104, s[56:59], s29 offen  lds
    s_mov_b32 m0, 84992
    s_add_u32 s29, s50, 884736
    buffer_load_dwordx4 v105, s[56:59], s29 offen  lds
    s_mov_b32 s27, 0
Tln_2:
    v_and_b32 v114, v114, v115
    s_nop 0
    v_readfirstlane_b32 s39, v114
    s_nop 3
    s_cmp_eq_u32 s39, -1
    s_cbranch_scc1 Tlnd_2
    v_mov_b32 v118, 0
    s_mov_b64 exec, 1
    global_load_dwordx2 v[114:115], v118, s[6:7] offset:128 sc1
    s_mov_b64 exec, -1
    s_waitcnt vmcnt(0)
    s_add_u32 s27, s27, 1
    s_cmp_lt_u32 s27, 400000
    s_cbranch_scc1 Tln_2
Tlnd_2:
    s_waitcnt vmcnt(8)
    s_waitcnt lgkmcnt(0)
    s_barrier
    ds_read_b64_tr_b16 v[16:17], v120 offset:8192
    ds_read_b64_tr_b16 v[18:19], v120 offset:8704
    ds_read_b64_tr_b16 v[20:21], v122 offset:8192
    ds_read_b64_tr_b16 v[22:23], v122 offset:8704
    ds_read_b64_tr_b16 v[24:25], v121 offset:8192
    ds_read_b64_tr_b16 v[26:27], v121 offset:8704
    ds_read_b64_tr_b16 v[28:29], v123 offset:8192
    ds_read_b64_tr_b16 v[30:31], v123 offset:8704
    ds_write_b128 v2, v[32:35] offset:4096
    ds_write_b128 v2, v[36:39] offset:5120
    ds_write_b128 v2, v[40:43] offset:6144
    ds_write_b128 v2, v[44:47] offset:7168
    s_mov_b32 m0, 86016
    s_add_u32 s29, s50, 1310720
    buffer_load_dwordx4 v104, s[56:59], s29 offen  lds
    s_mov_b32 m0, 87040
    s_add_u32 s29, s50, 1343488
    buffer_load_dwordx4 v105, s[56:59], s29 offen  lds
    s_mov_b32 m0, 88064
    s_add_u32 s29, s50, 1376256
    buffer_load_dwordx4 v104, s[56:59], s29 offen  lds
    s_mov_b32 m0, 89088
    s_add_u32 s29, s50, 1409024
    buffer_load_dwordx4 v105, s[56:59], s29 offen  lds
    v_mov_b32 v118, 0
    v_lshlrev_b32 v119, 12, v100
    s_lshl_b32 s38, s16, 7
    s_add_u32 s38, s38, 58720260
    s_mov_b64 exec, 1
    global_load_dwordx2 v[116:117], v118, s[6:7] sc1
    s_mov_b64 exec, 3
    buffer_load_dword v113, v119, s[8:11], s38 offen sc1
    s_mov_b64 exec, -1
    s_waitcnt vmcnt(10)
    s_waitcnt lgkmcnt(0)
    s_barrier
    ds_read_b64_tr_b16 v[32:33], v120 offset:12288
    ds_read_b64_tr_b16 v[34:35], v120 offset:12800
    ds_read_b64_tr_b16 v[36:37], v122 offset:12288
    ds_read_b64_tr_b16 v[38:39], v122 offset:12800
    ds_read_b64_tr_b16 v[40:41], v121 offset:12288
    ds_read_b64_tr_b16 v[42:43], v121 offset:12800
    ds_read_b64_tr_b16 v[44:45], v123 offset:12288
    ds_read_b64_tr_b16 v[46:47], v123 offset:12800
    ds_write_b128 v2, v[16:19] offset:8192
    ds_write_b128 v2, v[20:23] offset:9216
    ds_write_b128 v2, v[24:27] offset:10240
    ds_write_b128 v2, v[28:31] offset:11264
    s_mov_b32 m0, 90112
    s_add_u32 s29, s51, 33536
    buffer_load_dwordx4 v108, s[64:67], s29 offen  lds
    s_mov_b32 m0, 91136
    s_add_u32 s29, s51, 37632
    buffer_load_dwordx4 v108, s[64:67], s29 offen  lds
    s_mov_b32 m0, 92160
    s_add_u32 s29, s51, 41728
    buffer_load_dwordx4 v109, s[64:67], s29 offen  lds
    s_mov_b32 m0, 93184
    s_add_u32 s29, s51, 45824
    buffer_load_dwordx4 v109, s[64:67], s29 offen  lds
    s_waitcnt vmcnt(10)
    s_waitcnt lgkmcnt(0)
    s_barrier
    ds_read_b64_tr_b16 v[16:17], v120 offset:16384
    ds_read_b64_tr_b16 v[18:19], v120 offset:16896
    ds_read_b64_tr_b16 v[20:21], v122 offset:16384
    ds_read_b64_tr_b16 v[22:23], v122 offset:16896
    ds_read_b64_tr_b16 v[24:25], v121 offset:16384
    ds_read_b64_tr_b16 v[26:27], v121 offset:16896
    ds_read_b64_tr_b16 v[28:29], v123 offset:16384
    ds_read_b64_tr_b16 v[30:31], v123 offset:16896
    ds_write_b128 v2, v[32:35] offset:12288
    ds_write_b128 v2, v[36:39] offset:13312
    ds_write_b128 v2, v[40:43] offset:14336
    ds_write_b128 v2, v[44:47] offset:15360
    s_mov_b32 m0, 94208
    s_add_u32 s29, s51, 99072
    buffer_load_dwordx4 v108, s[64:67], s29 offen  lds
    s_mov_b32 m0, 95232
    s_add_u32 s29, s51, 103168
    buffer_load_dwordx4 v108, s[64:67], s29 offen  lds
    s_mov_b32 m0, 96256
    s_add_u32 s29, s51, 107264
    buffer_load_dwordx4 v109, s[64:67], s29 offen  lds
    s_mov_b32 m0, 97280
    s_add_u32 s29, s51, 111360
    buffer_load_dwordx4 v109, s[64:67], s29 offen  lds
    s_waitcnt vmcnt(10)
    s_waitcnt lgkmcnt(0)
    s_barrier
    ds_read_b64_tr_b16 v[32:33], v120 offset:20480
    ds_read_b64_tr_b16 v[34:35], v120 offset:20992
    ds_read_b64_tr_b16 v[36:37], v122 offset:20480
    ds_read_b64_tr_b16 v[38:39], v122 offset:20992
    ds_read_b64_tr_b16 v[40:41], v121 offset:20480
    ds_read_b64_tr_b16 v[42:43], v121 offset:20992
    ds_read_b64_tr_b16 v[44:45], v123 offset:20480
    ds_read_b64_tr_b16 v[46:47], v123 offset:20992
    ds_write_b128 v2, v[16:19] offset:16384
    ds_write_b128 v2, v[20:23] offset:17408
    ds_write_b128 v2, v[24:27] offset:18432
    ds_write_b128 v2, v[28:31] offset:19456
    s_mov_b32 s27, 0
    s_waitcnt vmcnt(8)
Tmeet_2:
    v_sad_u8 v112, v116, 0, 0
    v_sad_u8 v112, v117, 0, v112
    v_cmp_eq_u32 vcc, 1, v113
    v_readfirstlane_b32 s40, v112
    v_readfirstlane_b32 s36, v116
    v_readfirstlane_b32 s37, v117
    s_nop 3
    s_xor_b32 s40, s40, 32
    s_andn2_b32 s39, 3, vcc_lo
    s_or_b32 s40, s40, s39
    s_cbranch_scc0 Tmet_2
    v_mov_b32 v118, 0
    v_lshlrev_b32 v119, 12, v100
    s_lshl_b32 s38, s16, 7
    s_add_u32 s38, s38, 58720260
    s_mov_b64 exec, 1
    global_load_dwordx2 v[116:117], v118, s[6:7] sc1
    s_mov_b64 exec, 3
    buffer_load_dword v113, v119, s[8:11], s38 offen sc1
    s_mov_b64 exec, -1
    s_waitcnt vmcnt(0)
    s_add_u32 s27, s27, 1
    s_cmp_lt_u32 s27, 400000
    s_cbranch_scc1 Tmeet_2
Tmet_2:
    s_getreg_b32 s38, hwreg(HW_REG_XCC_ID, 0, 3)
    s_lshl_b32 s38, s38, 3
    s_lshl_b64 s[38:39], 32, s38
    s_cmp_eq_u64 s[36:37], s[38:39]
    s_cselect_b32 s41, 1, 0
    s_add_u32 s33, s18, 8192
    buffer_load_dwordx4 v[128:131], v9, s[8:11], s18 offen sc1
    buffer_load_dwordx4 v[132:135], v9, s[8:11], s33 offen sc1
    buffer_load_dwordx4 v[136:139], v3, s[8:11], s18 offen offset:2048 sc1
    buffer_load_dwordx4 v[140:143], v3, s[8:11], s18 offen offset:2176 sc1
    v_and_b32 v112, 15, v100
    v_lshlrev_b32 v112, 7, v112
    v_lshrrev_b32 v113, 4, v100
    v_lshl_add_u32 v114, v113, 13, v112
    s_mov_b32 s38, 53088256
    buffer_load_dword v114, v114, s[8:11], s38 offen sc1
    v_and_b32 v113, 1, v113
    v_lshl_add_u32 v115, v113, 18, v112
    s_add_u32 s38, s22, 131072
    buffer_load_dword v115, v115, s[8:11], s38 offen sc1
    s_waitcnt vmcnt(10)
    s_waitcnt lgkmcnt(0)
    s_barrier
    ds_read_b64_tr_b16 v[16:17], v124 offset:24576
    ds_read_b64_tr_b16 v[18:19], v124 offset:25088
    ds_read_b64_tr_b16 v[20:21], v124 offset:57344
    ds_read_b64_tr_b16 v[22:23], v124 offset:57856
    ds_read_b64_tr_b16 v[24:25], v125 offset:24576
    ds_read_b64_tr_b16 v[26:27], v125 offset:25088
    ds_read_b64_tr_b16 v[28:29], v125 offset:57344
    ds_read_b64_tr_b16 v[30:31], v125 offset:57856
    ds_write_b128 v2, v[32:35] offset:20480
    ds_write_b128 v2, v[36:39] offset:21504
    ds_write_b128 v2, v[40:43] offset:22528
    ds_write_b128 v2, v[44:47] offset:23552
    s_waitcnt vmcnt(6)
    s_waitcnt lgkmcnt(0)
    s_barrier
    ds_read_b64_tr_b16 v[32:33], v124 offset:28672
    ds_read_b64_tr_b16 v[34:35], v124 offset:29184
    ds_read_b64_tr_b16 v[36:37], v124 offset:61440
    ds_read_b64_tr_b16 v[38:39], v124 offset:61952
    ds_read_b64_tr_b16 v[40:41], v125 offset:28672
    ds_read_b64_tr_b16 v[42:43], v125 offset:29184
    ds_read_b64_tr_b16 v[44:45], v125 offset:61440
    ds_read_b64_tr_b16 v[46:47], v125 offset:61952
    ds_write_b128 v2, v[16:19] offset:24576
    ds_write_b128 v2, v[20:23] offset:25600
    ds_write_b128 v2, v[24:27] offset:26624
    ds_write_b128 v2, v[28:31] offset:27648
    s_waitcnt lgkmcnt(0)
    s_barrier
    ds_write_b128 v2, v[32:35] offset:28672
    ds_write_b128 v2, v[36:39] offset:29696
    ds_write_b128 v2, v[40:43] offset:30720
    ds_write_b128 v2, v[44:47] offset:31744
    s_waitcnt lgkmcnt(0)
    s_waitcnt vmcnt(0)
    s_cmp_eq_u32 s41, 0
    s_cbranch_scc1 Tslow_2
Tfast_2:
    s_mov_b32 s27, 0
    s_mov_b32 s46, 0
    v_mov_b32 v13, -1
    v_mov_b64 v[122:123], s[42:43]
    v_mov_b64 v[124:125], s[42:43]
    v_mov_b64 v[120:121], s[44:45]
    s_mov_b32 s26, 52957184
    s_add_u32 s21, s20, 4096
    s_lshl_b32 s54, s16, 7
    s_add_u32 s54, s54, 58720260
    s_add_u32 s51, s54, 4096
    s_add_u32 s18, s18, 524288
    s_add_u32 s33, s18, 8192
    s_add_u32 s51, s51, 4096
    v_mov_b64 v[72:73], v[128:129]
    ds_read_b128 v[32:35], v2 offset:0
    v_mov_b64 v[74:75], v[130:131]
    ds_read_b128 v[36:39], v2 offset:1024
    v_mov_b64 v[76:77], v[132:133]
    ds_read_b128 v[88:91], v2 offset:6144
    v_mov_b64 v[78:79], v[134:135]
    ds_read_b128 v[92:95], v2 offset:7168
    v_mov_b64 v[80:81], v[136:137]
    ds_read_b128 v[96:99], v2 offset:8192
    v_mov_b64 v[82:83], v[138:139]
    ds_read_b128 v[100:103], v2 offset:9216
    v_mov_b64 v[84:85], v[140:141]
    ds_read_b128 v[104:107], v2 offset:10240
    v_mov_b64 v[86:87], v[142:143]
    ds_read_b128 v[108:111], v2 offset:11264
    v_mov_b64 v[48:49], 0
    ds_read_b128 v[112:115], v1 offset:24576
    v_mov_b64 v[50:51], 0
    ds_read_b128 v[116:119], v1 offset:25600
    v_mov_b64 v[52:53], 0
    ds_read_b128 v[64:67], v1 offset:26624
    v_mov_b64 v[54:55], 0
    ds_read_b128 v[68:71], v1 offset:27648
    s_branch Tstep_2
.p2align 6
Tstep_2:
    buffer_load_dwordx4 v[40:43], v1, s[8:11], s26 offen offset:0 sc1
    buffer_load_dwordx4 v[44:47], v1, s[8:11], s26 offen offset:1024 sc1
    v_mov_b64 v[56:57], 0
    ds_read_b128 v[128:131], v2 offset:2048
    v_mov_b64 v[58:59], 0
    ds_read_b128 v[132:135], v2 offset:3072
    v_mov_b64 v[60:61], 0
    ds_read_b128 v[136:139], v2 offset:4096
    v_mov_b64 v[62:63], 0
    ds_read_b128 v[140:143], v2 offset:5120
    s_nop 15
    s_nop 1
    buffer_load_dwordx4 v[40:43], v1, s[8:11], s26 offen offset:0 sc1
    buffer_load_dwordx4 v[44:47], v1, s[8:11], s26 offen offset:1024 sc1
    s_waitcnt vmcnt(3)
    v_max3_u32 v11, v40, v41, v42
    v_max_u32 v11, v11, v43
    ds_write_b128 v1, v[40:43] offset:4096
    s_waitcnt vmcnt(2)
    v_max3_u32 v11, v11, v44, v45
    v_max3_u32 v11, v11, v46, v47
    v_cmp_eq_u32 vcc, -1, v11
    ds_write_b128 v1, v[44:47] offset:5120
    s_cbranch_vccnz Tr2_2
Tok2_2:
    s_barrier
    ds_read_b128 v[16:19], v1 offset:0
    ds_read_b128 v[20:23], v1 offset:1024
    buffer_store_dword v14, v8, s[8:11], s19 offen sc1
    s_waitcnt lgkmcnt(2)
    s_barrier
    ds_read_b128 v[24:27], v1 offset:2048
    ds_read_b128 v[28:31], v1 offset:3072
    s_waitcnt lgkmcnt(3)
    v_smfmac_f32_16x16x64_bf16 v[48:51], v[16:19], v[32:39], v0
    ds_read_b128 v[32:35], v1 offset:4096
    v_smfmac_f32_16x16x64_bf16 v[52:55], v[16:19], v[128:135], v0
    ds_read_b128 v[36:39], v1 offset:5120
    s_waitcnt lgkmcnt(4)
    v_smfmac_f32_16x16x64_bf16 v[48:51], v[20:23], v[136:143], v0
    s_waitcnt vmcnt(1)
    ds_read_b128 v[40:43], v1 offset:6144
    v_smfmac_f32_16x16x64_bf16 v[52:55], v[20:23], v[88:95], v0
    ds_read_b128 v[44:47], v1 offset:7168
    s_waitcnt lgkmcnt(5)
    v_smfmac_f32_16x16x64_bf16 v[48:51], v[24:27], v[96:103], v0
    buffer_load_dwordx4 v[128:131], v9, s[8:11], s18 offen sc1
    s_waitcnt lgkmcnt(3)
    v_smfmac_f32_16x16x64_bf16 v[48:51], v[28:31], v[112:119], v0
    ds_read_b128 v[88:91], v2 offset:12288
    s_waitcnt lgkmcnt(3)
    v_smfmac_f32_16x16x64_bf16 v[48:51], v[32:35], a[96:103], v0
    buffer_load_dwordx4 v[132:135], v9, s[8:11], s33 offen sc1
    v_smfmac_f32_16x16x64_bf16 v[48:51], v[36:39], a[112:119], v0
    ds_read_b128 v[92:95], v2 offset:13312
    s_waitcnt lgkmcnt(2)
    v_smfmac_f32_16x16x64_bf16 v[48:51], v[40:43], a[128:135], v0
    buffer_load_dwordx4 v[136:139], v3, s[8:11], s18 offen offset:2048 sc1
    v_smfmac_f32_16x16x64_bf16 v[48:51], v[44:47], a[144:151], v0
    s_nop 1
    s_waitcnt lgkmcnt(1)
    v_smfmac_f32_16x16x64_bf16 v[52:55], v[24:27], v[104:111], v0
    buffer_load_dwordx4 v[140:143], v3, s[8:11], s18 offen offset:2176 sc1
    v_smfmac_f32_16x16x64_bf16 v[52:55], v[28:31], v[64:71], v0
    s_waitcnt lgkmcnt(0)
    s_nop 0
    v_add_f32 v48, v48, v50
    v_smfmac_f32_16x16x64_bf16 v[52:55], v[32:35], a[104:111], v0
    ds_read_b128 v[96:99], v2 offset:16384
    v_add_f32 v49, v49, v51
    v_smfmac_f32_16x16x64_bf16 v[52:55], v[36:39], a[120:127], v0
    ds_read_b128 v[100:103], v2 offset:17408
    v_mul_f32 v48, s32, v48
    v_smfmac_f32_16x16x64_bf16 v[52:55], v[40:43], a[136:143], v0
    ds_read_b128 v[104:107], v2 offset:20480
    v_mul_f32 v49, s32, v49
    v_smfmac_f32_16x16x64_bf16 v[52:55], v[44:47], a[152:159], v0
    s_nop 1
    v_cvt_pk_bf16_f32 v48, v48, v49
    v_smfmac_f32_16x16x64_bf16 v[56:59], v[28:31], v[144:151], v0
    ds_write_b32 v4, v48 offset:0
    v_smfmac_f32_16x16x64_bf16 v[56:59], v[32:35], v[160:167], v0
    s_waitcnt lgkmcnt(2)
    s_nop 0
    v_add_f32 v52, v52, v54
    v_smfmac_f32_16x16x64_bf16 v[56:59], v[16:19], v[88:95], v0
    ds_read_b128 v[108:111], v2 offset:21504
    v_add_f32 v53, v53, v55
    v_mul_f32 v52, s32, v52
    v_smfmac_f32_16x16x64_bf16 v[56:59], v[20:23], v[96:103], v0
    ds_read_b128 v[112:115], v2 offset:14336
    v_mul_f32 v53, s32, v53
    v_smfmac_f32_16x16x64_bf16 v[56:59], v[36:39], v[176:183], v0
    ds_read_b128 v[116:119], v2 offset:15360
    v_cvt_pk_bf16_f32 v52, v52, v53
    v_smfmac_f32_16x16x64_bf16 v[56:59], v[40:43], v[192:199], v0
    ds_write_b32 v4, v52 offset:256
    v_smfmac_f32_16x16x64_bf16 v[56:59], v[44:47], v[208:215], v0
    ds_read_b128 v[88:91], v2 offset:18432
    s_waitcnt lgkmcnt(4)
    v_smfmac_f32_16x16x64_bf16 v[56:59], v[24:27], v[104:111], v0
    ds_read_b128 v[92:95], v2 offset:19456
    s_waitcnt lgkmcnt(4)
    v_smfmac_f32_16x16x64_bf16 v[60:63], v[28:31], v[152:159], v0
    ds_read_b128 v[96:99], v2 offset:22528
    ds_read_b128 v[100:103], v2 offset:23552
    v_smfmac_f32_16x16x64_bf16 v[60:63], v[32:35], v[168:175], v0
    s_waitcnt lgkmcnt(4)
    s_barrier
    v_smfmac_f32_16x16x64_bf16 v[60:63], v[36:39], v[184:191], v0
    ds_read_b64_tr_b16 v[104:105], v5 offset:0
    v_add_f32 v56, v56, v58
    v_smfmac_f32_16x16x64_bf16 v[60:63], v[40:43], v[200:207], v0
    ds_read_b64_tr_b16 v[106:107], v5 offset:256
    v_add_f32 v57, v57, v59
    v_smfmac_f32_16x16x64_bf16 v[60:63], v[44:47], v[216:223], v0
    ds_read_b64_tr_b16 v[108:109], v5 offset:2048
    v_cvt_pk_bf16_f32 v56, v56, v57
    v_smfmac_f32_16x16x64_bf16 v[60:63], v[16:19], v[112:119], v0
    ds_read_b64_tr_b16 v[110:111], v5 offset:2304
    s_waitcnt lgkmcnt(4)
    v_mov_b64 v[64:65], 0
    v_smfmac_f32_16x16x64_bf16 v[60:63], v[20:23], v[88:95], v0
    ds_write_b32 v4, v56 offset:512
    v_smfmac_f32_16x16x64_bf16 v[60:63], v[24:27], v[96:103], v0
    s_waitcnt lgkmcnt(3)
    v_mov_b64 v[66:67], 0
    v_mfma_f32_16x16x32_bf16 v[48:51], v[72:75], v[104:107], 0
    s_waitcnt lgkmcnt(1)
    v_mov_b64 v[68:69], 0
    v_mov_b64 v[70:71], 0
    v_mfma_f32_16x16x32_bf16 v[48:51], v[76:79], v[108:111], v[48:51]
    s_nop 0
    v_add_f32 v60, v60, v62
    v_add_f32 v61, v61, v63
    v_cvt_pk_bf16_f32 v60, v60, v61
    v_smfmac_f32_16x16x64_bf16 v[64:67], v[28:31], a[16:23], v0
    ds_write_b32 v4, v60 offset:768
    v_smfmac_f32_16x16x64_bf16 v[64:67], v[24:27], a[0:7], v0
    s_waitcnt lgkmcnt(1)
    v_add_f32_dpp v48, v50, v48 quad_perm:[2,3,0,1] row_mask:0xf bank_mask:0xf
    v_smfmac_f32_16x16x64_bf16 v[64:67], v[20:23], v[240:247], v0
    v_add_f32_dpp v49, v51, v49 quad_perm:[2,3,0,1] row_mask:0xf bank_mask:0xf
    v_smfmac_f32_16x16x64_bf16 v[64:67], v[16:19], v[224:231], v0
    v_exp_f32 v50, v48
    v_smfmac_f32_16x16x64_bf16 v[64:67], v[32:35], a[32:39], v0
    s_waitcnt lgkmcnt(0)
    s_barrier
    v_smfmac_f32_16x16x64_bf16 v[64:67], v[36:39], a[48:55], v0
    ds_read_b64_tr_b16 v[112:113], v5 offset:512
    v_exp_f32 v51, v49
    v_smfmac_f32_16x16x64_bf16 v[64:67], v[40:43], a[64:71], v0
    ds_read_b64_tr_b16 v[114:115], v5 offset:768
    v_cvt_pk_bf16_f32 v50, v50, v51
    v_smfmac_f32_16x16x64_bf16 v[64:67], v[44:47], a[80:87], v0
    ds_read_b64_tr_b16 v[116:117], v5 offset:2560
    v_smfmac_f32_16x16x64_bf16 v[68:71], v[28:31], a[24:31], v0
    ds_read_b64_tr_b16 v[118:119], v5 offset:2816
    v_smfmac_f32_16x16x64_bf16 v[68:71], v[24:27], a[8:15], v0
    ds_write_b32 v12, v50
    s_waitcnt lgkmcnt(3)
    v_mfma_f32_16x16x32_bf16 v[52:55], v[112:115], v[104:107], 0
    s_nop 0
    v_cvt_pk_bf16_f32 v60, v64, v65
    v_cvt_pk_bf16_f32 v61, v66, v67
    v_smfmac_f32_16x16x64_bf16 v[68:71], v[20:23], v[248:255], v0
    s_waitcnt lgkmcnt(1)
    v_mov_b64 v[30:31], 0
    v_mfma_f32_16x16x32_bf16 v[52:55], v[116:119], v[108:111], v[52:55]
    s_nop 0
    v_mov_b64 v[26:27], 0
    v_mov_b64 v[24:25], 0
    v_smfmac_f32_16x16x64_bf16 v[68:71], v[16:19], v[232:239], v0
    s_waitcnt lgkmcnt(0)
    s_barrier
    v_smfmac_f32_16x16x64_bf16 v[68:71], v[32:35], a[40:47], v0
    ds_read_b128 v[56:59], v6 offset:12288
    v_add_f32_dpp v52, v54, v52 quad_perm:[2,3,0,1] row_mask:0xf bank_mask:0xf
    v_smfmac_f32_16x16x64_bf16 v[68:71], v[36:39], a[56:63], v0
    ds_read_b128 v[104:107], v2 offset:28672
    v_add_f32_dpp v53, v55, v53 quad_perm:[2,3,0,1] row_mask:0xf bank_mask:0xf
    v_smfmac_f32_16x16x64_bf16 v[68:71], v[40:43], a[72:79], v0
    ds_read_b128 v[108:111], v2 offset:29696
    v_exp_f32_dpp v54, v52 quad_perm:[0,1,0,1] row_mask:0xf bank_mask:0xf
    v_smfmac_f32_16x16x64_bf16 v[68:71], v[44:47], a[88:95], v0
    s_nop 0
    s_waitcnt lgkmcnt(2)
    v_exp_f32_dpp v55, v53 quad_perm:[0,1,0,1] row_mask:0xf bank_mask:0xf
Tsm_2:
    v_mfma_f32_16x16x32_bf16 v[88:91], v[122:125], v[56:59], 0
    v_cvt_pk_bf16_f32 v28, v54, v55
    v_cvt_pk_bf16_f32 v29, v54, v55
    v_mfma_f32_16x16x32_bf16 v[96:99], v[80:83], v[56:59], 0
    s_nop 0
    v_cvt_pk_bf16_f32 v62, v68, v69
    v_cvt_pk_bf16_f32 v63, v70, v71
    v_mfma_f32_16x16x32_bf16 v[88:91], v[120:123], v[28:31], v[88:91]
    s_nop 0
    v_mov_b64 v[16:17], 0
    v_mov_b64 v[18:19], 0
    v_mfma_f32_16x16x32_bf16 v[96:99], v[60:63], v[28:31], v[96:99]
    s_nop 0
    v_mov_b64 v[20:21], 0
    v_mov_b64 v[22:23], 0
    v_mfma_f32_16x16x32_bf16 v[100:103], v[84:87], v[56:59], 0
    s_nop 0
    v_rcp_f32 v14, v88
    v_mfma_f32_16x16x32_bf16 v[100:103], v[60:63], v[26:29], v[100:103]
    s_nop 0
    v_mul_f32 v96, v96, v14
    v_mul_f32 v97, v97, v14
    v_mul_f32 v98, v98, v14
    v_mul_f32 v99, v99, v14
    v_subrev_u32 v11, s34, v88
    v_cmp_le_u32 vcc, s35, v11
    s_not_b64 exec, s[48:49]
    v_pk_mul_f32 v[96:97], v[100:101], v[14:15] op_sel_hi:[1,0]
    v_pk_mul_f32 v[98:99], v[102:103], v[14:15] op_sel_hi:[1,0]
    s_mov_b64 exec, -1
    v_cvt_pk_bf16_f32 v96, v96, v97
    v_cvt_pk_bf16_f32 v97, v98, v99
    ds_write_b64 v126, v[96:97]
    v_mov_b32_dpp v32, v96 quad_perm:[0,1,0,1] row_mask:0xf bank_mask:0xf
    v_mov_b32_dpp v33, v97 quad_perm:[0,1,0,1] row_mask:0xf bank_mask:0xf
    v_mov_b32_dpp v34, v96 quad_perm:[2,3,2,3] row_mask:0xf bank_mask:0xf
    v_mov_b32_dpp v35, v97 quad_perm:[2,3,2,3] row_mask:0xf bank_mask:0xf
    v_mov_b64 v[28:29], 0
    s_cbranch_vccnz Tmx_2
Tmxd_2:
    v_smfmac_f32_16x16x64_bf16 v[16:19], v[32:35], a[176:183], v0
    s_waitcnt lgkmcnt(0)
    s_barrier
    ds_read_b128 v[36:39], v127 offset:1536
    v_smfmac_f32_16x16x64_bf16 v[20:23], v[32:35], a[208:215], v0
    ds_read_b128 v[40:43], v127 offset:0
    v_smfmac_f32_16x16x64_bf16 v[24:27], v[32:35], a[240:247], v0
    ds_read_b128 v[44:47], v127 offset:512
    v_smfmac_f32_16x16x64_bf16 v[28:31], v[32:35], v[104:111], v0
    ds_read_b128 v[112:115], v2 offset:30720
    s_waitcnt lgkmcnt(3)
    v_smfmac_f32_16x16x64_bf16 v[16:19], v[36:39], a[184:191], v0
    ds_read_b128 v[116:119], v2 offset:31744
    s_waitcnt lgkmcnt(3)
    v_smfmac_f32_16x16x64_bf16 v[16:19], v[40:43], a[160:167], v0
    ds_read_b128 v[48:51], v2 offset:24576
    s_waitcnt lgkmcnt(3)
    v_smfmac_f32_16x16x64_bf16 v[16:19], v[44:47], a[168:175], v0
    s_nop 0
    ds_read_b128 v[56:59], v2 offset:26624
    v_smfmac_f32_16x16x64_bf16 v[20:23], v[36:39], a[216:223], v0
    s_nop 0
    ds_read_b128 v[52:55], v2 offset:25600
    v_smfmac_f32_16x16x64_bf16 v[20:23], v[40:43], a[192:199], v0
    s_nop 1
    v_cvt_pk_bf16_f32 v16, v16, v17
    v_cvt_pk_bf16_f32 v17, v18, v19
    v_and_or_b32 v16, v16, -2, s46
    v_smfmac_f32_16x16x64_bf16 v[20:23], v[44:47], a[200:207], v0
    buffer_store_dwordx2 v[16:17], v7, s[8:11], s20 offen offset:0
    v_smfmac_f32_16x16x64_bf16 v[24:27], v[36:39], a[248:255], v0
    s_nop 0
    ds_read_b128 v[60:63], v2 offset:27648
    v_smfmac_f32_16x16x64_bf16 v[24:27], v[40:43], a[224:231], v0
    s_nop 1
    s_nop 0
    v_cvt_pk_bf16_f32 v20, v20, v21
    v_cvt_pk_bf16_f32 v21, v22, v23
    v_and_or_b32 v20, v20, -2, s46
    v_smfmac_f32_16x16x64_bf16 v[24:27], v[44:47], a[232:239], v0
    buffer_store_dwordx2 v[20:21], v7, s[8:11], s20 offen offset:2048
    s_waitcnt lgkmcnt(4)
    v_smfmac_f32_16x16x64_bf16 v[28:31], v[36:39], v[112:119], v0
    s_nop 0
    s_waitcnt lgkmcnt(1)
    v_smfmac_f32_16x16x64_bf16 v[28:31], v[40:43], v[48:55], v0
    s_nop 1
    v_cvt_pk_bf16_f32 v24, v24, v25
    v_cvt_pk_bf16_f32 v25, v26, v27
    s_waitcnt lgkmcnt(0)
    v_and_or_b32 v24, v24, -2, s46
    v_smfmac_f32_16x16x64_bf16 v[28:31], v[44:47], v[56:63], v0
    buffer_store_dwordx2 v[24:25], v7, s[8:11], s21 offen offset:0
    s_nop 6
    v_cvt_pk_bf16_f32 v28, v28, v29
    v_cvt_pk_bf16_f32 v29, v30, v31
    v_and_or_b32 v28, v28, -2, s46
    buffer_store_dwordx2 v[28:29], v7, s[8:11], s21 offen offset:2048
    s_barrier
    ds_read_b128 v[16:19], v1 offset:13312
    s_waitcnt vmcnt(7)
    v_mov_b64 v[72:73], v[128:129]
    ds_read_b128 v[32:35], v2 offset:0
    s_add_u32 s17, s17, 1
    v_mov_b64 v[74:75], v[130:131]
    ds_read_b128 v[36:39], v2 offset:1024
    s_and_b32 s29, s17, 3
    s_waitcnt vmcnt(6)
    v_mov_b64 v[76:77], v[132:133]
    ds_read_b128 v[88:91], v2 offset:6144
    s_lshl_b32 s29, s29, 13
    v_mov_b64 v[78:79], v[134:135]
    ds_read_b128 v[92:95], v2 offset:7168
    s_add_u32 s30, s24, s29
    s_waitcnt vmcnt(5)
    v_mov_b64 v[80:81], v[136:137]
    ds_read_b128 v[96:99], v2 offset:8192
    s_add_u32 s26, s29, 52957184
    v_mov_b64 v[82:83], v[138:139]
    ds_read_b128 v[100:103], v2 offset:9216
    s_xor_b32 s25, s30, 16384
    s_waitcnt vmcnt(4)
    v_mov_b64 v[84:85], v[140:141]
    ds_read_b128 v[104:107], v2 offset:10240
    s_xor_b32 s20, s20, 262144
    v_mov_b64 v[86:87], v[142:143]
    ds_read_b128 v[108:111], v2 offset:11264
    s_add_u32 s21, s20, 4096
    s_nop 15
    s_nop 7
    buffer_load_dwordx4 v[40:43], v1, s[8:11], s22 offen offset:0 sc1
    buffer_load_dwordx4 v[44:47], v1, s[8:11], s22 offen offset:1024 sc1
    s_waitcnt lgkmcnt(8)
    s_waitcnt vmcnt(1)
    v_mfma_f32_16x16x32_bf16 v[20:23], v[16:19], v[40:43], 0
    v_bitop3_b32 v11, v40, v42, s46 bitop3:0x7e
    s_waitcnt vmcnt(0)
    v_mfma_f32_16x16x32_bf16 v[20:23], v[16:19], v[44:47], v[20:23]
    v_bitop3_b32 v15, v44, v46, s46 bitop3:0x7e
    v_bitop3_b32 v11, v11, v15, 1 bitop3:0xa8
    v_cmp_ne_u32 vcc, 0, v11
    s_nop 4
    v_add_f32_dpp v20, v20, v20 row_ror:4 row_mask:0xf bank_mask:0xf
    v_add_f32_dpp v21, v21, v21 row_ror:4 row_mask:0xf bank_mask:0xf
    s_cbranch_vccnz Tr1_2
Tok1_2:
    v_add_f32_dpp v20, v20, v20 row_ror:8 row_mask:0xf bank_mask:0xf
    v_add_f32_dpp v21, v21, v21 row_ror:8 row_mask:0xf bank_mask:0xf
    v_cvt_pk_bf16_f32 v14, v20, v21
    buffer_store_dword v14, v8, s[8:11], s30 offen
    buffer_store_dword v13, v8, s[8:11], s25 offen
    s_xor_b32 s22, s22, 262144
    s_bfe_u32 s46, s17, 0x10001
    v_mov_b64 v[48:49], 0
    ds_read_b128 v[112:115], v1 offset:24576
    s_add_u32 s19, s19, 8192
    v_mov_b64 v[50:51], 0
    ds_read_b128 v[116:119], v1 offset:25600
    s_cmp_ge_u32 s17, 62
    s_cselect_b32 s35, 0, s35
    s_cselect_b32 s18, 0x40000000, s18
    v_mov_b64 v[52:53], 0
    ds_read_b128 v[64:67], v1 offset:26624
    s_add_u32 s18, s18, 524288
    v_mov_b64 v[54:55], 0
    ds_read_b128 v[68:71], v1 offset:27648
    s_add_u32 s33, s18, 8192
    s_add_u32 s51, s51, 4096
    s_nop 5
    s_branch Tstep_2
Tr2_2:
    buffer_load_dwordx4 v[40:43], v1, s[8:11], s26 offen offset:0 sc1
    buffer_load_dwordx4 v[44:47], v1, s[8:11], s26 offen offset:1024 sc1
    s_waitcnt vmcnt(3)
    v_max3_u32 v11, v40, v41, v42
    v_max_u32 v11, v11, v43
    ds_write_b128 v1, v[40:43] offset:4096
    s_waitcnt vmcnt(2)
    v_max3_u32 v11, v11, v44, v45
    v_max3_u32 v11, v11, v46, v47
    v_cmp_eq_u32 vcc, -1, v11
    ds_write_b128 v1, v[44:47] offset:5120
    s_cbranch_vccz Tok2_2
    buffer_load_dwordx4 v[40:43], v1, s[8:11], s26 offen offset:0 sc1
    buffer_load_dwordx4 v[44:47], v1, s[8:11], s26 offen offset:1024 sc1
    s_waitcnt vmcnt(3)
    v_max3_u32 v11, v40, v41, v42
    v_max_u32 v11, v11, v43
    ds_write_b128 v1, v[40:43] offset:4096
    s_waitcnt vmcnt(2)
    v_max3_u32 v11, v11, v44, v45
    v_max3_u32 v11, v11, v46, v47
    v_cmp_eq_u32 vcc, -1, v11
    ds_write_b128 v1, v[44:47] offset:5120
    s_cbranch_vccz Tok2_2
    s_add_u32 s27, s27, 1
    s_cmp_lt_u32 s27, 400000
    s_cbranch_scc1 Tr2_2
    s_mov_b32 s28, 1
    s_branch Tok2_2
Tr1_2:
    buffer_load_dwordx4 v[40:43], v1, s[8:11], s22 offen offset:0 sc1
    buffer_load_dwordx4 v[44:47], v1, s[8:11], s22 offen offset:1024 sc1
    s_waitcnt vmcnt(1)
    v_mfma_f32_16x16x32_bf16 v[20:23], v[16:19], v[40:43], 0
    v_bitop3_b32 v11, v40, v42, s46 bitop3:0x7e
    s_waitcnt vmcnt(0)
    v_mfma_f32_16x16x32_bf16 v[20:23], v[16:19], v[44:47], v[20:23]
    v_bitop3_b32 v15, v44, v46, s46 bitop3:0x7e
    v_bitop3_b32 v11, v11, v15, 1 bitop3:0xa8
    v_cmp_ne_u32 vcc, 0, v11
    s_nop 4
    v_add_f32_dpp v20, v20, v20 row_ror:4 row_mask:0xf bank_mask:0xf
    v_add_f32_dpp v21, v21, v21 row_ror:4 row_mask:0xf bank_mask:0xf
    s_cbranch_vccz Tok1_2
    s_add_u32 s27, s27, 1
    s_cmp_lt_u32 s27, 400000
    s_cbranch_scc1 Tr1_2
    s_mov_b32 s28, 1
    s_waitcnt vmcnt(0)
    s_branch Tok1_2
Tmx_2:
    s_nop 7
    s_waitcnt lgkmcnt(0)
    s_cmp_lg_u32 s35, 0
    s_cbranch_scc1 Tmx2_2
    ds_read_b64_tr_b16 v[40:41], v5 offset:2560
    v_pk_add_f32 v[44:45], v[64:65], v[66:67]
    v_pk_add_f32 v[46:47], v[68:69], v[70:71]
    v_cvt_pk_bf16_f32 v42, v44, v45
    v_cvt_pk_bf16_f32 v43, v46, v47
    s_and_b32 s29, s17, 1
    s_lshl_b32 s29, s29, 5
    s_add_u32 s29, s29, s16
    s_lshl_b32 s29, s29, 12
    s_add_u32 s29, s29, 61736960
    s_waitcnt lgkmcnt(0)
    buffer_store_dwordx4 v[40:43], v1, s[8:11], s29 offen sc1
    s_cmp_eq_u32 s17, 63
    s_cbranch_scc1 Tend_2
    s_mov_b32 s35, 0x3c000000
    v_cmp_le_u32 vcc, s35, v11
    s_nop 4
    s_and_b64 vcc, vcc, s[48:49]
    s_cbranch_scc0 Tmxd_2
Tmx2_2:
    v_max3_f32 v14, v48, v49, v52
    v_max_f32 v14, v14, v53
    v_mov_b32 v15, v14
    s_nop 1
    v_permlane16_swap_b32 v14, v15
    v_max_f32 v14, v14, v15
    v_mov_b32 v15, v14
    s_nop 1
    v_permlane32_swap_b32 v14, v15
    v_max_f32 v14, v14, v15
    ds_write_b32 v1, v14 offset:14344
    s_waitcnt lgkmcnt(0)
    s_barrier
    ds_read_b128 v[88:91], v1 offset:14336
    s_waitcnt lgkmcnt(0)
    v_max3_f32 v14, v88, v89, v90
    v_max_f32 v14, v14, v91
    v_cmp_neq_f32 vcc, 0, v14
    v_mov_b32 v11, 0x1f8
    v_cmp_class_f32 s[36:37], v14, v11
    s_nop 4
    s_and_b64 vcc, vcc, s[36:37]
    s_and_b64 vcc, vcc, s[48:49]
    s_cbranch_scc0 Tmxd_2
    v_cndmask_b32 v14, 0, v14, vcc
    v_sub_f32 v48, v48, v14
    v_sub_f32 v49, v49, v14
    v_sub_f32 v52, v52, v14
    v_sub_f32 v53, v53, v14
    v_exp_f32 v50, v48
    v_exp_f32 v51, v49
    s_nop 0
    v_cvt_pk_bf16_f32 v50, v50, v51
    ds_write_b32 v12, v50
    v_exp_f32_dpp v54, v52 quad_perm:[0,1,0,1] row_mask:0xf bank_mask:0xf
    v_exp_f32_dpp v55, v53 quad_perm:[0,1,0,1] row_mask:0xf bank_mask:0xf
    s_waitcnt lgkmcnt(0)
    s_barrier
    ds_read_b128 v[56:59], v6 offset:12288
    s_waitcnt lgkmcnt(0)
    s_branch Tsm_2
Tend_2:
    s_endpgm
Tslow_2:
    s_mov_b32 s27, 0
    s_mov_b32 s46, 0
    v_mov_b32 v13, -1
    v_mov_b64 v[122:123], s[42:43]
    v_mov_b64 v[124:125], s[42:43]
    v_mov_b64 v[120:121], s[44:45]
    s_mov_b32 s26, 52957184
    s_add_u32 s21, s20, 4096
    s_lshl_b32 s54, s16, 7
    s_add_u32 s54, s54, 58720260
    s_add_u32 s51, s54, 4096
    s_add_u32 s18, s18, 524288
    s_add_u32 s33, s18, 8192
    s_add_u32 s51, s51, 4096
    v_mov_b64 v[72:73], v[128:129]
    ds_read_b128 v[32:35], v2 offset:0
    v_mov_b64 v[74:75], v[130:131]
    ds_read_b128 v[36:39], v2 offset:1024
    v_mov_b64 v[76:77], v[132:133]
    ds_read_b128 v[88:91], v2 offset:6144
    v_mov_b64 v[78:79], v[134:135]
    ds_read_b128 v[92:95], v2 offset:7168
    v_mov_b64 v[80:81], v[136:137]
    ds_read_b128 v[96:99], v2 offset:8192
    v_mov_b64 v[82:83], v[138:139]
    ds_read_b128 v[100:103], v2 offset:9216
    v_mov_b64 v[84:85], v[140:141]
    ds_read_b128 v[104:107], v2 offset:10240
    v_mov_b64 v[86:87], v[142:143]
    ds_read_b128 v[108:111], v2 offset:11264
    v_mov_b64 v[48:49], 0
    ds_read_b128 v[112:115], v1 offset:24576
    v_mov_b64 v[50:51], 0
    ds_read_b128 v[116:119], v1 offset:25600
    v_mov_b64 v[52:53], 0
    ds_read_b128 v[64:67], v1 offset:26624
    v_mov_b64 v[54:55], 0
    ds_read_b128 v[68:71], v1 offset:27648
    s_branch Tstep_2sc1
.p2align 6
Tstep_2sc1:
    buffer_load_dwordx4 v[40:43], v1, s[8:11], s26 offen offset:0 sc1
    buffer_load_dwordx4 v[44:47], v1, s[8:11], s26 offen offset:1024 sc1
    v_mov_b64 v[56:57], 0
    ds_read_b128 v[128:131], v2 offset:2048
    v_mov_b64 v[58:59], 0
    ds_read_b128 v[132:135], v2 offset:3072
    v_mov_b64 v[60:61], 0
    ds_read_b128 v[136:139], v2 offset:4096
    v_mov_b64 v[62:63], 0
    ds_read_b128 v[140:143], v2 offset:5120
    s_nop 15
    s_nop 1
    buffer_load_dwordx4 v[40:43], v1, s[8:11], s26 offen offset:0 sc1
    buffer_load_dwordx4 v[44:47], v1, s[8:11], s26 offen offset:1024 sc1
    s_waitcnt vmcnt(3)
    v_max3_u32 v11, v40, v41, v42
    v_max_u32 v11, v11, v43
    ds_write_b128 v1, v[40:43] offset:4096
    s_waitcnt vmcnt(2)
    v_max3_u32 v11, v11, v44, v45
    v_max3_u32 v11, v11, v46, v47
    v_cmp_eq_u32 vcc, -1, v11
    ds_write_b128 v1, v[44:47] offset:5120
    s_cbranch_vccnz Tr2_2sc1
Tok2_2sc1:
    s_barrier
    ds_read_b128 v[16:19], v1 offset:0
    ds_read_b128 v[20:23], v1 offset:1024
    buffer_store_dword v14, v8, s[8:11], s19 offen sc1
    s_waitcnt lgkmcnt(2)
    s_barrier
    ds_read_b128 v[24:27], v1 offset:2048
    ds_read_b128 v[28:31], v1 offset:3072
    s_waitcnt lgkmcnt(3)
    v_smfmac_f32_16x16x64_bf16 v[48:51], v[16:19], v[32:39], v0
    ds_read_b128 v[32:35], v1 offset:4096
    v_smfmac_f32_16x16x64_bf16 v[52:55], v[16:19], v[128:135], v0
    ds_read_b128 v[36:39], v1 offset:5120
    s_waitcnt lgkmcnt(4)
    v_smfmac_f32_16x16x64_bf16 v[48:51], v[20:23], v[136:143], v0
    s_waitcnt vmcnt(1)
    ds_read_b128 v[40:43], v1 offset:6144
    v_smfmac_f32_16x16x64_bf16 v[52:55], v[20:23], v[88:95], v0
    ds_read_b128 v[44:47], v1 offset:7168
    s_waitcnt lgkmcnt(5)
    v_smfmac_f32_16x16x64_bf16 v[48:51], v[24:27], v[96:103], v0
    buffer_load_dwordx4 v[128:131], v9, s[8:11], s18 offen sc1
    s_waitcnt lgkmcnt(3)
    v_smfmac_f32_16x16x64_bf16 v[48:51], v[28:31], v[112:119], v0
    ds_read_b128 v[88:91], v2 offset:12288
    s_waitcnt lgkmcnt(3)
    v_smfmac_f32_16x16x64_bf16 v[48:51], v[32:35], a[96:103], v0
    buffer_load_dwordx4 v[132:135], v9, s[8:11], s33 offen sc1
    v_smfmac_f32_16x16x64_bf16 v[48:51], v[36:39], a[112:119], v0
    ds_read_b128 v[92:95], v2 offset:13312
    s_waitcnt lgkmcnt(2)
    v_smfmac_f32_16x16x64_bf16 v[48:51], v[40:43], a[128:135], v0
    buffer_load_dwordx4 v[136:139], v3, s[8:11], s18 offen offset:2048 sc1
    v_smfmac_f32_16x16x64_bf16 v[48:51], v[44:47], a[144:151], v0
    s_nop 1
    s_waitcnt lgkmcnt(1)
    v_smfmac_f32_16x16x64_bf16 v[52:55], v[24:27], v[104:111], v0
    buffer_load_dwordx4 v[140:143], v3, s[8:11], s18 offen offset:2176 sc1
    v_smfmac_f32_16x16x64_bf16 v[52:55], v[28:31], v[64:71], v0
    s_waitcnt lgkmcnt(0)
    s_nop 0
    v_add_f32 v48, v48, v50
    v_smfmac_f32_16x16x64_bf16 v[52:55], v[32:35], a[104:111], v0
    ds_read_b128 v[96:99], v2 offset:16384
    v_add_f32 v49, v49, v51
    v_smfmac_f32_16x16x64_bf16 v[52:55], v[36:39], a[120:127], v0
    ds_read_b128 v[100:103], v2 offset:17408
    v_mul_f32 v48, s32, v48
    v_smfmac_f32_16x16x64_bf16 v[52:55], v[40:43], a[136:143], v0
    ds_read_b128 v[104:107], v2 offset:20480
    v_mul_f32 v49, s32, v49
    v_smfmac_f32_16x16x64_bf16 v[52:55], v[44:47], a[152:159], v0
    s_nop 1
    v_cvt_pk_bf16_f32 v48, v48, v49
    v_smfmac_f32_16x16x64_bf16 v[56:59], v[28:31], v[144:151], v0
    ds_write_b32 v4, v48 offset:0
    v_smfmac_f32_16x16x64_bf16 v[56:59], v[32:35], v[160:167], v0
    s_waitcnt lgkmcnt(2)
    s_nop 0
    v_add_f32 v52, v52, v54
    v_smfmac_f32_16x16x64_bf16 v[56:59], v[16:19], v[88:95], v0
    ds_read_b128 v[108:111], v2 offset:21504
    v_add_f32 v53, v53, v55
    v_mul_f32 v52, s32, v52
    v_smfmac_f32_16x16x64_bf16 v[56:59], v[20:23], v[96:103], v0
    ds_read_b128 v[112:115], v2 offset:14336
    v_mul_f32 v53, s32, v53
    v_smfmac_f32_16x16x64_bf16 v[56:59], v[36:39], v[176:183], v0
    ds_read_b128 v[116:119], v2 offset:15360
    v_cvt_pk_bf16_f32 v52, v52, v53
    v_smfmac_f32_16x16x64_bf16 v[56:59], v[40:43], v[192:199], v0
    ds_write_b32 v4, v52 offset:256
    v_smfmac_f32_16x16x64_bf16 v[56:59], v[44:47], v[208:215], v0
    ds_read_b128 v[88:91], v2 offset:18432
    s_waitcnt lgkmcnt(4)
    v_smfmac_f32_16x16x64_bf16 v[56:59], v[24:27], v[104:111], v0
    ds_read_b128 v[92:95], v2 offset:19456
    s_waitcnt lgkmcnt(4)
    v_smfmac_f32_16x16x64_bf16 v[60:63], v[28:31], v[152:159], v0
    ds_read_b128 v[96:99], v2 offset:22528
    ds_read_b128 v[100:103], v2 offset:23552
    v_smfmac_f32_16x16x64_bf16 v[60:63], v[32:35], v[168:175], v0
    s_waitcnt lgkmcnt(4)
    s_barrier
    v_smfmac_f32_16x16x64_bf16 v[60:63], v[36:39], v[184:191], v0
    ds_read_b64_tr_b16 v[104:105], v5 offset:0
    v_add_f32 v56, v56, v58
    v_smfmac_f32_16x16x64_bf16 v[60:63], v[40:43], v[200:207], v0
    ds_read_b64_tr_b16 v[106:107], v5 offset:256
    v_add_f32 v57, v57, v59
    v_smfmac_f32_16x16x64_bf16 v[60:63], v[44:47], v[216:223], v0
    ds_read_b64_tr_b16 v[108:109], v5 offset:2048
    v_cvt_pk_bf16_f32 v56, v56, v57
    v_smfmac_f32_16x16x64_bf16 v[60:63], v[16:19], v[112:119], v0
    ds_read_b64_tr_b16 v[110:111], v5 offset:2304
    s_waitcnt lgkmcnt(4)
    v_mov_b64 v[64:65], 0
    v_smfmac_f32_16x16x64_bf16 v[60:63], v[20:23], v[88:95], v0
    ds_write_b32 v4, v56 offset:512
    v_smfmac_f32_16x16x64_bf16 v[60:63], v[24:27], v[96:103], v0
    s_waitcnt lgkmcnt(3)
    v_mov_b64 v[66:67], 0
    v_mfma_f32_16x16x32_bf16 v[48:51], v[72:75], v[104:107], 0
    s_waitcnt lgkmcnt(1)
    v_mov_b64 v[68:69], 0
    v_mov_b64 v[70:71], 0
    v_mfma_f32_16x16x32_bf16 v[48:51], v[76:79], v[108:111], v[48:51]
    s_nop 0
    v_add_f32 v60, v60, v62
    v_add_f32 v61, v61, v63
    v_cvt_pk_bf16_f32 v60, v60, v61
    v_smfmac_f32_16x16x64_bf16 v[64:67], v[28:31], a[16:23], v0
    ds_write_b32 v4, v60 offset:768
    v_smfmac_f32_16x16x64_bf16 v[64:67], v[24:27], a[0:7], v0
    s_waitcnt lgkmcnt(1)
    v_add_f32_dpp v48, v50, v48 quad_perm:[2,3,0,1] row_mask:0xf bank_mask:0xf
    v_smfmac_f32_16x16x64_bf16 v[64:67], v[20:23], v[240:247], v0
    v_add_f32_dpp v49, v51, v49 quad_perm:[2,3,0,1] row_mask:0xf bank_mask:0xf
    v_smfmac_f32_16x16x64_bf16 v[64:67], v[16:19], v[224:231], v0
    v_exp_f32 v50, v48
    v_smfmac_f32_16x16x64_bf16 v[64:67], v[32:35], a[32:39], v0
    s_waitcnt lgkmcnt(0)
    s_barrier
    v_smfmac_f32_16x16x64_bf16 v[64:67], v[36:39], a[48:55], v0
    ds_read_b64_tr_b16 v[112:113], v5 offset:512
    v_exp_f32 v51, v49
    v_smfmac_f32_16x16x64_bf16 v[64:67], v[40:43], a[64:71], v0
    ds_read_b64_tr_b16 v[114:115], v5 offset:768
    v_cvt_pk_bf16_f32 v50, v50, v51
    v_smfmac_f32_16x16x64_bf16 v[64:67], v[44:47], a[80:87], v0
    ds_read_b64_tr_b16 v[116:117], v5 offset:2560
    v_smfmac_f32_16x16x64_bf16 v[68:71], v[28:31], a[24:31], v0
    ds_read_b64_tr_b16 v[118:119], v5 offset:2816
    v_smfmac_f32_16x16x64_bf16 v[68:71], v[24:27], a[8:15], v0
    ds_write_b32 v12, v50
    s_waitcnt lgkmcnt(3)
    v_mfma_f32_16x16x32_bf16 v[52:55], v[112:115], v[104:107], 0
    s_nop 0
    v_cvt_pk_bf16_f32 v60, v64, v65
    v_cvt_pk_bf16_f32 v61, v66, v67
    v_smfmac_f32_16x16x64_bf16 v[68:71], v[20:23], v[248:255], v0
    s_waitcnt lgkmcnt(1)
    v_mov_b64 v[30:31], 0
    v_mfma_f32_16x16x32_bf16 v[52:55], v[116:119], v[108:111], v[52:55]
    s_nop 0
    v_mov_b64 v[26:27], 0
    v_mov_b64 v[24:25], 0
    v_smfmac_f32_16x16x64_bf16 v[68:71], v[16:19], v[232:239], v0
    s_waitcnt lgkmcnt(0)
    s_barrier
    v_smfmac_f32_16x16x64_bf16 v[68:71], v[32:35], a[40:47], v0
    ds_read_b128 v[56:59], v6 offset:12288
    v_add_f32_dpp v52, v54, v52 quad_perm:[2,3,0,1] row_mask:0xf bank_mask:0xf
    v_smfmac_f32_16x16x64_bf16 v[68:71], v[36:39], a[56:63], v0
    ds_read_b128 v[104:107], v2 offset:28672
    v_add_f32_dpp v53, v55, v53 quad_perm:[2,3,0,1] row_mask:0xf bank_mask:0xf
    v_smfmac_f32_16x16x64_bf16 v[68:71], v[40:43], a[72:79], v0
    ds_read_b128 v[108:111], v2 offset:29696
    v_exp_f32_dpp v54, v52 quad_perm:[0,1,0,1] row_mask:0xf bank_mask:0xf
    v_smfmac_f32_16x16x64_bf16 v[68:71], v[44:47], a[88:95], v0
    s_nop 0
    s_waitcnt lgkmcnt(2)
    v_exp_f32_dpp v55, v53 quad_perm:[0,1,0,1] row_mask:0xf bank_mask:0xf
Tsm_2sc1:
    v_mfma_f32_16x16x32_bf16 v[88:91], v[122:125], v[56:59], 0
    v_cvt_pk_bf16_f32 v28, v54, v55
    v_cvt_pk_bf16_f32 v29, v54, v55
    v_mfma_f32_16x16x32_bf16 v[96:99], v[80:83], v[56:59], 0
    s_nop 0
    v_cvt_pk_bf16_f32 v62, v68, v69
    v_cvt_pk_bf16_f32 v63, v70, v71
    v_mfma_f32_16x16x32_bf16 v[88:91], v[120:123], v[28:31], v[88:91]
    s_nop 0
    v_mov_b64 v[16:17], 0
    v_mov_b64 v[18:19], 0
    v_mfma_f32_16x16x32_bf16 v[96:99], v[60:63], v[28:31], v[96:99]
    s_nop 0
    v_mov_b64 v[20:21], 0
    v_mov_b64 v[22:23], 0
    v_mfma_f32_16x16x32_bf16 v[100:103], v[84:87], v[56:59], 0
    s_nop 0
    v_rcp_f32 v14, v88
    v_mfma_f32_16x16x32_bf16 v[100:103], v[60:63], v[26:29], v[100:103]
    s_nop 0
    v_mul_f32 v96, v96, v14
    v_mul_f32 v97, v97, v14
    v_mul_f32 v98, v98, v14
    v_mul_f32 v99, v99, v14
    v_subrev_u32 v11, s34, v88
    v_cmp_le_u32 vcc, s35, v11
    s_not_b64 exec, s[48:49]
    v_pk_mul_f32 v[96:97], v[100:101], v[14:15] op_sel_hi:[1,0]
    v_pk_mul_f32 v[98:99], v[102:103], v[14:15] op_sel_hi:[1,0]
    s_mov_b64 exec, -1
    v_cvt_pk_bf16_f32 v96, v96, v97
    v_cvt_pk_bf16_f32 v97, v98, v99
    ds_write_b64 v126, v[96:97]
    v_mov_b32_dpp v32, v96 quad_perm:[0,1,0,1] row_mask:0xf bank_mask:0xf
    v_mov_b32_dpp v33, v97 quad_perm:[0,1,0,1] row_mask:0xf bank_mask:0xf
    v_mov_b32_dpp v34, v96 quad_perm:[2,3,2,3] row_mask:0xf bank_mask:0xf
    v_mov_b32_dpp v35, v97 quad_perm:[2,3,2,3] row_mask:0xf bank_mask:0xf
    v_mov_b64 v[28:29], 0
    s_cbranch_vccnz Tmx_2sc1
Tmxd_2sc1:
    v_smfmac_f32_16x16x64_bf16 v[16:19], v[32:35], a[176:183], v0
    s_waitcnt lgkmcnt(0)
    s_barrier
    ds_read_b128 v[36:39], v127 offset:1536
    v_smfmac_f32_16x16x64_bf16 v[20:23], v[32:35], a[208:215], v0
    ds_read_b128 v[40:43], v127 offset:0
    v_smfmac_f32_16x16x64_bf16 v[24:27], v[32:35], a[240:247], v0
    ds_read_b128 v[44:47], v127 offset:512
    v_smfmac_f32_16x16x64_bf16 v[28:31], v[32:35], v[104:111], v0
    ds_read_b128 v[112:115], v2 offset:30720
    s_waitcnt lgkmcnt(3)
    v_smfmac_f32_16x16x64_bf16 v[16:19], v[36:39], a[184:191], v0
    ds_read_b128 v[116:119], v2 offset:31744
    s_waitcnt lgkmcnt(3)
    v_smfmac_f32_16x16x64_bf16 v[16:19], v[40:43], a[160:167], v0
    ds_read_b128 v[48:51], v2 offset:24576
    s_waitcnt lgkmcnt(3)
    v_smfmac_f32_16x16x64_bf16 v[16:19], v[44:47], a[168:175], v0
    s_nop 0
    ds_read_b128 v[56:59], v2 offset:26624
    v_smfmac_f32_16x16x64_bf16 v[20:23], v[36:39], a[216:223], v0
    s_nop 0
    ds_read_b128 v[52:55], v2 offset:25600
    v_smfmac_f32_16x16x64_bf16 v[20:23], v[40:43], a[192:199], v0
    s_nop 1
    v_cvt_pk_bf16_f32 v16, v16, v17
    v_cvt_pk_bf16_f32 v17, v18, v19
    v_and_or_b32 v16, v16, -2, s46
    v_smfmac_f32_16x16x64_bf16 v[20:23], v[44:47], a[200:207], v0
    buffer_store_dwordx2 v[16:17], v7, s[8:11], s20 offen offset:0 sc1
    v_smfmac_f32_16x16x64_bf16 v[24:27], v[36:39], a[248:255], v0
    s_nop 0
    ds_read_b128 v[60:63], v2 offset:27648
    v_smfmac_f32_16x16x64_bf16 v[24:27], v[40:43], a[224:231], v0
    s_nop 1
    s_nop 0
    v_cvt_pk_bf16_f32 v20, v20, v21
    v_cvt_pk_bf16_f32 v21, v22, v23
    v_and_or_b32 v20, v20, -2, s46
    v_smfmac_f32_16x16x64_bf16 v[24:27], v[44:47], a[232:239], v0
    buffer_store_dwordx2 v[20:21], v7, s[8:11], s20 offen offset:2048 sc1
    s_waitcnt lgkmcnt(4)
    v_smfmac_f32_16x16x64_bf16 v[28:31], v[36:39], v[112:119], v0
    s_nop 0
    s_waitcnt lgkmcnt(1)
    v_smfmac_f32_16x16x64_bf16 v[28:31], v[40:43], v[48:55], v0
    s_nop 1
    v_cvt_pk_bf16_f32 v24, v24, v25
    v_cvt_pk_bf16_f32 v25, v26, v27
    s_waitcnt lgkmcnt(0)
    v_and_or_b32 v24, v24, -2, s46
    v_smfmac_f32_16x16x64_bf16 v[28:31], v[44:47], v[56:63], v0
    buffer_store_dwordx2 v[24:25], v7, s[8:11], s21 offen offset:0 sc1
    s_nop 6
    v_cvt_pk_bf16_f32 v28, v28, v29
    v_cvt_pk_bf16_f32 v29, v30, v31
    v_and_or_b32 v28, v28, -2, s46
    buffer_store_dwordx2 v[28:29], v7, s[8:11], s21 offen offset:2048 sc1
    s_barrier
    ds_read_b128 v[16:19], v1 offset:13312
    s_waitcnt vmcnt(7)
    v_mov_b64 v[72:73], v[128:129]
    ds_read_b128 v[32:35], v2 offset:0
    s_add_u32 s17, s17, 1
    v_mov_b64 v[74:75], v[130:131]
    ds_read_b128 v[36:39], v2 offset:1024
    s_and_b32 s29, s17, 3
    s_waitcnt vmcnt(6)
    v_mov_b64 v[76:77], v[132:133]
    ds_read_b128 v[88:91], v2 offset:6144
    s_lshl_b32 s29, s29, 13
    v_mov_b64 v[78:79], v[134:135]
    ds_read_b128 v[92:95], v2 offset:7168
    s_add_u32 s30, s24, s29
    s_waitcnt vmcnt(5)
    v_mov_b64 v[80:81], v[136:137]
    ds_read_b128 v[96:99], v2 offset:8192
    s_add_u32 s26, s29, 52957184
    v_mov_b64 v[82:83], v[138:139]
    ds_read_b128 v[100:103], v2 offset:9216
    s_xor_b32 s25, s30, 16384
    s_waitcnt vmcnt(4)
    v_mov_b64 v[84:85], v[140:141]
    ds_read_b128 v[104:107], v2 offset:10240
    s_xor_b32 s20, s20, 262144
    v_mov_b64 v[86:87], v[142:143]
    ds_read_b128 v[108:111], v2 offset:11264
    s_add_u32 s21, s20, 4096
    s_nop 15
    s_nop 7
    buffer_load_dwordx4 v[40:43], v1, s[8:11], s22 offen offset:0 sc1
    buffer_load_dwordx4 v[44:47], v1, s[8:11], s22 offen offset:1024 sc1
    s_waitcnt lgkmcnt(8)
    s_waitcnt vmcnt(1)
    v_mfma_f32_16x16x32_bf16 v[20:23], v[16:19], v[40:43], 0
    v_bitop3_b32 v11, v40, v42, s46 bitop3:0x7e
    s_waitcnt vmcnt(0)
    v_mfma_f32_16x16x32_bf16 v[20:23], v[16:19], v[44:47], v[20:23]
    v_bitop3_b32 v15, v44, v46, s46 bitop3:0x7e
    v_bitop3_b32 v11, v11, v15, 1 bitop3:0xa8
    v_cmp_ne_u32 vcc, 0, v11
    s_nop 4
    v_add_f32_dpp v20, v20, v20 row_ror:4 row_mask:0xf bank_mask:0xf
    v_add_f32_dpp v21, v21, v21 row_ror:4 row_mask:0xf bank_mask:0xf
    s_cbranch_vccnz Tr1_2sc1
Tok1_2sc1:
    v_add_f32_dpp v20, v20, v20 row_ror:8 row_mask:0xf bank_mask:0xf
    v_add_f32_dpp v21, v21, v21 row_ror:8 row_mask:0xf bank_mask:0xf
    v_cvt_pk_bf16_f32 v14, v20, v21
    buffer_store_dword v14, v8, s[8:11], s30 offen sc1
    buffer_store_dword v13, v8, s[8:11], s25 offen sc1
    s_xor_b32 s22, s22, 262144
    s_bfe_u32 s46, s17, 0x10001
    v_mov_b64 v[48:49], 0
    ds_read_b128 v[112:115], v1 offset:24576
    s_add_u32 s19, s19, 8192
    v_mov_b64 v[50:51], 0
    ds_read_b128 v[116:119], v1 offset:25600
    s_cmp_ge_u32 s17, 62
    s_cselect_b32 s35, 0, s35
    s_cselect_b32 s18, 0x40000000, s18
    v_mov_b64 v[52:53], 0
    ds_read_b128 v[64:67], v1 offset:26624
    s_add_u32 s18, s18, 524288
    v_mov_b64 v[54:55], 0
    ds_read_b128 v[68:71], v1 offset:27648
    s_add_u32 s33, s18, 8192
    s_add_u32 s51, s51, 4096
    s_nop 5
    s_branch Tstep_2sc1
Tr2_2sc1:
    buffer_load_dwordx4 v[40:43], v1, s[8:11], s26 offen offset:0 sc1
    buffer_load_dwordx4 v[44:47], v1, s[8:11], s26 offen offset:1024 sc1
    s_waitcnt vmcnt(3)
    v_max3_u32 v11, v40, v41, v42
    v_max_u32 v11, v11, v43
    ds_write_b128 v1, v[40:43] offset:4096
    s_waitcnt vmcnt(2)
    v_max3_u32 v11, v11, v44, v45
    v_max3_u32 v11, v11, v46, v47
    v_cmp_eq_u32 vcc, -1, v11
    ds_write_b128 v1, v[44:47] offset:5120
    s_cbranch_vccz Tok2_2sc1
    buffer_load_dwordx4 v[40:43], v1, s[8:11], s26 offen offset:0 sc1
    buffer_load_dwordx4 v[44:47], v1, s[8:11], s26 offen offset:1024 sc1
    s_waitcnt vmcnt(3)
    v_max3_u32 v11, v40, v41, v42
    v_max_u32 v11, v11, v43
    ds_write_b128 v1, v[40:43] offset:4096
    s_waitcnt vmcnt(2)
    v_max3_u32 v11, v11, v44, v45
    v_max3_u32 v11, v11, v46, v47
    v_cmp_eq_u32 vcc, -1, v11
    ds_write_b128 v1, v[44:47] offset:5120
    s_cbranch_vccz Tok2_2sc1
    s_add_u32 s27, s27, 1
    s_cmp_lt_u32 s27, 400000
    s_cbranch_scc1 Tr2_2sc1
    s_mov_b32 s28, 1
    s_branch Tok2_2sc1
Tr1_2sc1:
    buffer_load_dwordx4 v[40:43], v1, s[8:11], s22 offen offset:0 sc1
    buffer_load_dwordx4 v[44:47], v1, s[8:11], s22 offen offset:1024 sc1
    s_waitcnt vmcnt(1)
    v_mfma_f32_16x16x32_bf16 v[20:23], v[16:19], v[40:43], 0
    v_bitop3_b32 v11, v40, v42, s46 bitop3:0x7e
    s_waitcnt vmcnt(0)
    v_mfma_f32_16x16x32_bf16 v[20:23], v[16:19], v[44:47], v[20:23]
    v_bitop3_b32 v15, v44, v46, s46 bitop3:0x7e
    v_bitop3_b32 v11, v11, v15, 1 bitop3:0xa8
    v_cmp_ne_u32 vcc, 0, v11
    s_nop 4
    v_add_f32_dpp v20, v20, v20 row_ror:4 row_mask:0xf bank_mask:0xf
    v_add_f32_dpp v21, v21, v21 row_ror:4 row_mask:0xf bank_mask:0xf
    s_cbranch_vccz Tok1_2sc1
    s_add_u32 s27, s27, 1
    s_cmp_lt_u32 s27, 400000
    s_cbranch_scc1 Tr1_2sc1
    s_mov_b32 s28, 1
    s_waitcnt vmcnt(0)
    s_branch Tok1_2sc1
Tmx_2sc1:
    s_nop 7
    s_waitcnt lgkmcnt(0)
    s_cmp_lg_u32 s35, 0
    s_cbranch_scc1 Tmx2_2sc1
    ds_read_b64_tr_b16 v[40:41], v5 offset:2560
    v_pk_add_f32 v[44:45], v[64:65], v[66:67]
    v_pk_add_f32 v[46:47], v[68:69], v[70:71]
    v_cvt_pk_bf16_f32 v42, v44, v45
    v_cvt_pk_bf16_f32 v43, v46, v47
    s_and_b32 s29, s17, 1
    s_lshl_b32 s29, s29, 5
    s_add_u32 s29, s29, s16
    s_lshl_b32 s29, s29, 12
    s_add_u32 s29, s29, 61736960
    s_waitcnt lgkmcnt(0)
    buffer_store_dwordx4 v[40:43], v1, s[8:11], s29 offen sc1
    s_cmp_eq_u32 s17, 63
    s_cbranch_scc1 Tend_2sc1
    s_mov_b32 s35, 0x3c000000
    v_cmp_le_u32 vcc, s35, v11
    s_nop 4
    s_and_b64 vcc, vcc, s[48:49]
    s_cbranch_scc0 Tmxd_2sc1
Tmx2_2sc1:
    v_max3_f32 v14, v48, v49, v52
    v_max_f32 v14, v14, v53
    v_mov_b32 v15, v14
    s_nop 1
    v_permlane16_swap_b32 v14, v15
    v_max_f32 v14, v14, v15
    v_mov_b32 v15, v14
    s_nop 1
    v_permlane32_swap_b32 v14, v15
    v_max_f32 v14, v14, v15
    ds_write_b32 v1, v14 offset:14344
    s_waitcnt lgkmcnt(0)
    s_barrier
    ds_read_b128 v[88:91], v1 offset:14336
    s_waitcnt lgkmcnt(0)
    v_max3_f32 v14, v88, v89, v90
    v_max_f32 v14, v14, v91
    v_cmp_neq_f32 vcc, 0, v14
    v_mov_b32 v11, 0x1f8
    v_cmp_class_f32 s[36:37], v14, v11
    s_nop 4
    s_and_b64 vcc, vcc, s[36:37]
    s_and_b64 vcc, vcc, s[48:49]
    s_cbranch_scc0 Tmxd_2sc1
    v_cndmask_b32 v14, 0, v14, vcc
    v_sub_f32 v48, v48, v14
    v_sub_f32 v49, v49, v14
    v_sub_f32 v52, v52, v14
    v_sub_f32 v53, v53, v14
    v_exp_f32 v50, v48
    v_exp_f32 v51, v49
    s_nop 0
    v_cvt_pk_bf16_f32 v50, v50, v51
    ds_write_b32 v12, v50
    v_exp_f32_dpp v54, v52 quad_perm:[0,1,0,1] row_mask:0xf bank_mask:0xf
    v_exp_f32_dpp v55, v53 quad_perm:[0,1,0,1] row_mask:0xf bank_mask:0xf
    s_waitcnt lgkmcnt(0)
    s_barrier
    ds_read_b128 v[56:59], v6 offset:12288
    s_waitcnt lgkmcnt(0)
    s_branch Tsm_2sc1
Tend_2sc1:
    s_endpgm
Twave_3:
    v_and_b32 v100, 63, v0
    v_lshrrev_b32 v102, 1, v100
    v_and_b32 v102, 8, v102
    v_xor_b32 v102, v102, v100
    v_and_b32 v102, 15, v102
    v_lshlrev_b32 v102, 4, v102
    v_lshrrev_b32 v103, 4, v100
    v_lshl_add_u32 v104, v103, 13, v102
    v_lshl_add_u32 v108, v103, 10, v102
    v_xor_b32 v104, 16, v104
    v_xor_b32 v105, 64, v104
    v_xor_b32 v109, 64, v108
    s_mov_b32 s54, 0x400000
    s_mov_b32 s55, 0x20000
    s_mov_b32 s58, 0x400000
    s_mov_b32 s59, 0x20000
    s_mov_b32 s62, 0x400000
    s_mov_b32 s63, 0x20000
    s_mov_b32 s66, 0x400000
    s_mov_b32 s67, 0x20000
    s_lshl_b32 s50, s16, 8
    s_lshl_b32 s51, s16, 17
    s_waitcnt lgkmcnt(0)
    s_mov_b64 s[52:53], s[40:41]
    s_mov_b64 s[56:57], s[42:43]
    s_mov_b64 s[60:61], s[44:45]
    s_mov_b64 s[64:65], s[46:47]
    s_mov_b32 m0, 98304
    s_add_u32 s29, s50, 1966080
    buffer_load_dwordx4 v104, s[56:59], s29 offen  lds
    s_mov_b32 m0, 99328
    s_add_u32 s29, s50, 1998848
    buffer_load_dwordx4 v105, s[56:59], s29 offen  lds
    s_mov_b32 m0, 100352
    s_add_u32 s29, s50, 2031616
    buffer_load_dwordx4 v104, s[56:59], s29 offen  lds
    s_mov_b32 m0, 101376
    s_add_u32 s29, s50, 2064384
    buffer_load_dwordx4 v105, s[56:59], s29 offen  lds
    s_mov_b32 m0, 102400
    s_add_u32 s29, s50, 2490368
    buffer_load_dwordx4 v104, s[56:59], s29 offen  lds
    s_mov_b32 m0, 103424
    s_add_u32 s29, s50, 2523136
    buffer_load_dwordx4 v105, s[56:59], s29 offen  lds
    s_mov_b32 m0, 104448
    s_add_u32 s29, s50, 2555904
    buffer_load_dwordx4 v104, s[56:59], s29 offen  lds
    s_mov_b32 m0, 105472
    s_add_u32 s29, s50, 2588672
    buffer_load_dwordx4 v105, s[56:59], s29 offen  lds
    v_mov_b32 v120, 0
    v_bfe_u32 v101, v100, 2, 1
    v_lshl_add_u32 v120, v101, 8, v120
    v_bfe_u32 v101, v100, 4, 2
    v_lshl_add_u32 v120, v101, 10, v120
    v_bfe_u32 v101, v100, 3, 1
    v_lshl_add_u32 v120, v101, 15, v120
    v_bfe_u32 v101, v100, 2, 1
    v_lshl_add_u32 v120, v101, 7, v120
    v_bfe_u32 v101, v100, 4, 1
    v_lshl_add_u32 v120, v101, 6, v120
    v_bfe_u32 v101, v100, 1, 1
    v_lshl_add_u32 v120, v101, 5, v120
    v_bfe_u32 v101, v100, 3, 1
    v_lshl_add_u32 v120, v101, 4, v120
    v_bfe_u32 v101, v100, 0, 1
    v_lshl_add_u32 v120, v101, 3, v120
    v_xor_b32 v120, 192, v120
    v_xor_b32 v121, 16, v120
    v_add_u32 v122, 65536, v120
    v_add_u32 v123, 65536, v121
    v_mov_b32 v124, 0
    v_bfe_u32 v101, v100, 2, 1
    v_lshl_add_u32 v124, v101, 8, v124
    v_bfe_u32 v101, v100, 5, 1
    v_lshl_add_u32 v124, v101, 10, v124
    v_bfe_u32 v101, v100, 4, 1
    v_lshl_add_u32 v124, v101, 11, v124
    v_bfe_u32 v101, v100, 2, 1
    v_lshl_add_u32 v124, v101, 7, v124
    v_bfe_u32 v101, v100, 4, 1
    v_lshl_add_u32 v124, v101, 6, v124
    v_bfe_u32 v101, v100, 3, 1
    v_lshl_add_u32 v124, v101, 5, v124
    v_bfe_u32 v101, v100, 0, 2
    v_lshl_add_u32 v124, v101, 3, v124
    v_xor_b32 v124, 192, v124
    v_add_u32 v125, 65536, v124
    s_mov_b32 m0, 106496
    s_add_u32 s29, s50, 3014656
    buffer_load_dwordx4 v104, s[56:59], s29 offen  lds
    s_mov_b32 m0, 107520
    s_add_u32 s29, s50, 3047424
    buffer_load_dwordx4 v105, s[56:59], s29 offen  lds
    s_mov_b32 m0, 108544
    s_add_u32 s29, s50, 3080192
    buffer_load_dwordx4 v104, s[56:59], s29 offen  lds
    s_mov_b32 m0, 109568
    s_add_u32 s29, s50, 3112960
    buffer_load_dwordx4 v105, s[56:59], s29 offen  lds
    s_waitcnt vmcnt(8)
    s_waitcnt lgkmcnt(0)
    s_barrier
    ds_read_b64_tr_b16 v[144:145], v120 offset:0
    ds_read_b64_tr_b16 v[146:147], v120 offset:512
    ds_read_b64_tr_b16 v[148:149], v122 offset:0
    ds_read_b64_tr_b16 v[150:151], v122 offset:512
    ds_read_b64_tr_b16 v[152:153], v121 offset:0
    ds_read_b64_tr_b16 v[154:155], v121 offset:512
    ds_read_b64_tr_b16 v[156:157], v123 offset:0
    ds_read_b64_tr_b16 v[158:159], v123 offset:512
    s_mov_b32 m0, 110592
    s_add_u32 s29, s50, 3538944
    buffer_load_dwordx4 v104, s[56:59], s29 offen  lds
    s_mov_b32 m0, 111616
    s_add_u32 s29, s50, 3571712
    buffer_load_dwordx4 v105, s[56:59], s29 offen  lds
    s_mov_b32 m0, 112640
    s_add_u32 s29, s50, 3604480
    buffer_load_dwordx4 v104, s[56:59], s29 offen  lds
    s_mov_b32 m0, 113664
    s_add_u32 s29, s50, 3637248
    buffer_load_dwordx4 v105, s[56:59], s29 offen  lds
    v_mov_b32 v103, 768
    v_bfe_u32 v101, v100, 4, 1
    v_lshl_add_u32 v103, v101, 10, v103
    v_bfe_u32 v101, v100, 5, 1
    v_lshl_add_u32 v103, v101, 5, v103
    v_bfe_u32 v101, v100, 0, 2
    v_lshl_add_u32 v103, v101, 2, v103
    s_and_b32 s29, s16, 3
    s_lshl_b32 s29, s29, 11
    s_lshr_b32 s30, s16, 3
    s_lshl_b32 s30, s30, 6
    s_add_u32 s29, s29, s30
    s_and_b32 s30, s16, 4
    s_lshl_b32 s30, s30, 2
    s_add_u32 s29, s29, s30
    v_add_u32 v103, s29, v103
    global_load_dword v110, v103, s[48:49]
    s_waitcnt vmcnt(9)
    s_waitcnt lgkmcnt(0)
    s_barrier
    ds_read_b64_tr_b16 v[160:161], v120 offset:4096
    ds_read_b64_tr_b16 v[162:163], v120 offset:4608
    ds_read_b64_tr_b16 v[164:165], v122 offset:4096
    ds_read_b64_tr_b16 v[166:167], v122 offset:4608
    ds_read_b64_tr_b16 v[168:169], v121 offset:4096
    ds_read_b64_tr_b16 v[170:171], v121 offset:4608
    ds_read_b64_tr_b16 v[172:173], v123 offset:4096
    ds_read_b64_tr_b16 v[174:175], v123 offset:4608
    s_mov_b32 m0, 114688
    s_add_u32 s29, s50, 4063232
    buffer_load_dwordx4 v104, s[56:59], s29 offen  lds
    s_mov_b32 m0, 115712
    s_add_u32 s29, s50, 4096000
    buffer_load_dwordx4 v105, s[56:59], s29 offen  lds
    s_mov_b32 m0, 116736
    s_add_u32 s29, s50, 4128768
    buffer_load_dwordx4 v104, s[56:59], s29 offen  lds
    s_mov_b32 m0, 117760
    s_add_u32 s29, s50, 4161536
    buffer_load_dwordx4 v105, s[56:59], s29 offen  lds
    s_waitcnt vmcnt(9)
    s_waitcnt lgkmcnt(0)
    s_barrier
    ds_read_b64_tr_b16 v[176:177], v120 offset:8192
    ds_read_b64_tr_b16 v[178:179], v120 offset:8704
    ds_read_b64_tr_b16 v[180:181], v122 offset:8192
    ds_read_b64_tr_b16 v[182:183], v122 offset:8704
    ds_read_b64_tr_b16 v[184:185], v121 offset:8192
    ds_read_b64_tr_b16 v[186:187], v121 offset:8704
    ds_read_b64_tr_b16 v[188:189], v123 offset:8192
    ds_read_b64_tr_b16 v[190:191], v123 offset:8704
    s_mov_b32 m0, 118784
    s_add_u32 s29, s50, 393216
    buffer_load_dwordx4 v104, s[60:63], s29 offen  lds
    s_mov_b32 m0, 119808
    s_add_u32 s29, s50, 425984
    buffer_load_dwordx4 v105, s[60:63], s29 offen  lds
    s_mov_b32 m0, 120832
    s_add_u32 s29, s50, 458752
    buffer_load_dwordx4 v104, s[60:63], s29 offen  lds
    s_mov_b32 m0, 121856
    s_add_u32 s29, s50, 491520
    buffer_load_dwordx4 v105, s[60:63], s29 offen  lds
    v_mov_b32 v111, 0
    s_mov_b64 exec, 1
    global_load_dword v111, v111, s[6:7] offset:32 sc1
    s_mov_b64 exec, -1
    v_mov_b32 v2, 98304
    v_bfe_u32 v101, v100, 0, 6
    v_lshl_add_u32 v2, v101, 4, v2
    s_waitcnt vmcnt(10)
    s_waitcnt lgkmcnt(0)
    s_barrier
    ds_read_b64_tr_b16 v[192:193], v120 offset:12288
    ds_read_b64_tr_b16 v[194:195], v120 offset:12800
    ds_read_b64_tr_b16 v[196:197], v122 offset:12288
    ds_read_b64_tr_b16 v[198:199], v122 offset:12800
    ds_read_b64_tr_b16 v[200:201], v121 offset:12288
    ds_read_b64_tr_b16 v[202:203], v121 offset:12800
    ds_read_b64_tr_b16 v[204:205], v123 offset:12288
    ds_read_b64_tr_b16 v[206:207], v123 offset:12800
    s_mov_b32 m0, 122880
    s_add_u32 s29, s50, 917504
    buffer_load_dwordx4 v104, s[60:63], s29 offen  lds
    s_mov_b32 m0, 123904
    s_add_u32 s29, s50, 950272
    buffer_load_dwordx4 v105, s[60:63], s29 offen  lds
    s_mov_b32 m0, 124928
    s_add_u32 s29, s50, 983040
    buffer_load_dwordx4 v104, s[60:63], s29 offen  lds
    s_mov_b32 m0, 125952
    s_add_u32 s29, s50, 1015808
    buffer_load_dwordx4 v105, s[60:63], s29 offen  lds
    v_mov_b32 v4, 142336
    v_bfe_u32 v101, v100, 0, 3
    v_lshl_add_u32 v4, v101, 5, v4
    v_bfe_u32 v101, v100, 4, 2
    v_lshl_add_u32 v4, v101, 3, v4
    v_bfe_u32 v101, v100, 3, 1
    v_lshl_add_u32 v4, v101, 2, v4
    s_waitcnt vmcnt(9)
    s_waitcnt lgkmcnt(0)
    s_barrier
    ds_read_b64_tr_b16 v[208:209], v120 offset:16384
    ds_read_b64_tr_b16 v[210:211], v120 offset:16896
    ds_read_b64_tr_b16 v[212:213], v122 offset:16384
    ds_read_b64_tr_b16 v[214:215], v122 offset:16896
    ds_read_b64_tr_b16 v[216:217], v121 offset:16384
    ds_read_b64_tr_b16 v[218:219], v121 offset:16896
    ds_read_b64_tr_b16 v[220:221], v123 offset:16384
    ds_read_b64_tr_b16 v[222:223], v123 offset:16896
    s_mov_b32 m0, 126976
    s_add_u32 s29, s50, 1441792
    buffer_load_dwordx4 v104, s[60:63], s29 offen  lds
    s_mov_b32 m0, 128000
    s_add_u32 s29, s50, 1474560
    buffer_load_dwordx4 v105, s[60:63], s29 offen  lds
    s_mov_b32 m0, 129024
    s_add_u32 s29, s50, 1507328
    buffer_load_dwordx4 v104, s[60:63], s29 offen  lds
    s_mov_b32 m0, 130048
    s_add_u32 s29, s50, 1540096
    buffer_load_dwordx4 v105, s[60:63], s29 offen  lds
    v_mov_b32 v5, 139264
    v_bfe_u32 v101, v100, 5, 1
    v_lshl_add_u32 v5, v101, 10, v5
    v_bfe_u32 v101, v100, 0, 5
    v_lshl_add_u32 v5, v101, 3, v5
    s_waitcnt vmcnt(9)
    s_waitcnt lgkmcnt(0)
    s_barrier
    ds_read_b64_tr_b16 v[224:225], v120 offset:20480
    ds_read_b64_tr_b16 v[226:227], v120 offset:20992
    ds_read_b64_tr_b16 v[228:229], v122 offset:20480
    ds_read_b64_tr_b16 v[230:231], v122 offset:20992
    ds_read_b64_tr_b16 v[232:233], v121 offset:20480
    ds_read_b64_tr_b16 v[234:235], v121 offset:20992
    ds_read_b64_tr_b16 v[236:237], v123 offset:20480
    ds_read_b64_tr_b16 v[238:239], v123 offset:20992
    s_mov_b32 m0, 98304
    s_add_u32 s29, s50, 1966080
    buffer_load_dwordx4 v104, s[60:63], s29 offen  lds
    s_mov_b32 m0, 99328
    s_add_u32 s29, s50, 1998848
    buffer_load_dwordx4 v105, s[60:63], s29 offen  lds
    s_mov_b32 m0, 100352
    s_add_u32 s29, s50, 2031616
    buffer_load_dwordx4 v104, s[60:63], s29 offen  lds
    s_mov_b32 m0, 101376
    s_add_u32 s29, s50, 2064384
    buffer_load_dwordx4 v105, s[60:63], s29 offen  lds
    v_mov_b32 v6, 131072
    v_bfe_u32 v101, v100, 2, 4
    v_lshl_add_u32 v6, v101, 6, v6
    v_bfe_u32 v101, v100, 0, 1
    v_lshl_add_u32 v6, v101, 4, v6
    s_waitcnt vmcnt(8)
    s_waitcnt lgkmcnt(0)
    s_barrier
    ds_read_b64_tr_b16 v[240:241], v120 offset:24576
    ds_read_b64_tr_b16 v[242:243], v120 offset:25088
    ds_read_b64_tr_b16 v[244:245], v122 offset:24576
    ds_read_b64_tr_b16 v[246:247], v122 offset:25088
    ds_read_b64_tr_b16 v[248:249], v121 offset:24576
    ds_read_b64_tr_b16 v[250:251], v121 offset:25088
    ds_read_b64_tr_b16 v[252:253], v123 offset:24576
    ds_read_b64_tr_b16 v[254:255], v123 offset:25088
    s_mov_b32 m0, 102400
    s_add_u32 s29, s50, 2490368
    buffer_load_dwordx4 v104, s[60:63], s29 offen  lds
    s_mov_b32 m0, 103424
    s_add_u32 s29, s50, 2523136
    buffer_load_dwordx4 v105, s[60:63], s29 offen  lds
    s_mov_b32 m0, 104448
    s_add_u32 s29, s50, 2555904
    buffer_load_dwordx4 v104, s[60:63], s29 offen  lds
    s_mov_b32 m0, 105472
    s_add_u32 s29, s50, 2588672
    buffer_load_dwordx4 v105, s[60:63], s29 offen  lds
    s_mov_b32 s5, 0
Lrot_4:
    v_readfirstlane_b32 s4, v111
    s_nop 3
    s_sub_u32 s4, s4, 1
    s_cmp_eq_u32 s4, s14
    s_cbranch_scc1 Lrot_4_ok
    s_cmp_lt_u32 s4, 8
    s_cbranch_scc0 Lrot_4_again
    s_mov_b32 s14, s4
    s_waitcnt vmcnt(0) lgkmcnt(0)
    s_barrier
    s_branch Lrole
Lrot_4_again:
    v_mov_b32 v111, 0
    s_mov_b64 exec, 1
    global_load_dword v111, v111, s[6:7] offset:32 sc1
    s_mov_b64 exec, -1
    s_waitcnt vmcnt(0)
    s_add_u32 s5, s5, 1
    s_cmp_lt_u32 s5, 400000
    s_cbranch_scc1 Lrot_4
Lrot_4_ok:
    v_mov_b32 v12, 144128
    v_bfe_u32 v101, v100, 0, 4
    v_lshl_add_u32 v12, v101, 4, v12
    v_bfe_u32 v101, v100, 4, 2
    v_lshl_add_u32 v12, v101, 2, v12
    s_waitcnt vmcnt(8)
    s_waitcnt lgkmcnt(0)
    s_barrier
    ds_read_b64_tr_b16 a[0:1], v120 offset:28672
    ds_read_b64_tr_b16 a[2:3], v120 offset:29184
    ds_read_b64_tr_b16 a[4:5], v122 offset:28672
    ds_read_b64_tr_b16 a[6:7], v122 offset:29184
    ds_read_b64_tr_b16 a[8:9], v121 offset:28672
    ds_read_b64_tr_b16 a[10:11], v121 offset:29184
    ds_read_b64_tr_b16 a[12:13], v123 offset:28672
    ds_read_b64_tr_b16 a[14:15], v123 offset:29184
    s_mov_b32 m0, 106496
    s_add_u32 s29, s50, 3014656
    buffer_load_dwordx4 v104, s[60:63], s29 offen  lds
    s_mov_b32 m0, 107520
    s_add_u32 s29, s50, 3047424
    buffer_load_dwordx4 v105, s[60:63], s29 offen  lds
    s_mov_b32 m0, 108544
    s_add_u32 s29, s50, 3080192
    buffer_load_dwordx4 v104, s[60:63], s29 offen  lds
    s_mov_b32 m0, 109568
    s_add_u32 s29, s50, 3112960
    buffer_load_dwordx4 v105, s[60:63], s29 offen  lds
    v_mov_b32 v7, 131072
    v_bfe_u32 v101, v100, 3, 1
    v_lshl_add_u32 v7, v101, 15, v7
    v_bfe_u32 v101, v100, 4, 2
    v_lshl_add_u32 v7, v101, 13, v7
    v_bfe_u32 v101, v100, 0, 3
    v_lshl_add_u32 v7, v101, 3, v7
    v_mov_b32 v103, 24
    v_bfe_u32 v101, v100, 3, 1
    v_lshl_add_u32 v103, v101, 2, v103
    v_bfe_u32 v101, v100, 4, 2
    v_lshl_add_u32 v103, v101, 0, v103
    v_mul_u32_u24 v103, 0, v103
    v_add_u32 v103, s16, v103
    v_and_b32 v103, 31, v103
    v_lshl_add_u32 v7, v103, 6, v7
    s_waitcnt vmcnt(8)
    s_waitcnt lgkmcnt(0)
    s_barrier
    ds_read_b64_tr_b16 a[16:17], v120 offset:0
    ds_read_b64_tr_b16 a[18:19], v120 offset:512
    ds_read_b64_tr_b16 a[20:21], v122 offset:0
    ds_read_b64_tr_b16 a[22:23], v122 offset:512
    ds_read_b64_tr_b16 a[24:25], v121 offset:0
    ds_read_b64_tr_b16 a[26:27], v121 offset:512
    ds_read_b64_tr_b16 a[28:29], v123 offset:0
    ds_read_b64_tr_b16 a[30:31], v123 offset:512
    s_mov_b32 m0, 110592
    s_add_u32 s29, s50, 3538944
    buffer_load_dwordx4 v104, s[60:63], s29 offen  lds
    s_mov_b32 m0, 111616
    s_add_u32 s29, s50, 3571712
    buffer_load_dwordx4 v105, s[60:63], s29 offen  lds
    s_mov_b32 m0, 112640
    s_add_u32 s29, s50, 3604480
    buffer_load_dwordx4 v104, s[60:63], s29 offen  lds
    s_mov_b32 m0, 113664
    s_add_u32 s29, s50, 3637248
    buffer_load_dwordx4 v105, s[60:63], s29 offen  lds
    v_mov_b32 v1, 131072
    v_bfe_u32 v101, v100, 0, 6
    v_lshl_add_u32 v1, v101, 4, v1
    v_mov_b32 v112, -1
    v_mov_b32 v113, -1
    v_mov_b32 v114, -1
    v_mov_b32 v115, -1
    s_lshl_b32 s22, s16, 13
    s_add_u32 s22, s22, 52434944
    s_xor_b32 s23, s22, 262144
    buffer_store_dwordx4 v[112:115], v1, s[8:11], s22 offen offset:0 sc1
    buffer_store_dwordx4 v[112:115], v1, s[8:11], s22 offen offset:1024 sc1
    buffer_store_dwordx4 v[112:115], v1, s[8:11], s23 offen offset:0 sc1
    buffer_store_dwordx4 v[112:115], v1, s[8:11], s23 offen offset:1024 sc1
    s_waitcnt vmcnt(12)
    s_waitcnt lgkmcnt(0)
    s_barrier
    ds_read_b64_tr_b16 a[32:33], v120 offset:4096
    ds_read_b64_tr_b16 a[34:35], v120 offset:4608
    ds_read_b64_tr_b16 a[36:37], v122 offset:4096
    ds_read_b64_tr_b16 a[38:39], v122 offset:4608
    ds_read_b64_tr_b16 a[40:41], v121 offset:4096
    ds_read_b64_tr_b16 a[42:43], v121 offset:4608
    ds_read_b64_tr_b16 a[44:45], v123 offset:4096
    ds_read_b64_tr_b16 a[46:47], v123 offset:4608
    s_mov_b32 m0, 114688
    s_add_u32 s29, s50, 4063232
    buffer_load_dwordx4 v104, s[60:63], s29 offen  lds
    s_mov_b32 m0, 115712
    s_add_u32 s29, s50, 4096000
    buffer_load_dwordx4 v105, s[60:63], s29 offen  lds
    s_mov_b32 m0, 116736
    s_add_u32 s29, s50, 4128768
    buffer_load_dwordx4 v104, s[60:63], s29 offen  lds
    s_mov_b32 m0, 117760
    s_add_u32 s29, s50, 4161536
    buffer_load_dwordx4 v105, s[60:63], s29 offen  lds
    v_mov_b32 v8, 0
    v_bfe_u32 v101, v100, 4, 2
    v_lshl_add_u32 v8, v101, 4, v8
    v_bfe_u32 v101, v100, 0, 2
    v_lshl_add_u32 v8, v101, 2, v8
    v_bfe_u32 v101, v100, 2, 1
    v_lshl_add_u32 v8, v101, 30, v8
    v_bfe_u32 v101, v100, 3, 1
    v_lshlrev_b32 v101, 30, v101
    v_or_b32 v8, v101, v8
    s_lshl_b32 s24, s16, 6
    s_add_u32 s24, s24, 53090304
    s_add_u32 s29, s24, 8192
    buffer_store_dword v112, v8, s[8:11], s29 offen sc1
    s_add_u32 s29, s24, 16384
    buffer_store_dword v112, v8, s[8:11], s29 offen sc1
    s_add_u32 s29, s24, 24576
    buffer_store_dword v112, v8, s[8:11], s29 offen sc1
    buffer_store_dword v110, v8, s[8:11], s24 offen sc1
    s_waitcnt vmcnt(16)
    s_waitcnt lgkmcnt(0)
    s_barrier
    ds_read_b64_tr_b16 a[48:49], v120 offset:8192
    ds_read_b64_tr_b16 a[50:51], v120 offset:8704
    ds_read_b64_tr_b16 a[52:53], v122 offset:8192
    ds_read_b64_tr_b16 a[54:55], v122 offset:8704
    ds_read_b64_tr_b16 a[56:57], v121 offset:8192
    ds_read_b64_tr_b16 a[58:59], v121 offset:8704
    ds_read_b64_tr_b16 a[60:61], v123 offset:8192
    ds_read_b64_tr_b16 a[62:63], v123 offset:8704
    s_mov_b32 m0, 118784
    s_add_u32 s29, s50, 2490368
    buffer_load_dwordx4 v104, s[52:55], s29 offen  lds
    s_mov_b32 m0, 119808
    s_add_u32 s29, s50, 2523136
    buffer_load_dwordx4 v105, s[52:55], s29 offen  lds
    s_mov_b32 m0, 120832
    s_add_u32 s29, s50, 2555904
    buffer_load_dwordx4 v104, s[52:55], s29 offen  lds
    s_mov_b32 m0, 121856
    s_add_u32 s29, s50, 2588672
    buffer_load_dwordx4 v105, s[52:55], s29 offen  lds
    v_mov_b32 v3, 12288
    v_bfe_u32 v101, v100, 4, 2
    v_lshl_add_u32 v3, v101, 9, v3
    v_bfe_u32 v101, v100, 3, 1
    v_lshl_add_u32 v3, v101, 8, v3
    v_bfe_u32 v101, v100, 0, 3
    v_lshl_add_u32 v3, v101, 4, v3
    s_waitcnt vmcnt(16)
    s_waitcnt lgkmcnt(0)
    s_barrier
    ds_read_b64_tr_b16 a[64:65], v120 offset:12288
    ds_read_b64_tr_b16 a[66:67], v120 offset:12800
    ds_read_b64_tr_b16 a[68:69], v122 offset:12288
    ds_read_b64_tr_b16 a[70:71], v122 offset:12800
    ds_read_b64_tr_b16 a[72:73], v121 offset:12288
    ds_read_b64_tr_b16 a[74:75], v121 offset:12800
    ds_read_b64_tr_b16 a[76:77], v123 offset:12288
    ds_read_b64_tr_b16 a[78:79], v123 offset:12800
    s_mov_b32 m0, 122880
    s_add_u32 s29, s50, 3014656
    buffer_load_dwordx4 v104, s[52:55], s29 offen  lds
    s_mov_b32 m0, 123904
    s_add_u32 s29, s50, 3047424
    buffer_load_dwordx4 v105, s[52:55], s29 offen  lds
    s_mov_b32 m0, 124928
    s_add_u32 s29, s50, 3080192
    buffer_load_dwordx4 v104, s[52:55], s29 offen  lds
    s_mov_b32 m0, 125952
    s_add_u32 s29, s50, 3112960
    buffer_load_dwordx4 v105, s[52:55], s29 offen  lds
    v_mov_b32 v9, 768
    v_bfe_u32 v101, v100, 5, 1
    v_lshl_add_u32 v9, v101, 12, v9
    v_bfe_u32 v101, v100, 4, 1
    v_lshl_add_u32 v9, v101, 10, v9
    v_bfe_u32 v101, v100, 0, 4
    v_lshl_add_u32 v9, v101, 4, v9
    s_waitcnt vmcnt(12)
    s_waitcnt lgkmcnt(0)
    s_barrier
    ds_read_b64_tr_b16 a[80:81], v120 offset:16384
    ds_read_b64_tr_b16 a[82:83], v120 offset:16896
    ds_read_b64_tr_b16 a[84:85], v122 offset:16384
    ds_read_b64_tr_b16 a[86:87], v122 offset:16896
    ds_read_b64_tr_b16 a[88:89], v121 offset:16384
    ds_read_b64_tr_b16 a[90:91], v121 offset:16896
    ds_read_b64_tr_b16 a[92:93], v123 offset:16384
    ds_read_b64_tr_b16 a[94:95], v123 offset:16896
    s_mov_b32 m0, 126976
    s_add_u32 s29, s50, 3538944
    buffer_load_dwordx4 v104, s[52:55], s29 offen  lds
    s_mov_b32 m0, 128000
    s_add_u32 s29, s50, 3571712
    buffer_load_dwordx4 v105, s[52:55], s29 offen  lds
    s_mov_b32 m0, 129024
    s_add_u32 s29, s50, 3604480
    buffer_load_dwordx4 v104, s[52:55], s29 offen  lds
    s_mov_b32 m0, 130048
    s_add_u32 s29, s50, 3637248
    buffer_load_dwordx4 v105, s[52:55], s29 offen  lds
    v_mov_b32 v103, 0
    v_bfe_u32 v101, v100, 0, 2
    v_lshl_add_u32 v103, v101, 2, v103
    v_bfe_u32 v101, v100, 2, 2
    v_lshl_add_u32 v103, v101, 0, v103
    v_and_b32 v102, 1, v103
    v_lshlrev_b32 v102, 4, v102
    v_mov_b32 v101, 0x3f80
    v_lshlrev_b32 v102, v102, v101
    v_lshrrev_b32 v103, 1, v103
    v_cmp_eq_u32 vcc, 0, v103
    s_nop 1
    v_cndmask_b32 v112, 0, v102, vcc
    v_cmp_eq_u32 vcc, 1, v103
    s_nop 1
    v_cndmask_b32 v113, 0, v102, vcc
    v_cmp_eq_u32 vcc, 2, v103
    s_nop 1
    v_cndmask_b32 v114, 0, v102, vcc
    v_cmp_eq_u32 vcc, 3, v103
    s_nop 1
    v_cndmask_b32 v115, 0, v102, vcc
    ds_write_b128 v1, v[112:115] offset:13312
    v_bfe_u32 v101, v100, 1, 1
    v_mul_u32_u24 v101, 0xaaaa, v101
    v_add_u32 v0, 0x4444, v101
    s_waitcnt vmcnt(8)
    s_waitcnt lgkmcnt(0)
    s_barrier
    ds_read_b64_tr_b16 a[96:97], v120 offset:20480
    ds_read_b64_tr_b16 a[98:99], v120 offset:20992
    ds_read_b64_tr_b16 a[100:101], v122 offset:20480
    ds_read_b64_tr_b16 a[102:103], v122 offset:20992
    ds_read_b64_tr_b16 a[104:105], v121 offset:20480
    ds_read_b64_tr_b16 a[106:107], v121 offset:20992
    ds_read_b64_tr_b16 a[108:109], v123 offset:20480
    ds_read_b64_tr_b16 a[110:111], v123 offset:20992
    s_mov_b32 m0, 98304
    s_add_u32 s29, s50, 4063232
    buffer_load_dwordx4 v104, s[52:55], s29 offen  lds
    s_mov_b32 m0, 99328
    s_add_u32 s29, s50, 4096000
    buffer_load_dwordx4 v105, s[52:55], s29 offen  lds
    s_mov_b32 m0, 100352
    s_add_u32 s29, s50, 4128768
    buffer_load_dwordx4 v104, s[52:55], s29 offen  lds
    s_mov_b32 m0, 101376
    s_add_u32 s29, s50, 4161536
    buffer_load_dwordx4 v105, s[52:55], s29 offen  lds
    s_lshl_b32 s18, s16, 14
    s_add_u32 s18, s18, 4096
    s_add_u32 s19, s24, 7733248
    v_mov_b32 v14, v110
    s_mov_b32 s20, 52625408
    s_mov_b32 s17, 0
    s_mov_b32 s28, 0
    s_mov_b32 s32, 0x3e0293ee
    s_mov_b32 s42, 0x3f803f80
    s_mov_b32 s44, 0x3f003f00
    s_mov_b32 s48, 0x33333333
    s_mov_b32 s43, 0x3f803f80
    s_mov_b32 s45, 0x3f003f00
    s_mov_b32 s49, 0x33333333
    s_mov_b32 s34, 0x21800000
    s_mov_b32 s35, 0x3c000000
    s_waitcnt vmcnt(8)
    s_waitcnt lgkmcnt(0)
    s_barrier
    ds_read_b64_tr_b16 a[112:113], v120 offset:24576
    ds_read_b64_tr_b16 a[114:115], v120 offset:25088
    ds_read_b64_tr_b16 a[116:117], v122 offset:24576
    ds_read_b64_tr_b16 a[118:119], v122 offset:25088
    ds_read_b64_tr_b16 a[120:121], v121 offset:24576
    ds_read_b64_tr_b16 a[122:123], v121 offset:25088
    ds_read_b64_tr_b16 a[124:125], v123 offset:24576
    ds_read_b64_tr_b16 a[126:127], v123 offset:25088
    s_mov_b32 m0, 102400
    s_add_u32 s29, s51, 49152
    buffer_load_dwordx4 v108, s[64:67], s29 offen  lds
    s_mov_b32 m0, 103424
    s_add_u32 s29, s51, 53248
    buffer_load_dwordx4 v108, s[64:67], s29 offen  lds
    s_mov_b32 m0, 104448
    s_add_u32 s29, s51, 57344
    buffer_load_dwordx4 v109, s[64:67], s29 offen  lds
    s_mov_b32 m0, 105472
    s_add_u32 s29, s51, 61440
    buffer_load_dwordx4 v109, s[64:67], s29 offen  lds
    v_mov_b32 v126, 132608
    v_bfe_u32 v101, v100, 2, 4
    v_lshl_add_u32 v126, v101, 5, v126
    v_bfe_u32 v101, v100, 0, 1
    v_lshl_add_u32 v126, v101, 4, v126
    v_bfe_u32 v101, v100, 1, 1
    v_lshl_add_u32 v126, v101, 3, v126
    s_waitcnt vmcnt(8)
    s_waitcnt lgkmcnt(0)
    s_barrier
    ds_read_b64_tr_b16 a[128:129], v120 offset:28672
    ds_read_b64_tr_b16 a[130:131], v120 offset:29184
    ds_read_b64_tr_b16 a[132:133], v122 offset:28672
    ds_read_b64_tr_b16 a[134:135], v122 offset:29184
    ds_read_b64_tr_b16 a[136:137], v121 offset:28672
    ds_read_b64_tr_b16 a[138:139], v121 offset:29184
    ds_read_b64_tr_b16 a[140:141], v123 offset:28672
    ds_read_b64_tr_b16 a[142:143], v123 offset:29184
    s_mov_b32 m0, 106496
    s_add_u32 s29, s51, 114688
    buffer_load_dwordx4 v108, s[64:67], s29 offen  lds
    s_mov_b32 m0, 107520
    s_add_u32 s29, s51, 118784
    buffer_load_dwordx4 v108, s[64:67], s29 offen  lds
    s_mov_b32 m0, 108544
    s_add_u32 s29, s51, 122880
    buffer_load_dwordx4 v109, s[64:67], s29 offen  lds
    s_mov_b32 m0, 109568
    s_add_u32 s29, s51, 126976
    buffer_load_dwordx4 v109, s[64:67], s29 offen  lds
    v_mov_b32 v127, 131072
    v_bfe_u32 v101, v100, 2, 4
    v_lshl_add_u32 v127, v101, 5, v127
    v_bfe_u32 v101, v100, 0, 1
    v_lshl_add_u32 v127, v101, 4, v127
    s_waitcnt vmcnt(8)
    s_waitcnt lgkmcnt(0)
    s_barrier
    ds_read_b64_tr_b16 a[144:145], v120 offset:0
    ds_read_b64_tr_b16 a[146:147], v120 offset:512
    ds_read_b64_tr_b16 a[148:149], v122 offset:0
    ds_read_b64_tr_b16 a[150:151], v122 offset:512
    ds_read_b64_tr_b16 a[152:153], v121 offset:0
    ds_read_b64_tr_b16 a[154:155], v121 offset:512
    ds_read_b64_tr_b16 a[156:157], v123 offset:0
    ds_read_b64_tr_b16 a[158:159], v123 offset:512
    s_mov_b32 m0, 110592
    s_add_u32 s29, s51, 49408
    buffer_load_dwordx4 v108, s[64:67], s29 offen  lds
    s_mov_b32 m0, 111616
    s_add_u32 s29, s51, 53504
    buffer_load_dwordx4 v108, s[64:67], s29 offen  lds
    s_mov_b32 m0, 112640
    s_add_u32 s29, s51, 57600
    buffer_load_dwordx4 v109, s[64:67], s29 offen  lds
    s_mov_b32 m0, 113664
    s_add_u32 s29, s51, 61696
    buffer_load_dwordx4 v109, s[64:67], s29 offen  lds
    s_waitcnt vmcnt(8)
    s_waitcnt lgkmcnt(0)
    s_barrier
    ds_read_b64_tr_b16 a[160:161], v124 offset:4096
    ds_read_b64_tr_b16 a[162:163], v124 offset:4608
    ds_read_b64_tr_b16 a[164:165], v124 offset:36864
    ds_read_b64_tr_b16 a[166:167], v124 offset:37376
    ds_read_b64_tr_b16 a[168:169], v125 offset:4096
    ds_read_b64_tr_b16 a[170:171], v125 offset:4608
    ds_read_b64_tr_b16 a[172:173], v125 offset:36864
    ds_read_b64_tr_b16 a[174:175], v125 offset:37376
    s_mov_b32 m0, 114688
    s_add_u32 s29, s51, 114944
    buffer_load_dwordx4 v108, s[64:67], s29 offen  lds
    s_mov_b32 m0, 115712
    s_add_u32 s29, s51, 119040
    buffer_load_dwordx4 v108, s[64:67], s29 offen  lds
    s_mov_b32 m0, 116736
    s_add_u32 s29, s51, 123136
    buffer_load_dwordx4 v109, s[64:67], s29 offen  lds
    s_mov_b32 m0, 117760
    s_add_u32 s29, s51, 127232
    buffer_load_dwordx4 v109, s[64:67], s29 offen  lds
    s_waitcnt vmcnt(8)
    s_waitcnt lgkmcnt(0)
    s_barrier
    ds_read_b64_tr_b16 a[176:177], v124 offset:8192
    ds_read_b64_tr_b16 a[178:179], v124 offset:8704
    ds_read_b64_tr_b16 a[180:181], v124 offset:40960
    ds_read_b64_tr_b16 a[182:183], v124 offset:41472
    ds_read_b64_tr_b16 a[184:185], v125 offset:8192
    ds_read_b64_tr_b16 a[186:187], v125 offset:8704
    ds_read_b64_tr_b16 a[188:189], v125 offset:40960
    ds_read_b64_tr_b16 a[190:191], v125 offset:41472
    s_mov_b32 m0, 118784
    s_add_u32 s29, s51, 49664
    buffer_load_dwordx4 v108, s[64:67], s29 offen  lds
    s_mov_b32 m0, 119808
    s_add_u32 s29, s51, 53760
    buffer_load_dwordx4 v108, s[64:67], s29 offen  lds
    s_mov_b32 m0, 120832
    s_add_u32 s29, s51, 57856
    buffer_load_dwordx4 v109, s[64:67], s29 offen  lds
    s_mov_b32 m0, 121856
    s_add_u32 s29, s51, 61952
    buffer_load_dwordx4 v109, s[64:67], s29 offen  lds
    s_waitcnt vmcnt(8)
    s_waitcnt lgkmcnt(0)
    s_barrier
    ds_read_b64_tr_b16 a[192:193], v124 offset:12288
    ds_read_b64_tr_b16 a[194:195], v124 offset:12800
    ds_read_b64_tr_b16 a[196:197], v124 offset:45056
    ds_read_b64_tr_b16 a[198:199], v124 offset:45568
    ds_read_b64_tr_b16 a[200:201], v125 offset:12288
    ds_read_b64_tr_b16 a[202:203], v125 offset:12800
    ds_read_b64_tr_b16 a[204:205], v125 offset:45056
    ds_read_b64_tr_b16 a[206:207], v125 offset:45568
    s_mov_b32 m0, 122880
    s_add_u32 s29, s51, 115200
    buffer_load_dwordx4 v108, s[64:67], s29 offen  lds
    s_mov_b32 m0, 123904
    s_add_u32 s29, s51, 119296
    buffer_load_dwordx4 v108, s[64:67], s29 offen  lds
    s_mov_b32 m0, 124928
    s_add_u32 s29, s51, 123392
    buffer_load_dwordx4 v109, s[64:67], s29 offen  lds
    s_mov_b32 m0, 125952
    s_add_u32 s29, s51, 127488
    buffer_load_dwordx4 v109, s[64:67], s29 offen  lds
    s_waitcnt vmcnt(8)
    s_waitcnt lgkmcnt(0)
    s_barrier
    ds_read_b64_tr_b16 a[208:209], v124 offset:16384
    ds_read_b64_tr_b16 a[210:211], v124 offset:16896
    ds_read_b64_tr_b16 a[212:213], v124 offset:49152
    ds_read_b64_tr_b16 a[214:215], v124 offset:49664
    ds_read_b64_tr_b16 a[216:217], v125 offset:16384
    ds_read_b64_tr_b16 a[218:219], v125 offset:16896
    ds_read_b64_tr_b16 a[220:221], v125 offset:49152
    ds_read_b64_tr_b16 a[222:223], v125 offset:49664
    s_mov_b32 m0, 126976
    s_add_u32 s29, s50, 1966080
    buffer_load_dwordx4 v104, s[52:55], s29 offen  lds
    s_mov_b32 m0, 128000
    s_add_u32 s29, s50, 1998848
    buffer_load_dwordx4 v105, s[52:55], s29 offen  lds
    s_mov_b32 m0, 129024
    s_add_u32 s29, s50, 2031616
    buffer_load_dwordx4 v104, s[52:55], s29 offen  lds
    s_mov_b32 m0, 130048
    s_add_u32 s29, s50, 2064384
    buffer_load_dwordx4 v105, s[52:55], s29 offen  lds
    v_mov_b32 v118, 0
    s_mov_b64 exec, 1
    global_load_dwordx2 v[114:115], v118, s[6:7] offset:128 sc1
    s_mov_b64 exec, -1
    s_waitcnt vmcnt(9)
    s_waitcnt lgkmcnt(0)
    s_barrier
    ds_read_b64_tr_b16 a[224:225], v124 offset:20480
    ds_read_b64_tr_b16 a[226:227], v124 offset:20992
    ds_read_b64_tr_b16 a[228:229], v124 offset:53248
    ds_read_b64_tr_b16 a[230:231], v124 offset:53760
    ds_read_b64_tr_b16 a[232:233], v125 offset:20480
    ds_read_b64_tr_b16 a[234:235], v125 offset:20992
    ds_read_b64_tr_b16 a[236:237], v125 offset:53248
    ds_read_b64_tr_b16 a[238:239], v125 offset:53760
    s_mov_b32 m0, 98304
    s_add_u32 s29, s50, 393216
    buffer_load_dwordx4 v104, s[52:55], s29 offen  lds
    s_mov_b32 m0, 99328
    s_add_u32 s29, s50, 425984
    buffer_load_dwordx4 v105, s[52:55], s29 offen  lds
    s_mov_b32 m0, 100352
    s_add_u32 s29, s50, 458752
    buffer_load_dwordx4 v104, s[52:55], s29 offen  lds
    s_mov_b32 m0, 101376
    s_add_u32 s29, s50, 491520
    buffer_load_dwordx4 v105, s[52:55], s29 offen  lds
    s_waitcnt vmcnt(9)
    s_waitcnt lgkmcnt(0)
    s_barrier
    ds_read_b64_tr_b16 a[240:241], v124 offset:24576
    ds_read_b64_tr_b16 a[242:243], v124 offset:25088
    ds_read_b64_tr_b16 a[244:245], v124 offset:57344
    ds_read_b64_tr_b16 a[246:247], v124 offset:57856
    ds_read_b64_tr_b16 a[248:249], v125 offset:24576
    ds_read_b64_tr_b16 a[250:251], v125 offset:25088
    ds_read_b64_tr_b16 a[252:253], v125 offset:57344
    ds_read_b64_tr_b16 a[254:255], v125 offset:57856
    s_mov_b32 m0, 102400
    s_add_u32 s29, s50, 917504
    buffer_load_dwordx4 v104, s[52:55], s29 offen  lds
    s_mov_b32 m0, 103424
    s_add_u32 s29, s50, 950272
    buffer_load_dwordx4 v105, s[52:55], s29 offen  lds
    s_mov_b32 m0, 104448
    s_add_u32 s29, s50, 983040
    buffer_load_dwordx4 v104, s[52:55], s29 offen  lds
    s_mov_b32 m0, 105472
    s_add_u32 s29, s50, 1015808
    buffer_load_dwordx4 v105, s[52:55], s29 offen  lds
    s_waitcnt vmcnt(9)
    s_waitcnt lgkmcnt(0)
    s_barrier
    ds_read_b64_tr_b16 v[32:33], v120 offset:28672
    ds_read_b64_tr_b16 v[34:35], v120 offset:29184
    ds_read_b64_tr_b16 v[36:37], v122 offset:28672
    ds_read_b64_tr_b16 v[38:39], v122 offset:29184
    ds_read_b64_tr_b16 v[40:41], v121 offset:28672
    ds_read_b64_tr_b16 v[42:43], v121 offset:29184
    ds_read_b64_tr_b16 v[44:45], v123 offset:28672
    ds_read_b64_tr_b16 v[46:47], v123 offset:29184
    s_mov_b32 m0, 106496
    s_add_u32 s29, s50, 1441792
    buffer_load_dwordx4 v104, s[52:55], s29 offen  lds
    s_mov_b32 m0, 107520
    s_add_u32 s29, s50, 1474560
    buffer_load_dwordx4 v105, s[52:55], s29 offen  lds
    s_mov_b32 m0, 108544
    s_add_u32 s29, s50, 1507328
    buffer_load_dwordx4 v104, s[52:55], s29 offen  lds
    s_mov_b32 m0, 109568
    s_add_u32 s29, s50, 1540096
    buffer_load_dwordx4 v105, s[52:55], s29 offen  lds
    s_waitcnt vmcnt(8)
    s_waitcnt lgkmcnt(0)
    s_barrier
    ds_read_b64_tr_b16 v[16:17], v120 offset:0
    ds_read_b64_tr_b16 v[18:19], v120 offset:512
    ds_read_b64_tr_b16 v[20:21], v122 offset:0
    ds_read_b64_tr_b16 v[22:23], v122 offset:512
    ds_read_b64_tr_b16 v[24:25], v121 offset:0
    ds_read_b64_tr_b16 v[26:27], v121 offset:512
    ds_read_b64_tr_b16 v[28:29], v123 offset:0
    ds_read_b64_tr_b16 v[30:31], v123 offset:512
    ds_write_b128 v1, v[32:35] offset:28672
    ds_write_b128 v1, v[36:39] offset:29696
    ds_write_b128 v1, v[40:43] offset:30720
    ds_write_b128 v1, v[44:47] offset:31744
    s_mov_b32 m0, 110592
    s_add_u32 s29, s50, 393216
    buffer_load_dwordx4 v104, s[56:59], s29 offen  lds
    s_mov_b32 m0, 111616
    s_add_u32 s29, s50, 425984
    buffer_load_dwordx4 v105, s[56:59], s29 offen  lds
    s_mov_b32 m0, 112640
    s_add_u32 s29, s50, 458752
    buffer_load_dwordx4 v104, s[56:59], s29 offen  lds
    s_mov_b32 m0, 113664
    s_add_u32 s29, s50, 491520
    buffer_load_dwordx4 v105, s[56:59], s29 offen  lds
    s_waitcnt vmcnt(8)
    s_waitcnt lgkmcnt(0)
    s_barrier
    ds_read_b64_tr_b16 v[32:33], v120 offset:4096
    ds_read_b64_tr_b16 v[34:35], v120 offset:4608
    ds_read_b64_tr_b16 v[36:37], v122 offset:4096
    ds_read_b64_tr_b16 v[38:39], v122 offset:4608
    ds_read_b64_tr_b16 v[40:41], v121 offset:4096
    ds_read_b64_tr_b16 v[42:43], v121 offset:4608
    ds_read_b64_tr_b16 v[44:45], v123 offset:4096
    ds_read_b64_tr_b16 v[46:47], v123 offset:4608
    ds_write_b128 v2, v[16:19] offset:0
    ds_write_b128 v2, v[20:23] offset:1024
    ds_write_b128 v2, v[24:27] offset:2048
    ds_write_b128 v2, v[28:31] offset:3072
    s_mov_b32 m0, 114688
    s_add_u32 s29, s50, 917504
    buffer_load_dwordx4 v104, s[56:59], s29 offen  lds
    s_mov_b32 m0, 115712
    s_add_u32 s29, s50, 950272
    buffer_load_dwordx4 v105, s[56:59], s29 offen  lds
    s_mov_b32 m0, 116736
    s_add_u32 s29, s50, 983040
    buffer_load_dwordx4 v104, s[56:59], s29 offen  lds
    s_mov_b32 m0, 117760
    s_add_u32 s29, s50, 1015808
    buffer_load_dwordx4 v105, s[56:59], s29 offen  lds
    s_mov_b32 s27, 0
Tln_3:
    v_and_b32 v114, v114, v115
    s_nop 0
    v_readfirstlane_b32 s39, v114
    s_nop 3
    s_cmp_eq_u32 s39, -1
    s_cbranch_scc1 Tlnd_3
    v_mov_b32 v118, 0
    s_mov_b64 exec, 1
    global_load_dwordx2 v[114:115], v118, s[6:7] offset:128 sc1
    s_mov_b64 exec, -1
    s_waitcnt vmcnt(0)
    s_add_u32 s27, s27, 1
    s_cmp_lt_u32 s27, 400000
    s_cbranch_scc1 Tln_3
Tlnd_3:
    s_waitcnt vmcnt(8)
    s_waitcnt lgkmcnt(0)
    s_barrier
    ds_read_b64_tr_b16 v[16:17], v120 offset:8192
    ds_read_b64_tr_b16 v[18:19], v120 offset:8704
    ds_read_b64_tr_b16 v[20:21], v122 offset:8192
    ds_read_b64_tr_b16 v[22:23], v122 offset:8704
    ds_read_b64_tr_b16 v[24:25], v121 offset:8192
    ds_read_b64_tr_b16 v[26:27], v121 offset:8704
    ds_read_b64_tr_b16 v[28:29], v123 offset:8192
    ds_read_b64_tr_b16 v[30:31], v123 offset:8704
    ds_write_b128 v2, v[32:35] offset:4096
    ds_write_b128 v2, v[36:39] offset:5120
    ds_write_b128 v2, v[40:43] offset:6144
    ds_write_b128 v2, v[44:47] offset:7168
    s_mov_b32 m0, 118784
    s_add_u32 s29, s50, 1441792
    buffer_load_dwordx4 v104, s[56:59], s29 offen  lds
    s_mov_b32 m0, 119808
    s_add_u32 s29, s50, 1474560
    buffer_load_dwordx4 v105, s[56:59], s29 offen  lds
    s_mov_b32 m0, 120832
    s_add_u32 s29, s50, 1507328
    buffer_load_dwordx4 v104, s[56:59], s29 offen  lds
    s_mov_b32 m0, 121856
    s_add_u32 s29, s50, 1540096
    buffer_load_dwordx4 v105, s[56:59], s29 offen  lds
    v_mov_b32 v118, 0
    v_lshlrev_b32 v119, 12, v100
    s_lshl_b32 s38, s16, 7
    s_add_u32 s38, s38, 58720260
    s_mov_b64 exec, 1
    global_load_dwordx2 v[116:117], v118, s[6:7] sc1
    s_mov_b64 exec, 3
    buffer_load_dword v113, v119, s[8:11], s38 offen sc1
    s_mov_b64 exec, -1
    s_waitcnt vmcnt(10)
    s_waitcnt lgkmcnt(0)
    s_barrier
    ds_read_b64_tr_b16 v[32:33], v120 offset:12288
    ds_read_b64_tr_b16 v[34:35], v120 offset:12800
    ds_read_b64_tr_b16 v[36:37], v122 offset:12288
    ds_read_b64_tr_b16 v[38:39], v122 offset:12800
    ds_read_b64_tr_b16 v[40:41], v121 offset:12288
    ds_read_b64_tr_b16 v[42:43], v121 offset:12800
    ds_read_b64_tr_b16 v[44:45], v123 offset:12288
    ds_read_b64_tr_b16 v[46:47], v123 offset:12800
    ds_write_b128 v2, v[16:19] offset:8192
    ds_write_b128 v2, v[20:23] offset:9216
    ds_write_b128 v2, v[24:27] offset:10240
    ds_write_b128 v2, v[28:31] offset:11264
    s_mov_b32 m0, 122880
    s_add_u32 s29, s51, 49920
    buffer_load_dwordx4 v108, s[64:67], s29 offen  lds
    s_mov_b32 m0, 123904
    s_add_u32 s29, s51, 54016
    buffer_load_dwordx4 v108, s[64:67], s29 offen  lds
    s_mov_b32 m0, 124928
    s_add_u32 s29, s51, 58112
    buffer_load_dwordx4 v109, s[64:67], s29 offen  lds
    s_mov_b32 m0, 125952
    s_add_u32 s29, s51, 62208
    buffer_load_dwordx4 v109, s[64:67], s29 offen  lds
    s_waitcnt vmcnt(10)
    s_waitcnt lgkmcnt(0)
    s_barrier
    ds_read_b64_tr_b16 v[16:17], v120 offset:16384
    ds_read_b64_tr_b16 v[18:19], v120 offset:16896
    ds_read_b64_tr_b16 v[20:21], v122 offset:16384
    ds_read_b64_tr_b16 v[22:23], v122 offset:16896
    ds_read_b64_tr_b16 v[24:25], v121 offset:16384
    ds_read_b64_tr_b16 v[26:27], v121 offset:16896
    ds_read_b64_tr_b16 v[28:29], v123 offset:16384
    ds_read_b64_tr_b16 v[30:31], v123 offset:16896
    ds_write_b128 v2, v[32:35] offset:12288
    ds_write_b128 v2, v[36:39] offset:13312
    ds_write_b128 v2, v[40:43] offset:14336
    ds_write_b128 v2, v[44:47] offset:15360
    s_mov_b32 m0, 126976
    s_add_u32 s29, s51, 115456
    buffer_load_dwordx4 v108, s[64:67], s29 offen  lds
    s_mov_b32 m0, 128000
    s_add_u32 s29, s51, 119552
    buffer_load_dwordx4 v108, s[64:67], s29 offen  lds
    s_mov_b32 m0, 129024
    s_add_u32 s29, s51, 123648
    buffer_load_dwordx4 v109, s[64:67], s29 offen  lds
    s_mov_b32 m0, 130048
    s_add_u32 s29, s51, 127744
    buffer_load_dwordx4 v109, s[64:67], s29 offen  lds
    s_waitcnt vmcnt(10)
    s_waitcnt lgkmcnt(0)
    s_barrier
    ds_read_b64_tr_b16 v[32:33], v120 offset:20480
    ds_read_b64_tr_b16 v[34:35], v120 offset:20992
    ds_read_b64_tr_b16 v[36:37], v122 offset:20480
    ds_read_b64_tr_b16 v[38:39], v122 offset:20992
    ds_read_b64_tr_b16 v[40:41], v121 offset:20480
    ds_read_b64_tr_b16 v[42:43], v121 offset:20992
    ds_read_b64_tr_b16 v[44:45], v123 offset:20480
    ds_read_b64_tr_b16 v[46:47], v123 offset:20992
    ds_write_b128 v2, v[16:19] offset:16384
    ds_write_b128 v2, v[20:23] offset:17408
    ds_write_b128 v2, v[24:27] offset:18432
    ds_write_b128 v2, v[28:31] offset:19456
    s_mov_b32 s27, 0
    s_waitcnt vmcnt(8)
Tmeet_3:
    v_sad_u8 v112, v116, 0, 0
    v_sad_u8 v112, v117, 0, v112
    v_cmp_eq_u32 vcc, 1, v113
    v_readfirstlane_b32 s40, v112
    v_readfirstlane_b32 s36, v116
    v_readfirstlane_b32 s37, v117
    s_nop 3
    s_xor_b32 s40, s40, 32
    s_andn2_b32 s39, 3, vcc_lo
    s_or_b32 s40, s40, s39
    s_cbranch_scc0 Tmet_3
    v_mov_b32 v118, 0
    v_lshlrev_b32 v119, 12, v100
    s_lshl_b32 s38, s16, 7
    s_add_u32 s38, s38, 58720260
    s_mov_b64 exec, 1
    global_load_dwordx2 v[116:117], v118, s[6:7] sc1
    s_mov_b64 exec, 3
    buffer_load_dword v113, v119, s[8:11], s38 offen sc1
    s_mov_b64 exec, -1
    s_waitcnt vmcnt(0)
    s_add_u32 s27, s27, 1
    s_cmp_lt_u32 s27, 400000
    s_cbranch_scc1 Tmeet_3
Tmet_3:
    s_getreg_b32 s38, hwreg(HW_REG_XCC_ID, 0, 3)
    s_lshl_b32 s38, s38, 3
    s_lshl_b64 s[38:39], 32, s38
    s_cmp_eq_u64 s[36:37], s[38:39]
    s_cselect_b32 s41, 1, 0
    s_add_u32 s33, s18, 8192
    buffer_load_dwordx4 v[128:131], v9, s[8:11], s18 offen sc1
    buffer_load_dwordx4 v[132:135], v9, s[8:11], s33 offen sc1
    buffer_load_dwordx4 v[136:139], v3, s[8:11], s18 offen offset:2048 sc1
    buffer_load_dwordx4 v[140:143], v3, s[8:11], s18 offen offset:2176 sc1
    v_and_b32 v112, 15, v100
    v_lshlrev_b32 v112, 7, v112
    v_lshrrev_b32 v113, 4, v100
    v_lshl_add_u32 v114, v113, 13, v112
    s_mov_b32 s38, 53090304
    buffer_load_dword v114, v114, s[8:11], s38 offen sc1
    v_and_b32 v113, 1, v113
    v_lshl_add_u32 v115, v113, 18, v112
    s_add_u32 s38, s22, 131072
    buffer_load_dword v115, v115, s[8:11], s38 offen sc1
    s_waitcnt vmcnt(10)
    s_waitcnt lgkmcnt(0)
    s_barrier
    ds_read_b64_tr_b16 v[16:17], v124 offset:24576
    ds_read_b64_tr_b16 v[18:19], v124 offset:25088
    ds_read_b64_tr_b16 v[20:21], v124 offset:57344
    ds_read_b64_tr_b16 v[22:23], v124 offset:57856
    ds_read_b64_tr_b16 v[24:25], v125 offset:24576
    ds_read_b64_tr_b16 v[26:27], v125 offset:25088
    ds_read_b64_tr_b16 v[28:29], v125 offset:57344
    ds_read_b64_tr_b16 v[30:31], v125 offset:57856
    ds_write_b128 v2, v[32:35] offset:20480
    ds_write_b128 v2, v[36:39] offset:21504
    ds_write_b128 v2, v[40:43] offset:22528
    ds_write_b128 v2, v[44:47] offset:23552
    s_waitcnt vmcnt(6)
    s_waitcnt lgkmcnt(0)
    s_barrier
    ds_read_b64_tr_b16 v[32:33], v124 offset:28672
    ds_read_b64_tr_b16 v[34:35], v124 offset:29184
    ds_read_b64_tr_b16 v[36:37], v124 offset:61440
    ds_read_b64_tr_b16 v[38:39], v124 offset:61952
    ds_read_b64_tr_b16 v[40:41], v125 offset:28672
    ds_read_b64_tr_b16 v[42:43], v125 offset:29184
    ds_read_b64_tr_b16 v[44:45], v125 offset:61440
    ds_read_b64_tr_b16 v[46:47], v125 offset:61952
    ds_write_b128 v2, v[16:19] offset:24576
    ds_write_b128 v2, v[20:23] offset:25600
    ds_write_b128 v2, v[24:27] offset:26624
    ds_write_b128 v2, v[28:31] offset:27648
    s_waitcnt lgkmcnt(0)
    s_barrier
    ds_write_b128 v2, v[32:35] offset:28672
    ds_write_b128 v2, v[36:39] offset:29696
    ds_write_b128 v2, v[40:43] offset:30720
    ds_write_b128 v2, v[44:47] offset:31744
    s_waitcnt lgkmcnt(0)
    s_waitcnt vmcnt(0)
    s_cmp_eq_u32 s41, 0
    s_cbranch_scc1 Tslow_3
Tfast_3:
    s_mov_b32 s27, 0
    s_mov_b32 s46, 0
    v_mov_b32 v13, -1
    v_mov_b64 v[122:123], s[42:43]
    v_mov_b64 v[124:125], s[42:43]
    v_mov_b64 v[120:121], s[44:45]
    s_mov_b32 s26, 52959232
    s_add_u32 s21, s20, 4096
    s_lshl_b32 s54, s16, 7
    s_add_u32 s54, s54, 58720260
    s_add_u32 s51, s54, 4096
    s_add_u32 s18, s18, 524288
    s_add_u32 s33, s18, 8192
    s_add_u32 s51, s51, 4096
    v_mov_b64 v[72:73], v[128:129]
    ds_read_b128 v[32:35], v2 offset:0
    v_mov_b64 v[74:75], v[130:131]
    ds_read_b128 v[36:39], v2 offset:1024
    v_mov_b64 v[76:77], v[132:133]
    ds_read_b128 v[88:91], v2 offset:6144
    v_mov_b64 v[78:79], v[134:135]
    ds_read_b128 v[92:95], v2 offset:7168
    v_mov_b64 v[80:81], v[136:137]
    ds_read_b128 v[96:99], v2 offset:8192
    v_mov_b64 v[82:83], v[138:139]
    ds_read_b128 v[100:103], v2 offset:9216
    v_mov_b64 v[84:85], v[140:141]
    ds_read_b128 v[104:107], v2 offset:10240
    v_mov_b64 v[86:87], v[142:143]
    ds_read_b128 v[108:111], v2 offset:11264
    v_mov_b64 v[48:49], 0
    ds_read_b128 v[112:115], v1 offset:28672
    v_mov_b64 v[50:51], 0
    ds_read_b128 v[116:119], v1 offset:29696
    v_mov_b64 v[52:53], 0
    ds_read_b128 v[64:67], v1 offset:30720
    s_branch Tstep_3
.p2align 6
Tstep_3:
    buffer_load_dwordx4 v[40:43], v1, s[8:11], s26 offen offset:0 sc1
    buffer_load_dwordx4 v[44:47], v1, s[8:11], s26 offen offset:1024 sc1
    v_mov_b64 v[54:55], 0
    ds_read_b128 v[68:71], v1 offset:31744
    v_mov_b64 v[56:57], 0
    ds_read_b128 v[128:131], v2 offset:2048
    v_mov_b64 v[58:59], 0
    ds_read_b128 v[132:135], v2 offset:3072
    v_mov_b64 v[60:61], 0
    ds_read_b128 v[136:139], v2 offset:4096
    v_mov_b64 v[62:63], 0
    ds_read_b128 v[140:143], v2 offset:5120
    s_nop 14
    buffer_load_dwordx4 v[40:43], v1, s[8:11], s26 offen offset:0 sc1
    buffer_load_dwordx4 v[44:47], v1, s[8:11], s26 offen offset:1024 sc1
    s_waitcnt vmcnt(3)
    v_max3_u32 v11, v40, v41, v42
    v_max_u32 v11, v11, v43
    ds_write_b128 v1, v[40:43] offset:6144
    s_waitcnt vmcnt(2)
    v_max3_u32 v11, v11, v44, v45
    v_max3_u32 v11, v11, v46, v47
    v_cmp_eq_u32 vcc, -1, v11
    ds_write_b128 v1, v[44:47] offset:7168
    s_cbranch_vccnz Tr2_3
Tok2_3:
    s_barrier
    ds_read_b128 v[16:19], v1 offset:0
    ds_read_b128 v[20:23], v1 offset:1024
    buffer_store_dword v14, v8, s[8:11], s19 offen sc1
    s_waitcnt lgkmcnt(2)
    s_barrier
    ds_read_b128 v[24:27], v1 offset:2048
    ds_read_b128 v[28:31], v1 offset:3072
    s_waitcnt lgkmcnt(3)
    v_smfmac_f32_16x16x64_bf16 v[48:51], v[16:19], v[32:39], v0
    ds_read_b128 v[32:35], v1 offset:4096
    v_smfmac_f32_16x16x64_bf16 v[52:55], v[16:19], v[128:135], v0
    ds_read_b128 v[36:39], v1 offset:5120
    s_waitcnt lgkmcnt(4)
    v_smfmac_f32_16x16x64_bf16 v[48:51], v[20:23], v[136:143], v0
    s_waitcnt vmcnt(1)
    ds_read_b128 v[40:43], v1 offset:6144
    v_smfmac_f32_16x16x64_bf16 v[52:55], v[20:23], v[88:95], v0
    ds_read_b128 v[44:47], v1 offset:7168
    s_waitcnt lgkmcnt(5)
    v_smfmac_f32_16x16x64_bf16 v[48:51], v[24:27], v[96:103], v0
    buffer_load_dwordx4 v[128:131], v9, s[8:11], s18 offen sc1
    s_waitcnt lgkmcnt(3)
    v_smfmac_f32_16x16x64_bf16 v[48:51], v[28:31], v[112:119], v0
    ds_read_b128 v[88:91], v2 offset:12288
    s_waitcnt lgkmcnt(3)
    v_smfmac_f32_16x16x64_bf16 v[48:51], v[32:35], a[96:103], v0
    buffer_load_dwordx4 v[132:135], v9, s[8:11], s33 offen sc1
    v_smfmac_f32_16x16x64_bf16 v[48:51], v[36:39], a[112:119], v0
    ds_read_b128 v[92:95], v2 offset:13312
    s_waitcnt lgkmcnt(2)
    v_smfmac_f32_16x16x64_bf16 v[48:51], v[40:43], a[128:135], v0
    buffer_load_dwordx4 v[136:139], v3, s[8:11], s18 offen offset:2048 sc1
    v_smfmac_f32_16x16x64_bf16 v[48:51], v[44:47], a[144:151], v0
    s_nop 1
    s_waitcnt lgkmcnt(1)
    v_smfmac_f32_16x16x64_bf16 v[52:55], v[24:27], v[104:111], v0
    buffer_load_dwordx4 v[140:143], v3, s[8:11], s18 offen offset:2176 sc1
    v_smfmac_f32_16x16x64_bf16 v[52:55], v[28:31], v[64:71], v0
    s_waitcnt lgkmcnt(0)
    s_nop 0
    v_add_f32 v48, v48, v50
    v_smfmac_f32_16x16x64_bf16 v[52:55], v[32:35], a[104:111], v0
    ds_read_b128 v[96:99], v2 offset:16384
    v_add_f32 v49, v49, v51
    v_smfmac_f32_16x16x64_bf16 v[52:55], v[36:39], a[120:127], v0
    ds_read_b128 v[100:103], v2 offset:17408
    v_mul_f32 v48, s32, v48
    v_smfmac_f32_16x16x64_bf16 v[52:55], v[40:43], a[136:143], v0
    ds_read_b128 v[104:107], v2 offset:20480
    v_mul_f32 v49, s32, v49
    v_smfmac_f32_16x16x64_bf16 v[52:55], v[44:47], a[152:159], v0
    s_nop 1
    v_cvt_pk_bf16_f32 v48, v48, v49
    v_smfmac_f32_16x16x64_bf16 v[56:59], v[28:31], v[144:151], v0
    ds_write_b32 v4, v48 offset:0
    v_smfmac_f32_16x16x64_bf16 v[56:59], v[32:35], v[160:167], v0
    s_waitcnt lgkmcnt(2)
    s_nop 0
    v_add_f32 v52, v52, v54
    v_smfmac_f32_16x16x64_bf16 v[56:59], v[16:19], v[88:95], v0
    ds_read_b128 v[108:111], v2 offset:21504
    v_add_f32 v53, v53, v55
    v_mul_f32 v52, s32, v52
    v_smfmac_f32_16x16x64_bf16 v[56:59], v[20:23], v[96:103], v0
    ds_read_b128 v[112:115], v2 offset:14336
    v_mul_f32 v53, s32, v53
    v_smfmac_f32_16x16x64_bf16 v[56:59], v[36:39], v[176:183], v0
    ds_read_b128 v[116:119], v2 offset:15360
    v_cvt_pk_bf16_f32 v52, v52, v53
    v_smfmac_f32_16x16x64_bf16 v[56:59], v[40:43], v[192:199], v0
    ds_write_b32 v4, v52 offset:256
    v_smfmac_f32_16x16x64_bf16 v[56:59], v[44:47], v[208:215], v0
    ds_read_b128 v[88:91], v2 offset:18432
    s_waitcnt lgkmcnt(4)
    v_smfmac_f32_16x16x64_bf16 v[56:59], v[24:27], v[104:111], v0
    ds_read_b128 v[92:95], v2 offset:19456
    s_waitcnt lgkmcnt(4)
    v_smfmac_f32_16x16x64_bf16 v[60:63], v[28:31], v[152:159], v0
    ds_read_b128 v[96:99], v2 offset:22528
    ds_read_b128 v[100:103], v2 offset:23552
    v_smfmac_f32_16x16x64_bf16 v[60:63], v[32:35], v[168:175], v0
    s_waitcnt lgkmcnt(4)
    s_barrier
    v_smfmac_f32_16x16x64_bf16 v[60:63], v[36:39], v[184:191], v0
    ds_read_b64_tr_b16 v[104:105], v5 offset:0
    v_add_f32 v56, v56, v58
    v_smfmac_f32_16x16x64_bf16 v[60:63], v[40:43], v[200:207], v0
    ds_read_b64_tr_b16 v[106:107], v5 offset:256
    v_add_f32 v57, v57, v59
    v_smfmac_f32_16x16x64_bf16 v[60:63], v[44:47], v[216:223], v0
    ds_read_b64_tr_b16 v[108:109], v5 offset:2048
    v_cvt_pk_bf16_f32 v56, v56, v57
    v_smfmac_f32_16x16x64_bf16 v[60:63], v[16:19], v[112:119], v0
    ds_read_b64_tr_b16 v[110:111], v5 offset:2304
    s_waitcnt lgkmcnt(4)
    v_mov_b64 v[64:65], 0
    v_smfmac_f32_16x16x64_bf16 v[60:63], v[20:23], v[88:95], v0
    ds_write_b32 v4, v56 offset:512
    v_smfmac_f32_16x16x64_bf16 v[60:63], v[24:27], v[96:103], v0
    s_waitcnt lgkmcnt(3)
    v_mov_b64 v[66:67], 0
    v_mfma_f32_16x16x32_bf16 v[48:51], v[72:75], v[104:107], 0
    s_waitcnt lgkmcnt(1)
    v_mov_b64 v[68:69], 0
    v_mov_b64 v[70:71], 0
    v_mfma_f32_16x16x32_bf16 v[48:51], v[76:79], v[108:111], v[48:51]
    s_nop 0
    v_add_f32 v60, v60, v62
    v_add_f32 v61, v61, v63
    v_cvt_pk_bf16_f32 v60, v60, v61
    v_smfmac_f32_16x16x64_bf16 v[64:67], v[28:31], a[16:23], v0
    ds_write_b32 v4, v60 offset:768
    v_smfmac_f32_16x16x64_bf16 v[64:67], v[24:27], a[0:7], v0
    s_waitcnt lgkmcnt(1)
    v_add_f32_dpp v48, v50, v48 quad_perm:[2,3,0,1] row_mask:0xf bank_mask:0xf
    v_smfmac_f32_16x16x64_bf16 v[64:67], v[20:23], v[240:247], v0
    v_add_f32_dpp v49, v51, v49 quad_perm:[2,3,0,1] row_mask:0xf bank_mask:0xf
    v_smfmac_f32_16x16x64_bf16 v[64:67], v[16:19], v[224:231], v0
    v_exp_f32 v50, v48
    v_smfmac_f32_16x16x64_bf16 v[64:67], v[32:35], a[32:39], v0
    s_waitcnt lgkmcnt(0)
    s_barrier
    v_smfmac_f32_16x16x64_bf16 v[64:67], v[36:39], a[48:55], v0
    ds_read_b64_tr_b16 v[112:113], v5 offset:512
    v_exp_f32 v51, v49
    v_smfmac_f32_16x16x64_bf16 v[64:67], v[40:43], a[64:71], v0
    ds_read_b64_tr_b16 v[114:115], v5 offset:768
    v_cvt_pk_bf16_f32 v50, v50, v51
    v_smfmac_f32_16x16x64_bf16 v[64:67], v[44:47], a[80:87], v0
    ds_read_b64_tr_b16 v[116:117], v5 offset:2560
    v_smfmac_f32_16x16x64_bf16 v[68:71], v[28:31], a[24:31], v0
    ds_read_b64_tr_b16 v[118:119], v5 offset:2816
    v_smfmac_f32_16x16x64_bf16 v[68:71], v[24:27], a[8:15], v0
    ds_write_b32 v12, v50
    s_waitcnt lgkmcnt(3)
    v_mfma_f32_16x16x32_bf16 v[52:55], v[112:115], v[104:107], 0
    s_nop 0
    v_cvt_pk_bf16_f32 v60, v64, v65
    v_cvt_pk_bf16_f32 v61, v66, v67
    v_smfmac_f32_16x16x64_bf16 v[68:71], v[20:23], v[248:255], v0
    s_waitcnt lgkmcnt(1)
    v_mov_b64 v[30:31], 0
    v_mfma_f32_16x16x32_bf16 v[52:55], v[116:119], v[108:111], v[52:55]
    s_nop 0
    v_mov_b64 v[26:27], 0
    v_mov_b64 v[24:25], 0
    v_smfmac_f32_16x16x64_bf16 v[68:71], v[16:19], v[232:239], v0
    s_waitcnt lgkmcnt(0)
    s_barrier
    v_smfmac_f32_16x16x64_bf16 v[68:71], v[32:35], a[40:47], v0
    ds_read_b128 v[56:59], v6 offset:12288
    v_add_f32_dpp v52, v54, v52 quad_perm:[2,3,0,1] row_mask:0xf bank_mask:0xf
    v_smfmac_f32_16x16x64_bf16 v[68:71], v[36:39], a[56:63], v0
    ds_read_b128 v[104:107], v2 offset:30720
    v_add_f32_dpp v53, v55, v53 quad_perm:[2,3,0,1] row_mask:0xf bank_mask:0xf
    v_smfmac_f32_16x16x64_bf16 v[68:71], v[40:43], a[72:79], v0
    ds_read_b128 v[108:111], v2 offset:31744
    v_exp_f32_dpp v54, v52 quad_perm:[0,1,0,1] row_mask:0xf bank_mask:0xf
    v_smfmac_f32_16x16x64_bf16 v[68:71], v[44:47], a[88:95], v0
    s_nop 0
    s_waitcnt lgkmcnt(2)
    v_exp_f32_dpp v55, v53 quad_perm:[0,1,0,1] row_mask:0xf bank_mask:0xf
Tsm_3:
    v_mfma_f32_16x16x32_bf16 v[88:91], v[122:125], v[56:59], 0
    v_cvt_pk_bf16_f32 v28, v54, v55
    v_cvt_pk_bf16_f32 v29, v54, v55
    v_mfma_f32_16x16x32_bf16 v[96:99], v[80:83], v[56:59], 0
    s_nop 0
    v_cvt_pk_bf16_f32 v62, v68, v69
    v_cvt_pk_bf16_f32 v63, v70, v71
    v_mfma_f32_16x16x32_bf16 v[88:91], v[120:123], v[28:31], v[88:91]
    s_nop 0
    v_mov_b64 v[16:17], 0
    v_mov_b64 v[18:19], 0
    v_mfma_f32_16x16x32_bf16 v[96:99], v[60:63], v[28:31], v[96:99]
    s_nop 0
    v_mov_b64 v[20:21], 0
    v_mov_b64 v[22:23], 0
    v_mfma_f32_16x16x32_bf16 v[100:103], v[84:87], v[56:59], 0
    s_nop 0
    v_rcp_f32 v14, v88
    v_mfma_f32_16x16x32_bf16 v[100:103], v[60:63], v[26:29], v[100:103]
    s_nop 0
    v_mul_f32 v96, v96, v14
    v_mul_f32 v97, v97, v14
    v_mul_f32 v98, v98, v14
    v_mul_f32 v99, v99, v14
    v_subrev_u32 v11, s34, v88
    v_cmp_le_u32 vcc, s35, v11
    s_not_b64 exec, s[48:49]
    v_pk_mul_f32 v[96:97], v[100:101], v[14:15] op_sel_hi:[1,0]
    v_pk_mul_f32 v[98:99], v[102:103], v[14:15] op_sel_hi:[1,0]
    s_mov_b64 exec, -1
    v_cvt_pk_bf16_f32 v96, v96, v97
    v_cvt_pk_bf16_f32 v97, v98, v99
    ds_write_b64 v126, v[96:97]
    v_mov_b32_dpp v32, v96 quad_perm:[0,1,0,1] row_mask:0xf bank_mask:0xf
    v_mov_b32_dpp v33, v97 quad_perm:[0,1,0,1] row_mask:0xf bank_mask:0xf
    v_mov_b32_dpp v34, v96 quad_perm:[2,3,2,3] row_mask:0xf bank_mask:0xf
    v_mov_b32_dpp v35, v97 quad_perm:[2,3,2,3] row_mask:0xf bank_mask:0xf
    v_mov_b64 v[28:29], 0
    s_cbranch_vccnz Tmx_3
Tmxd_3:
    v_smfmac_f32_16x16x64_bf16 v[16:19], v[32:35], a[184:191], v0
    s_waitcnt lgkmcnt(0)
    s_barrier
    ds_read_b128 v[36:39], v127 offset:0
    v_smfmac_f32_16x16x64_bf16 v[20:23], v[32:35], a[216:223], v0
    ds_read_b128 v[40:43], v127 offset:512
    v_smfmac_f32_16x16x64_bf16 v[24:27], v[32:35], a[248:255], v0
    ds_read_b128 v[44:47], v127 offset:1024
    v_smfmac_f32_16x16x64_bf16 v[28:31], v[32:35], v[104:111], v0
    ds_read_b128 v[112:115], v2 offset:24576
    s_waitcnt lgkmcnt(3)
    v_smfmac_f32_16x16x64_bf16 v[16:19], v[36:39], a[160:167], v0
    ds_read_b128 v[116:119], v2 offset:25600
    s_waitcnt lgkmcnt(3)
    v_smfmac_f32_16x16x64_bf16 v[16:19], v[40:43], a[168:175], v0
    ds_read_b128 v[48:51], v2 offset:26624
    s_waitcnt lgkmcnt(3)
    v_smfmac_f32_16x16x64_bf16 v[16:19], v[44:47], a[176:183], v0
    s_nop 0
    ds_read_b128 v[56:59], v2 offset:28672
    v_smfmac_f32_16x16x64_bf16 v[20:23], v[36:39], a[192:199], v0
    s_nop 0
    ds_read_b128 v[52:55], v2 offset:27648
    v_smfmac_f32_16x16x64_bf16 v[20:23], v[40:43], a[200:207], v0
    s_nop 1
    v_cvt_pk_bf16_f32 v16, v16, v17
    v_cvt_pk_bf16_f32 v17, v18, v19
    v_and_or_b32 v16, v16, -2, s46
    v_smfmac_f32_16x16x64_bf16 v[20:23], v[44:47], a[208:215], v0
    buffer_store_dwordx2 v[16:17], v7, s[8:11], s20 offen offset:0
    v_smfmac_f32_16x16x64_bf16 v[24:27], v[36:39], a[224:231], v0
    s_nop 0
    ds_read_b128 v[60:63], v2 offset:29696
    v_smfmac_f32_16x16x64_bf16 v[24:27], v[40:43], a[232:239], v0
    s_nop 1
    s_nop 0
    v_cvt_pk_bf16_f32 v20, v20, v21
    v_cvt_pk_bf16_f32 v21, v22, v23
    v_and_or_b32 v20, v20, -2, s46
    v_smfmac_f32_16x16x64_bf16 v[24:27], v[44:47], a[240:247], v0
    buffer_store_dwordx2 v[20:21], v7, s[8:11], s20 offen offset:2048
    s_waitcnt lgkmcnt(4)
    v_smfmac_f32_16x16x64_bf16 v[28:31], v[36:39], v[112:119], v0
    s_nop 0
    s_waitcnt lgkmcnt(1)
    v_smfmac_f32_16x16x64_bf16 v[28:31], v[40:43], v[48:55], v0
    s_nop 1
    v_cvt_pk_bf16_f32 v24, v24, v25
    v_cvt_pk_bf16_f32 v25, v26, v27
    s_waitcnt lgkmcnt(0)
    v_and_or_b32 v24, v24, -2, s46
    v_smfmac_f32_16x16x64_bf16 v[28:31], v[44:47], v[56:63], v0
    buffer_store_dwordx2 v[24:25], v7, s[8:11], s21 offen offset:0
    s_nop 6
    v_cvt_pk_bf16_f32 v28, v28, v29
    v_cvt_pk_bf16_f32 v29, v30, v31
    v_and_or_b32 v28, v28, -2, s46
    buffer_store_dwordx2 v[28:29], v7, s[8:11], s21 offen offset:2048
    s_barrier
    ds_read_b128 v[16:19], v1 offset:13312
    s_waitcnt vmcnt(7)
    v_mov_b64 v[72:73], v[128:129]
    ds_read_b128 v[32:35], v2 offset:0
    s_add_u32 s17, s17, 1
    v_mov_b64 v[74:75], v[130:131]
    ds_read_b128 v[36:39], v2 offset:1024
    s_and_b32 s29, s17, 3
    s_waitcnt vmcnt(6)
    v_mov_b64 v[76:77], v[132:133]
    ds_read_b128 v[88:91], v2 offset:6144
    s_lshl_b32 s29, s29, 13
    v_mov_b64 v[78:79], v[134:135]
    ds_read_b128 v[92:95], v2 offset:7168
    s_add_u32 s30, s24, s29
    s_waitcnt vmcnt(5)
    v_mov_b64 v[80:81], v[136:137]
    ds_read_b128 v[96:99], v2 offset:8192
    s_add_u32 s26, s29, 52959232
    v_mov_b64 v[82:83], v[138:139]
    ds_read_b128 v[100:103], v2 offset:9216
    s_xor_b32 s25, s30, 16384
    s_waitcnt vmcnt(4)
    v_mov_b64 v[84:85], v[140:141]
    ds_read_b128 v[104:107], v2 offset:10240
    s_xor_b32 s20, s20, 262144
    v_mov_b64 v[86:87], v[142:143]
    ds_read_b128 v[108:111], v2 offset:11264
    s_add_u32 s21, s20, 4096
    s_nop 15
    s_nop 15
    s_nop 0
    buffer_load_dwordx4 v[40:43], v1, s[8:11], s22 offen offset:0 sc1
    buffer_load_dwordx4 v[44:47], v1, s[8:11], s22 offen offset:1024 sc1
    s_waitcnt lgkmcnt(8)
    s_waitcnt vmcnt(1)
    v_mfma_f32_16x16x32_bf16 v[20:23], v[16:19], v[40:43], 0
    v_bitop3_b32 v11, v40, v42, s46 bitop3:0x7e
    s_waitcnt vmcnt(0)
    v_mfma_f32_16x16x32_bf16 v[20:23], v[16:19], v[44:47], v[20:23]
    v_bitop3_b32 v15, v44, v46, s46 bitop3:0x7e
    v_bitop3_b32 v11, v11, v15, 1 bitop3:0xa8
    v_cmp_ne_u32 vcc, 0, v11
    s_nop 4
    v_add_f32_dpp v20, v20, v20 row_ror:4 row_mask:0xf bank_mask:0xf
    v_add_f32_dpp v21, v21, v21 row_ror:4 row_mask:0xf bank_mask:0xf
    s_cbranch_vccnz Tr1_3
Tok1_3:
    v_add_f32_dpp v20, v20, v20 row_ror:8 row_mask:0xf bank_mask:0xf
    v_add_f32_dpp v21, v21, v21 row_ror:8 row_mask:0xf bank_mask:0xf
    v_cvt_pk_bf16_f32 v14, v20, v21
    buffer_store_dword v14, v8, s[8:11], s30 offen
    buffer_store_dword v13, v8, s[8:11], s25 offen
    s_xor_b32 s22, s22, 262144
    s_bfe_u32 s46, s17, 0x10001
    v_mov_b64 v[48:49], 0
    ds_read_b128 v[112:115], v1 offset:28672
    s_add_u32 s19, s19, 8192
    v_mov_b64 v[50:51], 0
    ds_read_b128 v[116:119], v1 offset:29696
    s_cmp_ge_u32 s17, 62
    s_cselect_b32 s35, 0, s35
    s_cselect_b32 s18, 0x40000000, s18
    v_mov_b64 v[52:53], 0
    ds_read_b128 v[64:67], v1 offset:30720
    s_add_u32 s18, s18, 524288
    s_add_u32 s33, s18, 8192
    s_add_u32 s51, s51, 4096
    s_nop 6
    s_branch Tstep_3
Tr2_3:
    buffer_load_dwordx4 v[40:43], v1, s[8:11], s26 offen offset:0 sc1
    buffer_load_dwordx4 v[44:47], v1, s[8:11], s26 offen offset:1024 sc1
    s_waitcnt vmcnt(3)
    v_max3_u32 v11, v40, v41, v42
    v_max_u32 v11, v11, v43
    ds_write_b128 v1, v[40:43] offset:6144
    s_waitcnt vmcnt(2)
    v_max3_u32 v11, v11, v44, v45
    v_max3_u32 v11, v11, v46, v47
    v_cmp_eq_u32 vcc, -1, v11
    ds_write_b128 v1, v[44:47] offset:7168
    s_cbranch_vccz Tok2_3
    buffer_load_dwordx4 v[40:43], v1, s[8:11], s26 offen offset:0 sc1
    buffer_load_dwordx4 v[44:47], v1, s[8:11], s26 offen offset:1024 sc1
    s_waitcnt vmcnt(3)
    v_max3_u32 v11, v40, v41, v42
    v_max_u32 v11, v11, v43
    ds_write_b128 v1, v[40:43] offset:6144
    s_waitcnt vmcnt(2)
    v_max3_u32 v11, v11, v44, v45
    v_max3_u32 v11, v11, v46, v47
    v_cmp_eq_u32 vcc, -1, v11
    ds_write_b128 v1, v[44:47] offset:7168
    s_cbranch_vccz Tok2_3
    s_add_u32 s27, s27, 1
    s_cmp_lt_u32 s27, 400000
    s_cbranch_scc1 Tr2_3
    s_mov_b32 s28, 1
    s_branch Tok2_3
Tr1_3:
    buffer_load_dwordx4 v[40:43], v1, s[8:11], s22 offen offset:0 sc1
    buffer_load_dwordx4 v[44:47], v1, s[8:11], s22 offen offset:1024 sc1
    s_waitcnt vmcnt(1)
    v_mfma_f32_16x16x32_bf16 v[20:23], v[16:19], v[40:43], 0
    v_bitop3_b32 v11, v40, v42, s46 bitop3:0x7e
    s_waitcnt vmcnt(0)
    v_mfma_f32_16x16x32_bf16 v[20:23], v[16:19], v[44:47], v[20:23]
    v_bitop3_b32 v15, v44, v46, s46 bitop3:0x7e
    v_bitop3_b32 v11, v11, v15, 1 bitop3:0xa8
    v_cmp_ne_u32 vcc, 0, v11
    s_nop 4
    v_add_f32_dpp v20, v20, v20 row_ror:4 row_mask:0xf bank_mask:0xf
    v_add_f32_dpp v21, v21, v21 row_ror:4 row_mask:0xf bank_mask:0xf
    s_cbranch_vccz Tok1_3
    s_add_u32 s27, s27, 1
    s_cmp_lt_u32 s27, 400000
    s_cbranch_scc1 Tr1_3
    s_mov_b32 s28, 1
    s_waitcnt vmcnt(0)
    s_branch Tok1_3
Tmx_3:
    s_nop 7
    s_waitcnt lgkmcnt(0)
    s_cmp_lg_u32 s35, 0
    s_cbranch_scc1 Tmx2_3
    ds_read_b64_tr_b16 v[40:41], v5 offset:2816
    v_pk_add_f32 v[44:45], v[64:65], v[66:67]
    v_pk_add_f32 v[46:47], v[68:69], v[70:71]
    v_cvt_pk_bf16_f32 v42, v44, v45
    v_cvt_pk_bf16_f32 v43, v46, v47
    s_and_b32 s29, s17, 1
    s_lshl_b32 s29, s29, 5
    s_add_u32 s29, s29, s16
    s_lshl_b32 s29, s29, 12
    s_add_u32 s29, s29, 61737984
    s_waitcnt lgkmcnt(0)
    buffer_store_dwordx4 v[40:43], v1, s[8:11], s29 offen sc1
    s_cmp_eq_u32 s17, 63
    s_cbranch_scc1 Tend_3
    s_mov_b32 s35, 0x3c000000
    v_cmp_le_u32 vcc, s35, v11
    s_nop 4
    s_and_b64 vcc, vcc, s[48:49]
    s_cbranch_scc0 Tmxd_3
Tmx2_3:
    v_max3_f32 v14, v48, v49, v52
    v_max_f32 v14, v14, v53
    v_mov_b32 v15, v14
    s_nop 1
    v_permlane16_swap_b32 v14, v15
    v_max_f32 v14, v14, v15
    v_mov_b32 v15, v14
    s_nop 1
    v_permlane32_swap_b32 v14, v15
    v_max_f32 v14, v14, v15
    ds_write_b32 v1, v14 offset:14348
    s_waitcnt lgkmcnt(0)
    s_barrier
    ds_read_b128 v[88:91], v1 offset:14336
    s_waitcnt lgkmcnt(0)
    v_max3_f32 v14, v88, v89, v90
    v_max_f32 v14, v14, v91
    v_cmp_neq_f32 vcc, 0, v14
    v_mov_b32 v11, 0x1f8
    v_cmp_class_f32 s[36:37], v14, v11
    s_nop 4
    s_and_b64 vcc, vcc, s[36:37]
    s_and_b64 vcc, vcc, s[48:49]
    s_cbranch_scc0 Tmxd_3
    v_cndmask_b32 v14, 0, v14, vcc
    v_sub_f32 v48, v48, v14
    v_sub_f32 v49, v49, v14
    v_sub_f32 v52, v52, v14
    v_sub_f32 v53, v53, v14
    v_exp_f32 v50, v48
    v_exp_f32 v51, v49
    s_nop 0
    v_cvt_pk_bf16_f32 v50, v50, v51
    ds_write_b32 v12, v50
    v_exp_f32_dpp v54, v52 quad_perm:[0,1,0,1] row_mask:0xf bank_mask:0xf
    v_exp_f32_dpp v55, v53 quad_perm:[0,1,0,1] row_mask:0xf bank_mask:0xf
    s_waitcnt lgkmcnt(0)
    s_barrier
    ds_read_b128 v[56:59], v6 offset:12288
    s_waitcnt lgkmcnt(0)
    s_branch Tsm_3
Tend_3:
    s_endpgm
Tslow_3:
    s_mov_b32 s27, 0
    s_mov_b32 s46, 0
    v_mov_b32 v13, -1
    v_mov_b64 v[122:123], s[42:43]
    v_mov_b64 v[124:125], s[42:43]
    v_mov_b64 v[120:121], s[44:45]
    s_mov_b32 s26, 52959232
    s_add_u32 s21, s20, 4096
    s_lshl_b32 s54, s16, 7
    s_add_u32 s54, s54, 58720260
    s_add_u32 s51, s54, 4096
    s_add_u32 s18, s18, 524288
    s_add_u32 s33, s18, 8192
    s_add_u32 s51, s51, 4096
    v_mov_b64 v[72:73], v[128:129]
    ds_read_b128 v[32:35], v2 offset:0
    v_mov_b64 v[74:75], v[130:131]
    ds_read_b128 v[36:39], v2 offset:1024
    v_mov_b64 v[76:77], v[132:133]
    ds_read_b128 v[88:91], v2 offset:6144
    v_mov_b64 v[78:79], v[134:135]
    ds_read_b128 v[92:95], v2 offset:7168
    v_mov_b64 v[80:81], v[136:137]
    ds_read_b128 v[96:99], v2 offset:8192
    v_mov_b64 v[82:83], v[138:139]
    ds_read_b128 v[100:103], v2 offset:9216
    v_mov_b64 v[84:85], v[140:141]
    ds_read_b128 v[104:107], v2 offset:10240
    v_mov_b64 v[86:87], v[142:143]
    ds_read_b128 v[108:111], v2 offset:11264
    v_mov_b64 v[48:49], 0
    ds_read_b128 v[112:115], v1 offset:28672
    v_mov_b64 v[50:51], 0
    ds_read_b128 v[116:119], v1 offset:29696
    v_mov_b64 v[52:53], 0
    ds_read_b128 v[64:67], v1 offset:30720
    s_branch Tstep_3sc1
.p2align 6
Tstep_3sc1:
    buffer_load_dwordx4 v[40:43], v1, s[8:11], s26 offen offset:0 sc1
    buffer_load_dwordx4 v[44:47], v1, s[8:11], s26 offen offset:1024 sc1
    v_mov_b64 v[54:55], 0
    ds_read_b128 v[68:71], v1 offset:31744
    v_mov_b64 v[56:57], 0
    ds_read_b128 v[128:131], v2 offset:2048
    v_mov_b64 v[58:59], 0
    ds_read_b128 v[132:135], v2 offset:3072
    v_mov_b64 v[60:61], 0
    ds_read_b128 v[136:139], v2 offset:4096
    v_mov_b64 v[62:63], 0
    ds_read_b128 v[140:143], v2 offset:5120
    s_nop 14
    buffer_load_dwordx4 v[40:43], v1, s[8:11], s26 offen offset:0 sc1
    buffer_load_dwordx4 v[44:47], v1, s[8:11], s26 offen offset:1024 sc1
    s_waitcnt vmcnt(3)
    v_max3_u32 v11, v40, v41, v42
    v_max_u32 v11, v11, v43
    ds_write_b128 v1, v[40:43] offset:6144
    s_waitcnt vmcnt(2)
    v_max3_u32 v11, v11, v44, v45
    v_max3_u32 v11, v11, v46, v47
    v_cmp_eq_u32 vcc, -1, v11
    ds_write_b128 v1, v[44:47] offset:7168
    s_cbranch_vccnz Tr2_3sc1
Tok2_3sc1:
    s_barrier
    ds_read_b128 v[16:19], v1 offset:0
    ds_read_b128 v[20:23], v1 offset:1024
    buffer_store_dword v14, v8, s[8:11], s19 offen sc1
    s_waitcnt lgkmcnt(2)
    s_barrier
    ds_read_b128 v[24:27], v1 offset:2048
    ds_read_b128 v[28:31], v1 offset:3072
    s_waitcnt lgkmcnt(3)
    v_smfmac_f32_16x16x64_bf16 v[48:51], v[16:19], v[32:39], v0
    ds_read_b128 v[32:35], v1 offset:4096
    v_smfmac_f32_16x16x64_bf16 v[52:55], v[16:19], v[128:135], v0
    ds_read_b128 v[36:39], v1 offset:5120
    s_waitcnt lgkmcnt(4)
    v_smfmac_f32_16x16x64_bf16 v[48:51], v[20:23], v[136:143], v0
    s_waitcnt vmcnt(1)
    ds_read_b128 v[40:43], v1 offset:6144
    v_smfmac_f32_16x16x64_bf16 v[52:55], v[20:23], v[88:95], v0
    ds_read_b128 v[44:47], v1 offset:7168
    s_waitcnt lgkmcnt(5)
    v_smfmac_f32_16x16x64_bf16 v[48:51], v[24:27], v[96:103], v0
    buffer_load_dwordx4 v[128:131], v9, s[8:11], s18 offen sc1
    s_waitcnt lgkmcnt(3)
    v_smfmac_f32_16x16x64_bf16 v[48:51], v[28:31], v[112:119], v0
    ds_read_b128 v[88:91], v2 offset:12288
    s_waitcnt lgkmcnt(3)
    v_smfmac_f32_16x16x64_bf16 v[48:51], v[32:35], a[96:103], v0
    buffer_load_dwordx4 v[132:135], v9, s[8:11], s33 offen sc1
    v_smfmac_f32_16x16x64_bf16 v[48:51], v[36:39], a[112:119], v0
    ds_read_b128 v[92:95], v2 offset:13312
    s_waitcnt lgkmcnt(2)
    v_smfmac_f32_16x16x64_bf16 v[48:51], v[40:43], a[128:135], v0
    buffer_load_dwordx4 v[136:139], v3, s[8:11], s18 offen offset:2048 sc1
    v_smfmac_f32_16x16x64_bf16 v[48:51], v[44:47], a[144:151], v0
    s_nop 1
    s_waitcnt lgkmcnt(1)
    v_smfmac_f32_16x16x64_bf16 v[52:55], v[24:27], v[104:111], v0
    buffer_load_dwordx4 v[140:143], v3, s[8:11], s18 offen offset:2176 sc1
    v_smfmac_f32_16x16x64_bf16 v[52:55], v[28:31], v[64:71], v0
    s_waitcnt lgkmcnt(0)
    s_nop 0
    v_add_f32 v48, v48, v50
    v_smfmac_f32_16x16x64_bf16 v[52:55], v[32:35], a[104:111], v0
    ds_read_b128 v[96:99], v2 offset:16384
    v_add_f32 v49, v49, v51
    v_smfmac_f32_16x16x64_bf16 v[52:55], v[36:39], a[120:127], v0
    ds_read_b128 v[100:103], v2 offset:17408
    v_mul_f32 v48, s32, v48
    v_smfmac_f32_16x16x64_bf16 v[52:55], v[40:43], a[136:143], v0
    ds_read_b128 v[104:107], v2 offset:20480
    v_mul_f32 v49, s32, v49
    v_smfmac_f32_16x16x64_bf16 v[52:55], v[44:47], a[152:159], v0
    s_nop 1
    v_cvt_pk_bf16_f32 v48, v48, v49
    v_smfmac_f32_16x16x64_bf16 v[56:59], v[28:31], v[144:151], v0
    ds_write_b32 v4, v48 offset:0
    v_smfmac_f32_16x16x64_bf16 v[56:59], v[32:35], v[160:167], v0
    s_waitcnt lgkmcnt(2)
    s_nop 0
    v_add_f32 v52, v52, v54
    v_smfmac_f32_16x16x64_bf16 v[56:59], v[16:19], v[88:95], v0
    ds_read_b128 v[108:111], v2 offset:21504
    v_add_f32 v53, v53, v55
    v_mul_f32 v52, s32, v52
    v_smfmac_f32_16x16x64_bf16 v[56:59], v[20:23], v[96:103], v0
    ds_read_b128 v[112:115], v2 offset:14336
    v_mul_f32 v53, s32, v53
    v_smfmac_f32_16x16x64_bf16 v[56:59], v[36:39], v[176:183], v0
    ds_read_b128 v[116:119], v2 offset:15360
    v_cvt_pk_bf16_f32 v52, v52, v53
    v_smfmac_f32_16x16x64_bf16 v[56:59], v[40:43], v[192:199], v0
    ds_write_b32 v4, v52 offset:256
    v_smfmac_f32_16x16x64_bf16 v[56:59], v[44:47], v[208:215], v0
    ds_read_b128 v[88:91], v2 offset:18432
    s_waitcnt lgkmcnt(4)
    v_smfmac_f32_16x16x64_bf16 v[56:59], v[24:27], v[104:111], v0
    ds_read_b128 v[92:95], v2 offset:19456
    s_waitcnt lgkmcnt(4)
    v_smfmac_f32_16x16x64_bf16 v[60:63], v[28:31], v[152:159], v0
    ds_read_b128 v[96:99], v2 offset:22528
    ds_read_b128 v[100:103], v2 offset:23552
    v_smfmac_f32_16x16x64_bf16 v[60:63], v[32:35], v[168:175], v0
    s_waitcnt lgkmcnt(4)
    s_barrier
    v_smfmac_f32_16x16x64_bf16 v[60:63], v[36:39], v[184:191], v0
    ds_read_b64_tr_b16 v[104:105], v5 offset:0
    v_add_f32 v56, v56, v58
    v_smfmac_f32_16x16x64_bf16 v[60:63], v[40:43], v[200:207], v0
    ds_read_b64_tr_b16 v[106:107], v5 offset:256
    v_add_f32 v57, v57, v59
    v_smfmac_f32_16x16x64_bf16 v[60:63], v[44:47], v[216:223], v0
    ds_read_b64_tr_b16 v[108:109], v5 offset:2048
    v_cvt_pk_bf16_f32 v56, v56, v57
    v_smfmac_f32_16x16x64_bf16 v[60:63], v[16:19], v[112:119], v0
    ds_read_b64_tr_b16 v[110:111], v5 offset:2304
    s_waitcnt lgkmcnt(4)
    v_mov_b64 v[64:65], 0
    v_smfmac_f32_16x16x64_bf16 v[60:63], v[20:23], v[88:95], v0
    ds_write_b32 v4, v56 offset:512
    v_smfmac_f32_16x16x64_bf16 v[60:63], v[24:27], v[96:103], v0
    s_waitcnt lgkmcnt(3)
    v_mov_b64 v[66:67], 0
    v_mfma_f32_16x16x32_bf16 v[48:51], v[72:75], v[104:107], 0
    s_waitcnt lgkmcnt(1)
    v_mov_b64 v[68:69], 0
    v_mov_b64 v[70:71], 0
    v_mfma_f32_16x16x32_bf16 v[48:51], v[76:79], v[108:111], v[48:51]
    s_nop 0
    v_add_f32 v60, v60, v62
    v_add_f32 v61, v61, v63
    v_cvt_pk_bf16_f32 v60, v60, v61
    v_smfmac_f32_16x16x64_bf16 v[64:67], v[28:31], a[16:23], v0
    ds_write_b32 v4, v60 offset:768
    v_smfmac_f32_16x16x64_bf16 v[64:67], v[24:27], a[0:7], v0
    s_waitcnt lgkmcnt(1)
    v_add_f32_dpp v48, v50, v48 quad_perm:[2,3,0,1] row_mask:0xf bank_mask:0xf
    v_smfmac_f32_16x16x64_bf16 v[64:67], v[20:23], v[240:247], v0
    v_add_f32_dpp v49, v51, v49 quad_perm:[2,3,0,1] row_mask:0xf bank_mask:0xf
    v_smfmac_f32_16x16x64_bf16 v[64:67], v[16:19], v[224:231], v0
    v_exp_f32 v50, v48
    v_smfmac_f32_16x16x64_bf16 v[64:67], v[32:35], a[32:39], v0
    s_waitcnt lgkmcnt(0)
    s_barrier
    v_smfmac_f32_16x16x64_bf16 v[64:67], v[36:39], a[48:55], v0
    ds_read_b64_tr_b16 v[112:113], v5 offset:512
    v_exp_f32 v51, v49
    v_smfmac_f32_16x16x64_bf16 v[64:67], v[40:43], a[64:71], v0
    ds_read_b64_tr_b16 v[114:115], v5 offset:768
    v_cvt_pk_bf16_f32 v50, v50, v51
    v_smfmac_f32_16x16x64_bf16 v[64:67], v[44:47], a[80:87], v0
    ds_read_b64_tr_b16 v[116:117], v5 offset:2560
    v_smfmac_f32_16x16x64_bf16 v[68:71], v[28:31], a[24:31], v0
    ds_read_b64_tr_b16 v[118:119], v5 offset:2816
    v_smfmac_f32_16x16x64_bf16 v[68:71], v[24:27], a[8:15], v0
    ds_write_b32 v12, v50
    s_waitcnt lgkmcnt(3)
    v_mfma_f32_16x16x32_bf16 v[52:55], v[112:115], v[104:107], 0
    s_nop 0
    v_cvt_pk_bf16_f32 v60, v64, v65
    v_cvt_pk_bf16_f32 v61, v66, v67
    v_smfmac_f32_16x16x64_bf16 v[68:71], v[20:23], v[248:255], v0
    s_waitcnt lgkmcnt(1)
    v_mov_b64 v[30:31], 0
    v_mfma_f32_16x16x32_bf16 v[52:55], v[116:119], v[108:111], v[52:55]
    s_nop 0
    v_mov_b64 v[26:27], 0
    v_mov_b64 v[24:25], 0
    v_smfmac_f32_16x16x64_bf16 v[68:71], v[16:19], v[232:239], v0
    s_waitcnt lgkmcnt(0)
    s_barrier
    v_smfmac_f32_16x16x64_bf16 v[68:71], v[32:35], a[40:47], v0
    ds_read_b128 v[56:59], v6 offset:12288
    v_add_f32_dpp v52, v54, v52 quad_perm:[2,3,0,1] row_mask:0xf bank_mask:0xf
    v_smfmac_f32_16x16x64_bf16 v[68:71], v[36:39], a[56:63], v0
    ds_read_b128 v[104:107], v2 offset:30720
    v_add_f32_dpp v53, v55, v53 quad_perm:[2,3,0,1] row_mask:0xf bank_mask:0xf
    v_smfmac_f32_16x16x64_bf16 v[68:71], v[40:43], a[72:79], v0
    ds_read_b128 v[108:111], v2 offset:31744
    v_exp_f32_dpp v54, v52 quad_perm:[0,1,0,1] row_mask:0xf bank_mask:0xf
    v_smfmac_f32_16x16x64_bf16 v[68:71], v[44:47], a[88:95], v0
    s_nop 0
    s_waitcnt lgkmcnt(2)
    v_exp_f32_dpp v55, v53 quad_perm:[0,1,0,1] row_mask:0xf bank_mask:0xf
Tsm_3sc1:
    v_mfma_f32_16x16x32_bf16 v[88:91], v[122:125], v[56:59], 0
    v_cvt_pk_bf16_f32 v28, v54, v55
    v_cvt_pk_bf16_f32 v29, v54, v55
    v_mfma_f32_16x16x32_bf16 v[96:99], v[80:83], v[56:59], 0
    s_nop 0
    v_cvt_pk_bf16_f32 v62, v68, v69
    v_cvt_pk_bf16_f32 v63, v70, v71
    v_mfma_f32_16x16x32_bf16 v[88:91], v[120:123], v[28:31], v[88:91]
    s_nop 0
    v_mov_b64 v[16:17], 0
    v_mov_b64 v[18:19], 0
    v_mfma_f32_16x16x32_bf16 v[96:99], v[60:63], v[28:31], v[96:99]
    s_nop 0
    v_mov_b64 v[20:21], 0
    v_mov_b64 v[22:23], 0
    v_mfma_f32_16x16x32_bf16 v[100:103], v[84:87], v[56:59], 0
    s_nop 0
    v_rcp_f32 v14, v88
    v_mfma_f32_16x16x32_bf16 v[100:103], v[60:63], v[26:29], v[100:103]
    s_nop 0
    v_mul_f32 v96, v96, v14
    v_mul_f32 v97, v97, v14
    v_mul_f32 v98, v98, v14
    v_mul_f32 v99, v99, v14
    v_subrev_u32 v11, s34, v88
    v_cmp_le_u32 vcc, s35, v11
    s_not_b64 exec, s[48:49]
    v_pk_mul_f32 v[96:97], v[100:101], v[14:15] op_sel_hi:[1,0]
    v_pk_mul_f32 v[98:99], v[102:103], v[14:15] op_sel_hi:[1,0]
    s_mov_b64 exec, -1
    v_cvt_pk_bf16_f32 v96, v96, v97
    v_cvt_pk_bf16_f32 v97, v98, v99
    ds_write_b64 v126, v[96:97]
    v_mov_b32_dpp v32, v96 quad_perm:[0,1,0,1] row_mask:0xf bank_mask:0xf
    v_mov_b32_dpp v33, v97 quad_perm:[0,1,0,1] row_mask:0xf bank_mask:0xf
    v_mov_b32_dpp v34, v96 quad_perm:[2,3,2,3] row_mask:0xf bank_mask:0xf
    v_mov_b32_dpp v35, v97 quad_perm:[2,3,2,3] row_mask:0xf bank_mask:0xf
    v_mov_b64 v[28:29], 0
    s_cbranch_vccnz Tmx_3sc1
Tmxd_3sc1:
    v_smfmac_f32_16x16x64_bf16 v[16:19], v[32:35], a[184:191], v0
    s_waitcnt lgkmcnt(0)
    s_barrier
    ds_read_b128 v[36:39], v127 offset:0
    v_smfmac_f32_16x16x64_bf16 v[20:23], v[32:35], a[216:223], v0
    ds_read_b128 v[40:43], v127 offset:512
    v_smfmac_f32_16x16x64_bf16 v[24:27], v[32:35], a[248:255], v0
    ds_read_b128 v[44:47], v127 offset:1024
    v_smfmac_f32_16x16x64_bf16 v[28:31], v[32:35], v[104:111], v0
    ds_read_b128 v[112:115], v2 offset:24576
    s_waitcnt lgkmcnt(3)
    v_smfmac_f32_16x16x64_bf16 v[16:19], v[36:39], a[160:167], v0
    ds_read_b128 v[116:119], v2 offset:25600
    s_waitcnt lgkmcnt(3)
    v_smfmac_f32_16x16x64_bf16 v[16:19], v[40:43], a[168:175], v0
    ds_read_b128 v[48:51], v2 offset:26624
    s_waitcnt lgkmcnt(3)
    v_smfmac_f32_16x16x64_bf16 v[16:19], v[44:47], a[176:183], v0
    s_nop 0
    ds_read_b128 v[56:59], v2 offset:28672
    v_smfmac_f32_16x16x64_bf16 v[20:23], v[36:39], a[192:199], v0
    s_nop 0
    ds_read_b128 v[52:55], v2 offset:27648
    v_smfmac_f32_16x16x64_bf16 v[20:23], v[40:43], a[200:207], v0
    s_nop 1
    v_cvt_pk_bf16_f32 v16, v16, v17
    v_cvt_pk_bf16_f32 v17, v18, v19
    v_and_or_b32 v16, v16, -2, s46
    v_smfmac_f32_16x16x64_bf16 v[20:23], v[44:47], a[208:215], v0
    buffer_store_dwordx2 v[16:17], v7, s[8:11], s20 offen offset:0 sc1
    v_smfmac_f32_16x16x64_bf16 v[24:27], v[36:39], a[224:231], v0
    s_nop 0
    ds_read_b128 v[60:63], v2 offset:29696
    v_smfmac_f32_16x16x64_bf16 v[24:27], v[40:43], a[232:239], v0
    s_nop 1
    s_nop 0
    v_cvt_pk_bf16_f32 v20, v20, v21
    v_cvt_pk_bf16_f32 v21, v22, v23
    v_and_or_b32 v20, v20, -2, s46
    v_smfmac_f32_16x16x64_bf16 v[24:27], v[44:47], a[240:247], v0
    buffer_store_dwordx2 v[20:21], v7, s[8:11], s20 offen offset:2048 sc1
    s_waitcnt lgkmcnt(4)
    v_smfmac_f32_16x16x64_bf16 v[28:31], v[36:39], v[112:119], v0
    s_nop 0
    s_waitcnt lgkmcnt(1)
    v_smfmac_f32_16x16x64_bf16 v[28:31], v[40:43], v[48:55], v0
    s_nop 1
    v_cvt_pk_bf16_f32 v24, v24, v25
    v_cvt_pk_bf16_f32 v25, v26, v27
    s_waitcnt lgkmcnt(0)
    v_and_or_b32 v24, v24, -2, s46
    v_smfmac_f32_16x16x64_bf16 v[28:31], v[44:47], v[56:63], v0
    buffer_store_dwordx2 v[24:25], v7, s[8:11], s21 offen offset:0 sc1
    s_nop 6
    v_cvt_pk_bf16_f32 v28, v28, v29
    v_cvt_pk_bf16_f32 v29, v30, v31
    v_and_or_b32 v28, v28, -2, s46
    buffer_store_dwordx2 v[28:29], v7, s[8:11], s21 offen offset:2048 sc1
    s_barrier
    ds_read_b128 v[16:19], v1 offset:13312
    s_waitcnt vmcnt(7)
    v_mov_b64 v[72:73], v[128:129]
    ds_read_b128 v[32:35], v2 offset:0
    s_add_u32 s17, s17, 1
    v_mov_b64 v[74:75], v[130:131]
    ds_read_b128 v[36:39], v2 offset:1024
    s_and_b32 s29, s17, 3
    s_waitcnt vmcnt(6)
    v_mov_b64 v[76:77], v[132:133]
    ds_read_b128 v[88:91], v2 offset:6144
    s_lshl_b32 s29, s29, 13
    v_mov_b64 v[78:79], v[134:135]
    ds_read_b128 v[92:95], v2 offset:7168
    s_add_u32 s30, s24, s29
    s_waitcnt vmcnt(5)
    v_mov_b64 v[80:81], v[136:137]
    ds_read_b128 v[96:99], v2 offset:8192
    s_add_u32 s26, s29, 52959232
    v_mov_b64 v[82:83], v[138:139]
    ds_read_b128 v[100:103], v2 offset:9216
    s_xor_b32 s25, s30, 16384
    s_waitcnt vmcnt(4)
    v_mov_b64 v[84:85], v[140:141]
    ds_read_b128 v[104:107], v2 offset:10240
    s_xor_b32 s20, s20, 262144
    v_mov_b64 v[86:87], v[142:143]
    ds_read_b128 v[108:111], v2 offset:11264
    s_add_u32 s21, s20, 4096
    s_nop 15
    s_nop 15
    s_nop 0
    buffer_load_dwordx4 v[40:43], v1, s[8:11], s22 offen offset:0 sc1
    buffer_load_dwordx4 v[44:47], v1, s[8:11], s22 offen offset:1024 sc1
    s_waitcnt lgkmcnt(8)
    s_waitcnt vmcnt(1)
    v_mfma_f32_16x16x32_bf16 v[20:23], v[16:19], v[40:43], 0
    v_bitop3_b32 v11, v40, v42, s46 bitop3:0x7e
    s_waitcnt vmcnt(0)
    v_mfma_f32_16x16x32_bf16 v[20:23], v[16:19], v[44:47], v[20:23]
    v_bitop3_b32 v15, v44, v46, s46 bitop3:0x7e
    v_bitop3_b32 v11, v11, v15, 1 bitop3:0xa8
    v_cmp_ne_u32 vcc, 0, v11
    s_nop 4
    v_add_f32_dpp v20, v20, v20 row_ror:4 row_mask:0xf bank_mask:0xf
    v_add_f32_dpp v21, v21, v21 row_ror:4 row_mask:0xf bank_mask:0xf
    s_cbranch_vccnz Tr1_3sc1
Tok1_3sc1:
    v_add_f32_dpp v20, v20, v20 row_ror:8 row_mask:0xf bank_mask:0xf
    v_add_f32_dpp v21, v21, v21 row_ror:8 row_mask:0xf bank_mask:0xf
    v_cvt_pk_bf16_f32 v14, v20, v21
    buffer_store_dword v14, v8, s[8:11], s30 offen sc1
    buffer_store_dword v13, v8, s[8:11], s25 offen sc1
    s_xor_b32 s22, s22, 262144
    s_bfe_u32 s46, s17, 0x10001
    v_mov_b64 v[48:49], 0
    ds_read_b128 v[112:115], v1 offset:28672
    s_add_u32 s19, s19, 8192
    v_mov_b64 v[50:51], 0
    ds_read_b128 v[116:119], v1 offset:29696
    s_cmp_ge_u32 s17, 62
    s_cselect_b32 s35, 0, s35
    s_cselect_b32 s18, 0x40000000, s18
    v_mov_b64 v[52:53], 0
    ds_read_b128 v[64:67], v1 offset:30720
    s_add_u32 s18, s18, 524288
    s_add_u32 s33, s18, 8192
    s_add_u32 s51, s51, 4096
    s_nop 6
    s_branch Tstep_3sc1
Tr2_3sc1:
    buffer_load_dwordx4 v[40:43], v1, s[8:11], s26 offen offset:0 sc1
    buffer_load_dwordx4 v[44:47], v1, s[8:11], s26 offen offset:1024 sc1
    s_waitcnt vmcnt(3)
    v_max3_u32 v11, v40, v41, v42
    v_max_u32 v11, v11, v43
    ds_write_b128 v1, v[40:43] offset:6144
    s_waitcnt vmcnt(2)
    v_max3_u32 v11, v11, v44, v45
    v_max3_u32 v11, v11, v46, v47
    v_cmp_eq_u32 vcc, -1, v11
    ds_write_b128 v1, v[44:47] offset:7168
    s_cbranch_vccz Tok2_3sc1
    buffer_load_dwordx4 v[40:43], v1, s[8:11], s26 offen offset:0 sc1
    buffer_load_dwordx4 v[44:47], v1, s[8:11], s26 offen offset:1024 sc1
    s_waitcnt vmcnt(3)
    v_max3_u32 v11, v40, v41, v42
    v_max_u32 v11, v11, v43
    ds_write_b128 v1, v[40:43] offset:6144
    s_waitcnt vmcnt(2)
    v_max3_u32 v11, v11, v44, v45
    v_max3_u32 v11, v11, v46, v47
    v_cmp_eq_u32 vcc, -1, v11
    ds_write_b128 v1, v[44:47] offset:7168
    s_cbranch_vccz Tok2_3sc1
    s_add_u32 s27, s27, 1
    s_cmp_lt_u32 s27, 400000
    s_cbranch_scc1 Tr2_3sc1
    s_mov_b32 s28, 1
    s_branch Tok2_3sc1
Tr1_3sc1:
    buffer_load_dwordx4 v[40:43], v1, s[8:11], s22 offen offset:0 sc1
    buffer_load_dwordx4 v[44:47], v1, s[8:11], s22 offen offset:1024 sc1
    s_waitcnt vmcnt(1)
    v_mfma_f32_16x16x32_bf16 v[20:23], v[16:19], v[40:43], 0
    v_bitop3_b32 v11, v40, v42, s46 bitop3:0x7e
    s_waitcnt vmcnt(0)
    v_mfma_f32_16x16x32_bf16 v[20:23], v[16:19], v[44:47], v[20:23]
    v_bitop3_b32 v15, v44, v46, s46 bitop3:0x7e
    v_bitop3_b32 v11, v11, v15, 1 bitop3:0xa8
    v_cmp_ne_u32 vcc, 0, v11
    s_nop 4
    v_add_f32_dpp v20, v20, v20 row_ror:4 row_mask:0xf bank_mask:0xf
    v_add_f32_dpp v21, v21, v21 row_ror:4 row_mask:0xf bank_mask:0xf
    s_cbranch_vccz Tok1_3sc1
    s_add_u32 s27, s27, 1
    s_cmp_lt_u32 s27, 400000
    s_cbranch_scc1 Tr1_3sc1
    s_mov_b32 s28, 1
    s_waitcnt vmcnt(0)
    s_branch Tok1_3sc1
Tmx_3sc1:
    s_nop 7
    s_waitcnt lgkmcnt(0)
    s_cmp_lg_u32 s35, 0
    s_cbranch_scc1 Tmx2_3sc1
    ds_read_b64_tr_b16 v[40:41], v5 offset:2816
    v_pk_add_f32 v[44:45], v[64:65], v[66:67]
    v_pk_add_f32 v[46:47], v[68:69], v[70:71]
    v_cvt_pk_bf16_f32 v42, v44, v45
    v_cvt_pk_bf16_f32 v43, v46, v47
    s_and_b32 s29, s17, 1
    s_lshl_b32 s29, s29, 5
    s_add_u32 s29, s29, s16
    s_lshl_b32 s29, s29, 12
    s_add_u32 s29, s29, 61737984
    s_waitcnt lgkmcnt(0)
    buffer_store_dwordx4 v[40:43], v1, s[8:11], s29 offen sc1
    s_cmp_eq_u32 s17, 63
    s_cbranch_scc1 Tend_3sc1
    s_mov_b32 s35, 0x3c000000
    v_cmp_le_u32 vcc, s35, v11
    s_nop 4
    s_and_b64 vcc, vcc, s[48:49]
    s_cbranch_scc0 Tmxd_3sc1
Tmx2_3sc1:
    v_max3_f32 v14, v48, v49, v52
    v_max_f32 v14, v14, v53
    v_mov_b32 v15, v14
    s_nop 1
    v_permlane16_swap_b32 v14, v15
    v_max_f32 v14, v14, v15
    v_mov_b32 v15, v14
    s_nop 1
    v_permlane32_swap_b32 v14, v15
    v_max_f32 v14, v14, v15
    ds_write_b32 v1, v14 offset:14348
    s_waitcnt lgkmcnt(0)
    s_barrier
    ds_read_b128 v[88:91], v1 offset:14336
    s_waitcnt lgkmcnt(0)
    v_max3_f32 v14, v88, v89, v90
    v_max_f32 v14, v14, v91
    v_cmp_neq_f32 vcc, 0, v14
    v_mov_b32 v11, 0x1f8
    v_cmp_class_f32 s[36:37], v14, v11
    s_nop 4
    s_and_b64 vcc, vcc, s[36:37]
    s_and_b64 vcc, vcc, s[48:49]
    s_cbranch_scc0 Tmxd_3sc1
    v_cndmask_b32 v14, 0, v14, vcc
    v_sub_f32 v48, v48, v14
    v_sub_f32 v49, v49, v14
    v_sub_f32 v52, v52, v14
    v_sub_f32 v53, v53, v14
    v_exp_f32 v50, v48
    v_exp_f32 v51, v49
    s_nop 0
    v_cvt_pk_bf16_f32 v50, v50, v51
    ds_write_b32 v12, v50
    v_exp_f32_dpp v54, v52 quad_perm:[0,1,0,1] row_mask:0xf bank_mask:0xf
    v_exp_f32_dpp v55, v53 quad_perm:[0,1,0,1] row_mask:0xf bank_mask:0xf
    s_waitcnt lgkmcnt(0)
    s_barrier
    ds_read_b128 v[56:59], v6 offset:12288
    s_waitcnt lgkmcnt(0)
    s_branch Tsm_3sc1
Tend_3sc1:
    s_endpgm
Lwork:
    s_waitcnt lgkmcnt(0)
    s_sub_u32 s3, s3, 1
    s_lshl_b32 s3, s3, 5
    s_add_u32 s16, s16, s3
    s_load_dwordx2 s[40:41], s[0:1], 0
    s_mov_b32 s42, 2097152
    s_mov_b32 s43, 0x20000
    s_load_dwordx2 s[44:45], s[0:1], 96
    s_mov_b32 s46, 2097152
    s_mov_b32 s47, 0x20000
    s_load_dwordx2 s[32:33], s[0:1], 24
    s_mov_b32 s34, 4194304
    s_mov_b32 s35, 0x20000
    s_load_dwordx2 s[36:37], s[0:1], 32
    s_mov_b32 s38, 4194304
    s_mov_b32 s39, 0x20000
    s_load_dwordx2 s[60:61], s[0:1], 16
    s_load_dwordx2 s[64:65], s[0:1], 40
    v_and_b32 v0, 63, v0
    v_mov_b32 v9, 0
    v_lshlrev_b32 v1, 4, v0
    s_mov_b32 s21, 0
    s_mov_b64 s[48:49], 0
    s_lshl_b32 s25, s17, 15
    s_mul_i32 s18, s16, 10923
    s_lshr_b32 s18, s18, 16
    s_mul_i32 s19, s18, 6
    s_sub_u32 s19, s16, s19
    s_mov_b32 s62, 4194304
    s_mov_b32 s63, 0x20000
    s_mov_b32 s66, 4194304
    s_mov_b32 s67, 0x20000
    s_add_u32 s22, s19, 1
    s_cmp_lt_u32 s19, 4
    s_cselect_b32 s30, 0, 1073741824
    s_and_b32 s22, s22, 3
    s_lshl_b32 s22, s22, 2
    s_add_u32 s22, s22, s17
    v_mov_b32 v48, 0
    v_bfe_u32 v10, v0, 1, 5
    v_lshl_add_u32 v48, v10, 13, v48
    v_bfe_u32 v10, v0, 0, 1
    v_lshl_add_u32 v48, v10, 7, v48
    s_lshl_b32 s23, s22, 18
    s_lshl_b32 s24, s18, 8
    s_add_u32 s23, s23, s24
    s_add_u32 s23, s23, s30
    v_add_u32 v48, s23, v48
    s_lshl_b32 s23, s22, 13
    s_lshl_b32 s24, s18, 17
    s_add_u32 s23, s23, s24
    s_add_u32 s23, s23, s30
    v_lshl_add_u32 v49, v0, 7, s23
    s_waitcnt lgkmcnt(0)
    s_cmp_lt_u32 s16, 192
    s_cbranch_scc1 Wgo
    s_sub_u32 s56, s16, 192
    s_mov_b32 s19, 17
Wln:
    s_lshl_b32 s22, s56, 15
    s_lshl_b32 s23, s17, 13
    s_add_u32 s23, s22, s23
    s_add_u32 m0, s25, 0
    s_add_u32 s24, s23, 0
    v_xor_b32 v16, 0, v1
    buffer_load_dwordx4 v16, s[40:43], s24 offen offset:0 lds
    v_xor_b32 v17, 16, v1
    buffer_load_dwordx4 v17, s[40:43], s24 offen offset:1024 lds
    v_xor_b32 v18, 32, v1
    buffer_load_dwordx4 v18, s[40:43], s24 offen offset:2048 lds
    v_xor_b32 v19, 48, v1
    buffer_load_dwordx4 v19, s[40:43], s24 offen offset:3072 lds
    s_add_u32 m0, s25, 4096
    s_add_u32 s24, s23, 4096
    v_xor_b32 v20, 64, v1
    buffer_load_dwordx4 v20, s[40:43], s24 offen offset:0 lds
    v_xor_b32 v21, 80, v1
    buffer_load_dwordx4 v21, s[40:43], s24 offen offset:1024 lds
    v_xor_b32 v22, 96, v1
    buffer_load_dwordx4 v22, s[40:43], s24 offen offset:2048 lds
    v_xor_b32 v23, 112, v1
    buffer_load_dwordx4 v23, s[40:43], s24 offen offset:3072 lds
    s_lshl_b32 s23, s17, 7
    s_add_u32 s23, s22, s23
    v_mov_b32 v54, 0
    s_mov_b64 exec, 1
    global_load_dword v54, v54, s[6:7] offset:32 sc1
    s_mov_b64 exec, -1
    s_mov_b32 s5, 0
    s_waitcnt vmcnt(0)
Lrot_5:
    v_readfirstlane_b32 s4, v54
    s_nop 3
    s_sub_u32 s4, s4, 1
    s_cmp_eq_u32 s4, s14
    s_cbranch_scc1 Lrot_5_ok
    s_cmp_lt_u32 s4, 8
    s_cbranch_scc0 Lrot_5_again
    s_mov_b32 s14, s4
    s_waitcnt vmcnt(0) lgkmcnt(0)
    s_barrier
    s_branch Lrole
Lrot_5_again:
    v_mov_b32 v54, 0
    s_mov_b64 exec, 1
    global_load_dword v54, v54, s[6:7] offset:32 sc1
    s_mov_b64 exec, -1
    s_waitcnt vmcnt(0)
    s_add_u32 s5, s5, 1
    s_cmp_lt_u32 s5, 400000
    s_cbranch_scc1 Lrot_5
Lrot_5_ok:
    v_mov_b32 v13, 0
    v_bfe_u32 v10, v0, 0, 3
    v_lshl_add_u32 v13, v10, 4, v13
    v_bfe_u32 v10, v0, 3, 3
    v_lshl_add_u32 v13, v10, 9, v13
    v_lshrrev_b32 v12, 3, v0
    v_xor_b32 v12, v12, v0
    v_and_b32 v12, 7, v12
    v_lshlrev_b32 v12, 4, v12
    v_and_b32 v10, 7, v0
    v_lshl_add_u32 v12, v10, 10, v12
    v_add_u32 v12, s25, v12
    ds_read_b128 v[16:19], v12 offset:0
    ds_read_b128 v[20:23], v12 offset:128
    ds_read_b128 v[24:27], v12 offset:256
    ds_read_b128 v[28:31], v12 offset:384
    ds_read_b128 v[32:35], v12 offset:512
    ds_read_b128 v[36:39], v12 offset:640
    ds_read_b128 v[40:43], v12 offset:768
    ds_read_b128 v[44:47], v12 offset:896
    s_waitcnt lgkmcnt(7)
    v_lshlrev_b32 v64, 16, v16
    v_and_b32 v65, 0xffff0000, v16
    v_lshlrev_b32 v66, 16, v17
    v_and_b32 v67, 0xffff0000, v17
    v_lshlrev_b32 v68, 16, v18
    v_and_b32 v69, 0xffff0000, v18
    v_lshlrev_b32 v70, 16, v19
    v_and_b32 v71, 0xffff0000, v19
    s_waitcnt lgkmcnt(6)
    v_lshlrev_b32 v72, 16, v20
    v_and_b32 v73, 0xffff0000, v20
    v_lshlrev_b32 v74, 16, v21
    v_and_b32 v75, 0xffff0000, v21
    v_lshlrev_b32 v76, 16, v22
    v_and_b32 v77, 0xffff0000, v22
    v_lshlrev_b32 v78, 16, v23
    v_and_b32 v79, 0xffff0000, v23
    s_waitcnt lgkmcnt(5)
    v_lshlrev_b32 v80, 16, v24
    v_and_b32 v81, 0xffff0000, v24
    v_lshlrev_b32 v82, 16, v25
    v_and_b32 v83, 0xffff0000, v25
    v_lshlrev_b32 v84, 16, v26
    v_and_b32 v85, 0xffff0000, v26
    v_lshlrev_b32 v86, 16, v27
    v_and_b32 v87, 0xffff0000, v27
    s_waitcnt lgkmcnt(4)
    v_lshlrev_b32 v88, 16, v28
    v_and_b32 v89, 0xffff0000, v28
    v_lshlrev_b32 v90, 16, v29
    v_and_b32 v91, 0xffff0000, v29
    v_lshlrev_b32 v92, 16, v30
    v_and_b32 v93, 0xffff0000, v30
    v_lshlrev_b32 v94, 16, v31
    v_and_b32 v95, 0xffff0000, v31
    s_waitcnt lgkmcnt(3)
    v_lshlrev_b32 v96, 16, v32
    v_and_b32 v97, 0xffff0000, v32
    v_lshlrev_b32 v98, 16, v33
    v_and_b32 v99, 0xffff0000, v33
    v_lshlrev_b32 v100, 16, v34
    v_and_b32 v101, 0xffff0000, v34
    v_lshlrev_b32 v102, 16, v35
    v_and_b32 v103, 0xffff0000, v35
    s_waitcnt lgkmcnt(2)
    v_lshlrev_b32 v104, 16, v36
    v_and_b32 v105, 0xffff0000, v36
    v_lshlrev_b32 v106, 16, v37
    v_and_b32 v107, 0xffff0000, v37
    v_lshlrev_b32 v108, 16, v38
    v_and_b32 v109, 0xffff0000, v38
    v_lshlrev_b32 v110, 16, v39
    v_and_b32 v111, 0xffff0000, v39
    s_waitcnt lgkmcnt(1)
    v_lshlrev_b32 v112, 16, v40
    v_and_b32 v113, 0xffff0000, v40
    v_lshlrev_b32 v114, 16, v41
    v_and_b32 v115, 0xffff0000, v41
    v_lshlrev_b32 v116, 16, v42
    v_and_b32 v117, 0xffff0000, v42
    v_lshlrev_b32 v118, 16, v43
    v_and_b32 v119, 0xffff0000, v43
    s_waitcnt lgkmcnt(0)
    v_lshlrev_b32 v120, 16, v44
    v_and_b32 v121, 0xffff0000, v44
    v_lshlrev_b32 v122, 16, v45
    v_and_b32 v123, 0xffff0000, v45
    v_lshlrev_b32 v124, 16, v46
    v_and_b32 v125, 0xffff0000, v46
    v_lshlrev_b32 v126, 16, v47
    v_and_b32 v127, 0xffff0000, v47
    v_pk_add_f32 v[130:131], v[64:65], v[66:67]
    v_pk_add_f32 v[130:131], v[130:131], v[68:69]
    v_pk_add_f32 v[130:131], v[130:131], v[70:71]
    v_pk_add_f32 v[130:131], v[130:131], v[72:73]
    v_pk_add_f32 v[130:131], v[130:131], v[74:75]
    v_pk_add_f32 v[130:131], v[130:131], v[76:77]
    v_pk_add_f32 v[130:131], v[130:131], v[78:79]
    v_pk_add_f32 v[130:131], v[130:131], v[80:81]
    v_pk_add_f32 v[130:131], v[130:131], v[82:83]
    v_pk_add_f32 v[130:131], v[130:131], v[84:85]
    v_pk_add_f32 v[130:131], v[130:131], v[86:87]
    v_pk_add_f32 v[130:131], v[130:131], v[88:89]
    v_pk_add_f32 v[130:131], v[130:131], v[90:91]
    v_pk_add_f32 v[130:131], v[130:131], v[92:93]
    v_pk_add_f32 v[130:131], v[130:131], v[94:95]
    v_pk_add_f32 v[130:131], v[130:131], v[96:97]
    v_pk_add_f32 v[130:131], v[130:131], v[98:99]
    v_pk_add_f32 v[130:131], v[130:131], v[100:101]
    v_pk_add_f32 v[130:131], v[130:131], v[102:103]
    v_pk_add_f32 v[130:131], v[130:131], v[104:105]
    v_pk_add_f32 v[130:131], v[130:131], v[106:107]
    v_pk_add_f32 v[130:131], v[130:131], v[108:109]
    v_pk_add_f32 v[130:131], v[130:131], v[110:111]
    v_pk_add_f32 v[130:131], v[130:131], v[112:113]
    v_pk_add_f32 v[130:131], v[130:131], v[114:115]
    v_pk_add_f32 v[130:131], v[130:131], v[116:117]
    v_pk_add_f32 v[130:131], v[130:131], v[118:119]
    v_pk_add_f32 v[130:131], v[130:131], v[120:121]
    v_pk_add_f32 v[130:131], v[130:131], v[122:123]
    v_pk_add_f32 v[130:131], v[130:131], v[124:125]
    v_pk_add_f32 v[130:131], v[130:131], v[126:127]
    v_add_f32 v130, v130, v131
    s_nop 1
    v_add_f32_dpp v130, v130, v130 row_ror:8 row_mask:0xf bank_mask:0xf
    v_mov_b32 v131, v130
    s_nop 1
    v_permlane16_swap_b32 v130, v131
    v_add_f32 v130, v130, v131
    v_mov_b32 v131, v130
    s_nop 1
    v_permlane32_swap_b32 v130, v131
    v_add_f32 v130, v130, v131
    v_mul_f32 v132, 0xbb000000, v130
    v_pk_add_f32 v[64:65], v[64:65], v[132:133] op_sel_hi:[1,0]
    v_pk_add_f32 v[66:67], v[66:67], v[132:133] op_sel_hi:[1,0]
    v_pk_add_f32 v[68:69], v[68:69], v[132:133] op_sel_hi:[1,0]
    v_pk_add_f32 v[70:71], v[70:71], v[132:133] op_sel_hi:[1,0]
    v_pk_add_f32 v[72:73], v[72:73], v[132:133] op_sel_hi:[1,0]
    v_pk_add_f32 v[74:75], v[74:75], v[132:133] op_sel_hi:[1,0]
    v_pk_add_f32 v[76:77], v[76:77], v[132:133] op_sel_hi:[1,0]
    v_pk_add_f32 v[78:79], v[78:79], v[132:133] op_sel_hi:[1,0]
    v_pk_add_f32 v[80:81], v[80:81], v[132:133] op_sel_hi:[1,0]
    v_pk_add_f32 v[82:83], v[82:83], v[132:133] op_sel_hi:[1,0]
    v_pk_add_f32 v[84:85], v[84:85], v[132:133] op_sel_hi:[1,0]
    v_pk_add_f32 v[86:87], v[86:87], v[132:133] op_sel_hi:[1,0]
    v_pk_add_f32 v[88:89], v[88:89], v[132:133] op_sel_hi:[1,0]
    v_pk_add_f32 v[90:91], v[90:91], v[132:133] op_sel_hi:[1,0]
    v_pk_add_f32 v[92:93], v[92:93], v[132:133] op_sel_hi:[1,0]
    v_pk_add_f32 v[94:95], v[94:95], v[132:133] op_sel_hi:[1,0]
    v_pk_add_f32 v[96:97], v[96:97], v[132:133] op_sel_hi:[1,0]
    v_pk_add_f32 v[98:99], v[98:99], v[132:133] op_sel_hi:[1,0]
    v_pk_add_f32 v[100:101], v[100:101], v[132:133] op_sel_hi:[1,0]
    v_pk_add_f32 v[102:103], v[102:103], v[132:133] op_sel_hi:[1,0]
    v_pk_add_f32 v[104:105], v[104:105], v[132:133] op_sel_hi:[1,0]
    v_pk_add_f32 v[106:107], v[106:107], v[132:133] op_sel_hi:[1,0]
    v_pk_add_f32 v[108:109], v[108:109], v[132:133] op_sel_hi:[1,0]
    v_pk_add_f32 v[110:111], v[110:111], v[132:133] op_sel_hi:[1,0]
    v_pk_add_f32 v[112:113], v[112:113], v[132:133] op_sel_hi:[1,0]
    v_pk_add_f32 v[114:115], v[114:115], v[132:133] op_sel_hi:[1,0]
    v_pk_add_f32 v[116:117], v[116:117], v[132:133] op_sel_hi:[1,0]
    v_pk_add_f32 v[118:119], v[118:119], v[132:133] op_sel_hi:[1,0]
    v_pk_add_f32 v[120:121], v[120:121], v[132:133] op_sel_hi:[1,0]
    v_pk_add_f32 v[122:123], v[122:123], v[132:133] op_sel_hi:[1,0]
    v_pk_add_f32 v[124:125], v[124:125], v[132:133] op_sel_hi:[1,0]
    v_pk_add_f32 v[126:127], v[126:127], v[132:133] op_sel_hi:[1,0]
    v_pk_mul_f32 v[130:131], v[64:65], v[64:65]
    v_pk_fma_f32 v[130:131], v[66:67], v[66:67], v[130:131]
    v_pk_fma_f32 v[130:131], v[68:69], v[68:69], v[130:131]
    v_pk_fma_f32 v[130:131], v[70:71], v[70:71], v[130:131]
    v_pk_fma_f32 v[130:131], v[72:73], v[72:73], v[130:131]
    v_pk_fma_f32 v[130:131], v[74:75], v[74:75], v[130:131]
    v_pk_fma_f32 v[130:131], v[76:77], v[76:77], v[130:131]
    v_pk_fma_f32 v[130:131], v[78:79], v[78:79], v[130:131]
    v_pk_fma_f32 v[130:131], v[80:81], v[80:81], v[130:131]
    v_pk_fma_f32 v[130:131], v[82:83], v[82:83], v[130:131]
    v_pk_fma_f32 v[130:131], v[84:85], v[84:85], v[130:131]
    v_pk_fma_f32 v[130:131], v[86:87], v[86:87], v[130:131]
    v_pk_fma_f32 v[130:131], v[88:89], v[88:89], v[130:131]
    v_pk_fma_f32 v[130:131], v[90:91], v[90:91], v[130:131]
    v_pk_fma_f32 v[130:131], v[92:93], v[92:93], v[130:131]
    v_pk_fma_f32 v[130:131], v[94:95], v[94:95], v[130:131]
    v_pk_fma_f32 v[130:131], v[96:97], v[96:97], v[130:131]
    v_pk_fma_f32 v[130:131], v[98:99], v[98:99], v[130:131]
    v_pk_fma_f32 v[130:131], v[100:101], v[100:101], v[130:131]
    v_pk_fma_f32 v[130:131], v[102:103], v[102:103], v[130:131]
    v_pk_fma_f32 v[130:131], v[104:105], v[104:105], v[130:131]
    v_pk_fma_f32 v[130:131], v[106:107], v[106:107], v[130:131]
    v_pk_fma_f32 v[130:131], v[108:109], v[108:109], v[130:131]
    v_pk_fma_f32 v[130:131], v[110:111], v[110:111], v[130:131]
    v_pk_fma_f32 v[130:131], v[112:113], v[112:113], v[130:131]
    v_pk_fma_f32 v[130:131], v[114:115], v[114:115], v[130:131]
    v_pk_fma_f32 v[130:131], v[116:117], v[116:117], v[130:131]
    v_pk_fma_f32 v[130:131], v[118:119], v[118:119], v[130:131]
    v_pk_fma_f32 v[130:131], v[120:121], v[120:121], v[130:131]
    v_pk_fma_f32 v[130:131], v[122:123], v[122:123], v[130:131]
    v_pk_fma_f32 v[130:131], v[124:125], v[124:125], v[130:131]
    v_pk_fma_f32 v[130:131], v[126:127], v[126:127], v[130:131]
    v_add_f32 v130, v130, v131
    s_nop 1
    v_add_f32_dpp v130, v130, v130 row_ror:8 row_mask:0xf bank_mask:0xf
    v_mov_b32 v131, v130
    s_nop 1
    v_permlane16_swap_b32 v130, v131
    v_add_f32 v130, v130, v131
    v_mov_b32 v131, v130
    s_nop 1
    v_permlane32_swap_b32 v130, v131
    v_add_f32 v130, v130, v131
    v_mov_b32 v132, 0x3727c5ac
    v_fmac_f32 v132, 0x3b000000, v130
    v_rsq_f32 v132, v132
    s_nop 0
    v_pk_mul_f32 v[64:65], v[64:65], v[132:133] op_sel_hi:[1,0]
    v_cvt_pk_bf16_f32 v16, v64, v65
    v_pk_mul_f32 v[66:67], v[66:67], v[132:133] op_sel_hi:[1,0]
    v_cvt_pk_bf16_f32 v17, v66, v67
    v_pk_mul_f32 v[68:69], v[68:69], v[132:133] op_sel_hi:[1,0]
    v_cvt_pk_bf16_f32 v18, v68, v69
    v_pk_mul_f32 v[70:71], v[70:71], v[132:133] op_sel_hi:[1,0]
    v_cvt_pk_bf16_f32 v19, v70, v71
    v_pk_mul_f32 v[72:73], v[72:73], v[132:133] op_sel_hi:[1,0]
    v_cvt_pk_bf16_f32 v20, v72, v73
    v_pk_mul_f32 v[74:75], v[74:75], v[132:133] op_sel_hi:[1,0]
    v_cvt_pk_bf16_f32 v21, v74, v75
    v_pk_mul_f32 v[76:77], v[76:77], v[132:133] op_sel_hi:[1,0]
    v_cvt_pk_bf16_f32 v22, v76, v77
    v_pk_mul_f32 v[78:79], v[78:79], v[132:133] op_sel_hi:[1,0]
    v_cvt_pk_bf16_f32 v23, v78, v79
    v_pk_mul_f32 v[80:81], v[80:81], v[132:133] op_sel_hi:[1,0]
    v_cvt_pk_bf16_f32 v24, v80, v81
    v_pk_mul_f32 v[82:83], v[82:83], v[132:133] op_sel_hi:[1,0]
    v_cvt_pk_bf16_f32 v25, v82, v83
    v_pk_mul_f32 v[84:85], v[84:85], v[132:133] op_sel_hi:[1,0]
    v_cvt_pk_bf16_f32 v26, v84, v85
    v_pk_mul_f32 v[86:87], v[86:87], v[132:133] op_sel_hi:[1,0]
    v_cvt_pk_bf16_f32 v27, v86, v87
    v_pk_mul_f32 v[88:89], v[88:89], v[132:133] op_sel_hi:[1,0]
    v_cvt_pk_bf16_f32 v28, v88, v89
    v_pk_mul_f32 v[90:91], v[90:91], v[132:133] op_sel_hi:[1,0]
    v_cvt_pk_bf16_f32 v29, v90, v91
    v_pk_mul_f32 v[92:93], v[92:93], v[132:133] op_sel_hi:[1,0]
    v_cvt_pk_bf16_f32 v30, v92, v93
    v_pk_mul_f32 v[94:95], v[94:95], v[132:133] op_sel_hi:[1,0]
    v_cvt_pk_bf16_f32 v31, v94, v95
    v_pk_mul_f32 v[96:97], v[96:97], v[132:133] op_sel_hi:[1,0]
    v_cvt_pk_bf16_f32 v32, v96, v97
    v_pk_mul_f32 v[98:99], v[98:99], v[132:133] op_sel_hi:[1,0]
    v_cvt_pk_bf16_f32 v33, v98, v99
    v_pk_mul_f32 v[100:101], v[100:101], v[132:133] op_sel_hi:[1,0]
    v_cvt_pk_bf16_f32 v34, v100, v101
    v_pk_mul_f32 v[102:103], v[102:103], v[132:133] op_sel_hi:[1,0]
    v_cvt_pk_bf16_f32 v35, v102, v103
    v_pk_mul_f32 v[104:105], v[104:105], v[132:133] op_sel_hi:[1,0]
    v_cvt_pk_bf16_f32 v36, v104, v105
    v_pk_mul_f32 v[106:107], v[106:107], v[132:133] op_sel_hi:[1,0]
    v_cvt_pk_bf16_f32 v37, v106, v107
    v_pk_mul_f32 v[108:109], v[108:109], v[132:133] op_sel_hi:[1,0]
    v_cvt_pk_bf16_f32 v38, v108, v109
    v_pk_mul_f32 v[110:111], v[110:111], v[132:133] op_sel_hi:[1,0]
    v_cvt_pk_bf16_f32 v39, v110, v111
    v_pk_mul_f32 v[112:113], v[112:113], v[132:133] op_sel_hi:[1,0]
    v_cvt_pk_bf16_f32 v40, v112, v113
    v_pk_mul_f32 v[114:115], v[114:115], v[132:133] op_sel_hi:[1,0]
    v_cvt_pk_bf16_f32 v41, v114, v115
    v_pk_mul_f32 v[116:117], v[116:117], v[132:133] op_sel_hi:[1,0]
    v_cvt_pk_bf16_f32 v42, v116, v117
    v_pk_mul_f32 v[118:119], v[118:119], v[132:133] op_sel_hi:[1,0]
    v_cvt_pk_bf16_f32 v43, v118, v119
    v_pk_mul_f32 v[120:121], v[120:121], v[132:133] op_sel_hi:[1,0]
    v_cvt_pk_bf16_f32 v44, v120, v121
    v_pk_mul_f32 v[122:123], v[122:123], v[132:133] op_sel_hi:[1,0]
    v_cvt_pk_bf16_f32 v45, v122, v123
    v_pk_mul_f32 v[124:125], v[124:125], v[132:133] op_sel_hi:[1,0]
    v_cvt_pk_bf16_f32 v46, v124, v125
    v_pk_mul_f32 v[126:127], v[126:127], v[132:133] op_sel_hi:[1,0]
    v_cvt_pk_bf16_f32 v47, v126, v127
    v_lshlrev_b32 v64, 16, v16
    v_and_b32 v65, 0xffff0000, v16
    v_lshlrev_b32 v66, 16, v17
    v_and_b32 v67, 0xffff0000, v17
    v_lshlrev_b32 v68, 16, v18
    v_and_b32 v69, 0xffff0000, v18
    v_lshlrev_b32 v70, 16, v19
    v_and_b32 v71, 0xffff0000, v19
    v_lshlrev_b32 v72, 16, v20
    v_and_b32 v73, 0xffff0000, v20
    v_lshlrev_b32 v74, 16, v21
    v_and_b32 v75, 0xffff0000, v21
    v_lshlrev_b32 v76, 16, v22
    v_and_b32 v77, 0xffff0000, v22
    v_lshlrev_b32 v78, 16, v23
    v_and_b32 v79, 0xffff0000, v23
    v_lshlrev_b32 v80, 16, v24
    v_and_b32 v81, 0xffff0000, v24
    v_lshlrev_b32 v82, 16, v25
    v_and_b32 v83, 0xffff0000, v25
    v_lshlrev_b32 v84, 16, v26
    v_and_b32 v85, 0xffff0000, v26
    v_lshlrev_b32 v86, 16, v27
    v_and_b32 v87, 0xffff0000, v27
    v_lshlrev_b32 v88, 16, v28
    v_and_b32 v89, 0xffff0000, v28
    v_lshlrev_b32 v90, 16, v29
    v_and_b32 v91, 0xffff0000, v29
    v_lshlrev_b32 v92, 16, v30
    v_and_b32 v93, 0xffff0000, v30
    v_lshlrev_b32 v94, 16, v31
    v_and_b32 v95, 0xffff0000, v31
    v_lshlrev_b32 v96, 16, v32
    v_and_b32 v97, 0xffff0000, v32
    v_lshlrev_b32 v98, 16, v33
    v_and_b32 v99, 0xffff0000, v33
    v_lshlrev_b32 v100, 16, v34
    v_and_b32 v101, 0xffff0000, v34
    v_lshlrev_b32 v102, 16, v35
    v_and_b32 v103, 0xffff0000, v35
    v_lshlrev_b32 v104, 16, v36
    v_and_b32 v105, 0xffff0000, v36
    v_lshlrev_b32 v106, 16, v37
    v_and_b32 v107, 0xffff0000, v37
    v_lshlrev_b32 v108, 16, v38
    v_and_b32 v109, 0xffff0000, v38
    v_lshlrev_b32 v110, 16, v39
    v_and_b32 v111, 0xffff0000, v39
    v_lshlrev_b32 v112, 16, v40
    v_and_b32 v113, 0xffff0000, v40
    v_lshlrev_b32 v114, 16, v41
    v_and_b32 v115, 0xffff0000, v41
    v_lshlrev_b32 v116, 16, v42
    v_and_b32 v117, 0xffff0000, v42
    v_lshlrev_b32 v118, 16, v43
    v_and_b32 v119, 0xffff0000, v43
    v_lshlrev_b32 v120, 16, v44
    v_and_b32 v121, 0xffff0000, v44
    v_lshlrev_b32 v122, 16, v45
    v_and_b32 v123, 0xffff0000, v45
    v_lshlrev_b32 v124, 16, v46
    v_and_b32 v125, 0xffff0000, v46
    v_lshlrev_b32 v126, 16, v47
    v_and_b32 v127, 0xffff0000, v47
    v_pk_add_f32 v[130:131], v[64:65], v[66:67]
    v_pk_add_f32 v[130:131], v[130:131], v[68:69]
    v_pk_add_f32 v[130:131], v[130:131], v[70:71]
    v_pk_add_f32 v[130:131], v[130:131], v[72:73]
    v_pk_add_f32 v[130:131], v[130:131], v[74:75]
    v_pk_add_f32 v[130:131], v[130:131], v[76:77]
    v_pk_add_f32 v[130:131], v[130:131], v[78:79]
    v_pk_add_f32 v[130:131], v[130:131], v[80:81]
    v_pk_add_f32 v[130:131], v[130:131], v[82:83]
    v_pk_add_f32 v[130:131], v[130:131], v[84:85]
    v_pk_add_f32 v[130:131], v[130:131], v[86:87]
    v_pk_add_f32 v[130:131], v[130:131], v[88:89]
    v_pk_add_f32 v[130:131], v[130:131], v[90:91]
    v_pk_add_f32 v[130:131], v[130:131], v[92:93]
    v_pk_add_f32 v[130:131], v[130:131], v[94:95]
    v_pk_add_f32 v[130:131], v[130:131], v[96:97]
    v_pk_add_f32 v[130:131], v[130:131], v[98:99]
    v_pk_add_f32 v[130:131], v[130:131], v[100:101]
    v_pk_add_f32 v[130:131], v[130:131], v[102:103]
    v_pk_add_f32 v[130:131], v[130:131], v[104:105]
    v_pk_add_f32 v[130:131], v[130:131], v[106:107]
    v_pk_add_f32 v[130:131], v[130:131], v[108:109]
    v_pk_add_f32 v[130:131], v[130:131], v[110:111]
    v_pk_add_f32 v[130:131], v[130:131], v[112:113]
    v_pk_add_f32 v[130:131], v[130:131], v[114:115]
    v_pk_add_f32 v[130:131], v[130:131], v[116:117]
    v_pk_add_f32 v[130:131], v[130:131], v[118:119]
    v_pk_add_f32 v[130:131], v[130:131], v[120:121]
    v_pk_add_f32 v[130:131], v[130:131], v[122:123]
    v_pk_add_f32 v[130:131], v[130:131], v[124:125]
    v_pk_add_f32 v[130:131], v[130:131], v[126:127]
    v_add_f32 v130, v130, v131
    s_nop 1
    v_add_f32_dpp v130, v130, v130 row_ror:8 row_mask:0xf bank_mask:0xf
    v_mov_b32 v131, v130
    s_nop 1
    v_permlane16_swap_b32 v130, v131
    v_add_f32 v130, v130, v131
    v_mov_b32 v131, v130
    s_nop 1
    v_permlane32_swap_b32 v130, v131
    v_add_f32 v130, v130, v131
    v_mul_f32 v132, 0xbb000000, v130
    v_pk_add_f32 v[64:65], v[64:65], v[132:133] op_sel_hi:[1,0]
    v_pk_add_f32 v[66:67], v[66:67], v[132:133] op_sel_hi:[1,0]
    v_pk_add_f32 v[68:69], v[68:69], v[132:133] op_sel_hi:[1,0]
    v_pk_add_f32 v[70:71], v[70:71], v[132:133] op_sel_hi:[1,0]
    v_pk_add_f32 v[72:73], v[72:73], v[132:133] op_sel_hi:[1,0]
    v_pk_add_f32 v[74:75], v[74:75], v[132:133] op_sel_hi:[1,0]
    v_pk_add_f32 v[76:77], v[76:77], v[132:133] op_sel_hi:[1,0]
    v_pk_add_f32 v[78:79], v[78:79], v[132:133] op_sel_hi:[1,0]
    v_pk_add_f32 v[80:81], v[80:81], v[132:133] op_sel_hi:[1,0]
    v_pk_add_f32 v[82:83], v[82:83], v[132:133] op_sel_hi:[1,0]
    v_pk_add_f32 v[84:85], v[84:85], v[132:133] op_sel_hi:[1,0]
    v_pk_add_f32 v[86:87], v[86:87], v[132:133] op_sel_hi:[1,0]
    v_pk_add_f32 v[88:89], v[88:89], v[132:133] op_sel_hi:[1,0]
    v_pk_add_f32 v[90:91], v[90:91], v[132:133] op_sel_hi:[1,0]
    v_pk_add_f32 v[92:93], v[92:93], v[132:133] op_sel_hi:[1,0]
    v_pk_add_f32 v[94:95], v[94:95], v[132:133] op_sel_hi:[1,0]
    v_pk_add_f32 v[96:97], v[96:97], v[132:133] op_sel_hi:[1,0]
    v_pk_add_f32 v[98:99], v[98:99], v[132:133] op_sel_hi:[1,0]
    v_pk_add_f32 v[100:101], v[100:101], v[132:133] op_sel_hi:[1,0]
    v_pk_add_f32 v[102:103], v[102:103], v[132:133] op_sel_hi:[1,0]
    v_pk_add_f32 v[104:105], v[104:105], v[132:133] op_sel_hi:[1,0]
    v_pk_add_f32 v[106:107], v[106:107], v[132:133] op_sel_hi:[1,0]
    v_pk_add_f32 v[108:109], v[108:109], v[132:133] op_sel_hi:[1,0]
    v_pk_add_f32 v[110:111], v[110:111], v[132:133] op_sel_hi:[1,0]
    v_pk_add_f32 v[112:113], v[112:113], v[132:133] op_sel_hi:[1,0]
    v_pk_add_f32 v[114:115], v[114:115], v[132:133] op_sel_hi:[1,0]
    v_pk_add_f32 v[116:117], v[116:117], v[132:133] op_sel_hi:[1,0]
    v_pk_add_f32 v[118:119], v[118:119], v[132:133] op_sel_hi:[1,0]
    v_pk_add_f32 v[120:121], v[120:121], v[132:133] op_sel_hi:[1,0]
    v_pk_add_f32 v[122:123], v[122:123], v[132:133] op_sel_hi:[1,0]
    v_pk_add_f32 v[124:125], v[124:125], v[132:133] op_sel_hi:[1,0]
    v_pk_add_f32 v[126:127], v[126:127], v[132:133] op_sel_hi:[1,0]
    v_pk_mul_f32 v[130:131], v[64:65], v[64:65]
    v_pk_fma_f32 v[130:131], v[66:67], v[66:67], v[130:131]
    v_pk_fma_f32 v[130:131], v[68:69], v[68:69], v[130:131]
    v_pk_fma_f32 v[130:131], v[70:71], v[70:71], v[130:131]
    v_pk_fma_f32 v[130:131], v[72:73], v[72:73], v[130:131]
    v_pk_fma_f32 v[130:131], v[74:75], v[74:75], v[130:131]
    v_pk_fma_f32 v[130:131], v[76:77], v[76:77], v[130:131]
    v_pk_fma_f32 v[130:131], v[78:79], v[78:79], v[130:131]
    v_pk_fma_f32 v[130:131], v[80:81], v[80:81], v[130:131]
    v_pk_fma_f32 v[130:131], v[82:83], v[82:83], v[130:131]
    v_pk_fma_f32 v[130:131], v[84:85], v[84:85], v[130:131]
    v_pk_fma_f32 v[130:131], v[86:87], v[86:87], v[130:131]
    v_pk_fma_f32 v[130:131], v[88:89], v[88:89], v[130:131]
    v_pk_fma_f32 v[130:131], v[90:91], v[90:91], v[130:131]
    v_pk_fma_f32 v[130:131], v[92:93], v[92:93], v[130:131]
    v_pk_fma_f32 v[130:131], v[94:95], v[94:95], v[130:131]
    v_pk_fma_f32 v[130:131], v[96:97], v[96:97], v[130:131]
    v_pk_fma_f32 v[130:131], v[98:99], v[98:99], v[130:131]
    v_pk_fma_f32 v[130:131], v[100:101], v[100:101], v[130:131]
    v_pk_fma_f32 v[130:131], v[102:103], v[102:103], v[130:131]
    v_pk_fma_f32 v[130:131], v[104:105], v[104:105], v[130:131]
    v_pk_fma_f32 v[130:131], v[106:107], v[106:107], v[130:131]
    v_pk_fma_f32 v[130:131], v[108:109], v[108:109], v[130:131]
    v_pk_fma_f32 v[130:131], v[110:111], v[110:111], v[130:131]
    v_pk_fma_f32 v[130:131], v[112:113], v[112:113], v[130:131]
    v_pk_fma_f32 v[130:131], v[114:115], v[114:115], v[130:131]
    v_pk_fma_f32 v[130:131], v[116:117], v[116:117], v[130:131]
    v_pk_fma_f32 v[130:131], v[118:119], v[118:119], v[130:131]
    v_pk_fma_f32 v[130:131], v[120:121], v[120:121], v[130:131]
    v_pk_fma_f32 v[130:131], v[122:123], v[122:123], v[130:131]
    v_pk_fma_f32 v[130:131], v[124:125], v[124:125], v[130:131]
    v_pk_fma_f32 v[130:131], v[126:127], v[126:127], v[130:131]
    v_add_f32 v130, v130, v131
    s_nop 1
    v_add_f32_dpp v130, v130, v130 row_ror:8 row_mask:0xf bank_mask:0xf
    v_mov_b32 v131, v130
    s_nop 1
    v_permlane16_swap_b32 v130, v131
    v_add_f32 v130, v130, v131
    v_mov_b32 v131, v130
    s_nop 1
    v_permlane32_swap_b32 v130, v131
    v_add_f32 v130, v130, v131
    v_mov_b32 v132, 0x3727c5ac
    v_fmac_f32 v132, 0x3b000000, v130
    v_rsq_f32 v132, v132
    s_add_u32 s24, s23, 56623104
    v_pk_mul_f32 v[64:65], v[64:65], v[132:133] op_sel_hi:[1,0]
    v_cvt_pk_bf16_f32 v16, v64, v65
    v_pk_mul_f32 v[66:67], v[66:67], v[132:133] op_sel_hi:[1,0]
    v_cvt_pk_bf16_f32 v17, v66, v67
    v_pk_mul_f32 v[68:69], v[68:69], v[132:133] op_sel_hi:[1,0]
    v_cvt_pk_bf16_f32 v18, v68, v69
    v_pk_mul_f32 v[70:71], v[70:71], v[132:133] op_sel_hi:[1,0]
    v_cvt_pk_bf16_f32 v19, v70, v71
    buffer_store_dwordx4 v[16:19], v13, s[8:11], s24 offen sc1
    s_add_u32 s24, s24, 4096
    v_pk_mul_f32 v[72:73], v[72:73], v[132:133] op_sel_hi:[1,0]
    v_cvt_pk_bf16_f32 v20, v72, v73
    v_pk_mul_f32 v[74:75], v[74:75], v[132:133] op_sel_hi:[1,0]
    v_cvt_pk_bf16_f32 v21, v74, v75
    v_pk_mul_f32 v[76:77], v[76:77], v[132:133] op_sel_hi:[1,0]
    v_cvt_pk_bf16_f32 v22, v76, v77
    v_pk_mul_f32 v[78:79], v[78:79], v[132:133] op_sel_hi:[1,0]
    v_cvt_pk_bf16_f32 v23, v78, v79
    buffer_store_dwordx4 v[20:23], v13, s[8:11], s24 offen sc1
    s_add_u32 s24, s24, 4096
    v_pk_mul_f32 v[80:81], v[80:81], v[132:133] op_sel_hi:[1,0]
    v_cvt_pk_bf16_f32 v24, v80, v81
    v_pk_mul_f32 v[82:83], v[82:83], v[132:133] op_sel_hi:[1,0]
    v_cvt_pk_bf16_f32 v25, v82, v83
    v_pk_mul_f32 v[84:85], v[84:85], v[132:133] op_sel_hi:[1,0]
    v_cvt_pk_bf16_f32 v26, v84, v85
    v_pk_mul_f32 v[86:87], v[86:87], v[132:133] op_sel_hi:[1,0]
    v_cvt_pk_bf16_f32 v27, v86, v87
    buffer_store_dwordx4 v[24:27], v13, s[8:11], s24 offen sc1
    s_add_u32 s24, s24, 4096
    v_pk_mul_f32 v[88:89], v[88:89], v[132:133] op_sel_hi:[1,0]
    v_cvt_pk_bf16_f32 v28, v88, v89
    v_pk_mul_f32 v[90:91], v[90:91], v[132:133] op_sel_hi:[1,0]
    v_cvt_pk_bf16_f32 v29, v90, v91
    v_pk_mul_f32 v[92:93], v[92:93], v[132:133] op_sel_hi:[1,0]
    v_cvt_pk_bf16_f32 v30, v92, v93
    v_pk_mul_f32 v[94:95], v[94:95], v[132:133] op_sel_hi:[1,0]
    v_cvt_pk_bf16_f32 v31, v94, v95
    buffer_store_dwordx4 v[28:31], v13, s[8:11], s24 offen sc1
    s_add_u32 s24, s24, 4096
    v_pk_mul_f32 v[96:97], v[96:97], v[132:133] op_sel_hi:[1,0]
    v_cvt_pk_bf16_f32 v32, v96, v97
    v_pk_mul_f32 v[98:99], v[98:99], v[132:133] op_sel_hi:[1,0]
    v_cvt_pk_bf16_f32 v33, v98, v99
    v_pk_mul_f32 v[100:101], v[100:101], v[132:133] op_sel_hi:[1,0]
    v_cvt_pk_bf16_f32 v34, v100, v101
    v_pk_mul_f32 v[102:103], v[102:103], v[132:133] op_sel_hi:[1,0]
    v_cvt_pk_bf16_f32 v35, v102, v103
    buffer_store_dwordx4 v[32:35], v13, s[8:11], s24 offen sc1
    s_add_u32 s24, s24, 4096
    v_pk_mul_f32 v[104:105], v[104:105], v[132:133] op_sel_hi:[1,0]
    v_cvt_pk_bf16_f32 v36, v104, v105
    v_pk_mul_f32 v[106:107], v[106:107], v[132:133] op_sel_hi:[1,0]
    v_cvt_pk_bf16_f32 v37, v106, v107
    v_pk_mul_f32 v[108:109], v[108:109], v[132:133] op_sel_hi:[1,0]
    v_cvt_pk_bf16_f32 v38, v108, v109
    v_pk_mul_f32 v[110:111], v[110:111], v[132:133] op_sel_hi:[1,0]
    v_cvt_pk_bf16_f32 v39, v110, v111
    buffer_store_dwordx4 v[36:39], v13, s[8:11], s24 offen sc1
    s_add_u32 s24, s24, 4096
    v_pk_mul_f32 v[112:113], v[112:113], v[132:133] op_sel_hi:[1,0]
    v_cvt_pk_bf16_f32 v40, v112, v113
    v_pk_mul_f32 v[114:115], v[114:115], v[132:133] op_sel_hi:[1,0]
    v_cvt_pk_bf16_f32 v41, v114, v115
    v_pk_mul_f32 v[116:117], v[116:117], v[132:133] op_sel_hi:[1,0]
    v_cvt_pk_bf16_f32 v42, v116, v117
    v_pk_mul_f32 v[118:119], v[118:119], v[132:133] op_sel_hi:[1,0]
    v_cvt_pk_bf16_f32 v43, v118, v119
    buffer_store_dwordx4 v[40:43], v13, s[8:11], s24 offen sc1
    s_add_u32 s24, s24, 4096
    v_pk_mul_f32 v[120:121], v[120:121], v[132:133] op_sel_hi:[1,0]
    v_cvt_pk_bf16_f32 v44, v120, v121
    v_pk_mul_f32 v[122:123], v[122:123], v[132:133] op_sel_hi:[1,0]
    v_cvt_pk_bf16_f32 v45, v122, v123
    v_pk_mul_f32 v[124:125], v[124:125], v[132:133] op_sel_hi:[1,0]
    v_cvt_pk_bf16_f32 v46, v124, v125
    v_pk_mul_f32 v[126:127], v[126:127], v[132:133] op_sel_hi:[1,0]
    v_cvt_pk_bf16_f32 v47, v126, v127
    buffer_store_dwordx4 v[44:47], v13, s[8:11], s24 offen sc1
    s_add_u32 s24, s24, 4096
    s_waitcnt vmcnt(0)
    s_barrier
    s_cmp_lg_u32 s17, 0
    s_cbranch_scc1 Wb_6
    s_lshl_b64 s[50:51], 1, s56
    v_mov_b32 v10, s50
    v_mov_b32 v11, s51
    s_mov_b64 exec, 1
    global_atomic_or_x2 v9, v[10:11], s[6:7] offset:64
    s_mov_b64 exec, -1
Wb_6:
    s_add_u32 s56, s56, 32
    s_cmp_lt_u32 s56, 64
    s_cbranch_scc1 Wln
    s_branch Wend
Wgo:
    s_cmp_ge_u32 s19, 4
    s_cbranch_scc1 Wln1
    buffer_load_dword v51, v48, s[32:35], 0 offen
    s_branch Wln_done
Wln1:
    s_lshl_b32 s56, s18, 1
    s_add_u32 s56, s56, s19
    s_sub_u32 s56, s56, 4
    s_lshl_b32 s22, s56, 15
    s_lshl_b32 s23, s17, 13
    s_add_u32 s23, s22, s23
    s_add_u32 m0, s25, 0
    s_add_u32 s24, s23, 0
    v_xor_b32 v16, 0, v1
    buffer_load_dwordx4 v16, s[40:43], s24 offen offset:0 lds
    v_xor_b32 v17, 16, v1
    buffer_load_dwordx4 v17, s[40:43], s24 offen offset:1024 lds
    v_xor_b32 v18, 32, v1
    buffer_load_dwordx4 v18, s[40:43], s24 offen offset:2048 lds
    v_xor_b32 v19, 48, v1
    buffer_load_dwordx4 v19, s[40:43], s24 offen offset:3072 lds
    s_add_u32 m0, s25, 4096
    s_add_u32 s24, s23, 4096
    v_xor_b32 v20, 64, v1
    buffer_load_dwordx4 v20, s[40:43], s24 offen offset:0 lds
    v_xor_b32 v21, 80, v1
    buffer_load_dwordx4 v21, s[40:43], s24 offen offset:1024 lds
    v_xor_b32 v22, 96, v1
    buffer_load_dwordx4 v22, s[40:43], s24 offen offset:2048 lds
    v_xor_b32 v23, 112, v1
    buffer_load_dwordx4 v23, s[40:43], s24 offen offset:3072 lds
    s_lshl_b32 s23, s17, 7
    s_add_u32 s23, s22, s23
    v_mov_b32 v54, 0
    s_mov_b64 exec, 1
    global_load_dword v54, v54, s[6:7] offset:32 sc1
    s_mov_b64 exec, -1
    s_mov_b32 s5, 0
    s_waitcnt vmcnt(0)
Lrot_7:
    v_readfirstlane_b32 s4, v54
    s_nop 3
    s_sub_u32 s4, s4, 1
    s_cmp_eq_u32 s4, s14
    s_cbranch_scc1 Lrot_7_ok
    s_cmp_lt_u32 s4, 8
    s_cbranch_scc0 Lrot_7_again
    s_mov_b32 s14, s4
    s_waitcnt vmcnt(0) lgkmcnt(0)
    s_barrier
    s_branch Lrole
Lrot_7_again:
    v_mov_b32 v54, 0
    s_mov_b64 exec, 1
    global_load_dword v54, v54, s[6:7] offset:32 sc1
    s_mov_b64 exec, -1
    s_waitcnt vmcnt(0)
    s_add_u32 s5, s5, 1
    s_cmp_lt_u32 s5, 400000
    s_cbranch_scc1 Lrot_7
Lrot_7_ok:
    v_mov_b32 v64, -1
    v_mov_b32 v68, 0
    v_mov_b32 v65, -1
    v_mov_b32 v69, 0
    v_mov_b32 v66, -1
    v_mov_b32 v70, 0
    v_mov_b32 v67, -1
    v_mov_b32 v71, 0
    s_lshl_b32 s24, s56, 12
    s_lshl_b32 s30, s17, 10
    s_add_u32 s31, s24, s30
    s_add_u32 s24, s31, 58720256
    buffer_store_dwordx4 v[68:71], v1, s[8:11], s24 offen sc1
    s_add_u32 s24, s31, 61865984
    buffer_store_dwordx4 v[64:67], v1, s[8:11], s24 offen sc1
    s_lshl_b32 s24, s31, 1
    s_add_u32 s24, s24, 60817408
    buffer_store_dwordx4 v[64:67], v1, s[8:11], s24 offen offset:0 sc1
    buffer_store_dwordx4 v[64:67], v1, s[8:11], s24 offen offset:1024 sc1
    v_mov_b32 v13, 0
    v_bfe_u32 v10, v0, 0, 3
    v_lshl_add_u32 v13, v10, 4, v13
    v_bfe_u32 v10, v0, 3, 3
    v_lshl_add_u32 v13, v10, 9, v13
    v_lshrrev_b32 v12, 3, v0
    v_xor_b32 v12, v12, v0
    v_and_b32 v12, 7, v12
    v_lshlrev_b32 v12, 4, v12
    v_and_b32 v10, 7, v0
    v_lshl_add_u32 v12, v10, 10, v12
    v_add_u32 v12, s25, v12
    ds_read_b128 v[16:19], v12 offset:0
    ds_read_b128 v[20:23], v12 offset:128
    ds_read_b128 v[24:27], v12 offset:256
    ds_read_b128 v[28:31], v12 offset:384
    ds_read_b128 v[32:35], v12 offset:512
    ds_read_b128 v[36:39], v12 offset:640
    ds_read_b128 v[40:43], v12 offset:768
    ds_read_b128 v[44:47], v12 offset:896
    s_waitcnt lgkmcnt(7)
    v_lshlrev_b32 v64, 16, v16
    v_and_b32 v65, 0xffff0000, v16
    v_lshlrev_b32 v66, 16, v17
    v_and_b32 v67, 0xffff0000, v17
    v_lshlrev_b32 v68, 16, v18
    v_and_b32 v69, 0xffff0000, v18
    v_lshlrev_b32 v70, 16, v19
    v_and_b32 v71, 0xffff0000, v19
    s_waitcnt lgkmcnt(6)
    v_lshlrev_b32 v72, 16, v20
    v_and_b32 v73, 0xffff0000, v20
    v_lshlrev_b32 v74, 16, v21
    v_and_b32 v75, 0xffff0000, v21
    v_lshlrev_b32 v76, 16, v22
    v_and_b32 v77, 0xffff0000, v22
    v_lshlrev_b32 v78, 16, v23
    v_and_b32 v79, 0xffff0000, v23
    s_waitcnt lgkmcnt(5)
    v_lshlrev_b32 v80, 16, v24
    v_and_b32 v81, 0xffff0000, v24
    v_lshlrev_b32 v82, 16, v25
    v_and_b32 v83, 0xffff0000, v25
    v_lshlrev_b32 v84, 16, v26
    v_and_b32 v85, 0xffff0000, v26
    v_lshlrev_b32 v86, 16, v27
    v_and_b32 v87, 0xffff0000, v27
    s_waitcnt lgkmcnt(4)
    v_lshlrev_b32 v88, 16, v28
    v_and_b32 v89, 0xffff0000, v28
    v_lshlrev_b32 v90, 16, v29
    v_and_b32 v91, 0xffff0000, v29
    v_lshlrev_b32 v92, 16, v30
    v_and_b32 v93, 0xffff0000, v30
    v_lshlrev_b32 v94, 16, v31
    v_and_b32 v95, 0xffff0000, v31
    s_waitcnt lgkmcnt(3)
    v_lshlrev_b32 v96, 16, v32
    v_and_b32 v97, 0xffff0000, v32
    v_lshlrev_b32 v98, 16, v33
    v_and_b32 v99, 0xffff0000, v33
    v_lshlrev_b32 v100, 16, v34
    v_and_b32 v101, 0xffff0000, v34
    v_lshlrev_b32 v102, 16, v35
    v_and_b32 v103, 0xffff0000, v35
    s_waitcnt lgkmcnt(2)
    v_lshlrev_b32 v104, 16, v36
    v_and_b32 v105, 0xffff0000, v36
    v_lshlrev_b32 v106, 16, v37
    v_and_b32 v107, 0xffff0000, v37
    v_lshlrev_b32 v108, 16, v38
    v_and_b32 v109, 0xffff0000, v38
    v_lshlrev_b32 v110, 16, v39
    v_and_b32 v111, 0xffff0000, v39
    s_waitcnt lgkmcnt(1)
    v_lshlrev_b32 v112, 16, v40
    v_and_b32 v113, 0xffff0000, v40
    v_lshlrev_b32 v114, 16, v41
    v_and_b32 v115, 0xffff0000, v41
    v_lshlrev_b32 v116, 16, v42
    v_and_b32 v117, 0xffff0000, v42
    v_lshlrev_b32 v118, 16, v43
    v_and_b32 v119, 0xffff0000, v43
    s_waitcnt lgkmcnt(0)
    v_lshlrev_b32 v120, 16, v44
    v_and_b32 v121, 0xffff0000, v44
    v_lshlrev_b32 v122, 16, v45
    v_and_b32 v123, 0xffff0000, v45
    v_lshlrev_b32 v124, 16, v46
    v_and_b32 v125, 0xffff0000, v46
    v_lshlrev_b32 v126, 16, v47
    v_and_b32 v127, 0xffff0000, v47
    v_pk_add_f32 v[130:131], v[64:65], v[66:67]
    v_pk_add_f32 v[130:131], v[130:131], v[68:69]
    v_pk_add_f32 v[130:131], v[130:131], v[70:71]
    v_pk_add_f32 v[130:131], v[130:131], v[72:73]
    v_pk_add_f32 v[130:131], v[130:131], v[74:75]
    v_pk_add_f32 v[130:131], v[130:131], v[76:77]
    v_pk_add_f32 v[130:131], v[130:131], v[78:79]
    v_pk_add_f32 v[130:131], v[130:131], v[80:81]
    v_pk_add_f32 v[130:131], v[130:131], v[82:83]
    v_pk_add_f32 v[130:131], v[130:131], v[84:85]
    v_pk_add_f32 v[130:131], v[130:131], v[86:87]
    v_pk_add_f32 v[130:131], v[130:131], v[88:89]
    v_pk_add_f32 v[130:131], v[130:131], v[90:91]
    v_pk_add_f32 v[130:131], v[130:131], v[92:93]
    v_pk_add_f32 v[130:131], v[130:131], v[94:95]
    v_pk_add_f32 v[130:131], v[130:131], v[96:97]
    v_pk_add_f32 v[130:131], v[130:131], v[98:99]
    v_pk_add_f32 v[130:131], v[130:131], v[100:101]
    v_pk_add_f32 v[130:131], v[130:131], v[102:103]
    v_pk_add_f32 v[130:131], v[130:131], v[104:105]
    v_pk_add_f32 v[130:131], v[130:131], v[106:107]
    v_pk_add_f32 v[130:131], v[130:131], v[108:109]
    v_pk_add_f32 v[130:131], v[130:131], v[110:111]
    v_pk_add_f32 v[130:131], v[130:131], v[112:113]
    v_pk_add_f32 v[130:131], v[130:131], v[114:115]
    v_pk_add_f32 v[130:131], v[130:131], v[116:117]
    v_pk_add_f32 v[130:131], v[130:131], v[118:119]
    v_pk_add_f32 v[130:131], v[130:131], v[120:121]
    v_pk_add_f32 v[130:131], v[130:131], v[122:123]
    v_pk_add_f32 v[130:131], v[130:131], v[124:125]
    v_pk_add_f32 v[130:131], v[130:131], v[126:127]
    v_add_f32 v130, v130, v131
    s_nop 1
    v_add_f32_dpp v130, v130, v130 row_ror:8 row_mask:0xf bank_mask:0xf
    v_mov_b32 v131, v130
    s_nop 1
    v_permlane16_swap_b32 v130, v131
    v_add_f32 v130, v130, v131
    v_mov_b32 v131, v130
    s_nop 1
    v_permlane32_swap_b32 v130, v131
    v_add_f32 v130, v130, v131
    v_mul_f32 v132, 0xbb000000, v130
    v_pk_add_f32 v[64:65], v[64:65], v[132:133] op_sel_hi:[1,0]
    v_pk_add_f32 v[66:67], v[66:67], v[132:133] op_sel_hi:[1,0]
    v_pk_add_f32 v[68:69], v[68:69], v[132:133] op_sel_hi:[1,0]
    v_pk_add_f32 v[70:71], v[70:71], v[132:133] op_sel_hi:[1,0]
    v_pk_add_f32 v[72:73], v[72:73], v[132:133] op_sel_hi:[1,0]
    v_pk_add_f32 v[74:75], v[74:75], v[132:133] op_sel_hi:[1,0]
    v_pk_add_f32 v[76:77], v[76:77], v[132:133] op_sel_hi:[1,0]
    v_pk_add_f32 v[78:79], v[78:79], v[132:133] op_sel_hi:[1,0]
    v_pk_add_f32 v[80:81], v[80:81], v[132:133] op_sel_hi:[1,0]
    v_pk_add_f32 v[82:83], v[82:83], v[132:133] op_sel_hi:[1,0]
    v_pk_add_f32 v[84:85], v[84:85], v[132:133] op_sel_hi:[1,0]
    v_pk_add_f32 v[86:87], v[86:87], v[132:133] op_sel_hi:[1,0]
    v_pk_add_f32 v[88:89], v[88:89], v[132:133] op_sel_hi:[1,0]
    v_pk_add_f32 v[90:91], v[90:91], v[132:133] op_sel_hi:[1,0]
    v_pk_add_f32 v[92:93], v[92:93], v[132:133] op_sel_hi:[1,0]
    v_pk_add_f32 v[94:95], v[94:95], v[132:133] op_sel_hi:[1,0]
    v_pk_add_f32 v[96:97], v[96:97], v[132:133] op_sel_hi:[1,0]
    v_pk_add_f32 v[98:99], v[98:99], v[132:133] op_sel_hi:[1,0]
    v_pk_add_f32 v[100:101], v[100:101], v[132:133] op_sel_hi:[1,0]
    v_pk_add_f32 v[102:103], v[102:103], v[132:133] op_sel_hi:[1,0]
    v_pk_add_f32 v[104:105], v[104:105], v[132:133] op_sel_hi:[1,0]
    v_pk_add_f32 v[106:107], v[106:107], v[132:133] op_sel_hi:[1,0]
    v_pk_add_f32 v[108:109], v[108:109], v[132:133] op_sel_hi:[1,0]
    v_pk_add_f32 v[110:111], v[110:111], v[132:133] op_sel_hi:[1,0]
    v_pk_add_f32 v[112:113], v[112:113], v[132:133] op_sel_hi:[1,0]
    v_pk_add_f32 v[114:115], v[114:115], v[132:133] op_sel_hi:[1,0]
    v_pk_add_f32 v[116:117], v[116:117], v[132:133] op_sel_hi:[1,0]
    v_pk_add_f32 v[118:119], v[118:119], v[132:133] op_sel_hi:[1,0]
    v_pk_add_f32 v[120:121], v[120:121], v[132:133] op_sel_hi:[1,0]
    v_pk_add_f32 v[122:123], v[122:123], v[132:133] op_sel_hi:[1,0]
    v_pk_add_f32 v[124:125], v[124:125], v[132:133] op_sel_hi:[1,0]
    v_pk_add_f32 v[126:127], v[126:127], v[132:133] op_sel_hi:[1,0]
    v_pk_mul_f32 v[130:131], v[64:65], v[64:65]
    v_pk_fma_f32 v[130:131], v[66:67], v[66:67], v[130:131]
    v_pk_fma_f32 v[130:131], v[68:69], v[68:69], v[130:131]
    v_pk_fma_f32 v[130:131], v[70:71], v[70:71], v[130:131]
    v_pk_fma_f32 v[130:131], v[72:73], v[72:73], v[130:131]
    v_pk_fma_f32 v[130:131], v[74:75], v[74:75], v[130:131]
    v_pk_fma_f32 v[130:131], v[76:77], v[76:77], v[130:131]
    v_pk_fma_f32 v[130:131], v[78:79], v[78:79], v[130:131]
    v_pk_fma_f32 v[130:131], v[80:81], v[80:81], v[130:131]
    v_pk_fma_f32 v[130:131], v[82:83], v[82:83], v[130:131]
    v_pk_fma_f32 v[130:131], v[84:85], v[84:85], v[130:131]
    v_pk_fma_f32 v[130:131], v[86:87], v[86:87], v[130:131]
    v_pk_fma_f32 v[130:131], v[88:89], v[88:89], v[130:131]
    v_pk_fma_f32 v[130:131], v[90:91], v[90:91], v[130:131]
    v_pk_fma_f32 v[130:131], v[92:93], v[92:93], v[130:131]
    v_pk_fma_f32 v[130:131], v[94:95], v[94:95], v[130:131]
    v_pk_fma_f32 v[130:131], v[96:97], v[96:97], v[130:131]
    v_pk_fma_f32 v[130:131], v[98:99], v[98:99], v[130:131]
    v_pk_fma_f32 v[130:131], v[100:101], v[100:101], v[130:131]
    v_pk_fma_f32 v[130:131], v[102:103], v[102:103], v[130:131]
    v_pk_fma_f32 v[130:131], v[104:105], v[104:105], v[130:131]
    v_pk_fma_f32 v[130:131], v[106:107], v[106:107], v[130:131]
    v_pk_fma_f32 v[130:131], v[108:109], v[108:109], v[130:131]
    v_pk_fma_f32 v[130:131], v[110:111], v[110:111], v[130:131]
    v_pk_fma_f32 v[130:131], v[112:113], v[112:113], v[130:131]
    v_pk_fma_f32 v[130:131], v[114:115], v[114:115], v[130:131]
    v_pk_fma_f32 v[130:131], v[116:117], v[116:117], v[130:131]
    v_pk_fma_f32 v[130:131], v[118:119], v[118:119], v[130:131]
    v_pk_fma_f32 v[130:131], v[120:121], v[120:121], v[130:131]
    v_pk_fma_f32 v[130:131], v[122:123], v[122:123], v[130:131]
    v_pk_fma_f32 v[130:131], v[124:125], v[124:125], v[130:131]
    v_pk_fma_f32 v[130:131], v[126:127], v[126:127], v[130:131]
    v_add_f32 v130, v130, v131
    s_nop 1
    v_add_f32_dpp v130, v130, v130 row_ror:8 row_mask:0xf bank_mask:0xf
    v_mov_b32 v131, v130
    s_nop 1
    v_permlane16_swap_b32 v130, v131
    v_add_f32 v130, v130, v131
    v_mov_b32 v131, v130
    s_nop 1
    v_permlane32_swap_b32 v130, v131
    v_add_f32 v130, v130, v131
    v_mov_b32 v132, 0x3727c5ac
    v_fmac_f32 v132, 0x3b000000, v130
    v_rsq_f32 v132, v132
    s_add_u32 s24, s23, 54525952
    v_pk_mul_f32 v[64:65], v[64:65], v[132:133] op_sel_hi:[1,0]
    v_cvt_pk_bf16_f32 v16, v64, v65
    v_pk_mul_f32 v[66:67], v[66:67], v[132:133] op_sel_hi:[1,0]
    v_cvt_pk_bf16_f32 v17, v66, v67
    v_pk_mul_f32 v[68:69], v[68:69], v[132:133] op_sel_hi:[1,0]
    v_cvt_pk_bf16_f32 v18, v68, v69
    v_pk_mul_f32 v[70:71], v[70:71], v[132:133] op_sel_hi:[1,0]
    v_cvt_pk_bf16_f32 v19, v70, v71
    buffer_store_dwordx4 v[16:19], v13, s[8:11], s24 offen sc1
    s_add_u32 s24, s24, 4096
    v_pk_mul_f32 v[72:73], v[72:73], v[132:133] op_sel_hi:[1,0]
    v_cvt_pk_bf16_f32 v20, v72, v73
    v_pk_mul_f32 v[74:75], v[74:75], v[132:133] op_sel_hi:[1,0]
    v_cvt_pk_bf16_f32 v21, v74, v75
    v_pk_mul_f32 v[76:77], v[76:77], v[132:133] op_sel_hi:[1,0]
    v_cvt_pk_bf16_f32 v22, v76, v77
    v_pk_mul_f32 v[78:79], v[78:79], v[132:133] op_sel_hi:[1,0]
    v_cvt_pk_bf16_f32 v23, v78, v79
    buffer_store_dwordx4 v[20:23], v13, s[8:11], s24 offen sc1
    s_add_u32 s24, s24, 4096
    v_pk_mul_f32 v[80:81], v[80:81], v[132:133] op_sel_hi:[1,0]
    v_cvt_pk_bf16_f32 v24, v80, v81
    v_pk_mul_f32 v[82:83], v[82:83], v[132:133] op_sel_hi:[1,0]
    v_cvt_pk_bf16_f32 v25, v82, v83
    v_pk_mul_f32 v[84:85], v[84:85], v[132:133] op_sel_hi:[1,0]
    v_cvt_pk_bf16_f32 v26, v84, v85
    v_pk_mul_f32 v[86:87], v[86:87], v[132:133] op_sel_hi:[1,0]
    v_cvt_pk_bf16_f32 v27, v86, v87
    buffer_store_dwordx4 v[24:27], v13, s[8:11], s24 offen sc1
    s_add_u32 s24, s24, 4096
    v_pk_mul_f32 v[88:89], v[88:89], v[132:133] op_sel_hi:[1,0]
    v_cvt_pk_bf16_f32 v28, v88, v89
    v_pk_mul_f32 v[90:91], v[90:91], v[132:133] op_sel_hi:[1,0]
    v_cvt_pk_bf16_f32 v29, v90, v91
    v_pk_mul_f32 v[92:93], v[92:93], v[132:133] op_sel_hi:[1,0]
    v_cvt_pk_bf16_f32 v30, v92, v93
    v_pk_mul_f32 v[94:95], v[94:95], v[132:133] op_sel_hi:[1,0]
    v_cvt_pk_bf16_f32 v31, v94, v95
    buffer_store_dwordx4 v[28:31], v13, s[8:11], s24 offen sc1
    s_add_u32 s24, s24, 4096
    v_pk_mul_f32 v[96:97], v[96:97], v[132:133] op_sel_hi:[1,0]
    v_cvt_pk_bf16_f32 v32, v96, v97
    v_pk_mul_f32 v[98:99], v[98:99], v[132:133] op_sel_hi:[1,0]
    v_cvt_pk_bf16_f32 v33, v98, v99
    v_pk_mul_f32 v[100:101], v[100:101], v[132:133] op_sel_hi:[1,0]
    v_cvt_pk_bf16_f32 v34, v100, v101
    v_pk_mul_f32 v[102:103], v[102:103], v[132:133] op_sel_hi:[1,0]
    v_cvt_pk_bf16_f32 v35, v102, v103
    buffer_store_dwordx4 v[32:35], v13, s[8:11], s24 offen sc1
    s_add_u32 s24, s24, 4096
    v_pk_mul_f32 v[104:105], v[104:105], v[132:133] op_sel_hi:[1,0]
    v_cvt_pk_bf16_f32 v36, v104, v105
    v_pk_mul_f32 v[106:107], v[106:107], v[132:133] op_sel_hi:[1,0]
    v_cvt_pk_bf16_f32 v37, v106, v107
    v_pk_mul_f32 v[108:109], v[108:109], v[132:133] op_sel_hi:[1,0]
    v_cvt_pk_bf16_f32 v38, v108, v109
    v_pk_mul_f32 v[110:111], v[110:111], v[132:133] op_sel_hi:[1,0]
    v_cvt_pk_bf16_f32 v39, v110, v111
    buffer_store_dwordx4 v[36:39], v13, s[8:11], s24 offen sc1
    s_add_u32 s24, s24, 4096
    v_pk_mul_f32 v[112:113], v[112:113], v[132:133] op_sel_hi:[1,0]
    v_cvt_pk_bf16_f32 v40, v112, v113
    v_pk_mul_f32 v[114:115], v[114:115], v[132:133] op_sel_hi:[1,0]
    v_cvt_pk_bf16_f32 v41, v114, v115
    v_pk_mul_f32 v[116:117], v[116:117], v[132:133] op_sel_hi:[1,0]
    v_cvt_pk_bf16_f32 v42, v116, v117
    v_pk_mul_f32 v[118:119], v[118:119], v[132:133] op_sel_hi:[1,0]
    v_cvt_pk_bf16_f32 v43, v118, v119
    buffer_store_dwordx4 v[40:43], v13, s[8:11], s24 offen sc1
    s_add_u32 s24, s24, 4096
    v_pk_mul_f32 v[120:121], v[120:121], v[132:133] op_sel_hi:[1,0]
    v_cvt_pk_bf16_f32 v44, v120, v121
    v_pk_mul_f32 v[122:123], v[122:123], v[132:133] op_sel_hi:[1,0]
    v_cvt_pk_bf16_f32 v45, v122, v123
    v_pk_mul_f32 v[124:125], v[124:125], v[132:133] op_sel_hi:[1,0]
    v_cvt_pk_bf16_f32 v46, v124, v125
    v_pk_mul_f32 v[126:127], v[126:127], v[132:133] op_sel_hi:[1,0]
    v_cvt_pk_bf16_f32 v47, v126, v127
    buffer_store_dwordx4 v[44:47], v13, s[8:11], s24 offen sc1
    s_add_u32 s24, s24, 4096
    s_waitcnt vmcnt(0)
    s_barrier
    s_cmp_lg_u32 s17, 0
    s_cbranch_scc1 Wb_8
    s_lshl_b64 s[50:51], 1, s56
    v_mov_b32 v10, s50
    v_mov_b32 v11, s51
    s_mov_b64 exec, 1
    global_atomic_or_x2 v9, v[10:11], s[6:7] offset:128
    s_mov_b64 exec, -1
Wb_8:
Wln_done:
    v_mov_b32 v6, 0
    v_bfe_u32 v10, v0, 5, 1
    v_lshl_add_u32 v6, v10, 10, v6
    v_bfe_u32 v10, v0, 4, 1
    v_lshl_add_u32 v6, v10, 9, v6
    v_bfe_u32 v10, v0, 2, 1
    v_lshl_add_u32 v6, v10, 8, v6
    v_bfe_u32 v10, v0, 3, 1
    v_lshl_add_u32 v6, v10, 7, v6
    v_bfe_u32 v10, v0, 0, 2
    v_lshl_add_u32 v6, v10, 4, v6
    v_mov_b32 v2, 0
    v_bfe_u32 v10, v0, 3, 2
    v_lshl_add_u32 v2, v10, 15, v2
    v_bfe_u32 v10, v0, 5, 1
    v_lshl_add_u32 v2, v10, 7, v2
    v_bfe_u32 v10, v0, 0, 3
    v_lshl_add_u32 v2, v10, 4, v2
    v_add_u32 v7, 65536, v1
    s_lshl_b32 s30, s18, 8
    v_lshrrev_b32 v11, 4, v0
    v_lshlrev_b32 v12, 2, v11
    v_xor_b32 v12, v12, v0
    v_and_b32 v12, 15, v12
    v_mul_u32_u24 v55, 8192, v11
    v_lshl_add_u32 v55, v12, 4, v55
    s_mul_i32 s22, s17, 131072
    v_add_u32 v55, s22, v55
    v_mul_u32_u24 v56, 8192, v11
    v_lshl_add_u32 v56, v12, 4, v56
    s_mul_i32 s22, s17, 131072
    v_add_u32 v56, s22, v56
    v_mul_u32_u24 v57, 8192, v11
    v_lshl_add_u32 v57, v12, 4, v57
    s_mul_i32 s22, s17, 131072
    v_add_u32 v57, s22, v57
    s_barrier
    s_add_u32 m0, s25, 0
    s_add_u32 s22, s30, 0
    buffer_load_dwordx4 v55, s[32:35], s22 offen lds
    s_add_u32 m0, s25, 1024
    s_add_u32 s22, s30, 32768
    buffer_load_dwordx4 v55, s[32:35], s22 offen lds
    s_add_u32 m0, s25, 2048
    s_add_u32 s22, s30, 65536
    buffer_load_dwordx4 v55, s[32:35], s22 offen lds
    s_add_u32 m0, s25, 3072
    s_add_u32 s22, s30, 98304
    buffer_load_dwordx4 v55, s[32:35], s22 offen lds
    s_add_u32 m0, s25, 4096
    s_add_u32 s22, s30, 524288
    buffer_load_dwordx4 v55, s[32:35], s22 offen lds
    s_add_u32 m0, s25, 5120
    s_add_u32 s22, s30, 557056
    buffer_load_dwordx4 v55, s[32:35], s22 offen lds
    s_add_u32 m0, s25, 6144
    s_add_u32 s22, s30, 589824
    buffer_load_dwordx4 v55, s[32:35], s22 offen lds
    s_add_u32 m0, s25, 7168
    s_add_u32 s22, s30, 622592
    buffer_load_dwordx4 v55, s[32:35], s22 offen lds
    s_add_u32 m0, s25, 8192
    s_add_u32 s22, s30, 1048576
    buffer_load_dwordx4 v55, s[32:35], s22 offen lds
    s_add_u32 m0, s25, 9216
    s_add_u32 s22, s30, 1081344
    buffer_load_dwordx4 v55, s[32:35], s22 offen lds
    s_add_u32 m0, s25, 10240
    s_add_u32 s22, s30, 1114112
    buffer_load_dwordx4 v55, s[32:35], s22 offen lds
    s_add_u32 m0, s25, 11264
    s_add_u32 s22, s30, 1146880
    buffer_load_dwordx4 v55, s[32:35], s22 offen lds
    s_add_u32 m0, s25, 12288
    s_add_u32 s22, s30, 1572864
    buffer_load_dwordx4 v55, s[32:35], s22 offen lds
    s_add_u32 m0, s25, 13312
    s_add_u32 s22, s30, 1605632
    buffer_load_dwordx4 v55, s[32:35], s22 offen lds
    s_add_u32 m0, s25, 14336
    s_add_u32 s22, s30, 1638400
    buffer_load_dwordx4 v55, s[32:35], s22 offen lds
    s_add_u32 m0, s25, 15360
    s_add_u32 s22, s30, 1671168
    buffer_load_dwordx4 v55, s[32:35], s22 offen lds
    s_add_u32 m0, s25, 16384
    s_add_u32 s22, s30, 2097152
    buffer_load_dwordx4 v55, s[32:35], s22 offen lds
    s_add_u32 m0, s25, 17408
    s_add_u32 s22, s30, 2129920
    buffer_load_dwordx4 v55, s[32:35], s22 offen lds
    s_add_u32 m0, s25, 18432
    s_add_u32 s22, s30, 2162688
    buffer_load_dwordx4 v55, s[32:35], s22 offen lds
    s_add_u32 m0, s25, 19456
    s_add_u32 s22, s30, 2195456
    buffer_load_dwordx4 v55, s[32:35], s22 offen lds
    v_mov_b32 v60, 0
    v_bfe_u32 v10, v0, 5, 1
    v_lshl_add_u32 v60, v10, 11, v60
    v_bfe_u32 v10, v0, 2, 2
    v_lshl_add_u32 v60, v10, 8, v60
    v_bfe_u32 v10, v0, 2, 2
    v_lshl_add_u32 v60, v10, 6, v60
    v_bfe_u32 v10, v0, 4, 1
    v_lshl_add_u32 v60, v10, 5, v60
    v_bfe_u32 v10, v0, 0, 2
    v_lshl_add_u32 v60, v10, 3, v60
    s_lshl_b32 s22, s17, 6
    v_xor_b32 v58, s22, v60
    v_add_u32 v59, 65536, v58
    v_add_u32 v60, s25, v60
    v_xor_b32 v61, 64, v60
    v_xor_b32 v62, 128, v60
    v_xor_b32 v63, 192, v60
    s_waitcnt vmcnt(16)
    s_waitcnt lgkmcnt(0)
    s_barrier
    ds_read_b64_tr_b16 a[0:1], v58 offset:0
    ds_read_b64_tr_b16 a[2:3], v58 offset:1024
    ds_read_b64_tr_b16 a[4:5], v58 offset:32768
    ds_read_b64_tr_b16 a[6:7], v58 offset:33792
    ds_read_b64_tr_b16 a[8:9], v59 offset:0
    ds_read_b64_tr_b16 a[10:11], v59 offset:1024
    ds_read_b64_tr_b16 a[12:13], v59 offset:32768
    ds_read_b64_tr_b16 a[14:15], v59 offset:33792
    s_add_u32 m0, s25, 20480
    s_add_u32 s22, s30, 2621440
    buffer_load_dwordx4 v55, s[32:35], s22 offen lds
    s_add_u32 m0, s25, 21504
    s_add_u32 s22, s30, 2654208
    buffer_load_dwordx4 v55, s[32:35], s22 offen lds
    s_add_u32 m0, s25, 22528
    s_add_u32 s22, s30, 2686976
    buffer_load_dwordx4 v55, s[32:35], s22 offen lds
    s_add_u32 m0, s25, 23552
    s_add_u32 s22, s30, 2719744
    buffer_load_dwordx4 v55, s[32:35], s22 offen lds
    buffer_load_dword v52, v48, s[36:39], 0 offen
    s_waitcnt vmcnt(17)
    s_waitcnt lgkmcnt(0)
    s_barrier
    ds_read_b64_tr_b16 a[16:17], v58 offset:4096
    ds_read_b64_tr_b16 a[18:19], v58 offset:5120
    ds_read_b64_tr_b16 a[20:21], v58 offset:36864
    ds_read_b64_tr_b16 a[22:23], v58 offset:37888
    ds_read_b64_tr_b16 a[24:25], v59 offset:4096
    ds_read_b64_tr_b16 a[26:27], v59 offset:5120
    ds_read_b64_tr_b16 a[28:29], v59 offset:36864
    ds_read_b64_tr_b16 a[30:31], v59 offset:37888
    s_add_u32 m0, s25, 24576
    s_add_u32 s22, s30, 3145728
    buffer_load_dwordx4 v55, s[32:35], s22 offen lds
    s_add_u32 m0, s25, 25600
    s_add_u32 s22, s30, 3178496
    buffer_load_dwordx4 v55, s[32:35], s22 offen lds
    s_add_u32 m0, s25, 26624
    s_add_u32 s22, s30, 3211264
    buffer_load_dwordx4 v55, s[32:35], s22 offen lds
    s_add_u32 m0, s25, 27648
    s_add_u32 s22, s30, 3244032
    buffer_load_dwordx4 v55, s[32:35], s22 offen lds
    v_mov_b32 v54, 0
    s_mov_b64 exec, 1
    global_load_dword v54, v54, s[6:7] offset:32 sc1
    s_mov_b64 exec, -1
    s_waitcnt vmcnt(18)
    s_waitcnt lgkmcnt(0)
    s_barrier
    ds_read_b64_tr_b16 a[32:33], v58 offset:8192
    ds_read_b64_tr_b16 a[34:35], v58 offset:9216
    ds_read_b64_tr_b16 a[36:37], v58 offset:40960
    ds_read_b64_tr_b16 a[38:39], v58 offset:41984
    ds_read_b64_tr_b16 a[40:41], v59 offset:8192
    ds_read_b64_tr_b16 a[42:43], v59 offset:9216
    ds_read_b64_tr_b16 a[44:45], v59 offset:40960
    ds_read_b64_tr_b16 a[46:47], v59 offset:41984
    s_add_u32 m0, s25, 28672
    s_add_u32 s22, s30, 3670016
    buffer_load_dwordx4 v55, s[32:35], s22 offen lds
    s_add_u32 m0, s25, 29696
    s_add_u32 s22, s30, 3702784
    buffer_load_dwordx4 v55, s[32:35], s22 offen lds
    s_add_u32 m0, s25, 30720
    s_add_u32 s22, s30, 3735552
    buffer_load_dwordx4 v55, s[32:35], s22 offen lds
    s_add_u32 m0, s25, 31744
    s_add_u32 s22, s30, 3768320
    buffer_load_dwordx4 v55, s[32:35], s22 offen lds
    s_waitcnt vmcnt(18)
    s_waitcnt lgkmcnt(0)
    s_barrier
    ds_read_b64_tr_b16 a[48:49], v58 offset:12288
    ds_read_b64_tr_b16 a[50:51], v58 offset:13312
    ds_read_b64_tr_b16 a[52:53], v58 offset:45056
    ds_read_b64_tr_b16 a[54:55], v58 offset:46080
    ds_read_b64_tr_b16 a[56:57], v59 offset:12288
    ds_read_b64_tr_b16 a[58:59], v59 offset:13312
    ds_read_b64_tr_b16 a[60:61], v59 offset:45056
    ds_read_b64_tr_b16 a[62:63], v59 offset:46080
    s_add_u32 m0, s25, 0
    s_add_u32 s22, s30, 0
    buffer_load_dwordx4 v56, s[36:39], s22 offen lds
    s_add_u32 m0, s25, 1024
    s_add_u32 s22, s30, 32768
    buffer_load_dwordx4 v56, s[36:39], s22 offen lds
    s_add_u32 m0, s25, 2048
    s_add_u32 s22, s30, 65536
    buffer_load_dwordx4 v56, s[36:39], s22 offen lds
    s_add_u32 m0, s25, 3072
    s_add_u32 s22, s30, 98304
    buffer_load_dwordx4 v56, s[36:39], s22 offen lds
    buffer_load_dword v50, v48, s[60:63], 0 offen
    s_waitcnt vmcnt(19)
    s_waitcnt lgkmcnt(0)
    s_barrier
    ds_read_b64_tr_b16 a[64:65], v58 offset:16384
    ds_read_b64_tr_b16 a[66:67], v58 offset:17408
    ds_read_b64_tr_b16 a[68:69], v58 offset:49152
    ds_read_b64_tr_b16 a[70:71], v58 offset:50176
    ds_read_b64_tr_b16 a[72:73], v59 offset:16384
    ds_read_b64_tr_b16 a[74:75], v59 offset:17408
    ds_read_b64_tr_b16 a[76:77], v59 offset:49152
    ds_read_b64_tr_b16 a[78:79], v59 offset:50176
    s_add_u32 m0, s25, 4096
    s_add_u32 s22, s30, 524288
    buffer_load_dwordx4 v56, s[36:39], s22 offen lds
    s_add_u32 m0, s25, 5120
    s_add_u32 s22, s30, 557056
    buffer_load_dwordx4 v56, s[36:39], s22 offen lds
    s_add_u32 m0, s25, 6144
    s_add_u32 s22, s30, 589824
    buffer_load_dwordx4 v56, s[36:39], s22 offen lds
    s_add_u32 m0, s25, 7168
    s_add_u32 s22, s30, 622592
    buffer_load_dwordx4 v56, s[36:39], s22 offen lds
    s_waitcnt vmcnt(19)
    s_waitcnt lgkmcnt(0)
    s_barrier
    ds_read_b64_tr_b16 a[80:81], v58 offset:20480
    ds_read_b64_tr_b16 a[82:83], v58 offset:21504
    ds_read_b64_tr_b16 a[84:85], v58 offset:53248
    ds_read_b64_tr_b16 a[86:87], v58 offset:54272
    ds_read_b64_tr_b16 a[88:89], v59 offset:20480
    ds_read_b64_tr_b16 a[90:91], v59 offset:21504
    ds_read_b64_tr_b16 a[92:93], v59 offset:53248
    ds_read_b64_tr_b16 a[94:95], v59 offset:54272
    s_add_u32 m0, s25, 8192
    s_add_u32 s22, s30, 1048576
    buffer_load_dwordx4 v56, s[36:39], s22 offen lds
    s_add_u32 m0, s25, 9216
    s_add_u32 s22, s30, 1081344
    buffer_load_dwordx4 v56, s[36:39], s22 offen lds
    s_add_u32 m0, s25, 10240
    s_add_u32 s22, s30, 1114112
    buffer_load_dwordx4 v56, s[36:39], s22 offen lds
    s_add_u32 m0, s25, 11264
    s_add_u32 s22, s30, 1146880
    buffer_load_dwordx4 v56, s[36:39], s22 offen lds
    s_waitcnt vmcnt(18)
    s_waitcnt lgkmcnt(0)
    s_barrier
    ds_read_b64_tr_b16 a[96:97], v58 offset:24576
    ds_read_b64_tr_b16 a[98:99], v58 offset:25600
    ds_read_b64_tr_b16 a[100:101], v58 offset:57344
    ds_read_b64_tr_b16 a[102:103], v58 offset:58368
    ds_read_b64_tr_b16 a[104:105], v59 offset:24576
    ds_read_b64_tr_b16 a[106:107], v59 offset:25600
    ds_read_b64_tr_b16 a[108:109], v59 offset:57344
    ds_read_b64_tr_b16 a[110:111], v59 offset:58368
    s_add_u32 m0, s25, 12288
    s_add_u32 s22, s30, 1572864
    buffer_load_dwordx4 v56, s[36:39], s22 offen lds
    s_add_u32 m0, s25, 13312
    s_add_u32 s22, s30, 1605632
    buffer_load_dwordx4 v56, s[36:39], s22 offen lds
    s_add_u32 m0, s25, 14336
    s_add_u32 s22, s30, 1638400
    buffer_load_dwordx4 v56, s[36:39], s22 offen lds
    s_add_u32 m0, s25, 15360
    s_add_u32 s22, s30, 1671168
    buffer_load_dwordx4 v56, s[36:39], s22 offen lds
    buffer_load_dword v53, v49, s[64:67], 0 offen
    s_waitcnt vmcnt(18)
    s_waitcnt lgkmcnt(0)
    s_barrier
    ds_read_b64_tr_b16 a[112:113], v58 offset:28672
    ds_read_b64_tr_b16 a[114:115], v58 offset:29696
    ds_read_b64_tr_b16 a[116:117], v58 offset:61440
    ds_read_b64_tr_b16 a[118:119], v58 offset:62464
    ds_read_b64_tr_b16 a[120:121], v59 offset:28672
    ds_read_b64_tr_b16 a[122:123], v59 offset:29696
    ds_read_b64_tr_b16 a[124:125], v59 offset:61440
    ds_read_b64_tr_b16 a[126:127], v59 offset:62464
    s_add_u32 m0, s25, 16384
    s_add_u32 s22, s30, 2097152
    buffer_load_dwordx4 v56, s[36:39], s22 offen lds
    s_add_u32 m0, s25, 17408
    s_add_u32 s22, s30, 2129920
    buffer_load_dwordx4 v56, s[36:39], s22 offen lds
    s_add_u32 m0, s25, 18432
    s_add_u32 s22, s30, 2162688
    buffer_load_dwordx4 v56, s[36:39], s22 offen lds
    s_add_u32 m0, s25, 19456
    s_add_u32 s22, s30, 2195456
    buffer_load_dwordx4 v56, s[36:39], s22 offen lds
    s_waitcnt vmcnt(18)
    s_waitcnt lgkmcnt(0)
    s_barrier
    ds_read_b64_tr_b16 a[128:129], v58 offset:0
    ds_read_b64_tr_b16 a[130:131], v58 offset:1024
    ds_read_b64_tr_b16 a[132:133], v58 offset:32768
    ds_read_b64_tr_b16 a[134:135], v58 offset:33792
    ds_read_b64_tr_b16 a[136:137], v59 offset:0
    ds_read_b64_tr_b16 a[138:139], v59 offset:1024
    ds_read_b64_tr_b16 a[140:141], v59 offset:32768
    ds_read_b64_tr_b16 a[142:143], v59 offset:33792
    s_add_u32 m0, s25, 20480
    s_add_u32 s22, s30, 2621440
    buffer_load_dwordx4 v56, s[36:39], s22 offen lds
    s_add_u32 m0, s25, 21504
    s_add_u32 s22, s30, 2654208
    buffer_load_dwordx4 v56, s[36:39], s22 offen lds
    s_add_u32 m0, s25, 22528
    s_add_u32 s22, s30, 2686976
    buffer_load_dwordx4 v56, s[36:39], s22 offen lds
    s_add_u32 m0, s25, 23552
    s_add_u32 s22, s30, 2719744
    buffer_load_dwordx4 v56, s[36:39], s22 offen lds
    s_mov_b32 s5, 0
Lrot_9:
    v_readfirstlane_b32 s4, v54
    s_nop 3
    s_sub_u32 s4, s4, 1
    s_cmp_eq_u32 s4, s14
    s_cbranch_scc1 Lrot_9_ok
    s_cmp_lt_u32 s4, 8
    s_cbranch_scc0 Lrot_9_again
    s_mov_b32 s14, s4
    s_waitcnt vmcnt(0) lgkmcnt(0)
    s_barrier
    s_branch Lrole
Lrot_9_again:
    v_mov_b32 v54, 0
    s_mov_b64 exec, 1
    global_load_dword v54, v54, s[6:7] offset:32 sc1
    s_mov_b64 exec, -1
    s_waitcnt vmcnt(0)
    s_add_u32 s5, s5, 1
    s_cmp_lt_u32 s5, 400000
    s_cbranch_scc1 Lrot_9
Lrot_9_ok:
    s_waitcnt vmcnt(17)
    s_waitcnt lgkmcnt(0)
    s_barrier
    ds_read_b64_tr_b16 a[144:145], v58 offset:4096
    ds_read_b64_tr_b16 a[146:147], v58 offset:5120
    ds_read_b64_tr_b16 a[148:149], v58 offset:36864
    ds_read_b64_tr_b16 a[150:151], v58 offset:37888
    ds_read_b64_tr_b16 a[152:153], v59 offset:4096
    ds_read_b64_tr_b16 a[154:155], v59 offset:5120
    ds_read_b64_tr_b16 a[156:157], v59 offset:36864
    ds_read_b64_tr_b16 a[158:159], v59 offset:37888
    s_add_u32 m0, s25, 24576
    s_add_u32 s22, s30, 3145728
    buffer_load_dwordx4 v56, s[36:39], s22 offen lds
    s_add_u32 m0, s25, 25600
    s_add_u32 s22, s30, 3178496
    buffer_load_dwordx4 v56, s[36:39], s22 offen lds
    s_add_u32 m0, s25, 26624
    s_add_u32 s22, s30, 3211264
    buffer_load_dwordx4 v56, s[36:39], s22 offen lds
    s_add_u32 m0, s25, 27648
    s_add_u32 s22, s30, 3244032
    buffer_load_dwordx4 v56, s[36:39], s22 offen lds
    s_waitcnt vmcnt(17)
    s_waitcnt lgkmcnt(0)
    s_barrier
    ds_read_b64_tr_b16 a[160:161], v58 offset:8192
    ds_read_b64_tr_b16 a[162:163], v58 offset:9216
    ds_read_b64_tr_b16 a[164:165], v58 offset:40960
    ds_read_b64_tr_b16 a[166:167], v58 offset:41984
    ds_read_b64_tr_b16 a[168:169], v59 offset:8192
    ds_read_b64_tr_b16 a[170:171], v59 offset:9216
    ds_read_b64_tr_b16 a[172:173], v59 offset:40960
    ds_read_b64_tr_b16 a[174:175], v59 offset:41984
    s_add_u32 m0, s25, 28672
    s_add_u32 s22, s30, 3670016
    buffer_load_dwordx4 v56, s[36:39], s22 offen lds
    s_add_u32 m0, s25, 29696
    s_add_u32 s22, s30, 3702784
    buffer_load_dwordx4 v56, s[36:39], s22 offen lds
    s_add_u32 m0, s25, 30720
    s_add_u32 s22, s30, 3735552
    buffer_load_dwordx4 v56, s[36:39], s22 offen lds
    s_add_u32 m0, s25, 31744
    s_add_u32 s22, s30, 3768320
    buffer_load_dwordx4 v56, s[36:39], s22 offen lds
    s_waitcnt vmcnt(17)
    s_waitcnt lgkmcnt(0)
    s_barrier
    ds_read_b64_tr_b16 a[176:177], v58 offset:12288
    ds_read_b64_tr_b16 a[178:179], v58 offset:13312
    ds_read_b64_tr_b16 a[180:181], v58 offset:45056
    ds_read_b64_tr_b16 a[182:183], v58 offset:46080
    ds_read_b64_tr_b16 a[184:185], v59 offset:12288
    ds_read_b64_tr_b16 a[186:187], v59 offset:13312
    ds_read_b64_tr_b16 a[188:189], v59 offset:45056
    ds_read_b64_tr_b16 a[190:191], v59 offset:46080
    s_add_u32 m0, s25, 0
    s_add_u32 s22, s30, 0
    buffer_load_dwordx4 v57, s[60:63], s22 offen lds
    s_add_u32 m0, s25, 1024
    s_add_u32 s22, s30, 32768
    buffer_load_dwordx4 v57, s[60:63], s22 offen lds
    s_add_u32 m0, s25, 2048
    s_add_u32 s22, s30, 65536
    buffer_load_dwordx4 v57, s[60:63], s22 offen lds
    s_add_u32 m0, s25, 3072
    s_add_u32 s22, s30, 98304
    buffer_load_dwordx4 v57, s[60:63], s22 offen lds
    s_waitcnt vmcnt(16)
    s_waitcnt lgkmcnt(0)
    s_barrier
    ds_read_b64_tr_b16 a[192:193], v58 offset:16384
    ds_read_b64_tr_b16 a[194:195], v58 offset:17408
    ds_read_b64_tr_b16 a[196:197], v58 offset:49152
    ds_read_b64_tr_b16 a[198:199], v58 offset:50176
    ds_read_b64_tr_b16 a[200:201], v59 offset:16384
    ds_read_b64_tr_b16 a[202:203], v59 offset:17408
    ds_read_b64_tr_b16 a[204:205], v59 offset:49152
    ds_read_b64_tr_b16 a[206:207], v59 offset:50176
    s_add_u32 m0, s25, 4096
    s_add_u32 s22, s30, 524288
    buffer_load_dwordx4 v57, s[60:63], s22 offen lds
    s_add_u32 m0, s25, 5120
    s_add_u32 s22, s30, 557056
    buffer_load_dwordx4 v57, s[60:63], s22 offen lds
    s_add_u32 m0, s25, 6144
    s_add_u32 s22, s30, 589824
    buffer_load_dwordx4 v57, s[60:63], s22 offen lds
    s_add_u32 m0, s25, 7168
    s_add_u32 s22, s30, 622592
    buffer_load_dwordx4 v57, s[60:63], s22 offen lds
    s_waitcnt vmcnt(16)
    s_waitcnt lgkmcnt(0)
    s_barrier
    ds_read_b64_tr_b16 a[208:209], v58 offset:20480
    ds_read_b64_tr_b16 a[210:211], v58 offset:21504
    ds_read_b64_tr_b16 a[212:213], v58 offset:53248
    ds_read_b64_tr_b16 a[214:215], v58 offset:54272
    ds_read_b64_tr_b16 a[216:217], v59 offset:20480
    ds_read_b64_tr_b16 a[218:219], v59 offset:21504
    ds_read_b64_tr_b16 a[220:221], v59 offset:53248
    ds_read_b64_tr_b16 a[222:223], v59 offset:54272
    s_add_u32 m0, s25, 8192
    s_add_u32 s22, s30, 1048576
    buffer_load_dwordx4 v57, s[60:63], s22 offen lds
    s_add_u32 m0, s25, 9216
    s_add_u32 s22, s30, 1081344
    buffer_load_dwordx4 v57, s[60:63], s22 offen lds
    s_add_u32 m0, s25, 10240
    s_add_u32 s22, s30, 1114112
    buffer_load_dwordx4 v57, s[60:63], s22 offen lds
    s_add_u32 m0, s25, 11264
    s_add_u32 s22, s30, 1146880
    buffer_load_dwordx4 v57, s[60:63], s22 offen lds
    s_waitcnt vmcnt(16)
    s_waitcnt lgkmcnt(0)
    s_barrier
    ds_read_b64_tr_b16 a[224:225], v58 offset:24576
    ds_read_b64_tr_b16 a[226:227], v58 offset:25600
    ds_read_b64_tr_b16 a[228:229], v58 offset:57344
    ds_read_b64_tr_b16 a[230:231], v58 offset:58368
    ds_read_b64_tr_b16 a[232:233], v59 offset:24576
    ds_read_b64_tr_b16 a[234:235], v59 offset:25600
    ds_read_b64_tr_b16 a[236:237], v59 offset:57344
    ds_read_b64_tr_b16 a[238:239], v59 offset:58368
    s_add_u32 m0, s25, 12288
    s_add_u32 s22, s30, 1572864
    buffer_load_dwordx4 v57, s[60:63], s22 offen lds
    s_add_u32 m0, s25, 13312
    s_add_u32 s22, s30, 1605632
    buffer_load_dwordx4 v57, s[60:63], s22 offen lds
    s_add_u32 m0, s25, 14336
    s_add_u32 s22, s30, 1638400
    buffer_load_dwordx4 v57, s[60:63], s22 offen lds
    s_add_u32 m0, s25, 15360
    s_add_u32 s22, s30, 1671168
    buffer_load_dwordx4 v57, s[60:63], s22 offen lds
    s_waitcnt vmcnt(16)
    s_waitcnt lgkmcnt(0)
    s_barrier
    ds_read_b64_tr_b16 a[240:241], v58 offset:28672
    ds_read_b64_tr_b16 a[242:243], v58 offset:29696
    ds_read_b64_tr_b16 a[244:245], v58 offset:61440
    ds_read_b64_tr_b16 a[246:247], v58 offset:62464
    ds_read_b64_tr_b16 a[248:249], v59 offset:28672
    ds_read_b64_tr_b16 a[250:251], v59 offset:29696
    ds_read_b64_tr_b16 a[252:253], v59 offset:61440
    ds_read_b64_tr_b16 a[254:255], v59 offset:62464
    s_add_u32 m0, s25, 16384
    s_add_u32 s22, s30, 2097152
    buffer_load_dwordx4 v57, s[60:63], s22 offen lds
    s_add_u32 m0, s25, 17408
    s_add_u32 s22, s30, 2129920
    buffer_load_dwordx4 v57, s[60:63], s22 offen lds
    s_add_u32 m0, s25, 18432
    s_add_u32 s22, s30, 2162688
    buffer_load_dwordx4 v57, s[60:63], s22 offen lds
    s_add_u32 m0, s25, 19456
    s_add_u32 s22, s30, 2195456
    buffer_load_dwordx4 v57, s[60:63], s22 offen lds
    s_waitcnt vmcnt(16)
    s_waitcnt lgkmcnt(0)
    s_barrier
    ds_read_b64_tr_b16 v[128:129], v58 offset:0
    ds_read_b64_tr_b16 v[130:131], v58 offset:1024
    ds_read_b64_tr_b16 v[132:133], v58 offset:32768
    ds_read_b64_tr_b16 v[134:135], v58 offset:33792
    ds_read_b64_tr_b16 v[136:137], v59 offset:0
    ds_read_b64_tr_b16 v[138:139], v59 offset:1024
    ds_read_b64_tr_b16 v[140:141], v59 offset:32768
    ds_read_b64_tr_b16 v[142:143], v59 offset:33792
    s_add_u32 m0, s25, 20480
    s_add_u32 s22, s30, 2621440
    buffer_load_dwordx4 v57, s[60:63], s22 offen lds
    s_add_u32 m0, s25, 21504
    s_add_u32 s22, s30, 2654208
    buffer_load_dwordx4 v57, s[60:63], s22 offen lds
    s_add_u32 m0, s25, 22528
    s_add_u32 s22, s30, 2686976
    buffer_load_dwordx4 v57, s[60:63], s22 offen lds
    s_add_u32 m0, s25, 23552
    s_add_u32 s22, s30, 2719744
    buffer_load_dwordx4 v57, s[60:63], s22 offen lds
    s_waitcnt vmcnt(16)
    s_waitcnt lgkmcnt(0)
    s_barrier
    ds_read_b64_tr_b16 v[144:145], v58 offset:4096
    ds_read_b64_tr_b16 v[146:147], v58 offset:5120
    ds_read_b64_tr_b16 v[148:149], v58 offset:36864
    ds_read_b64_tr_b16 v[150:151], v58 offset:37888
    ds_read_b64_tr_b16 v[152:153], v59 offset:4096
    ds_read_b64_tr_b16 v[154:155], v59 offset:5120
    ds_read_b64_tr_b16 v[156:157], v59 offset:36864
    ds_read_b64_tr_b16 v[158:159], v59 offset:37888
    s_add_u32 m0, s25, 24576
    s_add_u32 s22, s30, 3145728
    buffer_load_dwordx4 v57, s[60:63], s22 offen lds
    s_add_u32 m0, s25, 25600
    s_add_u32 s22, s30, 3178496
    buffer_load_dwordx4 v57, s[60:63], s22 offen lds
    s_add_u32 m0, s25, 26624
    s_add_u32 s22, s30, 3211264
    buffer_load_dwordx4 v57, s[60:63], s22 offen lds
    s_add_u32 m0, s25, 27648
    s_add_u32 s22, s30, 3244032
    buffer_load_dwordx4 v57, s[60:63], s22 offen lds
    s_waitcnt vmcnt(16)
    s_waitcnt lgkmcnt(0)
    s_barrier
    ds_read_b64_tr_b16 v[160:161], v58 offset:8192
    ds_read_b64_tr_b16 v[162:163], v58 offset:9216
    ds_read_b64_tr_b16 v[164:165], v58 offset:40960
    ds_read_b64_tr_b16 v[166:167], v58 offset:41984
    ds_read_b64_tr_b16 v[168:169], v59 offset:8192
    ds_read_b64_tr_b16 v[170:171], v59 offset:9216
    ds_read_b64_tr_b16 v[172:173], v59 offset:40960
    ds_read_b64_tr_b16 v[174:175], v59 offset:41984
    s_add_u32 m0, s25, 28672
    s_add_u32 s22, s30, 3670016
    buffer_load_dwordx4 v57, s[60:63], s22 offen lds
    s_add_u32 m0, s25, 29696
    s_add_u32 s22, s30, 3702784
    buffer_load_dwordx4 v57, s[60:63], s22 offen lds
    s_add_u32 m0, s25, 30720
    s_add_u32 s22, s30, 3735552
    buffer_load_dwordx4 v57, s[60:63], s22 offen lds
    s_add_u32 m0, s25, 31744
    s_add_u32 s22, s30, 3768320
    buffer_load_dwordx4 v57, s[60:63], s22 offen lds
    s_waitcnt vmcnt(16)
    s_waitcnt lgkmcnt(0)
    s_barrier
    ds_read_b64_tr_b16 v[176:177], v58 offset:12288
    ds_read_b64_tr_b16 v[178:179], v58 offset:13312
    ds_read_b64_tr_b16 v[180:181], v58 offset:45056
    ds_read_b64_tr_b16 v[182:183], v58 offset:46080
    ds_read_b64_tr_b16 v[184:185], v59 offset:12288
    ds_read_b64_tr_b16 v[186:187], v59 offset:13312
    ds_read_b64_tr_b16 v[188:189], v59 offset:45056
    ds_read_b64_tr_b16 v[190:191], v59 offset:46080
    s_waitcnt vmcnt(12)
    s_waitcnt lgkmcnt(0)
    s_barrier
    ds_read_b64_tr_b16 v[192:193], v58 offset:16384
    ds_read_b64_tr_b16 v[194:195], v58 offset:17408
    ds_read_b64_tr_b16 v[196:197], v58 offset:49152
    ds_read_b64_tr_b16 v[198:199], v58 offset:50176
    ds_read_b64_tr_b16 v[200:201], v59 offset:16384
    ds_read_b64_tr_b16 v[202:203], v59 offset:17408
    ds_read_b64_tr_b16 v[204:205], v59 offset:49152
    ds_read_b64_tr_b16 v[206:207], v59 offset:50176
    s_waitcnt vmcnt(8)
    s_waitcnt lgkmcnt(0)
    s_barrier
    ds_read_b64_tr_b16 v[208:209], v58 offset:20480
    ds_read_b64_tr_b16 v[210:211], v58 offset:21504
    ds_read_b64_tr_b16 v[212:213], v58 offset:53248
    ds_read_b64_tr_b16 v[214:215], v58 offset:54272
    ds_read_b64_tr_b16 v[216:217], v59 offset:20480
    ds_read_b64_tr_b16 v[218:219], v59 offset:21504
    ds_read_b64_tr_b16 v[220:221], v59 offset:53248
    ds_read_b64_tr_b16 v[222:223], v59 offset:54272
    s_waitcnt vmcnt(4)
    s_waitcnt lgkmcnt(0)
    s_barrier
    ds_read_b64_tr_b16 v[224:225], v58 offset:24576
    ds_read_b64_tr_b16 v[226:227], v58 offset:25600
    ds_read_b64_tr_b16 v[228:229], v58 offset:57344
    ds_read_b64_tr_b16 v[230:231], v58 offset:58368
    ds_read_b64_tr_b16 v[232:233], v59 offset:24576
    ds_read_b64_tr_b16 v[234:235], v59 offset:25600
    ds_read_b64_tr_b16 v[236:237], v59 offset:57344
    ds_read_b64_tr_b16 v[238:239], v59 offset:58368
    s_waitcnt vmcnt(0)
    s_waitcnt lgkmcnt(0)
    s_barrier
    ds_read_b64_tr_b16 v[240:241], v58 offset:28672
    ds_read_b64_tr_b16 v[242:243], v58 offset:29696
    ds_read_b64_tr_b16 v[244:245], v58 offset:61440
    ds_read_b64_tr_b16 v[246:247], v58 offset:62464
    ds_read_b64_tr_b16 v[248:249], v59 offset:28672
    ds_read_b64_tr_b16 v[250:251], v59 offset:29696
    ds_read_b64_tr_b16 v[252:253], v59 offset:61440
    ds_read_b64_tr_b16 v[254:255], v59 offset:62464
    s_waitcnt lgkmcnt(0)
    s_barrier
    s_mov_b32 s20, s19
    s_mov_b32 s29, 64
    s_mov_b32 s26, 0
    s_mov_b32 s27, -1
    s_bitcmp1_b64 s[48:49], s20
    s_cbranch_scc1 Wkv_l0_ok
Wkv_l0_poll:
    s_mov_b64 exec, 1
    global_load_dwordx2 v[10:11], v9, s[6:7] offset:128 sc1
    s_mov_b64 exec, -1
    s_waitcnt vmcnt(0)
    v_readfirstlane_b32 s48, v10
    v_readfirstlane_b32 s49, v11
    s_nop 3
    s_bitcmp1_b64 s[48:49], s20
    s_cbranch_scc1 Wkv_l0_ok
    s_add_u32 s21, s21, 1
    s_cmp_lt_u32 s21, 400000
    s_cbranch_scc1 Wkv_l0_poll
Wkv_l0_ok:
    s_lshl_b32 s57, s20, 15
    s_lshl_b32 s58, s17, 13
    s_add_u32 s57, s57, s58
    s_add_u32 s57, s57, 54525952
    s_add_u32 s58, s58, s26
    s_add_u32 s22, s16, 0
    s_and_b32 s22, s22, 7
    s_lshl_b32 s22, s22, 10
    s_add_u32 m0, s58, s22
    s_add_u32 s22, s57, s22
    buffer_load_dwordx4 v1, s[8:11], s22 offen sc1 lds
    s_add_u32 s22, s16, 1
    s_and_b32 s22, s22, 7
    s_lshl_b32 s22, s22, 10
    s_add_u32 m0, s58, s22
    s_add_u32 s22, s57, s22
    buffer_load_dwordx4 v1, s[8:11], s22 offen sc1 lds
    s_add_u32 s22, s16, 2
    s_and_b32 s22, s22, 7
    s_lshl_b32 s22, s22, 10
    s_add_u32 m0, s58, s22
    s_add_u32 s22, s57, s22
    buffer_load_dwordx4 v1, s[8:11], s22 offen sc1 lds
    s_add_u32 s22, s16, 3
    s_and_b32 s22, s22, 7
    s_lshl_b32 s22, s22, 10
    s_add_u32 m0, s58, s22
    s_add_u32 s22, s57, s22
    buffer_load_dwordx4 v1, s[8:11], s22 offen sc1 lds
    s_add_u32 s22, s16, 4
    s_and_b32 s22, s22, 7
    s_lshl_b32 s22, s22, 10
    s_add_u32 m0, s58, s22
    s_add_u32 s22, s57, s22
    buffer_load_dwordx4 v1, s[8:11], s22 offen sc1 lds
    s_add_u32 s22, s16, 5
    s_and_b32 s22, s22, 7
    s_lshl_b32 s22, s22, 10
    s_add_u32 m0, s58, s22
    s_add_u32 s22, s57, s22
    buffer_load_dwordx4 v1, s[8:11], s22 offen sc1 lds
    s_add_u32 s22, s16, 6
    s_and_b32 s22, s22, 7
    s_lshl_b32 s22, s22, 10
    s_add_u32 m0, s58, s22
    s_add_u32 s22, s57, s22
    buffer_load_dwordx4 v1, s[8:11], s22 offen sc1 lds
    s_add_u32 s22, s16, 7
    s_and_b32 s22, s22, 7
    s_lshl_b32 s22, s22, 10
    s_add_u32 m0, s58, s22
    s_add_u32 s22, s57, s22
    buffer_load_dwordx4 v1, s[8:11], s22 offen sc1 lds
    s_waitcnt vmcnt(0)
    s_barrier
Wkv_top:
    s_add_u32 s30, s20, 6
    s_cmp_ge_u32 s30, s29
    s_cbranch_scc1 Wkv_nn
    s_bitcmp1_b64 s[48:49], s30
    s_cbranch_scc1 Wkv_l1_ok
Wkv_l1_poll:
    s_mov_b64 exec, 1
    global_load_dwordx2 v[10:11], v9, s[6:7] offset:128 sc1
    s_mov_b64 exec, -1
    s_waitcnt vmcnt(0)
    v_readfirstlane_b32 s48, v10
    v_readfirstlane_b32 s49, v11
    s_nop 3
    s_bitcmp1_b64 s[48:49], s30
    s_cbranch_scc1 Wkv_l1_ok
    s_add_u32 s21, s21, 1
    s_cmp_lt_u32 s21, 400000
    s_cbranch_scc1 Wkv_l1_poll
Wkv_l1_ok:
    s_xor_b32 s31, s26, 32768
    s_lshl_b32 s57, s30, 15
    s_lshl_b32 s58, s17, 13
    s_add_u32 s57, s57, s58
    s_add_u32 s57, s57, 54525952
    s_add_u32 s58, s58, s31
    s_add_u32 s22, s16, 0
    s_and_b32 s22, s22, 7
    s_lshl_b32 s22, s22, 10
    s_add_u32 m0, s58, s22
    s_add_u32 s22, s57, s22
    buffer_load_dwordx4 v1, s[8:11], s22 offen sc1 lds
    s_add_u32 s22, s16, 1
    s_and_b32 s22, s22, 7
    s_lshl_b32 s22, s22, 10
    s_add_u32 m0, s58, s22
    s_add_u32 s22, s57, s22
    buffer_load_dwordx4 v1, s[8:11], s22 offen sc1 lds
    s_add_u32 s22, s16, 2
    s_and_b32 s22, s22, 7
    s_lshl_b32 s22, s22, 10
    s_add_u32 m0, s58, s22
    s_add_u32 s22, s57, s22
    buffer_load_dwordx4 v1, s[8:11], s22 offen sc1 lds
    s_add_u32 s22, s16, 3
    s_and_b32 s22, s22, 7
    s_lshl_b32 s22, s22, 10
    s_add_u32 m0, s58, s22
    s_add_u32 s22, s57, s22
    buffer_load_dwordx4 v1, s[8:11], s22 offen sc1 lds
    s_add_u32 s22, s16, 4
    s_and_b32 s22, s22, 7
    s_lshl_b32 s22, s22, 10
    s_add_u32 m0, s58, s22
    s_add_u32 s22, s57, s22
    buffer_load_dwordx4 v1, s[8:11], s22 offen sc1 lds
    s_add_u32 s22, s16, 5
    s_and_b32 s22, s22, 7
    s_lshl_b32 s22, s22, 10
    s_add_u32 m0, s58, s22
    s_add_u32 s22, s57, s22
    buffer_load_dwordx4 v1, s[8:11], s22 offen sc1 lds
    s_add_u32 s22, s16, 6
    s_and_b32 s22, s22, 7
    s_lshl_b32 s22, s22, 10
    s_add_u32 m0, s58, s22
    s_add_u32 s22, s57, s22
    buffer_load_dwordx4 v1, s[8:11], s22 offen sc1 lds
    s_add_u32 s22, s16, 7
    s_and_b32 s22, s22, 7
    s_lshl_b32 s22, s22, 10
    s_add_u32 m0, s58, s22
    s_add_u32 s22, s57, s22
    buffer_load_dwordx4 v1, s[8:11], s22 offen sc1 lds
Wkv_nn:
    v_add_u32 v12, s26, v1
    ds_read_b128 v[48:51], v12 offset:0
    ds_read_b128 v[52:55], v12 offset:1024
    ds_read_b128 v[56:59], v12 offset:2048
    ds_read_b128 v[60:63], v12 offset:3072
    ds_read_b128 v[64:67], v12 offset:4096
    ds_read_b128 v[68:71], v12 offset:5120
    s_waitcnt lgkmcnt(5)
    v_mfma_f32_32x32x16_bf16 v[16:31], a[0:3], v[48:51], 0
    ds_read_b128 v[72:75], v12 offset:6144
    v_mfma_f32_32x32x16_bf16 v[32:47], v[48:51], a[128:131], 0
    v_mfma_f32_32x32x16_bf16 v[80:95], v[128:131], v[48:51], 0
    s_waitcnt lgkmcnt(5)
    v_mfma_f32_32x32x16_bf16 v[16:31], a[4:7], v[52:55], v[16:31]
    ds_read_b128 v[76:79], v12 offset:7168
    v_mfma_f32_32x32x16_bf16 v[32:47], v[52:55], a[132:135], v[32:47]
    v_mfma_f32_32x32x16_bf16 v[80:95], v[132:135], v[52:55], v[80:95]
    s_waitcnt lgkmcnt(5)
    v_mfma_f32_32x32x16_bf16 v[16:31], a[8:11], v[56:59], v[16:31]
    ds_read_b128 v[48:51], v12 offset:8192
    v_mfma_f32_32x32x16_bf16 v[32:47], v[56:59], a[136:139], v[32:47]
    v_mfma_f32_32x32x16_bf16 v[80:95], v[136:139], v[56:59], v[80:95]
    s_waitcnt lgkmcnt(5)
    v_mfma_f32_32x32x16_bf16 v[16:31], a[12:15], v[60:63], v[16:31]
    ds_read_b128 v[52:55], v12 offset:9216
    v_mfma_f32_32x32x16_bf16 v[32:47], v[60:63], a[140:143], v[32:47]
    v_mfma_f32_32x32x16_bf16 v[80:95], v[140:143], v[60:63], v[80:95]
    s_waitcnt lgkmcnt(5)
    v_mfma_f32_32x32x16_bf16 v[16:31], a[16:19], v[64:67], v[16:31]
    ds_read_b128 v[56:59], v12 offset:10240
    v_mfma_f32_32x32x16_bf16 v[32:47], v[64:67], a[144:147], v[32:47]
    v_mfma_f32_32x32x16_bf16 v[80:95], v[144:147], v[64:67], v[80:95]
    s_waitcnt lgkmcnt(5)
    v_mfma_f32_32x32x16_bf16 v[16:31], a[20:23], v[68:71], v[16:31]
    ds_read_b128 v[60:63], v12 offset:11264
    v_mfma_f32_32x32x16_bf16 v[32:47], v[68:71], a[148:151], v[32:47]
    v_mfma_f32_32x32x16_bf16 v[80:95], v[148:151], v[68:71], v[80:95]
    s_waitcnt lgkmcnt(5)
    v_mfma_f32_32x32x16_bf16 v[16:31], a[24:27], v[72:75], v[16:31]
    ds_read_b128 v[64:67], v12 offset:12288
    v_mfma_f32_32x32x16_bf16 v[32:47], v[72:75], a[152:155], v[32:47]
    v_mfma_f32_32x32x16_bf16 v[80:95], v[152:155], v[72:75], v[80:95]
    s_waitcnt lgkmcnt(5)
    v_mfma_f32_32x32x16_bf16 v[16:31], a[28:31], v[76:79], v[16:31]
    ds_read_b128 v[68:71], v12 offset:13312
    v_mfma_f32_32x32x16_bf16 v[32:47], v[76:79], a[156:159], v[32:47]
    v_mfma_f32_32x32x16_bf16 v[80:95], v[156:159], v[76:79], v[80:95]
    s_waitcnt lgkmcnt(5)
    v_mfma_f32_32x32x16_bf16 v[16:31], a[32:35], v[48:51], v[16:31]
    ds_read_b128 v[72:75], v12 offset:14336
    v_mfma_f32_32x32x16_bf16 v[32:47], v[48:51], a[160:163], v[32:47]
    v_mfma_f32_32x32x16_bf16 v[80:95], v[160:163], v[48:51], v[80:95]
    s_waitcnt lgkmcnt(5)
    v_mfma_f32_32x32x16_bf16 v[16:31], a[36:39], v[52:55], v[16:31]
    ds_read_b128 v[76:79], v12 offset:15360
    v_mfma_f32_32x32x16_bf16 v[32:47], v[52:55], a[164:167], v[32:47]
    v_mfma_f32_32x32x16_bf16 v[80:95], v[164:167], v[52:55], v[80:95]
    s_waitcnt lgkmcnt(5)
    v_mfma_f32_32x32x16_bf16 v[16:31], a[40:43], v[56:59], v[16:31]
    ds_read_b128 v[48:51], v12 offset:16384
    v_mfma_f32_32x32x16_bf16 v[32:47], v[56:59], a[168:171], v[32:47]
    v_mfma_f32_32x32x16_bf16 v[80:95], v[168:171], v[56:59], v[80:95]
    s_waitcnt lgkmcnt(5)
    v_mfma_f32_32x32x16_bf16 v[16:31], a[44:47], v[60:63], v[16:31]
    ds_read_b128 v[52:55], v12 offset:17408
    v_mfma_f32_32x32x16_bf16 v[32:47], v[60:63], a[172:175], v[32:47]
    v_mfma_f32_32x32x16_bf16 v[80:95], v[172:175], v[60:63], v[80:95]
    s_waitcnt lgkmcnt(5)
    v_mfma_f32_32x32x16_bf16 v[16:31], a[48:51], v[64:67], v[16:31]
    ds_read_b128 v[56:59], v12 offset:18432
    v_mfma_f32_32x32x16_bf16 v[32:47], v[64:67], a[176:179], v[32:47]
    v_mfma_f32_32x32x16_bf16 v[80:95], v[176:179], v[64:67], v[80:95]
    s_waitcnt lgkmcnt(5)
    v_mfma_f32_32x32x16_bf16 v[16:31], a[52:55], v[68:71], v[16:31]
    ds_read_b128 v[60:63], v12 offset:19456
    v_mfma_f32_32x32x16_bf16 v[32:47], v[68:71], a[180:183], v[32:47]
    v_mfma_f32_32x32x16_bf16 v[80:95], v[180:183], v[68:71], v[80:95]
    s_waitcnt lgkmcnt(5)
    v_mfma_f32_32x32x16_bf16 v[16:31], a[56:59], v[72:75], v[16:31]
    ds_read_b128 v[64:67], v12 offset:20480
    v_mfma_f32_32x32x16_bf16 v[32:47], v[72:75], a[184:187], v[32:47]
    v_mfma_f32_32x32x16_bf16 v[80:95], v[184:187], v[72:75], v[80:95]
    s_waitcnt lgkmcnt(5)
    v_mfma_f32_32x32x16_bf16 v[16:31], a[60:63], v[76:79], v[16:31]
    ds_read_b128 v[68:71], v12 offset:21504
    v_mfma_f32_32x32x16_bf16 v[32:47], v[76:79], a[188:191], v[32:47]
    v_mfma_f32_32x32x16_bf16 v[80:95], v[188:191], v[76:79], v[80:95]
    s_waitcnt lgkmcnt(5)
    v_mfma_f32_32x32x16_bf16 v[16:31], a[64:67], v[48:51], v[16:31]
    ds_read_b128 v[72:75], v12 offset:22528
    v_mfma_f32_32x32x16_bf16 v[32:47], v[48:51], a[192:195], v[32:47]
    v_mfma_f32_32x32x16_bf16 v[80:95], v[192:195], v[48:51], v[80:95]
    s_waitcnt lgkmcnt(5)
    v_mfma_f32_32x32x16_bf16 v[16:31], a[68:71], v[52:55], v[16:31]
    ds_read_b128 v[76:79], v12 offset:23552
    v_mfma_f32_32x32x16_bf16 v[32:47], v[52:55], a[196:199], v[32:47]
    v_mfma_f32_32x32x16_bf16 v[80:95], v[196:199], v[52:55], v[80:95]
    s_waitcnt lgkmcnt(5)
    v_mfma_f32_32x32x16_bf16 v[16:31], a[72:75], v[56:59], v[16:31]
    ds_read_b128 v[48:51], v12 offset:24576
    v_mfma_f32_32x32x16_bf16 v[32:47], v[56:59], a[200:203], v[32:47]
    v_mfma_f32_32x32x16_bf16 v[80:95], v[200:203], v[56:59], v[80:95]
    s_waitcnt lgkmcnt(5)
    v_mfma_f32_32x32x16_bf16 v[16:31], a[76:79], v[60:63], v[16:31]
    ds_read_b128 v[52:55], v12 offset:25600
    v_mfma_f32_32x32x16_bf16 v[32:47], v[60:63], a[204:207], v[32:47]
    v_mfma_f32_32x32x16_bf16 v[80:95], v[204:207], v[60:63], v[80:95]
    s_waitcnt lgkmcnt(5)
    v_mfma_f32_32x32x16_bf16 v[16:31], a[80:83], v[64:67], v[16:31]
    ds_read_b128 v[56:59], v12 offset:26624
    v_mfma_f32_32x32x16_bf16 v[32:47], v[64:67], a[208:211], v[32:47]
    v_mfma_f32_32x32x16_bf16 v[80:95], v[208:211], v[64:67], v[80:95]
    s_waitcnt lgkmcnt(5)
    v_mfma_f32_32x32x16_bf16 v[16:31], a[84:87], v[68:71], v[16:31]
    ds_read_b128 v[60:63], v12 offset:27648
    v_mfma_f32_32x32x16_bf16 v[32:47], v[68:71], a[212:215], v[32:47]
    v_mfma_f32_32x32x16_bf16 v[80:95], v[212:215], v[68:71], v[80:95]
    s_waitcnt lgkmcnt(5)
    v_mfma_f32_32x32x16_bf16 v[16:31], a[88:91], v[72:75], v[16:31]
    ds_read_b128 v[64:67], v12 offset:28672
    v_mfma_f32_32x32x16_bf16 v[32:47], v[72:75], a[216:219], v[32:47]
    v_mfma_f32_32x32x16_bf16 v[80:95], v[216:219], v[72:75], v[80:95]
    s_waitcnt lgkmcnt(5)
    v_mfma_f32_32x32x16_bf16 v[16:31], a[92:95], v[76:79], v[16:31]
    ds_read_b128 v[68:71], v12 offset:29696
    v_mfma_f32_32x32x16_bf16 v[32:47], v[76:79], a[220:223], v[32:47]
    v_mfma_f32_32x32x16_bf16 v[80:95], v[220:223], v[76:79], v[80:95]
    s_waitcnt lgkmcnt(5)
    v_mfma_f32_32x32x16_bf16 v[16:31], a[96:99], v[48:51], v[16:31]
    ds_read_b128 v[72:75], v12 offset:30720
    v_mfma_f32_32x32x16_bf16 v[32:47], v[48:51], a[224:227], v[32:47]
    v_mfma_f32_32x32x16_bf16 v[80:95], v[224:227], v[48:51], v[80:95]
    s_waitcnt lgkmcnt(5)
    v_mfma_f32_32x32x16_bf16 v[16:31], a[100:103], v[52:55], v[16:31]
    ds_read_b128 v[76:79], v12 offset:31744
    v_mfma_f32_32x32x16_bf16 v[32:47], v[52:55], a[228:231], v[32:47]
    v_mfma_f32_32x32x16_bf16 v[80:95], v[228:231], v[52:55], v[80:95]
    s_waitcnt lgkmcnt(5)
    v_mfma_f32_32x32x16_bf16 v[16:31], a[104:107], v[56:59], v[16:31]
    v_mfma_f32_32x32x16_bf16 v[32:47], v[56:59], a[232:235], v[32:47]
    v_mfma_f32_32x32x16_bf16 v[80:95], v[232:235], v[56:59], v[80:95]
    s_waitcnt lgkmcnt(4)
    v_mfma_f32_32x32x16_bf16 v[16:31], a[108:111], v[60:63], v[16:31]
    v_mfma_f32_32x32x16_bf16 v[32:47], v[60:63], a[236:239], v[32:47]
    v_mfma_f32_32x32x16_bf16 v[80:95], v[236:239], v[60:63], v[80:95]
    s_waitcnt lgkmcnt(3)
    v_mfma_f32_32x32x16_bf16 v[16:31], a[112:115], v[64:67], v[16:31]
    v_mfma_f32_32x32x16_bf16 v[32:47], v[64:67], a[240:243], v[32:47]
    v_mfma_f32_32x32x16_bf16 v[80:95], v[240:243], v[64:67], v[80:95]
    s_waitcnt lgkmcnt(2)
    v_mfma_f32_32x32x16_bf16 v[16:31], a[116:119], v[68:71], v[16:31]
    v_mfma_f32_32x32x16_bf16 v[32:47], v[68:71], a[244:247], v[32:47]
    v_mfma_f32_32x32x16_bf16 v[80:95], v[244:247], v[68:71], v[80:95]
    s_waitcnt lgkmcnt(1)
    v_mfma_f32_32x32x16_bf16 v[16:31], a[120:123], v[72:75], v[16:31]
    v_mfma_f32_32x32x16_bf16 v[32:47], v[72:75], a[248:251], v[32:47]
    v_mfma_f32_32x32x16_bf16 v[80:95], v[248:251], v[72:75], v[80:95]
    s_waitcnt lgkmcnt(0)
    v_mfma_f32_32x32x16_bf16 v[16:31], a[124:127], v[76:79], v[16:31]
    v_mfma_f32_32x32x16_bf16 v[32:47], v[76:79], a[252:255], v[32:47]
    v_mfma_f32_32x32x16_bf16 v[80:95], v[252:255], v[76:79], v[80:95]
    s_waitcnt vmcnt(0)
    s_barrier
    s_lshr_b32 s22, s27, 31
    s_or_b32 s22, s22, s17
    s_cbranch_scc1 Wf_10
    s_lshl_b32 s22, s27, 12
    s_lshl_b32 s23, s18, 7
    s_add_u32 s22, s22, s23
    s_add_u32 s22, s22, 58720260
    v_mov_b32 v10, 1
    s_mov_b64 exec, 1
    buffer_store_dword v10, off, s[8:11], s22 sc1
    s_mov_b64 exec, -1
Wf_10:
    s_lshl_b32 s22, s20, 19
    s_lshl_b32 s23, s18, 14
    s_add_u32 s22, s22, s23
    s_add_u32 s22, s22, 4096
    s_lshl_b32 s23, s17, 12
    s_add_u32 s24, s22, s23
    v_cvt_pk_bf16_f32 v16, v16, v17
    v_cvt_pk_bf16_f32 v17, v18, v19
    v_cvt_pk_bf16_f32 v18, v20, v21
    v_cvt_pk_bf16_f32 v19, v22, v23
    v_cvt_pk_bf16_f32 v20, v24, v25
    v_cvt_pk_bf16_f32 v21, v26, v27
    v_cvt_pk_bf16_f32 v22, v28, v29
    v_cvt_pk_bf16_f32 v23, v30, v31
    s_mov_b32 vcc_lo, 0x33333333
    s_mov_b32 vcc_hi, 0x33333333
    v_cndmask_b32_dpp v24, v20, v16, vcc quad_perm:[2,3,0,1] row_mask:0xf bank_mask:0xf
    v_cndmask_b32_dpp v25, v21, v17, vcc quad_perm:[2,3,0,1] row_mask:0xf bank_mask:0xf
    v_cndmask_b32_dpp v26, v22, v18, vcc quad_perm:[2,3,0,1] row_mask:0xf bank_mask:0xf
    v_cndmask_b32_dpp v27, v23, v19, vcc quad_perm:[2,3,0,1] row_mask:0xf bank_mask:0xf
    buffer_store_dwordx4 v[24:27], v6, s[8:11], s24 offen offset:0 sc1
    s_mov_b32 vcc_lo, 0xcccccccc
    s_mov_b32 vcc_hi, 0xcccccccc
    v_cndmask_b32_dpp v28, v16, v20, vcc quad_perm:[2,3,0,1] row_mask:0xf bank_mask:0xf
    v_cndmask_b32_dpp v29, v17, v21, vcc quad_perm:[2,3,0,1] row_mask:0xf bank_mask:0xf
    v_cndmask_b32_dpp v30, v18, v22, vcc quad_perm:[2,3,0,1] row_mask:0xf bank_mask:0xf
    v_cndmask_b32_dpp v31, v19, v23, vcc quad_perm:[2,3,0,1] row_mask:0xf bank_mask:0xf
    buffer_store_dwordx4 v[28:31], v6, s[8:11], s24 offen offset:64 sc1
    v_cvt_pk_bf16_f32 v32, v32, v33
    v_cvt_pk_bf16_f32 v33, v34, v35
    v_cvt_pk_bf16_f32 v34, v36, v37
    v_cvt_pk_bf16_f32 v35, v38, v39
    v_cvt_pk_bf16_f32 v36, v40, v41
    v_cvt_pk_bf16_f32 v37, v42, v43
    v_cvt_pk_bf16_f32 v38, v44, v45
    v_cvt_pk_bf16_f32 v39, v46, v47
    buffer_store_dwordx4 v[32:35], v1, s[8:11], s24 offen offset:2048 sc1
    buffer_store_dwordx4 v[36:39], v1, s[8:11], s24 offen offset:3072 sc1
    v_mul_f32 v80, 0x3e0293ee, v80
    v_mul_f32 v81, 0x3e0293ee, v81
    v_mul_f32 v82, 0x3e0293ee, v82
    v_mul_f32 v83, 0x3e0293ee, v83
    v_mul_f32 v84, 0x3e0293ee, v84
    v_mul_f32 v85, 0x3e0293ee, v85
    v_mul_f32 v86, 0x3e0293ee, v86
    v_mul_f32 v87, 0x3e0293ee, v87
    v_mul_f32 v88, 0x3e0293ee, v88
    v_mul_f32 v89, 0x3e0293ee, v89
    v_mul_f32 v90, 0x3e0293ee, v90
    v_mul_f32 v91, 0x3e0293ee, v91
    v_mul_f32 v92, 0x3e0293ee, v92
    v_mul_f32 v93, 0x3e0293ee, v93
    v_mul_f32 v94, 0x3e0293ee, v94
    v_mul_f32 v95, 0x3e0293ee, v95
    v_cvt_pk_bf16_f32 v80, v80, v81
    v_cvt_pk_bf16_f32 v81, v82, v83
    v_cvt_pk_bf16_f32 v82, v84, v85
    v_cvt_pk_bf16_f32 v83, v86, v87
    v_cvt_pk_bf16_f32 v84, v88, v89
    v_cvt_pk_bf16_f32 v85, v90, v91
    v_cvt_pk_bf16_f32 v86, v92, v93
    v_cvt_pk_bf16_f32 v87, v94, v95
    s_sub_u32 s24, s24, 4096
    s_lshr_b32 s24, s24, 1
    s_add_u32 s24, s24, 134217728
    buffer_store_dwordx4 v[80:83], v1, s[8:11], s24 offen offset:0 sc1
    buffer_store_dwordx4 v[84:87], v1, s[8:11], s24 offen offset:1024 sc1
    s_cmp_ge_u32 s20, 6
    s_cbranch_scc1 Wkv_n1
    s_mov_b32 s27, s20
    s_waitcnt vmcnt(0)
    s_barrier
    s_lshr_b32 s22, s27, 31
    s_or_b32 s22, s22, s17
    s_cbranch_scc1 Wf_11
    s_lshl_b32 s22, s27, 12
    s_lshl_b32 s23, s18, 7
    s_add_u32 s22, s22, s23
    s_add_u32 s22, s22, 58720260
    v_mov_b32 v10, 1
    s_mov_b64 exec, 1
    buffer_store_dword v10, off, s[8:11], s22 sc1
    s_mov_b64 exec, -1
Wf_11:
Wkv_n1:
    s_mov_b32 s27, s20
    s_xor_b32 s26, s26, 32768
    s_add_u32 s20, s20, 6
    s_cmp_lt_u32 s20, s29
    s_cbranch_scc1 Wkv_top
    s_waitcnt vmcnt(0)
    s_barrier
    s_lshr_b32 s22, s27, 31
    s_or_b32 s22, s22, s17
    s_cbranch_scc1 Wf_12
    s_lshl_b32 s22, s27, 12
    s_lshl_b32 s23, s18, 7
    s_add_u32 s22, s22, s23
    s_add_u32 s22, s22, 58720260
    v_mov_b32 v10, 1
    s_mov_b64 exec, 1
    buffer_store_dword v10, off, s[8:11], s22 sc1
    s_mov_b64 exec, -1
Wf_12:
    s_mov_b64 exec, 1
Wall:
    global_load_dwordx2 v[10:11], v9, s[6:7] offset:64 sc1
    global_load_dwordx2 v[12:13], v9, s[6:7] offset:128 sc1
    s_waitcnt vmcnt(1)
    v_and_b32 v10, v10, v11
    s_waitcnt vmcnt(0)
    v_and_b32 v10, v10, v12
    v_and_b32 v10, v10, v13
    v_cmp_ne_u32 vcc, -1, v10
    s_cbranch_vccz Wall_ok
    s_add_u32 s21, s21, 1
    s_cmp_lt_u32 s21, 400000
    s_cbranch_scc1 Wall
Wall_ok:
    s_mov_b64 exec, -1
    s_mov_b64 s[48:49], -1
    s_cmp_lt_u32 s19, 5
    s_cbranch_scc1 Wmlp
    s_mov_b32 s19, 15
    v_mov_b32 v15, 0
    v_bfe_u32 v10, v0, 5, 1
    v_lshl_add_u32 v15, v10, 11, v15
    v_bfe_u32 v10, v0, 1, 1
    v_lshl_add_u32 v15, v10, 10, v15
    v_bfe_u32 v10, v0, 4, 1
    v_lshl_add_u32 v15, v10, 9, v15
    v_bfe_u32 v10, v0, 2, 2
    v_lshl_add_u32 v15, v10, 5, v15
    v_bfe_u32 v10, v0, 0, 1
    v_lshl_add_u32 v15, v10, 4, v15
    s_lshl_b32 s22, s17, 7
    v_add_u32 v15, s22, v15
    s_mov_b32 s20, 0
    s_mov_b32 s26, 0
Whp_top:
    s_lshl_b32 s22, s20, 2
    s_add_u32 s22, s22, s17
    s_max_u32 s22, s22, 1
    s_sub_u32 s22, s22, 1
    s_min_u32 s22, s22, 61
    s_lshl_b32 s22, s22, 13
    s_add_u32 s22, s22, 60817408
    s_lshl_b32 s23, s18, 6
    s_add_u32 s23, s23, s22
    s_add_u32 s23, s23, 6144
    s_add_u32 s24, s22, 4096
    s_mov_b64 exec, 1
Whp_ka:
    v_mov_b32 v10, 0
    buffer_atomic_or v10, off, s[8:11], s23 sc0
    s_waitcnt vmcnt(0)
    v_cmp_eq_u32 vcc, -1, v10
    s_cbranch_vccz Whp_ka_ok
    s_add_u32 s21, s21, 1
    s_cmp_lt_u32 s21, 400000
    s_cbranch_scc1 Whp_ka
Whp_ka_ok:
    s_mov_b64 exec, -1
Whp_ld:
    buffer_load_dwordx4 v[112:115], v1, s[8:11], s22 offen offset:0 sc1
    buffer_load_dwordx4 v[116:119], v1, s[8:11], s22 offen offset:1024 sc1
    buffer_load_dwordx4 v[120:123], v1, s[8:11], s22 offen offset:2048 sc1
    buffer_load_dwordx4 v[124:127], v1, s[8:11], s22 offen offset:3072 sc1
    buffer_load_dwordx4 v[128:131], v1, s[8:11], s24 offen offset:0 sc1
    buffer_load_dwordx4 v[132:135], v1, s[8:11], s24 offen offset:1024 sc1
    buffer_load_dwordx4 v[136:139], v1, s[8:11], s24 offen offset:2048 sc1
    buffer_load_dwordx4 v[140:143], v1, s[8:11], s24 offen offset:3072 sc1
    v_mov_b32 v10, 0
    s_waitcnt vmcnt(7)
    ds_write_b128 v15, v[112:115] offset:0
    v_max3_u32 v10, v10, v112, v113
    v_max3_u32 v10, v10, v114, v115
    s_waitcnt vmcnt(6)
    ds_write_b128 v15, v[116:119] offset:4096
    v_max3_u32 v10, v10, v116, v117
    v_max3_u32 v10, v10, v118, v119
    s_waitcnt vmcnt(5)
    ds_write_b128 v15, v[120:123] offset:8192
    v_max3_u32 v10, v10, v120, v121
    v_max3_u32 v10, v10, v122, v123
    s_waitcnt vmcnt(4)
    ds_write_b128 v15, v[124:127] offset:12288
    v_max3_u32 v10, v10, v124, v125
    v_max3_u32 v10, v10, v126, v127
    s_waitcnt vmcnt(3)
    ds_write_b128 v15, v[128:131] offset:16384
    v_max3_u32 v10, v10, v128, v129
    v_max3_u32 v10, v10, v130, v131
    s_waitcnt vmcnt(2)
    ds_write_b128 v15, v[132:135] offset:20480
    v_max3_u32 v10, v10, v132, v133
    v_max3_u32 v10, v10, v134, v135
    s_waitcnt vmcnt(1)
    ds_write_b128 v15, v[136:139] offset:24576
    v_max3_u32 v10, v10, v136, v137
    v_max3_u32 v10, v10, v138, v139
    s_waitcnt vmcnt(0)
    ds_write_b128 v15, v[140:143] offset:28672
    v_max3_u32 v10, v10, v140, v141
    v_max3_u32 v10, v10, v142, v143
    v_cmp_eq_u32 vcc, -1, v10
    s_cbranch_vccz Whp_ok
    s_add_u32 s21, s21, 1
    s_cmp_lt_u32 s21, 400000
    s_cbranch_scc1 Whp_ld
Whp_ok:
    s_waitcnt lgkmcnt(0)
    s_barrier
    v_add_u32 v12, s26, v1
    ds_read_b128 v[48:51], v12 offset:0
    ds_read_b128 v[52:55], v12 offset:1024
    ds_read_b128 v[56:59], v12 offset:2048
    ds_read_b128 v[60:63], v12 offset:3072
    ds_read_b128 v[64:67], v12 offset:4096
    ds_read_b128 v[68:71], v12 offset:5120
    s_waitcnt lgkmcnt(5)
    v_mfma_f32_32x32x16_bf16 v[16:31], a[0:3], v[48:51], 0
    ds_read_b128 v[72:75], v12 offset:6144
    v_mfma_f32_32x32x16_bf16 v[32:47], v[48:51], a[128:131], 0
    s_waitcnt lgkmcnt(5)
    v_mfma_f32_32x32x16_bf16 v[16:31], a[4:7], v[52:55], v[16:31]
    ds_read_b128 v[76:79], v12 offset:7168
    v_mfma_f32_32x32x16_bf16 v[32:47], v[52:55], a[132:135], v[32:47]
    s_waitcnt lgkmcnt(5)
    v_mfma_f32_32x32x16_bf16 v[16:31], a[8:11], v[56:59], v[16:31]
    ds_read_b128 v[48:51], v12 offset:8192
    v_mfma_f32_32x32x16_bf16 v[32:47], v[56:59], a[136:139], v[32:47]
    s_waitcnt lgkmcnt(5)
    v_mfma_f32_32x32x16_bf16 v[16:31], a[12:15], v[60:63], v[16:31]
    ds_read_b128 v[52:55], v12 offset:9216
    v_mfma_f32_32x32x16_bf16 v[32:47], v[60:63], a[140:143], v[32:47]
    s_waitcnt lgkmcnt(5)
    v_mfma_f32_32x32x16_bf16 v[16:31], a[16:19], v[64:67], v[16:31]
    ds_read_b128 v[56:59], v12 offset:10240
    v_mfma_f32_32x32x16_bf16 v[32:47], v[64:67], a[144:147], v[32:47]
    s_waitcnt lgkmcnt(5)
    v_mfma_f32_32x32x16_bf16 v[16:31], a[20:23], v[68:71], v[16:31]
    ds_read_b128 v[60:63], v12 offset:11264
    v_mfma_f32_32x32x16_bf16 v[32:47], v[68:71], a[148:151], v[32:47]
    s_waitcnt lgkmcnt(5)
    v_mfma_f32_32x32x16_bf16 v[16:31], a[24:27], v[72:75], v[16:31]
    ds_read_b128 v[64:67], v12 offset:12288
    v_mfma_f32_32x32x16_bf16 v[32:47], v[72:75], a[152:155], v[32:47]
    s_waitcnt lgkmcnt(5)
    v_mfma_f32_32x32x16_bf16 v[16:31], a[28:31], v[76:79], v[16:31]
    ds_read_b128 v[68:71], v12 offset:13312
    v_mfma_f32_32x32x16_bf16 v[32:47], v[76:79], a[156:159], v[32:47]
    s_waitcnt lgkmcnt(5)
    v_mfma_f32_32x32x16_bf16 v[16:31], a[32:35], v[48:51], v[16:31]
    ds_read_b128 v[72:75], v12 offset:14336
    v_mfma_f32_32x32x16_bf16 v[32:47], v[48:51], a[160:163], v[32:47]
    s_waitcnt lgkmcnt(5)
    v_mfma_f32_32x32x16_bf16 v[16:31], a[36:39], v[52:55], v[16:31]
    ds_read_b128 v[76:79], v12 offset:15360
    v_mfma_f32_32x32x16_bf16 v[32:47], v[52:55], a[164:167], v[32:47]
    s_waitcnt lgkmcnt(5)
    v_mfma_f32_32x32x16_bf16 v[16:31], a[40:43], v[56:59], v[16:31]
    ds_read_b128 v[48:51], v12 offset:16384
    v_mfma_f32_32x32x16_bf16 v[32:47], v[56:59], a[168:171], v[32:47]
    s_waitcnt lgkmcnt(5)
    v_mfma_f32_32x32x16_bf16 v[16:31], a[44:47], v[60:63], v[16:31]
    ds_read_b128 v[52:55], v12 offset:17408
    v_mfma_f32_32x32x16_bf16 v[32:47], v[60:63], a[172:175], v[32:47]
    s_waitcnt lgkmcnt(5)
    v_mfma_f32_32x32x16_bf16 v[16:31], a[48:51], v[64:67], v[16:31]
    ds_read_b128 v[56:59], v12 offset:18432
    v_mfma_f32_32x32x16_bf16 v[32:47], v[64:67], a[176:179], v[32:47]
    s_waitcnt lgkmcnt(5)
    v_mfma_f32_32x32x16_bf16 v[16:31], a[52:55], v[68:71], v[16:31]
    ds_read_b128 v[60:63], v12 offset:19456
    v_mfma_f32_32x32x16_bf16 v[32:47], v[68:71], a[180:183], v[32:47]
    s_waitcnt lgkmcnt(5)
    v_mfma_f32_32x32x16_bf16 v[16:31], a[56:59], v[72:75], v[16:31]
    ds_read_b128 v[64:67], v12 offset:20480
    v_mfma_f32_32x32x16_bf16 v[32:47], v[72:75], a[184:187], v[32:47]
    s_waitcnt lgkmcnt(5)
    v_mfma_f32_32x32x16_bf16 v[16:31], a[60:63], v[76:79], v[16:31]
    ds_read_b128 v[68:71], v12 offset:21504
    v_mfma_f32_32x32x16_bf16 v[32:47], v[76:79], a[188:191], v[32:47]
    s_waitcnt lgkmcnt(5)
    v_mfma_f32_32x32x16_bf16 v[16:31], a[64:67], v[48:51], v[16:31]
    ds_read_b128 v[72:75], v12 offset:22528
    v_mfma_f32_32x32x16_bf16 v[32:47], v[48:51], a[192:195], v[32:47]
    s_waitcnt lgkmcnt(5)
    v_mfma_f32_32x32x16_bf16 v[16:31], a[68:71], v[52:55], v[16:31]
    ds_read_b128 v[76:79], v12 offset:23552
    v_mfma_f32_32x32x16_bf16 v[32:47], v[52:55], a[196:199], v[32:47]
    s_waitcnt lgkmcnt(5)
    v_mfma_f32_32x32x16_bf16 v[16:31], a[72:75], v[56:59], v[16:31]
    ds_read_b128 v[48:51], v12 offset:24576
    v_mfma_f32_32x32x16_bf16 v[32:47], v[56:59], a[200:203], v[32:47]
    s_waitcnt lgkmcnt(5)
    v_mfma_f32_32x32x16_bf16 v[16:31], a[76:79], v[60:63], v[16:31]
    ds_read_b128 v[52:55], v12 offset:25600
    v_mfma_f32_32x32x16_bf16 v[32:47], v[60:63], a[204:207], v[32:47]
    s_waitcnt lgkmcnt(5)
    v_mfma_f32_32x32x16_bf16 v[16:31], a[80:83], v[64:67], v[16:31]
    ds_read_b128 v[56:59], v12 offset:26624
    v_mfma_f32_32x32x16_bf16 v[32:47], v[64:67], a[208:211], v[32:47]
    s_waitcnt lgkmcnt(5)
    v_mfma_f32_32x32x16_bf16 v[16:31], a[84:87], v[68:71], v[16:31]
    ds_read_b128 v[60:63], v12 offset:27648
    v_mfma_f32_32x32x16_bf16 v[32:47], v[68:71], a[212:215], v[32:47]
    s_waitcnt lgkmcnt(5)
    v_mfma_f32_32x32x16_bf16 v[16:31], a[88:91], v[72:75], v[16:31]
    ds_read_b128 v[64:67], v12 offset:28672
    v_mfma_f32_32x32x16_bf16 v[32:47], v[72:75], a[216:219], v[32:47]
    s_waitcnt lgkmcnt(5)
    v_mfma_f32_32x32x16_bf16 v[16:31], a[92:95], v[76:79], v[16:31]
    ds_read_b128 v[68:71], v12 offset:29696
    v_mfma_f32_32x32x16_bf16 v[32:47], v[76:79], a[220:223], v[32:47]
    s_waitcnt lgkmcnt(5)
    v_mfma_f32_32x32x16_bf16 v[16:31], a[96:99], v[48:51], v[16:31]
    ds_read_b128 v[72:75], v12 offset:30720
    v_mfma_f32_32x32x16_bf16 v[32:47], v[48:51], a[224:227], v[32:47]
    s_waitcnt lgkmcnt(5)
    v_mfma_f32_32x32x16_bf16 v[16:31], a[100:103], v[52:55], v[16:31]
    ds_read_b128 v[76:79], v12 offset:31744
    v_mfma_f32_32x32x16_bf16 v[32:47], v[52:55], a[228:231], v[32:47]
    s_waitcnt lgkmcnt(5)
    v_mfma_f32_32x32x16_bf16 v[16:31], a[104:107], v[56:59], v[16:31]
    v_mfma_f32_32x32x16_bf16 v[32:47], v[56:59], a[232:235], v[32:47]
    s_waitcnt lgkmcnt(4)
    v_mfma_f32_32x32x16_bf16 v[16:31], a[108:111], v[60:63], v[16:31]
    v_mfma_f32_32x32x16_bf16 v[32:47], v[60:63], a[236:239], v[32:47]
    s_waitcnt lgkmcnt(3)
    v_mfma_f32_32x32x16_bf16 v[16:31], a[112:115], v[64:67], v[16:31]
    v_mfma_f32_32x32x16_bf16 v[32:47], v[64:67], a[240:243], v[32:47]
    s_waitcnt lgkmcnt(2)
    v_mfma_f32_32x32x16_bf16 v[16:31], a[116:119], v[68:71], v[16:31]
    v_mfma_f32_32x32x16_bf16 v[32:47], v[68:71], a[244:247], v[32:47]
    s_waitcnt lgkmcnt(1)
    v_mfma_f32_32x32x16_bf16 v[16:31], a[120:123], v[72:75], v[16:31]
    v_mfma_f32_32x32x16_bf16 v[32:47], v[72:75], a[248:251], v[32:47]
    s_waitcnt lgkmcnt(0)
    v_mfma_f32_32x32x16_bf16 v[16:31], a[124:127], v[76:79], v[16:31]
    s_nop 4
    v_mfma_f32_32x32x16_bf16 v[32:47], v[76:79], a[252:255], v[32:47]
    s_lshl_b32 s22, s20, 19
    s_lshl_b32 s23, s18, 14
    s_add_u32 s22, s22, s23
    s_add_u32 s22, s22, 34603008
    s_lshl_b32 s23, s17, 12
    s_add_u32 s24, s22, s23
    v_cvt_pk_bf16_f32 v16, v16, v17
    v_cvt_pk_bf16_f32 v17, v18, v19
    v_cvt_pk_bf16_f32 v18, v20, v21
    v_cvt_pk_bf16_f32 v19, v22, v23
    v_cvt_pk_bf16_f32 v20, v24, v25
    v_cvt_pk_bf16_f32 v21, v26, v27
    v_cvt_pk_bf16_f32 v22, v28, v29
    v_cvt_pk_bf16_f32 v23, v30, v31
    buffer_store_dwordx4 v[16:19], v1, s[8:11], s24 offen offset:0 sc1
    buffer_store_dwordx4 v[20:23], v1, s[8:11], s24 offen offset:1024 sc1
    v_cvt_pk_bf16_f32 v32, v32, v33
    v_cvt_pk_bf16_f32 v33, v34, v35
    v_cvt_pk_bf16_f32 v34, v36, v37
    v_cvt_pk_bf16_f32 v35, v38, v39
    v_cvt_pk_bf16_f32 v36, v40, v41
    v_cvt_pk_bf16_f32 v37, v42, v43
    v_cvt_pk_bf16_f32 v38, v44, v45
    v_cvt_pk_bf16_f32 v39, v46, v47
    buffer_store_dwordx4 v[32:35], v1, s[8:11], s24 offen offset:2048 sc1
    buffer_store_dwordx4 v[36:39], v1, s[8:11], s24 offen offset:3072 sc1
    s_mov_b32 s27, s20
    s_waitcnt vmcnt(0)
    s_barrier
    s_lshr_b32 s22, s27, 31
    s_or_b32 s22, s22, s17
    s_cbranch_scc1 Wf_13
    s_lshl_b32 s22, s27, 12
    s_lshl_b32 s23, s18, 7
    s_add_u32 s22, s22, s23
    s_add_u32 s22, s22, 58720264
    v_mov_b32 v10, 1
    s_mov_b64 exec, 1
    buffer_store_dword v10, off, s[8:11], s22 sc1
    s_mov_b64 exec, -1
Wf_13:
    s_add_u32 s20, s20, 1
    s_cmp_lt_u32 s20, 16
    s_cbranch_scc1 Whp_top
    s_branch Wend
Wmlp:
    s_load_dwordx2 s[32:33], s[0:1], 64
    s_mov_b32 s34, 1835008
    s_mov_b32 s35, 0x20000
    s_load_dwordx2 s[36:37], s[0:1], 80
    s_mov_b32 s38, 1835008
    s_mov_b32 s39, 0x20000
    s_load_dwordx2 s[4:5], s[0:1], 72
    s_sub_u32 s22, s16, s18
    s_mul_i32 s28, s22, 5958
    s_lshr_b32 s28, s28, 16
    s_mul_i32 s23, s28, 11
    s_sub_u32 s22, s22, s23
    s_mul_i32 s20, s22, 6
    s_add_u32 s29, s20, 6
    s_min_u32 s29, s29, 64
    s_waitcnt lgkmcnt(0)
    s_cmp_ge_u32 s28, 14
    s_cbranch_scc1 Watt
    s_lshl_b32 s30, s28, 8
    s_lshl_b32 s22, s17, 6
    s_add_u32 s22, s30, s22
    v_lshrrev_b32 v10, 5, v0
    v_lshl_add_u32 v13, v10, 3, s22
    s_lshl_b32 s31, s28, 17
    s_lshl_b32 s22, s17, 8
    s_add_u32 s31, s31, s22
    global_load_dwordx2 v[16:17], v13, s[4:5] offset:0
    global_load_dwordx2 v[18:19], v13, s[4:5] offset:16
    global_load_dwordx2 v[20:21], v13, s[4:5] offset:32
    global_load_dwordx2 v[22:23], v13, s[4:5] offset:48
    v_lshrrev_b32 v11, 4, v0
    v_lshlrev_b32 v12, 2, v11
    v_xor_b32 v12, v12, v0
    v_and_b32 v12, 15, v12
    v_mul_u32_u24 v55, 3584, v11
    v_lshl_add_u32 v55, v12, 4, v55
    s_mul_i32 s22, s17, 57344
    v_add_u32 v55, s22, v55
    v_mul_u32_u24 v56, 1024, v11
    v_lshl_add_u32 v56, v12, 4, v56
    s_barrier
    s_add_u32 m0, s25, 0
    s_add_u32 s22, s30, 0
    buffer_load_dwordx4 v55, s[32:35], s22 offen lds
    s_add_u32 m0, s25, 1024
    s_add_u32 s22, s30, 14336
    buffer_load_dwordx4 v55, s[32:35], s22 offen lds
    s_add_u32 m0, s25, 2048
    s_add_u32 s22, s30, 28672
    buffer_load_dwordx4 v55, s[32:35], s22 offen lds
    s_add_u32 m0, s25, 3072
    s_add_u32 s22, s30, 43008
    buffer_load_dwordx4 v55, s[32:35], s22 offen lds
    s_add_u32 m0, s25, 4096
    s_add_u32 s22, s30, 229376
    buffer_load_dwordx4 v55, s[32:35], s22 offen lds
    s_add_u32 m0, s25, 5120
    s_add_u32 s22, s30, 243712
    buffer_load_dwordx4 v55, s[32:35], s22 offen lds
    s_add_u32 m0, s25, 6144
    s_add_u32 s22, s30, 258048
    buffer_load_dwordx4 v55, s[32:35], s22 offen lds
    s_add_u32 m0, s25, 7168
    s_add_u32 s22, s30, 272384
    buffer_load_dwordx4 v55, s[32:35], s22 offen lds
    s_add_u32 m0, s25, 8192
    s_add_u32 s22, s30, 458752
    buffer_load_dwordx4 v55, s[32:35], s22 offen lds
    s_add_u32 m0, s25, 9216
    s_add_u32 s22, s30, 473088
    buffer_load_dwordx4 v55, s[32:35], s22 offen lds
    s_add_u32 m0, s25, 10240
    s_add_u32 s22, s30, 487424
    buffer_load_dwordx4 v55, s[32:35], s22 offen lds
    s_add_u32 m0, s25, 11264
    s_add_u32 s22, s30, 501760
    buffer_load_dwordx4 v55, s[32:35], s22 offen lds
    s_add_u32 m0, s25, 12288
    s_add_u32 s22, s30, 688128
    buffer_load_dwordx4 v55, s[32:35], s22 offen lds
    s_add_u32 m0, s25, 13312
    s_add_u32 s22, s30, 702464
    buffer_load_dwordx4 v55, s[32:35], s22 offen lds
    s_add_u32 m0, s25, 14336
    s_add_u32 s22, s30, 716800
    buffer_load_dwordx4 v55, s[32:35], s22 offen lds
    s_add_u32 m0, s25, 15360
    s_add_u32 s22, s30, 731136
    buffer_load_dwordx4 v55, s[32:35], s22 offen lds
    s_add_u32 m0, s25, 16384
    s_add_u32 s22, s30, 917504
    buffer_load_dwordx4 v55, s[32:35], s22 offen lds
    s_add_u32 m0, s25, 17408
    s_add_u32 s22, s30, 931840
    buffer_load_dwordx4 v55, s[32:35], s22 offen lds
    s_add_u32 m0, s25, 18432
    s_add_u32 s22, s30, 946176
    buffer_load_dwordx4 v55, s[32:35], s22 offen lds
    s_add_u32 m0, s25, 19456
    s_add_u32 s22, s30, 960512
    buffer_load_dwordx4 v55, s[32:35], s22 offen lds
    v_mov_b32 v60, 0
    v_bfe_u32 v10, v0, 5, 1
    v_lshl_add_u32 v60, v10, 11, v60
    v_bfe_u32 v10, v0, 2, 2
    v_lshl_add_u32 v60, v10, 8, v60
    v_bfe_u32 v10, v0, 2, 2
    v_lshl_add_u32 v60, v10, 6, v60
    v_bfe_u32 v10, v0, 4, 1
    v_lshl_add_u32 v60, v10, 5, v60
    v_bfe_u32 v10, v0, 0, 2
    v_lshl_add_u32 v60, v10, 3, v60
    s_lshl_b32 s22, s17, 6
    v_xor_b32 v58, s22, v60
    v_add_u32 v59, 65536, v58
    v_add_u32 v60, s25, v60
    v_xor_b32 v61, 64, v60
    v_xor_b32 v62, 128, v60
    v_xor_b32 v63, 192, v60
    s_waitcnt vmcnt(16)
    s_waitcnt lgkmcnt(0)
    s_barrier
    ds_read_b64_tr_b16 a[0:1], v58 offset:0
    ds_read_b64_tr_b16 a[2:3], v58 offset:1024
    ds_read_b64_tr_b16 a[4:5], v58 offset:32768
    ds_read_b64_tr_b16 a[6:7], v58 offset:33792
    ds_read_b64_tr_b16 a[8:9], v59 offset:0
    ds_read_b64_tr_b16 a[10:11], v59 offset:1024
    ds_read_b64_tr_b16 a[12:13], v59 offset:32768
    ds_read_b64_tr_b16 a[14:15], v59 offset:33792
    s_add_u32 m0, s25, 20480
    s_add_u32 s22, s30, 1146880
    buffer_load_dwordx4 v55, s[32:35], s22 offen lds
    s_add_u32 m0, s25, 21504
    s_add_u32 s22, s30, 1161216
    buffer_load_dwordx4 v55, s[32:35], s22 offen lds
    s_add_u32 m0, s25, 22528
    s_add_u32 s22, s30, 1175552
    buffer_load_dwordx4 v55, s[32:35], s22 offen lds
    s_add_u32 m0, s25, 23552
    s_add_u32 s22, s30, 1189888
    buffer_load_dwordx4 v55, s[32:35], s22 offen lds
    s_waitcnt vmcnt(16)
    s_waitcnt lgkmcnt(0)
    s_barrier
    ds_read_b64_tr_b16 a[16:17], v58 offset:4096
    ds_read_b64_tr_b16 a[18:19], v58 offset:5120
    ds_read_b64_tr_b16 a[20:21], v58 offset:36864
    ds_read_b64_tr_b16 a[22:23], v58 offset:37888
    ds_read_b64_tr_b16 a[24:25], v59 offset:4096
    ds_read_b64_tr_b16 a[26:27], v59 offset:5120
    ds_read_b64_tr_b16 a[28:29], v59 offset:36864
    ds_read_b64_tr_b16 a[30:31], v59 offset:37888
    s_add_u32 m0, s25, 24576
    s_add_u32 s22, s30, 1376256
    buffer_load_dwordx4 v55, s[32:35], s22 offen lds
    s_add_u32 m0, s25, 25600
    s_add_u32 s22, s30, 1390592
    buffer_load_dwordx4 v55, s[32:35], s22 offen lds
    s_add_u32 m0, s25, 26624
    s_add_u32 s22, s30, 1404928
    buffer_load_dwordx4 v55, s[32:35], s22 offen lds
    s_add_u32 m0, s25, 27648
    s_add_u32 s22, s30, 1419264
    buffer_load_dwordx4 v55, s[32:35], s22 offen lds
    s_waitcnt vmcnt(16)
    s_waitcnt lgkmcnt(0)
    s_barrier
    ds_read_b64_tr_b16 a[32:33], v58 offset:8192
    ds_read_b64_tr_b16 a[34:35], v58 offset:9216
    ds_read_b64_tr_b16 a[36:37], v58 offset:40960
    ds_read_b64_tr_b16 a[38:39], v58 offset:41984
    ds_read_b64_tr_b16 a[40:41], v59 offset:8192
    ds_read_b64_tr_b16 a[42:43], v59 offset:9216
    ds_read_b64_tr_b16 a[44:45], v59 offset:40960
    ds_read_b64_tr_b16 a[46:47], v59 offset:41984
    s_add_u32 m0, s25, 28672
    s_add_u32 s22, s30, 1605632
    buffer_load_dwordx4 v55, s[32:35], s22 offen lds
    s_add_u32 m0, s25, 29696
    s_add_u32 s22, s30, 1619968
    buffer_load_dwordx4 v55, s[32:35], s22 offen lds
    s_add_u32 m0, s25, 30720
    s_add_u32 s22, s30, 1634304
    buffer_load_dwordx4 v55, s[32:35], s22 offen lds
    s_add_u32 m0, s25, 31744
    s_add_u32 s22, s30, 1648640
    buffer_load_dwordx4 v55, s[32:35], s22 offen lds
    s_waitcnt vmcnt(16)
    s_waitcnt lgkmcnt(0)
    s_barrier
    ds_read_b64_tr_b16 a[48:49], v58 offset:12288
    ds_read_b64_tr_b16 a[50:51], v58 offset:13312
    ds_read_b64_tr_b16 a[52:53], v58 offset:45056
    ds_read_b64_tr_b16 a[54:55], v58 offset:46080
    ds_read_b64_tr_b16 a[56:57], v59 offset:12288
    ds_read_b64_tr_b16 a[58:59], v59 offset:13312
    ds_read_b64_tr_b16 a[60:61], v59 offset:45056
    ds_read_b64_tr_b16 a[62:63], v59 offset:46080
    s_add_u32 m0, s25, 0
    s_add_u32 s22, s31, 0
    buffer_load_dwordx4 v56, s[36:39], s22 offen lds
    s_add_u32 m0, s25, 1024
    s_add_u32 s22, s31, 8192
    buffer_load_dwordx4 v56, s[36:39], s22 offen lds
    s_add_u32 m0, s25, 2048
    s_add_u32 s22, s31, 4096
    buffer_load_dwordx4 v56, s[36:39], s22 offen lds
    s_add_u32 m0, s25, 3072
    s_add_u32 s22, s31, 12288
    buffer_load_dwordx4 v56, s[36:39], s22 offen lds
    s_waitcnt vmcnt(16)
    s_waitcnt lgkmcnt(0)
    s_barrier
    ds_read_b64_tr_b16 a[64:65], v58 offset:16384
    ds_read_b64_tr_b16 a[66:67], v58 offset:17408
    ds_read_b64_tr_b16 a[68:69], v58 offset:49152
    ds_read_b64_tr_b16 a[70:71], v58 offset:50176
    ds_read_b64_tr_b16 a[72:73], v59 offset:16384
    ds_read_b64_tr_b16 a[74:75], v59 offset:17408
    ds_read_b64_tr_b16 a[76:77], v59 offset:49152
    ds_read_b64_tr_b16 a[78:79], v59 offset:50176
    s_add_u32 m0, s25, 4096
    s_add_u32 s22, s31, 16384
    buffer_load_dwordx4 v56, s[36:39], s22 offen lds
    s_add_u32 m0, s25, 5120
    s_add_u32 s22, s31, 24576
    buffer_load_dwordx4 v56, s[36:39], s22 offen lds
    s_add_u32 m0, s25, 6144
    s_add_u32 s22, s31, 20480
    buffer_load_dwordx4 v56, s[36:39], s22 offen lds
    s_add_u32 m0, s25, 7168
    s_add_u32 s22, s31, 28672
    buffer_load_dwordx4 v56, s[36:39], s22 offen lds
    s_waitcnt vmcnt(16)
    s_waitcnt lgkmcnt(0)
    s_barrier
    ds_read_b64_tr_b16 a[80:81], v58 offset:20480
    ds_read_b64_tr_b16 a[82:83], v58 offset:21504
    ds_read_b64_tr_b16 a[84:85], v58 offset:53248
    ds_read_b64_tr_b16 a[86:87], v58 offset:54272
    ds_read_b64_tr_b16 a[88:89], v59 offset:20480
    ds_read_b64_tr_b16 a[90:91], v59 offset:21504
    ds_read_b64_tr_b16 a[92:93], v59 offset:53248
    ds_read_b64_tr_b16 a[94:95], v59 offset:54272
    s_add_u32 m0, s25, 8192
    s_add_u32 s22, s31, 32768
    buffer_load_dwordx4 v56, s[36:39], s22 offen lds
    s_add_u32 m0, s25, 9216
    s_add_u32 s22, s31, 40960
    buffer_load_dwordx4 v56, s[36:39], s22 offen lds
    s_add_u32 m0, s25, 10240
    s_add_u32 s22, s31, 36864
    buffer_load_dwordx4 v56, s[36:39], s22 offen lds
    s_add_u32 m0, s25, 11264
    s_add_u32 s22, s31, 45056
    buffer_load_dwordx4 v56, s[36:39], s22 offen lds
    s_waitcnt vmcnt(16)
    s_waitcnt lgkmcnt(0)
    s_barrier
    ds_read_b64_tr_b16 a[96:97], v58 offset:24576
    ds_read_b64_tr_b16 a[98:99], v58 offset:25600
    ds_read_b64_tr_b16 a[100:101], v58 offset:57344
    ds_read_b64_tr_b16 a[102:103], v58 offset:58368
    ds_read_b64_tr_b16 a[104:105], v59 offset:24576
    ds_read_b64_tr_b16 a[106:107], v59 offset:25600
    ds_read_b64_tr_b16 a[108:109], v59 offset:57344
    ds_read_b64_tr_b16 a[110:111], v59 offset:58368
    s_add_u32 m0, s25, 12288
    s_add_u32 s22, s31, 49152
    buffer_load_dwordx4 v56, s[36:39], s22 offen lds
    s_add_u32 m0, s25, 13312
    s_add_u32 s22, s31, 57344
    buffer_load_dwordx4 v56, s[36:39], s22 offen lds
    s_add_u32 m0, s25, 14336
    s_add_u32 s22, s31, 53248
    buffer_load_dwordx4 v56, s[36:39], s22 offen lds
    s_add_u32 m0, s25, 15360
    s_add_u32 s22, s31, 61440
    buffer_load_dwordx4 v56, s[36:39], s22 offen lds
    s_waitcnt vmcnt(16)
    s_waitcnt lgkmcnt(0)
    s_barrier
    ds_read_b64_tr_b16 a[112:113], v58 offset:28672
    ds_read_b64_tr_b16 a[114:115], v58 offset:29696
    ds_read_b64_tr_b16 a[116:117], v58 offset:61440
    ds_read_b64_tr_b16 a[118:119], v58 offset:62464
    ds_read_b64_tr_b16 a[120:121], v59 offset:28672
    ds_read_b64_tr_b16 a[122:123], v59 offset:29696
    ds_read_b64_tr_b16 a[124:125], v59 offset:61440
    ds_read_b64_tr_b16 a[126:127], v59 offset:62464
    s_add_u32 m0, s25, 16384
    s_add_u32 s22, s31, 65536
    buffer_load_dwordx4 v56, s[36:39], s22 offen lds
    s_add_u32 m0, s25, 17408
    s_add_u32 s22, s31, 73728
    buffer_load_dwordx4 v56, s[36:39], s22 offen lds
    s_add_u32 m0, s25, 18432
    s_add_u32 s22, s31, 69632
    buffer_load_dwordx4 v56, s[36:39], s22 offen lds
    s_add_u32 m0, s25, 19456
    s_add_u32 s22, s31, 77824
    buffer_load_dwordx4 v56, s[36:39], s22 offen lds
    s_waitcnt vmcnt(16)
    s_waitcnt lgkmcnt(0)
    s_barrier
    ds_read_b64_tr_b16 a[128:129], v60 offset:0
    ds_read_b64_tr_b16 a[130:131], v60 offset:1024
    ds_read_b64_tr_b16 a[160:161], v61 offset:0
    ds_read_b64_tr_b16 a[162:163], v61 offset:1024
    ds_read_b64_tr_b16 a[192:193], v62 offset:0
    ds_read_b64_tr_b16 a[194:195], v62 offset:1024
    ds_read_b64_tr_b16 a[224:225], v63 offset:0
    ds_read_b64_tr_b16 a[226:227], v63 offset:1024
    s_add_u32 m0, s25, 20480
    s_add_u32 s22, s31, 81920
    buffer_load_dwordx4 v56, s[36:39], s22 offen lds
    s_add_u32 m0, s25, 21504
    s_add_u32 s22, s31, 90112
    buffer_load_dwordx4 v56, s[36:39], s22 offen lds
    s_add_u32 m0, s25, 22528
    s_add_u32 s22, s31, 86016
    buffer_load_dwordx4 v56, s[36:39], s22 offen lds
    s_add_u32 m0, s25, 23552
    s_add_u32 s22, s31, 94208
    buffer_load_dwordx4 v56, s[36:39], s22 offen lds
    s_waitcnt vmcnt(16)
    s_waitcnt lgkmcnt(0)
    s_barrier
    ds_read_b64_tr_b16 a[132:133], v60 offset:4096
    ds_read_b64_tr_b16 a[134:135], v60 offset:5120
    ds_read_b64_tr_b16 a[164:165], v61 offset:4096
    ds_read_b64_tr_b16 a[166:167], v61 offset:5120
    ds_read_b64_tr_b16 a[196:197], v62 offset:4096
    ds_read_b64_tr_b16 a[198:199], v62 offset:5120
    ds_read_b64_tr_b16 a[228:229], v63 offset:4096
    ds_read_b64_tr_b16 a[230:231], v63 offset:5120
    s_add_u32 m0, s25, 24576
    s_add_u32 s22, s31, 98304
    buffer_load_dwordx4 v56, s[36:39], s22 offen lds
    s_add_u32 m0, s25, 25600
    s_add_u32 s22, s31, 106496
    buffer_load_dwordx4 v56, s[36:39], s22 offen lds
    s_add_u32 m0, s25, 26624
    s_add_u32 s22, s31, 102400
    buffer_load_dwordx4 v56, s[36:39], s22 offen lds
    s_add_u32 m0, s25, 27648
    s_add_u32 s22, s31, 110592
    buffer_load_dwordx4 v56, s[36:39], s22 offen lds
    s_waitcnt vmcnt(16)
    s_waitcnt lgkmcnt(0)
    s_barrier
    ds_read_b64_tr_b16 a[136:137], v60 offset:8192
    ds_read_b64_tr_b16 a[138:139], v60 offset:9216
    ds_read_b64_tr_b16 a[168:169], v61 offset:8192
    ds_read_b64_tr_b16 a[170:171], v61 offset:9216
    ds_read_b64_tr_b16 a[200:201], v62 offset:8192
    ds_read_b64_tr_b16 a[202:203], v62 offset:9216
    ds_read_b64_tr_b16 a[232:233], v63 offset:8192
    ds_read_b64_tr_b16 a[234:235], v63 offset:9216
    s_add_u32 m0, s25, 28672
    s_add_u32 s22, s31, 114688
    buffer_load_dwordx4 v56, s[36:39], s22 offen lds
    s_add_u32 m0, s25, 29696
    s_add_u32 s22, s31, 122880
    buffer_load_dwordx4 v56, s[36:39], s22 offen lds
    s_add_u32 m0, s25, 30720
    s_add_u32 s22, s31, 118784
    buffer_load_dwordx4 v56, s[36:39], s22 offen lds
    s_add_u32 m0, s25, 31744
    s_add_u32 s22, s31, 126976
    buffer_load_dwordx4 v56, s[36:39], s22 offen lds
    s_waitcnt vmcnt(16)
    s_waitcnt lgkmcnt(0)
    s_barrier
    ds_read_b64_tr_b16 a[140:141], v60 offset:12288
    ds_read_b64_tr_b16 a[142:143], v60 offset:13312
    ds_read_b64_tr_b16 a[172:173], v61 offset:12288
    ds_read_b64_tr_b16 a[174:175], v61 offset:13312
    ds_read_b64_tr_b16 a[204:205], v62 offset:12288
    ds_read_b64_tr_b16 a[206:207], v62 offset:13312
    ds_read_b64_tr_b16 a[236:237], v63 offset:12288
    ds_read_b64_tr_b16 a[238:239], v63 offset:13312
    s_waitcnt vmcnt(12)
    s_waitcnt lgkmcnt(0)
    s_barrier
    ds_read_b64_tr_b16 a[144:145], v60 offset:16384
    ds_read_b64_tr_b16 a[146:147], v60 offset:17408
    ds_read_b64_tr_b16 a[176:177], v61 offset:16384
    ds_read_b64_tr_b16 a[178:179], v61 offset:17408
    ds_read_b64_tr_b16 a[208:209], v62 offset:16384
    ds_read_b64_tr_b16 a[210:211], v62 offset:17408
    ds_read_b64_tr_b16 a[240:241], v63 offset:16384
    ds_read_b64_tr_b16 a[242:243], v63 offset:17408
    s_waitcnt vmcnt(8)
    s_waitcnt lgkmcnt(0)
    s_barrier
    ds_read_b64_tr_b16 a[148:149], v60 offset:20480
    ds_read_b64_tr_b16 a[150:151], v60 offset:21504
    ds_read_b64_tr_b16 a[180:181], v61 offset:20480
    ds_read_b64_tr_b16 a[182:183], v61 offset:21504
    ds_read_b64_tr_b16 a[212:213], v62 offset:20480
    ds_read_b64_tr_b16 a[214:215], v62 offset:21504
    ds_read_b64_tr_b16 a[244:245], v63 offset:20480
    ds_read_b64_tr_b16 a[246:247], v63 offset:21504
    s_waitcnt vmcnt(4)
    s_waitcnt lgkmcnt(0)
    s_barrier
    ds_read_b64_tr_b16 a[152:153], v60 offset:24576
    ds_read_b64_tr_b16 a[154:155], v60 offset:25600
    ds_read_b64_tr_b16 a[184:185], v61 offset:24576
    ds_read_b64_tr_b16 a[186:187], v61 offset:25600
    ds_read_b64_tr_b16 a[216:217], v62 offset:24576
    ds_read_b64_tr_b16 a[218:219], v62 offset:25600
    ds_read_b64_tr_b16 a[248:249], v63 offset:24576
    ds_read_b64_tr_b16 a[250:251], v63 offset:25600
    s_waitcnt vmcnt(0)
    s_waitcnt lgkmcnt(0)
    s_barrier
    ds_read_b64_tr_b16 a[156:157], v60 offset:28672
    ds_read_b64_tr_b16 a[158:159], v60 offset:29696
    ds_read_b64_tr_b16 a[188:189], v61 offset:28672
    ds_read_b64_tr_b16 a[190:191], v61 offset:29696
    ds_read_b64_tr_b16 a[220:221], v62 offset:28672
    ds_read_b64_tr_b16 a[222:223], v62 offset:29696
    ds_read_b64_tr_b16 a[252:253], v63 offset:28672
    ds_read_b64_tr_b16 a[254:255], v63 offset:29696
    s_waitcnt lgkmcnt(0)
    s_barrier
    v_lshlrev_b32 v192, 16, v16
    v_and_b32 v193, 0xffff0000, v16
    v_lshlrev_b32 v194, 16, v17
    v_and_b32 v195, 0xffff0000, v17
    v_lshlrev_b32 v196, 16, v18
    v_and_b32 v197, 0xffff0000, v18
    v_lshlrev_b32 v198, 16, v19
    v_and_b32 v199, 0xffff0000, v19
    v_lshlrev_b32 v200, 16, v20
    v_and_b32 v201, 0xffff0000, v20
    v_lshlrev_b32 v202, 16, v21
    v_and_b32 v203, 0xffff0000, v21
    v_lshlrev_b32 v204, 16, v22
    v_and_b32 v205, 0xffff0000, v22
    v_lshlrev_b32 v206, 16, v23
    v_and_b32 v207, 0xffff0000, v23
    s_add_u32 s28, s28, 16
    s_mov_b32 s26, 0
    s_mov_b32 s27, -1
    s_bitcmp1_b64 s[48:49], s20
    s_cbranch_scc1 Wml_l0_ok
Wml_l0_poll:
    s_mov_b64 exec, 1
    global_load_dwordx2 v[10:11], v9, s[6:7] offset:128 sc1
    s_mov_b64 exec, -1
    s_waitcnt vmcnt(0)
    v_readfirstlane_b32 s48, v10
    v_readfirstlane_b32 s49, v11
    s_nop 3
    s_bitcmp1_b64 s[48:49], s20
    s_cbranch_scc1 Wml_l0_ok
    s_add_u32 s21, s21, 1
    s_cmp_lt_u32 s21, 400000
    s_cbranch_scc1 Wml_l0_poll
Wml_l0_ok:
    s_lshl_b32 s57, s20, 15
    s_lshl_b32 s58, s17, 13
    s_add_u32 s57, s57, s58
    s_add_u32 s57, s57, 56623104
    s_add_u32 s58, s58, s26
    s_add_u32 s22, s16, 0
    s_and_b32 s22, s22, 7
    s_lshl_b32 s22, s22, 10
    s_add_u32 m0, s58, s22
    s_add_u32 s22, s57, s22
    buffer_load_dwordx4 v1, s[8:11], s22 offen sc1 lds
    s_add_u32 s22, s16, 1
    s_and_b32 s22, s22, 7
    s_lshl_b32 s22, s22, 10
    s_add_u32 m0, s58, s22
    s_add_u32 s22, s57, s22
    buffer_load_dwordx4 v1, s[8:11], s22 offen sc1 lds
    s_add_u32 s22, s16, 2
    s_and_b32 s22, s22, 7
    s_lshl_b32 s22, s22, 10
    s_add_u32 m0, s58, s22
    s_add_u32 s22, s57, s22
    buffer_load_dwordx4 v1, s[8:11], s22 offen sc1 lds
    s_add_u32 s22, s16, 3
    s_and_b32 s22, s22, 7
    s_lshl_b32 s22, s22, 10
    s_add_u32 m0, s58, s22
    s_add_u32 s22, s57, s22
    buffer_load_dwordx4 v1, s[8:11], s22 offen sc1 lds
    s_add_u32 s22, s16, 4
    s_and_b32 s22, s22, 7
    s_lshl_b32 s22, s22, 10
    s_add_u32 m0, s58, s22
    s_add_u32 s22, s57, s22
    buffer_load_dwordx4 v1, s[8:11], s22 offen sc1 lds
    s_add_u32 s22, s16, 5
    s_and_b32 s22, s22, 7
    s_lshl_b32 s22, s22, 10
    s_add_u32 m0, s58, s22
    s_add_u32 s22, s57, s22
    buffer_load_dwordx4 v1, s[8:11], s22 offen sc1 lds
    s_add_u32 s22, s16, 6
    s_and_b32 s22, s22, 7
    s_lshl_b32 s22, s22, 10
    s_add_u32 m0, s58, s22
    s_add_u32 s22, s57, s22
    buffer_load_dwordx4 v1, s[8:11], s22 offen sc1 lds
    s_add_u32 s22, s16, 7
    s_and_b32 s22, s22, 7
    s_lshl_b32 s22, s22, 10
    s_add_u32 m0, s58, s22
    s_add_u32 s22, s57, s22
    buffer_load_dwordx4 v1, s[8:11], s22 offen sc1 lds
    s_waitcnt vmcnt(0)
    s_barrier
Wml_top:
    s_add_u32 s30, s20, 1
    s_cmp_ge_u32 s30, s29
    s_cbranch_scc1 Wml_nn
    s_bitcmp1_b64 s[48:49], s30
    s_cbranch_scc1 Wml_l1_ok
Wml_l1_poll:
    s_mov_b64 exec, 1
    global_load_dwordx2 v[10:11], v9, s[6:7] offset:128 sc1
    s_mov_b64 exec, -1
    s_waitcnt vmcnt(0)
    v_readfirstlane_b32 s48, v10
    v_readfirstlane_b32 s49, v11
    s_nop 3
    s_bitcmp1_b64 s[48:49], s30
    s_cbranch_scc1 Wml_l1_ok
    s_add_u32 s21, s21, 1
    s_cmp_lt_u32 s21, 400000
    s_cbranch_scc1 Wml_l1_poll
Wml_l1_ok:
    s_xor_b32 s31, s26, 32768
    s_lshl_b32 s57, s30, 15
    s_lshl_b32 s58, s17, 13
    s_add_u32 s57, s57, s58
    s_add_u32 s57, s57, 56623104
    s_add_u32 s58, s58, s31
    s_add_u32 s22, s16, 0
    s_and_b32 s22, s22, 7
    s_lshl_b32 s22, s22, 10
    s_add_u32 m0, s58, s22
    s_add_u32 s22, s57, s22
    buffer_load_dwordx4 v1, s[8:11], s22 offen sc1 lds
    s_add_u32 s22, s16, 1
    s_and_b32 s22, s22, 7
    s_lshl_b32 s22, s22, 10
    s_add_u32 m0, s58, s22
    s_add_u32 s22, s57, s22
    buffer_load_dwordx4 v1, s[8:11], s22 offen sc1 lds
    s_add_u32 s22, s16, 2
    s_and_b32 s22, s22, 7
    s_lshl_b32 s22, s22, 10
    s_add_u32 m0, s58, s22
    s_add_u32 s22, s57, s22
    buffer_load_dwordx4 v1, s[8:11], s22 offen sc1 lds
    s_add_u32 s22, s16, 3
    s_and_b32 s22, s22, 7
    s_lshl_b32 s22, s22, 10
    s_add_u32 m0, s58, s22
    s_add_u32 s22, s57, s22
    buffer_load_dwordx4 v1, s[8:11], s22 offen sc1 lds
    s_add_u32 s22, s16, 4
    s_and_b32 s22, s22, 7
    s_lshl_b32 s22, s22, 10
    s_add_u32 m0, s58, s22
    s_add_u32 s22, s57, s22
    buffer_load_dwordx4 v1, s[8:11], s22 offen sc1 lds
    s_add_u32 s22, s16, 5
    s_and_b32 s22, s22, 7
    s_lshl_b32 s22, s22, 10
    s_add_u32 m0, s58, s22
    s_add_u32 s22, s57, s22
    buffer_load_dwordx4 v1, s[8:11], s22 offen sc1 lds
    s_add_u32 s22, s16, 6
    s_and_b32 s22, s22, 7
    s_lshl_b32 s22, s22, 10
    s_add_u32 m0, s58, s22
    s_add_u32 s22, s57, s22
    buffer_load_dwordx4 v1, s[8:11], s22 offen sc1 lds
    s_add_u32 s22, s16, 7
    s_and_b32 s22, s22, 7
    s_lshl_b32 s22, s22, 10
    s_add_u32 m0, s58, s22
    s_add_u32 s22, s57, s22
    buffer_load_dwordx4 v1, s[8:11], s22 offen sc1 lds
Wml_nn:
    v_add_u32 v12, s26, v1
    ds_read_b128 v[48:51], v12 offset:0
    ds_read_b128 v[52:55], v12 offset:1024
    ds_read_b128 v[56:59], v12 offset:2048
    ds_read_b128 v[60:63], v12 offset:3072
    ds_read_b128 v[64:67], v12 offset:4096
    ds_read_b128 v[68:71], v12 offset:5120
    s_waitcnt lgkmcnt(5)
    v_mfma_f32_32x32x16_bf16 v[16:31], a[0:3], v[48:51], v[192:207]
    ds_read_b128 v[72:75], v12 offset:6144
    s_waitcnt lgkmcnt(5)
    v_mfma_f32_32x32x16_bf16 v[16:31], a[4:7], v[52:55], v[16:31]
    ds_read_b128 v[76:79], v12 offset:7168
    s_waitcnt lgkmcnt(5)
    v_mfma_f32_32x32x16_bf16 v[16:31], a[8:11], v[56:59], v[16:31]
    ds_read_b128 v[48:51], v12 offset:8192
    s_waitcnt lgkmcnt(5)
    v_mfma_f32_32x32x16_bf16 v[16:31], a[12:15], v[60:63], v[16:31]
    ds_read_b128 v[52:55], v12 offset:9216
    s_waitcnt lgkmcnt(5)
    v_mfma_f32_32x32x16_bf16 v[16:31], a[16:19], v[64:67], v[16:31]
    ds_read_b128 v[56:59], v12 offset:10240
    s_waitcnt lgkmcnt(5)
    v_mfma_f32_32x32x16_bf16 v[16:31], a[20:23], v[68:71], v[16:31]
    ds_read_b128 v[60:63], v12 offset:11264
    s_waitcnt lgkmcnt(5)
    v_mfma_f32_32x32x16_bf16 v[16:31], a[24:27], v[72:75], v[16:31]
    ds_read_b128 v[64:67], v12 offset:12288
    s_waitcnt lgkmcnt(5)
    v_mfma_f32_32x32x16_bf16 v[16:31], a[28:31], v[76:79], v[16:31]
    ds_read_b128 v[68:71], v12 offset:13312
    s_waitcnt lgkmcnt(5)
    v_mfma_f32_32x32x16_bf16 v[16:31], a[32:35], v[48:51], v[16:31]
    ds_read_b128 v[72:75], v12 offset:14336
    s_waitcnt lgkmcnt(5)
    v_mfma_f32_32x32x16_bf16 v[16:31], a[36:39], v[52:55], v[16:31]
    ds_read_b128 v[76:79], v12 offset:15360
    s_waitcnt lgkmcnt(5)
    v_mfma_f32_32x32x16_bf16 v[16:31], a[40:43], v[56:59], v[16:31]
    ds_read_b128 v[48:51], v12 offset:16384
    s_waitcnt lgkmcnt(5)
    v_mfma_f32_32x32x16_bf16 v[16:31], a[44:47], v[60:63], v[16:31]
    ds_read_b128 v[52:55], v12 offset:17408
    s_waitcnt lgkmcnt(5)
    v_mfma_f32_32x32x16_bf16 v[16:31], a[48:51], v[64:67], v[16:31]
    ds_read_b128 v[56:59], v12 offset:18432
    s_waitcnt lgkmcnt(5)
    v_mfma_f32_32x32x16_bf16 v[16:31], a[52:55], v[68:71], v[16:31]
    ds_read_b128 v[60:63], v12 offset:19456
    s_waitcnt lgkmcnt(5)
    v_mfma_f32_32x32x16_bf16 v[16:31], a[56:59], v[72:75], v[16:31]
    ds_read_b128 v[64:67], v12 offset:20480
    s_waitcnt lgkmcnt(5)
    v_mfma_f32_32x32x16_bf16 v[16:31], a[60:63], v[76:79], v[16:31]
    ds_read_b128 v[68:71], v12 offset:21504
    s_waitcnt lgkmcnt(5)
    v_mfma_f32_32x32x16_bf16 v[16:31], a[64:67], v[48:51], v[16:31]
    ds_read_b128 v[72:75], v12 offset:22528
    s_waitcnt lgkmcnt(5)
    v_mfma_f32_32x32x16_bf16 v[16:31], a[68:71], v[52:55], v[16:31]
    ds_read_b128 v[76:79], v12 offset:23552
    s_waitcnt lgkmcnt(5)
    v_mfma_f32_32x32x16_bf16 v[16:31], a[72:75], v[56:59], v[16:31]
    ds_read_b128 v[48:51], v12 offset:24576
    s_waitcnt lgkmcnt(5)
    v_mfma_f32_32x32x16_bf16 v[16:31], a[76:79], v[60:63], v[16:31]
    ds_read_b128 v[52:55], v12 offset:25600
    s_waitcnt lgkmcnt(5)
    v_mfma_f32_32x32x16_bf16 v[16:31], a[80:83], v[64:67], v[16:31]
    ds_read_b128 v[56:59], v12 offset:26624
    s_waitcnt lgkmcnt(5)
    v_mfma_f32_32x32x16_bf16 v[16:31], a[84:87], v[68:71], v[16:31]
    ds_read_b128 v[60:63], v12 offset:27648
    s_waitcnt lgkmcnt(5)
    v_mfma_f32_32x32x16_bf16 v[16:31], a[88:91], v[72:75], v[16:31]
    ds_read_b128 v[64:67], v12 offset:28672
    s_waitcnt lgkmcnt(5)
    v_mfma_f32_32x32x16_bf16 v[16:31], a[92:95], v[76:79], v[16:31]
    ds_read_b128 v[68:71], v12 offset:29696
    s_waitcnt lgkmcnt(5)
    v_mfma_f32_32x32x16_bf16 v[16:31], a[96:99], v[48:51], v[16:31]
    ds_read_b128 v[72:75], v12 offset:30720
    s_waitcnt lgkmcnt(5)
    v_mfma_f32_32x32x16_bf16 v[16:31], a[100:103], v[52:55], v[16:31]
    ds_read_b128 v[76:79], v12 offset:31744
    s_waitcnt lgkmcnt(5)
    v_mfma_f32_32x32x16_bf16 v[16:31], a[104:107], v[56:59], v[16:31]
    s_waitcnt lgkmcnt(4)
    v_mfma_f32_32x32x16_bf16 v[16:31], a[108:111], v[60:63], v[16:31]
    s_waitcnt lgkmcnt(3)
    v_mfma_f32_32x32x16_bf16 v[16:31], a[112:115], v[64:67], v[16:31]
    s_waitcnt lgkmcnt(2)
    v_mfma_f32_32x32x16_bf16 v[16:31], a[116:119], v[68:71], v[16:31]
    s_waitcnt lgkmcnt(1)
    v_mfma_f32_32x32x16_bf16 v[16:31], a[120:123], v[72:75], v[16:31]
    s_waitcnt lgkmcnt(0)
    v_mfma_f32_32x32x16_bf16 v[16:31], a[124:127], v[76:79], v[16:31]
    s_mov_b32 s22, 0xbdd2d3e8
    v_mov_b32 v10, 0xc0135761
    s_nop 9
    v_mul_f32 v32, v16, v16
    v_mul_f32 v33, v17, v17
    v_mul_f32 v34, v18, v18
    v_mul_f32 v35, v19, v19
    v_mul_f32 v36, v20, v20
    v_mul_f32 v37, v21, v21
    v_mul_f32 v38, v22, v22
    v_mul_f32 v39, v23, v23
    v_mul_f32 v40, v24, v24
    v_mul_f32 v41, v25, v25
    v_mul_f32 v42, v26, v26
    v_mul_f32 v43, v27, v27
    v_mul_f32 v44, v28, v28
    v_mul_f32 v45, v29, v29
    v_mul_f32 v46, v30, v30
    v_mul_f32 v47, v31, v31
    v_fma_f32 v32, v32, s22, v10
    v_fma_f32 v33, v33, s22, v10
    v_fma_f32 v34, v34, s22, v10
    v_fma_f32 v35, v35, s22, v10
    v_fma_f32 v36, v36, s22, v10
    v_fma_f32 v37, v37, s22, v10
    v_fma_f32 v38, v38, s22, v10
    v_fma_f32 v39, v39, s22, v10
    v_fma_f32 v40, v40, s22, v10
    v_fma_f32 v41, v41, s22, v10
    v_fma_f32 v42, v42, s22, v10
    v_fma_f32 v43, v43, s22, v10
    v_fma_f32 v44, v44, s22, v10
    v_fma_f32 v45, v45, s22, v10
    v_fma_f32 v46, v46, s22, v10
    v_fma_f32 v47, v47, s22, v10
    v_pk_mul_f32 v[32:33], v[32:33], v[16:17]
    v_pk_mul_f32 v[34:35], v[34:35], v[18:19]
    v_pk_mul_f32 v[36:37], v[36:37], v[20:21]
    v_pk_mul_f32 v[38:39], v[38:39], v[22:23]
    v_pk_mul_f32 v[40:41], v[40:41], v[24:25]
    v_pk_mul_f32 v[42:43], v[42:43], v[26:27]
    v_pk_mul_f32 v[44:45], v[44:45], v[28:29]
    v_pk_mul_f32 v[46:47], v[46:47], v[30:31]
    v_exp_f32 v32, v32
    v_exp_f32 v33, v33
    v_exp_f32 v34, v34
    v_exp_f32 v35, v35
    v_exp_f32 v36, v36
    v_exp_f32 v37, v37
    v_exp_f32 v38, v38
    v_exp_f32 v39, v39
    v_exp_f32 v40, v40
    v_exp_f32 v41, v41
    v_exp_f32 v42, v42
    v_exp_f32 v43, v43
    v_exp_f32 v44, v44
    v_exp_f32 v45, v45
    v_exp_f32 v46, v46
    v_exp_f32 v47, v47
    v_add_f32 v32, 1.0, v32
    v_add_f32 v33, 1.0, v33
    v_add_f32 v34, 1.0, v34
    v_add_f32 v35, 1.0, v35
    v_add_f32 v36, 1.0, v36
    v_add_f32 v37, 1.0, v37
    v_add_f32 v38, 1.0, v38
    v_add_f32 v39, 1.0, v39
    v_add_f32 v40, 1.0, v40
    v_add_f32 v41, 1.0, v41
    v_add_f32 v42, 1.0, v42
    v_add_f32 v43, 1.0, v43
    v_add_f32 v44, 1.0, v44
    v_add_f32 v45, 1.0, v45
    v_add_f32 v46, 1.0, v46
    v_add_f32 v47, 1.0, v47
    v_rcp_f32 v32, v32
    v_rcp_f32 v33, v33
    v_rcp_f32 v34, v34
    v_rcp_f32 v35, v35
    v_rcp_f32 v36, v36
    v_rcp_f32 v37, v37
    v_rcp_f32 v38, v38
    v_rcp_f32 v39, v39
    v_rcp_f32 v40, v40
    v_rcp_f32 v41, v41
    v_rcp_f32 v42, v42
    v_rcp_f32 v43, v43
    v_rcp_f32 v44, v44
    v_rcp_f32 v45, v45
    v_rcp_f32 v46, v46
    v_rcp_f32 v47, v47
    v_pk_mul_f32 v[16:17], v[16:17], v[32:33]
    v_pk_mul_f32 v[18:19], v[18:19], v[34:35]
    v_pk_mul_f32 v[20:21], v[20:21], v[36:37]
    v_pk_mul_f32 v[22:23], v[22:23], v[38:39]
    v_pk_mul_f32 v[24:25], v[24:25], v[40:41]
    v_pk_mul_f32 v[26:27], v[26:27], v[42:43]
    v_pk_mul_f32 v[28:29], v[28:29], v[44:45]
    v_pk_mul_f32 v[30:31], v[30:31], v[46:47]
    v_cvt_pk_bf16_f32 v16, v16, v17
    v_cvt_pk_bf16_f32 v17, v18, v19
    v_cvt_pk_bf16_f32 v18, v20, v21
    v_cvt_pk_bf16_f32 v19, v22, v23
    v_cvt_pk_bf16_f32 v20, v24, v25
    v_cvt_pk_bf16_f32 v21, v26, v27
    v_cvt_pk_bf16_f32 v22, v28, v29
    v_cvt_pk_bf16_f32 v23, v30, v31
    v_xor_b32 v7, 8192, v7
    s_lshl_b32 s22, s17, 11
    v_add_u32 v12, s22, v7
    ds_write_b128 v12, v[16:19] offset:0
    ds_write_b128 v12, v[20:23] offset:1024
    s_waitcnt vmcnt(0) lgkmcnt(0)
    s_barrier
    ds_read_b128 v[48:51], v7 offset:0
    ds_read_b128 v[52:55], v7 offset:1024
    ds_read_b128 v[56:59], v7 offset:2048
    ds_read_b128 v[60:63], v7 offset:3072
    ds_read_b128 v[64:67], v7 offset:4096
    ds_read_b128 v[68:71], v7 offset:5120
    ds_read_b128 v[72:75], v7 offset:6144
    ds_read_b128 v[76:79], v7 offset:7168
    s_lshr_b32 s22, s27, 31
    s_or_b32 s22, s22, s17
    s_cbranch_scc1 Wf_14
    s_lshl_b32 s22, s27, 12
    s_lshl_b32 s23, s28, 7
    s_add_u32 s22, s22, s23
    s_add_u32 s22, s22, 58718220
    v_mov_b32 v10, 1
    s_mov_b64 exec, 1
    buffer_store_dword v10, off, s[8:11], s22 sc1
    s_mov_b64 exec, -1
Wf_14:
    s_mul_i32 s61, s20, 1048576
    s_add_u32 s61, s61, 67108864
    s_mul_i32 s23, s17, 262144
    s_add_u32 s61, s61, s23
    s_lshl_b32 s23, s28, 10
    s_add_u32 s61, s61, s23
    s_waitcnt lgkmcnt(7)
    v_mfma_f32_32x32x16_bf16 v[160:175], a[128:131], v[48:51], 0
    s_waitcnt lgkmcnt(6)
    v_mfma_f32_32x32x16_bf16 v[160:175], a[132:135], v[52:55], v[160:175]
    s_waitcnt lgkmcnt(5)
    v_mfma_f32_32x32x16_bf16 v[160:175], a[136:139], v[56:59], v[160:175]
    s_waitcnt lgkmcnt(4)
    v_mfma_f32_32x32x16_bf16 v[160:175], a[140:143], v[60:63], v[160:175]
    s_waitcnt lgkmcnt(3)
    v_mfma_f32_32x32x16_bf16 v[160:175], a[144:147], v[64:67], v[160:175]
    s_waitcnt lgkmcnt(2)
    v_mfma_f32_32x32x16_bf16 v[160:175], a[148:151], v[68:71], v[160:175]
    s_waitcnt lgkmcnt(1)
    v_mfma_f32_32x32x16_bf16 v[160:175], a[152:155], v[72:75], v[160:175]
    s_waitcnt lgkmcnt(0)
    v_mfma_f32_32x32x16_bf16 v[160:175], a[156:159], v[76:79], v[160:175]
    s_nop 6
    v_mfma_f32_32x32x16_bf16 v[176:191], a[160:163], v[48:51], 0
    s_nop 0
    v_mfma_f32_32x32x16_bf16 v[176:191], a[164:167], v[52:55], v[176:191]
    v_mfma_f32_32x32x16_bf16 v[176:191], a[168:171], v[56:59], v[176:191]
    s_nop 0
    v_cvt_pk_bf16_f32 v160, v160, v161
    v_cvt_pk_bf16_f32 v161, v162, v163
    v_cvt_pk_bf16_f32 v162, v164, v165
    v_cvt_pk_bf16_f32 v163, v166, v167
    buffer_store_dwordx4 v[160:163], v2, s[8:11], s61 offen offset:0 sc1
    v_mfma_f32_32x32x16_bf16 v[176:191], a[172:175], v[60:63], v[176:191]
    v_mfma_f32_32x32x16_bf16 v[176:191], a[176:179], v[64:67], v[176:191]
    v_cvt_pk_bf16_f32 v168, v168, v169
    v_cvt_pk_bf16_f32 v169, v170, v171
    v_cvt_pk_bf16_f32 v170, v172, v173
    v_cvt_pk_bf16_f32 v171, v174, v175
    buffer_store_dwordx4 v[168:171], v2, s[8:11], s61 offen offset:256 sc1
    v_mfma_f32_32x32x16_bf16 v[176:191], a[180:183], v[68:71], v[176:191]
    v_mfma_f32_32x32x16_bf16 v[176:191], a[184:187], v[72:75], v[176:191]
    v_mfma_f32_32x32x16_bf16 v[176:191], a[188:191], v[76:79], v[176:191]
    s_nop 6
    v_mfma_f32_32x32x16_bf16 v[160:175], a[192:195], v[48:51], 0
    s_nop 0
    v_mfma_f32_32x32x16_bf16 v[160:175], a[196:199], v[52:55], v[160:175]
    v_mfma_f32_32x32x16_bf16 v[160:175], a[200:203], v[56:59], v[160:175]
    s_nop 0
    v_cvt_pk_bf16_f32 v176, v176, v177
    v_cvt_pk_bf16_f32 v177, v178, v179
    v_cvt_pk_bf16_f32 v178, v180, v181
    v_cvt_pk_bf16_f32 v179, v182, v183
    buffer_store_dwordx4 v[176:179], v2, s[8:11], s61 offen offset:512 sc1
    v_mfma_f32_32x32x16_bf16 v[160:175], a[204:207], v[60:63], v[160:175]
    v_mfma_f32_32x32x16_bf16 v[160:175], a[208:211], v[64:67], v[160:175]
    v_cvt_pk_bf16_f32 v184, v184, v185
    v_cvt_pk_bf16_f32 v185, v186, v187
    v_cvt_pk_bf16_f32 v186, v188, v189
    v_cvt_pk_bf16_f32 v187, v190, v191
    buffer_store_dwordx4 v[184:187], v2, s[8:11], s61 offen offset:768 sc1
    s_add_u32 s61, s61, 131072
    v_mfma_f32_32x32x16_bf16 v[160:175], a[212:215], v[68:71], v[160:175]
    v_mfma_f32_32x32x16_bf16 v[160:175], a[216:219], v[72:75], v[160:175]
    v_mfma_f32_32x32x16_bf16 v[160:175], a[220:223], v[76:79], v[160:175]
    s_nop 6
    v_mfma_f32_32x32x16_bf16 v[176:191], a[224:227], v[48:51], 0
    s_nop 0
    v_mfma_f32_32x32x16_bf16 v[176:191], a[228:231], v[52:55], v[176:191]
    v_mfma_f32_32x32x16_bf16 v[176:191], a[232:235], v[56:59], v[176:191]
    s_nop 0
    v_cvt_pk_bf16_f32 v160, v160, v161
    v_cvt_pk_bf16_f32 v161, v162, v163
    v_cvt_pk_bf16_f32 v162, v164, v165
    v_cvt_pk_bf16_f32 v163, v166, v167
    buffer_store_dwordx4 v[160:163], v2, s[8:11], s61 offen offset:0 sc1
    v_mfma_f32_32x32x16_bf16 v[176:191], a[236:239], v[60:63], v[176:191]
    v_mfma_f32_32x32x16_bf16 v[176:191], a[240:243], v[64:67], v[176:191]
    v_cvt_pk_bf16_f32 v168, v168, v169
    v_cvt_pk_bf16_f32 v169, v170, v171
    v_cvt_pk_bf16_f32 v170, v172, v173
    v_cvt_pk_bf16_f32 v171, v174, v175
    buffer_store_dwordx4 v[168:171], v2, s[8:11], s61 offen offset:256 sc1
    v_mfma_f32_32x32x16_bf16 v[176:191], a[244:247], v[68:71], v[176:191]
    v_mfma_f32_32x32x16_bf16 v[176:191], a[248:251], v[72:75], v[176:191]
    v_mfma_f32_32x32x16_bf16 v[176:191], a[252:255], v[76:79], v[176:191]
    s_nop 0
    s_nop 10
    v_cvt_pk_bf16_f32 v176, v176, v177
    v_cvt_pk_bf16_f32 v177, v178, v179
    v_cvt_pk_bf16_f32 v178, v180, v181
    v_cvt_pk_bf16_f32 v179, v182, v183
    buffer_store_dwordx4 v[176:179], v2, s[8:11], s61 offen offset:512 sc1
    v_cvt_pk_bf16_f32 v184, v184, v185
    v_cvt_pk_bf16_f32 v185, v186, v187
    v_cvt_pk_bf16_f32 v186, v188, v189
    v_cvt_pk_bf16_f32 v187, v190, v191
    buffer_store_dwordx4 v[184:187], v2, s[8:11], s61 offen offset:768 sc1
    s_mov_b32 s27, s20
    s_xor_b32 s26, s26, 32768
    s_add_u32 s20, s20, 1
    s_cmp_lt_u32 s20, s29
    s_cbranch_scc1 Wml_top
    s_waitcnt vmcnt(0)
    s_barrier
    s_lshr_b32 s22, s27, 31
    s_or_b32 s22, s22, s17
    s_cbranch_scc1 Wf_15
    s_lshl_b32 s22, s27, 12
    s_lshl_b32 s23, s28, 7
    s_add_u32 s22, s22, s23
    s_add_u32 s22, s22, 58718220
    v_mov_b32 v10, 1
    s_mov_b64 exec, 1
    buffer_store_dword v10, off, s[8:11], s22 sc1
    s_mov_b64 exec, -1
Wf_15:
Watt:
    s_load_dwordx2 s[36:37], s[0:1], 40
    s_mov_b32 s38, 4194304
    s_mov_b32 s39, 0x20000
    s_load_dwordx2 s[4:5], s[0:1], 88
    s_and_b32 s22, s18, 1
    s_mul_i32 s22, s22, 5
    s_add_u32 s19, s19, s22
    s_lshr_b32 s16, s18, 1
    s_lshr_b32 s22, s17, 1
    s_and_b32 s18, s18, 30
    s_add_u32 s18, s18, s22
    s_lshl_b32 s31, s16, 18
    s_lshl_b32 s22, s17, 8
    s_add_u32 s31, s31, s22
    v_mov_b32 v8, 0
    v_bfe_u32 v10, v0, 3, 1
    v_lshl_add_u32 v8, v10, 3, v8
    v_bfe_u32 v10, v0, 5, 1
    v_lshl_add_u32 v8, v10, 4, v8
    v_bfe_u32 v10, v0, 4, 1
    v_lshl_add_u32 v8, v10, 2, v8
    s_lshr_b32 s22, s16, 2
    s_lshl_b32 s22, s22, 8
    s_lshl_b32 s23, s17, 5
    s_add_u32 s22, s22, s23
    v_add_u32 v8, s22, v8
    s_waitcnt lgkmcnt(0)
    global_load_dword v244, v8, s[4:5] offset:0
    global_load_dword v246, v8, s[4:5] offset:128
    v_mov_b32 v4, 0
    v_bfe_u32 v10, v0, 4, 2
    v_lshl_add_u32 v4, v10, 10, v4
    v_bfe_u32 v10, v0, 0, 4
    v_lshl_add_u32 v4, v10, 4, v4
    s_lshl_b32 s22, s17, 8
    v_add_u32 v4, s22, v4
    s_add_u32 s63, s19, 1
    s_lshr_b32 s63, s63, 1
    s_cmp_eq_u32 s63, 5
    s_cselect_b32 s63, 0, s63
    s_add_u32 s63, s63, 59
    s_mul_i32 s22, s63, 1048576
    s_add_u32 s22, s22, 67108864
    s_and_b32 s23, s16, 12
    s_add_u32 s23, s23, s16
    s_lshl_b32 s23, s23, 15
    s_add_u32 s22, s22, s23
    s_and_b32 s23, s19, 1
    s_lshl_b32 s23, s23, 17
    s_add_u32 s22, s22, s23
    v_mov_b32 v80, -1
    v_mov_b32 v81, -1
    v_mov_b32 v82, -1
    v_mov_b32 v83, -1
    s_add_u32 s23, s22, 0
    buffer_store_dwordx4 v[80:83], v4, s[8:11], s23 offen sc1
    s_add_u32 s23, s22, 4096
    buffer_store_dwordx4 v[80:83], v4, s[8:11], s23 offen sc1
    s_add_u32 s23, s22, 8192
    buffer_store_dwordx4 v[80:83], v4, s[8:11], s23 offen sc1
    s_add_u32 s23, s22, 12288
    buffer_store_dwordx4 v[80:83], v4, s[8:11], s23 offen sc1
    v_lshrrev_b32 v11, 4, v0
    v_lshlrev_b32 v12, 2, v11
    v_xor_b32 v12, v12, v0
    v_and_b32 v12, 15, v12
    v_mul_u32_u24 v55, 1024, v11
    v_lshl_add_u32 v55, v12, 4, v55
    v_mul_u32_u24 v56, 1024, v11
    v_lshl_add_u32 v56, v12, 4, v56
    s_barrier
    s_add_u32 m0, s25, 0
    s_add_u32 s22, s31, 0
    buffer_load_dwordx4 v55, s[36:39], s22 offen lds
    s_add_u32 m0, s25, 1024
    s_add_u32 s22, s31, 8192
    buffer_load_dwordx4 v55, s[36:39], s22 offen lds
    s_add_u32 m0, s25, 2048
    s_add_u32 s22, s31, 4096
    buffer_load_dwordx4 v55, s[36:39], s22 offen lds
    s_add_u32 m0, s25, 3072
    s_add_u32 s22, s31, 12288
    buffer_load_dwordx4 v55, s[36:39], s22 offen lds
    s_add_u32 m0, s25, 4096
    s_add_u32 s22, s31, 16384
    buffer_load_dwordx4 v55, s[36:39], s22 offen lds
    s_add_u32 m0, s25, 5120
    s_add_u32 s22, s31, 24576
    buffer_load_dwordx4 v55, s[36:39], s22 offen lds
    s_add_u32 m0, s25, 6144
    s_add_u32 s22, s31, 20480
    buffer_load_dwordx4 v55, s[36:39], s22 offen lds
    s_add_u32 m0, s25, 7168
    s_add_u32 s22, s31, 28672
    buffer_load_dwordx4 v55, s[36:39], s22 offen lds
    s_add_u32 m0, s25, 8192
    s_add_u32 s22, s31, 32768
    buffer_load_dwordx4 v55, s[36:39], s22 offen lds
    s_add_u32 m0, s25, 9216
    s_add_u32 s22, s31, 40960
    buffer_load_dwordx4 v55, s[36:39], s22 offen lds
    s_add_u32 m0, s25, 10240
    s_add_u32 s22, s31, 36864
    buffer_load_dwordx4 v55, s[36:39], s22 offen lds
    s_add_u32 m0, s25, 11264
    s_add_u32 s22, s31, 45056
    buffer_load_dwordx4 v55, s[36:39], s22 offen lds
    s_add_u32 m0, s25, 12288
    s_add_u32 s22, s31, 49152
    buffer_load_dwordx4 v55, s[36:39], s22 offen lds
    s_add_u32 m0, s25, 13312
    s_add_u32 s22, s31, 57344
    buffer_load_dwordx4 v55, s[36:39], s22 offen lds
    s_add_u32 m0, s25, 14336
    s_add_u32 s22, s31, 53248
    buffer_load_dwordx4 v55, s[36:39], s22 offen lds
    s_add_u32 m0, s25, 15360
    s_add_u32 s22, s31, 61440
    buffer_load_dwordx4 v55, s[36:39], s22 offen lds
    s_add_u32 m0, s25, 16384
    s_add_u32 s22, s31, 65536
    buffer_load_dwordx4 v55, s[36:39], s22 offen lds
    s_add_u32 m0, s25, 17408
    s_add_u32 s22, s31, 73728
    buffer_load_dwordx4 v55, s[36:39], s22 offen lds
    s_add_u32 m0, s25, 18432
    s_add_u32 s22, s31, 69632
    buffer_load_dwordx4 v55, s[36:39], s22 offen lds
    s_add_u32 m0, s25, 19456
    s_add_u32 s22, s31, 77824
    buffer_load_dwordx4 v55, s[36:39], s22 offen lds
    v_mov_b32 v60, 0
    v_bfe_u32 v10, v0, 5, 1
    v_lshl_add_u32 v60, v10, 11, v60
    v_bfe_u32 v10, v0, 2, 2
    v_lshl_add_u32 v60, v10, 8, v60
    v_bfe_u32 v10, v0, 2, 2
    v_lshl_add_u32 v60, v10, 6, v60
    v_bfe_u32 v10, v0, 4, 1
    v_lshl_add_u32 v60, v10, 5, v60
    v_bfe_u32 v10, v0, 0, 2
    v_lshl_add_u32 v60, v10, 3, v60
    s_lshl_b32 s22, s17, 6
    v_xor_b32 v58, s22, v60
    v_add_u32 v59, 65536, v58
    v_add_u32 v60, s25, v60
    v_xor_b32 v61, 64, v60
    v_xor_b32 v62, 128, v60
    v_xor_b32 v63, 192, v60
    s_waitcnt vmcnt(16)
    s_waitcnt lgkmcnt(0)
    s_barrier
    ds_read_b64_tr_b16 a[0:1], v60 offset:0
    ds_read_b64_tr_b16 a[2:3], v60 offset:1024
    ds_read_b64_tr_b16 a[64:65], v61 offset:0
    ds_read_b64_tr_b16 a[66:67], v61 offset:1024
    ds_read_b64_tr_b16 a[128:129], v62 offset:0
    ds_read_b64_tr_b16 a[130:131], v62 offset:1024
    ds_read_b64_tr_b16 a[192:193], v63 offset:0
    ds_read_b64_tr_b16 a[194:195], v63 offset:1024
    s_add_u32 m0, s25, 20480
    s_add_u32 s22, s31, 81920
    buffer_load_dwordx4 v55, s[36:39], s22 offen lds
    s_add_u32 m0, s25, 21504
    s_add_u32 s22, s31, 90112
    buffer_load_dwordx4 v55, s[36:39], s22 offen lds
    s_add_u32 m0, s25, 22528
    s_add_u32 s22, s31, 86016
    buffer_load_dwordx4 v55, s[36:39], s22 offen lds
    s_add_u32 m0, s25, 23552
    s_add_u32 s22, s31, 94208
    buffer_load_dwordx4 v55, s[36:39], s22 offen lds
    s_waitcnt vmcnt(16)
    s_waitcnt lgkmcnt(0)
    s_barrier
    ds_read_b64_tr_b16 a[4:5], v60 offset:4096
    ds_read_b64_tr_b16 a[6:7], v60 offset:5120
    ds_read_b64_tr_b16 a[68:69], v61 offset:4096
    ds_read_b64_tr_b16 a[70:71], v61 offset:5120
    ds_read_b64_tr_b16 a[132:133], v62 offset:4096
    ds_read_b64_tr_b16 a[134:135], v62 offset:5120
    ds_read_b64_tr_b16 a[196:197], v63 offset:4096
    ds_read_b64_tr_b16 a[198:199], v63 offset:5120
    s_add_u32 m0, s25, 24576
    s_add_u32 s22, s31, 98304
    buffer_load_dwordx4 v55, s[36:39], s22 offen lds
    s_add_u32 m0, s25, 25600
    s_add_u32 s22, s31, 106496
    buffer_load_dwordx4 v55, s[36:39], s22 offen lds
    s_add_u32 m0, s25, 26624
    s_add_u32 s22, s31, 102400
    buffer_load_dwordx4 v55, s[36:39], s22 offen lds
    s_add_u32 m0, s25, 27648
    s_add_u32 s22, s31, 110592
    buffer_load_dwordx4 v55, s[36:39], s22 offen lds
    s_waitcnt vmcnt(16)
    s_waitcnt lgkmcnt(0)
    s_barrier
    ds_read_b64_tr_b16 a[8:9], v60 offset:8192
    ds_read_b64_tr_b16 a[10:11], v60 offset:9216
    ds_read_b64_tr_b16 a[72:73], v61 offset:8192
    ds_read_b64_tr_b16 a[74:75], v61 offset:9216
    ds_read_b64_tr_b16 a[136:137], v62 offset:8192
    ds_read_b64_tr_b16 a[138:139], v62 offset:9216
    ds_read_b64_tr_b16 a[200:201], v63 offset:8192
    ds_read_b64_tr_b16 a[202:203], v63 offset:9216
    s_add_u32 m0, s25, 28672
    s_add_u32 s22, s31, 114688
    buffer_load_dwordx4 v55, s[36:39], s22 offen lds
    s_add_u32 m0, s25, 29696
    s_add_u32 s22, s31, 122880
    buffer_load_dwordx4 v55, s[36:39], s22 offen lds
    s_add_u32 m0, s25, 30720
    s_add_u32 s22, s31, 118784
    buffer_load_dwordx4 v55, s[36:39], s22 offen lds
    s_add_u32 m0, s25, 31744
    s_add_u32 s22, s31, 126976
    buffer_load_dwordx4 v55, s[36:39], s22 offen lds
    s_waitcnt vmcnt(16)
    s_waitcnt lgkmcnt(0)
    s_barrier
    ds_read_b64_tr_b16 a[12:13], v60 offset:12288
    ds_read_b64_tr_b16 a[14:15], v60 offset:13312
    ds_read_b64_tr_b16 a[76:77], v61 offset:12288
    ds_read_b64_tr_b16 a[78:79], v61 offset:13312
    ds_read_b64_tr_b16 a[140:141], v62 offset:12288
    ds_read_b64_tr_b16 a[142:143], v62 offset:13312
    ds_read_b64_tr_b16 a[204:205], v63 offset:12288
    ds_read_b64_tr_b16 a[206:207], v63 offset:13312
    s_add_u32 m0, s25, 0
    s_add_u32 s22, s31, 131072
    buffer_load_dwordx4 v56, s[36:39], s22 offen lds
    s_add_u32 m0, s25, 1024
    s_add_u32 s22, s31, 139264
    buffer_load_dwordx4 v56, s[36:39], s22 offen lds
    s_add_u32 m0, s25, 2048
    s_add_u32 s22, s31, 135168
    buffer_load_dwordx4 v56, s[36:39], s22 offen lds
    s_add_u32 m0, s25, 3072
    s_add_u32 s22, s31, 143360
    buffer_load_dwordx4 v56, s[36:39], s22 offen lds
    s_waitcnt vmcnt(16)
    s_waitcnt lgkmcnt(0)
    s_barrier
    ds_read_b64_tr_b16 a[16:17], v60 offset:16384
    ds_read_b64_tr_b16 a[18:19], v60 offset:17408
    ds_read_b64_tr_b16 a[80:81], v61 offset:16384
    ds_read_b64_tr_b16 a[82:83], v61 offset:17408
    ds_read_b64_tr_b16 a[144:145], v62 offset:16384
    ds_read_b64_tr_b16 a[146:147], v62 offset:17408
    ds_read_b64_tr_b16 a[208:209], v63 offset:16384
    ds_read_b64_tr_b16 a[210:211], v63 offset:17408
    s_add_u32 m0, s25, 4096
    s_add_u32 s22, s31, 147456
    buffer_load_dwordx4 v56, s[36:39], s22 offen lds
    s_add_u32 m0, s25, 5120
    s_add_u32 s22, s31, 155648
    buffer_load_dwordx4 v56, s[36:39], s22 offen lds
    s_add_u32 m0, s25, 6144
    s_add_u32 s22, s31, 151552
    buffer_load_dwordx4 v56, s[36:39], s22 offen lds
    s_add_u32 m0, s25, 7168
    s_add_u32 s22, s31, 159744
    buffer_load_dwordx4 v56, s[36:39], s22 offen lds
    s_waitcnt vmcnt(16)
    s_waitcnt lgkmcnt(0)
    s_barrier
    ds_read_b64_tr_b16 a[20:21], v60 offset:20480
    ds_read_b64_tr_b16 a[22:23], v60 offset:21504
    ds_read_b64_tr_b16 a[84:85], v61 offset:20480
    ds_read_b64_tr_b16 a[86:87], v61 offset:21504
    ds_read_b64_tr_b16 a[148:149], v62 offset:20480
    ds_read_b64_tr_b16 a[150:151], v62 offset:21504
    ds_read_b64_tr_b16 a[212:213], v63 offset:20480
    ds_read_b64_tr_b16 a[214:215], v63 offset:21504
    s_add_u32 m0, s25, 8192
    s_add_u32 s22, s31, 163840
    buffer_load_dwordx4 v56, s[36:39], s22 offen lds
    s_add_u32 m0, s25, 9216
    s_add_u32 s22, s31, 172032
    buffer_load_dwordx4 v56, s[36:39], s22 offen lds
    s_add_u32 m0, s25, 10240
    s_add_u32 s22, s31, 167936
    buffer_load_dwordx4 v56, s[36:39], s22 offen lds
    s_add_u32 m0, s25, 11264
    s_add_u32 s22, s31, 176128
    buffer_load_dwordx4 v56, s[36:39], s22 offen lds
    s_waitcnt vmcnt(16)
    s_waitcnt lgkmcnt(0)
    s_barrier
    ds_read_b64_tr_b16 a[24:25], v60 offset:24576
    ds_read_b64_tr_b16 a[26:27], v60 offset:25600
    ds_read_b64_tr_b16 a[88:89], v61 offset:24576
    ds_read_b64_tr_b16 a[90:91], v61 offset:25600
    ds_read_b64_tr_b16 a[152:153], v62 offset:24576
    ds_read_b64_tr_b16 a[154:155], v62 offset:25600
    ds_read_b64_tr_b16 a[216:217], v63 offset:24576
    ds_read_b64_tr_b16 a[218:219], v63 offset:25600
    s_add_u32 m0, s25, 12288
    s_add_u32 s22, s31, 180224
    buffer_load_dwordx4 v56, s[36:39], s22 offen lds
    s_add_u32 m0, s25, 13312
    s_add_u32 s22, s31, 188416
    buffer_load_dwordx4 v56, s[36:39], s22 offen lds
    s_add_u32 m0, s25, 14336
    s_add_u32 s22, s31, 184320
    buffer_load_dwordx4 v56, s[36:39], s22 offen lds
    s_add_u32 m0, s25, 15360
    s_add_u32 s22, s31, 192512
    buffer_load_dwordx4 v56, s[36:39], s22 offen lds
    s_waitcnt vmcnt(16)
    s_waitcnt lgkmcnt(0)
    s_barrier
    ds_read_b64_tr_b16 a[28:29], v60 offset:28672
    ds_read_b64_tr_b16 a[30:31], v60 offset:29696
    ds_read_b64_tr_b16 a[92:93], v61 offset:28672
    ds_read_b64_tr_b16 a[94:95], v61 offset:29696
    ds_read_b64_tr_b16 a[156:157], v62 offset:28672
    ds_read_b64_tr_b16 a[158:159], v62 offset:29696
    ds_read_b64_tr_b16 a[220:221], v63 offset:28672
    ds_read_b64_tr_b16 a[222:223], v63 offset:29696
    s_add_u32 m0, s25, 16384
    s_add_u32 s22, s31, 196608
    buffer_load_dwordx4 v56, s[36:39], s22 offen lds
    s_add_u32 m0, s25, 17408
    s_add_u32 s22, s31, 204800
    buffer_load_dwordx4 v56, s[36:39], s22 offen lds
    s_add_u32 m0, s25, 18432
    s_add_u32 s22, s31, 200704
    buffer_load_dwordx4 v56, s[36:39], s22 offen lds
    s_add_u32 m0, s25, 19456
    s_add_u32 s22, s31, 208896
    buffer_load_dwordx4 v56, s[36:39], s22 offen lds
    s_waitcnt vmcnt(16)
    s_waitcnt lgkmcnt(0)
    s_barrier
    ds_read_b64_tr_b16 a[32:33], v60 offset:0
    ds_read_b64_tr_b16 a[34:35], v60 offset:1024
    ds_read_b64_tr_b16 a[96:97], v61 offset:0
    ds_read_b64_tr_b16 a[98:99], v61 offset:1024
    ds_read_b64_tr_b16 a[160:161], v62 offset:0
    ds_read_b64_tr_b16 a[162:163], v62 offset:1024
    ds_read_b64_tr_b16 a[224:225], v63 offset:0
    ds_read_b64_tr_b16 a[226:227], v63 offset:1024
    s_add_u32 m0, s25, 20480
    s_add_u32 s22, s31, 212992
    buffer_load_dwordx4 v56, s[36:39], s22 offen lds
    s_add_u32 m0, s25, 21504
    s_add_u32 s22, s31, 221184
    buffer_load_dwordx4 v56, s[36:39], s22 offen lds
    s_add_u32 m0, s25, 22528
    s_add_u32 s22, s31, 217088
    buffer_load_dwordx4 v56, s[36:39], s22 offen lds
    s_add_u32 m0, s25, 23552
    s_add_u32 s22, s31, 225280
    buffer_load_dwordx4 v56, s[36:39], s22 offen lds
    s_waitcnt vmcnt(16)
    s_waitcnt lgkmcnt(0)
    s_barrier
    ds_read_b64_tr_b16 a[36:37], v60 offset:4096
    ds_read_b64_tr_b16 a[38:39], v60 offset:5120
    ds_read_b64_tr_b16 a[100:101], v61 offset:4096
    ds_read_b64_tr_b16 a[102:103], v61 offset:5120
    ds_read_b64_tr_b16 a[164:165], v62 offset:4096
    ds_read_b64_tr_b16 a[166:167], v62 offset:5120
    ds_read_b64_tr_b16 a[228:229], v63 offset:4096
    ds_read_b64_tr_b16 a[230:231], v63 offset:5120
    s_add_u32 m0, s25, 24576
    s_add_u32 s22, s31, 229376
    buffer_load_dwordx4 v56, s[36:39], s22 offen lds
    s_add_u32 m0, s25, 25600
    s_add_u32 s22, s31, 237568
    buffer_load_dwordx4 v56, s[36:39], s22 offen lds
    s_add_u32 m0, s25, 26624
    s_add_u32 s22, s31, 233472
    buffer_load_dwordx4 v56, s[36:39], s22 offen lds
    s_add_u32 m0, s25, 27648
    s_add_u32 s22, s31, 241664
    buffer_load_dwordx4 v56, s[36:39], s22 offen lds
    s_waitcnt vmcnt(16)
    s_waitcnt lgkmcnt(0)
    s_barrier
    ds_read_b64_tr_b16 a[40:41], v60 offset:8192
    ds_read_b64_tr_b16 a[42:43], v60 offset:9216
    ds_read_b64_tr_b16 a[104:105], v61 offset:8192
    ds_read_b64_tr_b16 a[106:107], v61 offset:9216
    ds_read_b64_tr_b16 a[168:169], v62 offset:8192
    ds_read_b64_tr_b16 a[170:171], v62 offset:9216
    ds_read_b64_tr_b16 a[232:233], v63 offset:8192
    ds_read_b64_tr_b16 a[234:235], v63 offset:9216
    s_add_u32 m0, s25, 28672
    s_add_u32 s22, s31, 245760
    buffer_load_dwordx4 v56, s[36:39], s22 offen lds
    s_add_u32 m0, s25, 29696
    s_add_u32 s22, s31, 253952
    buffer_load_dwordx4 v56, s[36:39], s22 offen lds
    s_add_u32 m0, s25, 30720
    s_add_u32 s22, s31, 249856
    buffer_load_dwordx4 v56, s[36:39], s22 offen lds
    s_add_u32 m0, s25, 31744
    s_add_u32 s22, s31, 258048
    buffer_load_dwordx4 v56, s[36:39], s22 offen lds
    s_waitcnt vmcnt(16)
    s_waitcnt lgkmcnt(0)
    s_barrier
    ds_read_b64_tr_b16 a[44:45], v60 offset:12288
    ds_read_b64_tr_b16 a[46:47], v60 offset:13312
    ds_read_b64_tr_b16 a[108:109], v61 offset:12288
    ds_read_b64_tr_b16 a[110:111], v61 offset:13312
    ds_read_b64_tr_b16 a[172:173], v62 offset:12288
    ds_read_b64_tr_b16 a[174:175], v62 offset:13312
    ds_read_b64_tr_b16 a[236:237], v63 offset:12288
    ds_read_b64_tr_b16 a[238:239], v63 offset:13312
    s_waitcnt vmcnt(12)
    s_waitcnt lgkmcnt(0)
    s_barrier
    ds_read_b64_tr_b16 a[48:49], v60 offset:16384
    ds_read_b64_tr_b16 a[50:51], v60 offset:17408
    ds_read_b64_tr_b16 a[112:113], v61 offset:16384
    ds_read_b64_tr_b16 a[114:115], v61 offset:17408
    ds_read_b64_tr_b16 a[176:177], v62 offset:16384
    ds_read_b64_tr_b16 a[178:179], v62 offset:17408
    ds_read_b64_tr_b16 a[240:241], v63 offset:16384
    ds_read_b64_tr_b16 a[242:243], v63 offset:17408
    s_waitcnt vmcnt(8)
    s_waitcnt lgkmcnt(0)
    s_barrier
    ds_read_b64_tr_b16 a[52:53], v60 offset:20480
    ds_read_b64_tr_b16 a[54:55], v60 offset:21504
    ds_read_b64_tr_b16 a[116:117], v61 offset:20480
    ds_read_b64_tr_b16 a[118:119], v61 offset:21504
    ds_read_b64_tr_b16 a[180:181], v62 offset:20480
    ds_read_b64_tr_b16 a[182:183], v62 offset:21504
    ds_read_b64_tr_b16 a[244:245], v63 offset:20480
    ds_read_b64_tr_b16 a[246:247], v63 offset:21504
    s_waitcnt vmcnt(4)
    s_waitcnt lgkmcnt(0)
    s_barrier
    ds_read_b64_tr_b16 a[56:57], v60 offset:24576
    ds_read_b64_tr_b16 a[58:59], v60 offset:25600
    ds_read_b64_tr_b16 a[120:121], v61 offset:24576
    ds_read_b64_tr_b16 a[122:123], v61 offset:25600
    ds_read_b64_tr_b16 a[184:185], v62 offset:24576
    ds_read_b64_tr_b16 a[186:187], v62 offset:25600
    ds_read_b64_tr_b16 a[248:249], v63 offset:24576
    ds_read_b64_tr_b16 a[250:251], v63 offset:25600
    s_waitcnt vmcnt(0)
    s_waitcnt lgkmcnt(0)
    s_barrier
    ds_read_b64_tr_b16 a[60:61], v60 offset:28672
    ds_read_b64_tr_b16 a[62:63], v60 offset:29696
    ds_read_b64_tr_b16 a[124:125], v61 offset:28672
    ds_read_b64_tr_b16 a[126:127], v61 offset:29696
    ds_read_b64_tr_b16 a[188:189], v62 offset:28672
    ds_read_b64_tr_b16 a[190:191], v62 offset:29696
    ds_read_b64_tr_b16 a[252:253], v63 offset:28672
    ds_read_b64_tr_b16 a[254:255], v63 offset:29696
    s_waitcnt lgkmcnt(0)
    s_barrier
    v_and_b32 v245, 0xffff0000, v244
    v_lshlrev_b32 v244, 16, v244
    v_and_b32 v247, 0xffff0000, v246
    v_lshlrev_b32 v246, 16, v246
    v_and_b32 v10, 7, v0
    v_lshl_add_u32 v8, v10, 10, v8
    s_and_b32 s22, s16, 3
    s_lshl_b32 s22, s22, 13
    v_add_u32 v8, s22, v8
    v_and_b32 v11, 31, v0
    v_lshrrev_b32 v10, 5, v0
    v_lshlrev_b32 v10, 2, v10
    v_sub_u32 v11, v11, v10
    v_mov_b32 v10, 0xceabfb8f
    v_cmp_gt_i32 vcc, 0, v11
    s_nop 1
    v_cndmask_b32 v192, 0, v10, vcc
    v_cmp_gt_i32 vcc, 1, v11
    s_nop 1
    v_cndmask_b32 v193, 0, v10, vcc
    v_cmp_gt_i32 vcc, 2, v11
    s_nop 1
    v_cndmask_b32 v194, 0, v10, vcc
    v_cmp_gt_i32 vcc, 3, v11
    s_nop 1
    v_cndmask_b32 v195, 0, v10, vcc
    v_cmp_gt_i32 vcc, 8, v11
    s_nop 1
    v_cndmask_b32 v196, 0, v10, vcc
    v_cmp_gt_i32 vcc, 9, v11
    s_nop 1
    v_cndmask_b32 v197, 0, v10, vcc
    v_cmp_gt_i32 vcc, 10, v11
    s_nop 1
    v_cndmask_b32 v198, 0, v10, vcc
    v_cmp_gt_i32 vcc, 11, v11
    s_nop 1
    v_cndmask_b32 v199, 0, v10, vcc
    v_cmp_gt_i32 vcc, 16, v11
    s_nop 1
    v_cndmask_b32 v200, 0, v10, vcc
    v_cmp_gt_i32 vcc, 17, v11
    s_nop 1
    v_cndmask_b32 v201, 0, v10, vcc
    v_cmp_gt_i32 vcc, 18, v11
    s_nop 1
    v_cndmask_b32 v202, 0, v10, vcc
    v_cmp_gt_i32 vcc, 19, v11
    s_nop 1
    v_cndmask_b32 v203, 0, v10, vcc
    v_cmp_gt_i32 vcc, 24, v11
    s_nop 1
    v_cndmask_b32 v204, 0, v10, vcc
    v_cmp_gt_i32 vcc, 25, v11
    s_nop 1
    v_cndmask_b32 v205, 0, v10, vcc
    v_cmp_gt_i32 vcc, 26, v11
    s_nop 1
    v_cndmask_b32 v206, 0, v10, vcc
    v_cmp_gt_i32 vcc, 27, v11
    s_nop 1
    v_cndmask_b32 v207, 0, v10, vcc
    v_and_b32 v11, 1, v0
    v_lshlrev_b32 v11, 4, v11
    v_mov_b32 v10, 0x3f80
    v_lshlrev_b32 v11, v11, v10
    v_bfe_u32 v10, v0, 1, 3
    v_cmp_eq_u32 vcc, 0, v10
    s_nop 1
    v_cndmask_b32 v208, 0, v11, vcc
    v_cmp_eq_u32 vcc, 2, v10
    s_nop 1
    v_cndmask_b32 v209, 0, v11, vcc
    v_cmp_eq_u32 vcc, 4, v10
    s_nop 1
    v_cndmask_b32 v210, 0, v11, vcc
    v_cmp_eq_u32 vcc, 6, v10
    s_nop 1
    v_cndmask_b32 v211, 0, v11, vcc
    v_lshrrev_b32 v10, 5, v0
    v_lshl_add_u32 v5, v10, 30, v4
    s_and_b32 s22, s17, 2
    s_lshl_b32 s22, s22, 12
    v_mov_b32 v6, 16384
    v_bfe_u32 v10, v0, 5, 1
    v_lshl_add_u32 v6, v10, 10, v6
    v_bfe_u32 v10, v0, 4, 1
    v_lshl_add_u32 v6, v10, 9, v6
    v_bfe_u32 v10, v0, 2, 1
    v_lshl_add_u32 v6, v10, 8, v6
    v_bfe_u32 v10, v0, 3, 1
    v_lshl_add_u32 v6, v10, 7, v6
    v_bfe_u32 v10, v0, 1, 1
    v_lshl_add_u32 v6, v10, 6, v6
    v_bfe_u32 v10, v0, 0, 1
    v_lshl_add_u32 v6, v10, 4, v6
    v_add_u32 v6, s22, v6
    v_add_u32 v7, s22, v1
    v_mov_b32 v14, 0
    v_bfe_u32 v10, v0, 5, 1
    v_lshl_add_u32 v14, v10, 9, v14
    v_bfe_u32 v10, v0, 0, 3
    v_lshl_add_u32 v14, v10, 4, v14
    v_mov_b32 v3, 0
    v_bfe_u32 v10, v0, 0, 4
    v_lshl_add_u32 v3, v10, 7, v3
    v_mov_b64 v[234:235], 0
    v_mov_b64 v[238:239], 0
    v_mov_b64 v[242:243], 0
    s_lshl_b32 s22, s18, 7
    s_add_u32 s22, s22, 58720260
    v_lshlrev_b32 v11, 12, v0
Wp_16:
    buffer_load_dword v10, v11, s[8:11], s22 offen sc1
    s_waitcnt vmcnt(0)
    v_cmp_ne_u32 vcc, 1, v10
    s_cbranch_vccz Wp_16_ok
    s_mov_b64 exec, vcc
    s_add_u32 s21, s21, 1
    s_cmp_lt_u32 s21, 400000
    s_cbranch_scc1 Wp_16
Wp_16_ok:
    s_mov_b64 exec, -1
    v_and_b32 v12, 15, v0
    v_min_u32 v12, 13, v12
    v_lshlrev_b32 v12, 7, v12
    s_mov_b32 s22, 58720268
    v_lshrrev_b32 v11, 4, v0
    v_add_u32 v11, 0, v11
    v_mul_u32_u24 v11, 10, v11
    v_add_u32 v11, s19, v11
    v_mov_b32 v13, s63
    v_cmp_gt_u32 vcc, 59, v11
    s_nop 1
    v_cndmask_b32 v11, v13, v11, vcc
    v_lshl_add_u32 v11, v11, 12, v12
Wp_17:
    buffer_load_dword v10, v11, s[8:11], s22 offen sc1
    s_waitcnt vmcnt(0)
    v_cmp_ne_u32 vcc, 1, v10
    s_cbranch_vccz Wp_17_ok
    s_mov_b64 exec, vcc
    s_add_u32 s21, s21, 1
    s_cmp_lt_u32 s21, 400000
    s_cbranch_scc1 Wp_17
Wp_17_ok:
    s_mov_b64 exec, -1
    v_lshrrev_b32 v11, 4, v0
    v_add_u32 v11, 4, v11
    v_mul_u32_u24 v11, 10, v11
    v_add_u32 v11, s19, v11
    v_mov_b32 v13, s63
    v_cmp_gt_u32 vcc, 59, v11
    s_nop 1
    v_cndmask_b32 v11, v13, v11, vcc
    v_lshl_add_u32 v11, v11, 12, v12
Wp_18:
    buffer_load_dword v10, v11, s[8:11], s22 offen sc1
    s_waitcnt vmcnt(0)
    v_cmp_ne_u32 vcc, 1, v10
    s_cbranch_vccz Wp_18_ok
    s_mov_b64 exec, vcc
    s_add_u32 s21, s21, 1
    s_cmp_lt_u32 s21, 400000
    s_cbranch_scc1 Wp_18
Wp_18_ok:
    s_mov_b64 exec, -1
    s_mov_b32 s20, s19
    s_mov_b32 s28, s16
    s_mov_b32 s64, 0
    s_mov_b32 s27, -1
    s_lshl_b32 s22, s20, 18
    s_lshl_b32 s23, s16, 14
    s_add_u32 s22, s22, s23
    s_lshl_b32 s57, s17, 12
    s_add_u32 s22, s22, s57
    s_add_u32 s67, s22, 134217728
    s_lshl_b32 s66, s22, 1
    s_add_u32 s66, s66, 4096
    s_add_u32 m0, s57, 0
    s_nop 0
    buffer_load_dwordx4 v1, s[8:11], s67 offen offset:0 sc1 lds
    buffer_load_dwordx4 v1, s[8:11], s67 offen offset:1024 sc1 lds
    buffer_load_dwordx4 v1, s[8:11], s67 offen offset:2048 sc1 lds
    buffer_load_dwordx4 v1, s[8:11], s67 offen offset:3072 sc1 lds
    s_add_u32 m0, s57, 16384
    s_add_u32 s67, s66, 2048
    buffer_load_dwordx4 v1, s[8:11], s66 offen offset:0 sc1 lds
    buffer_load_dwordx4 v1, s[8:11], s66 offen offset:1024 sc1 lds
    buffer_load_dwordx4 v1, s[8:11], s67 offen offset:2048 sc1 lds
    buffer_load_dwordx4 v1, s[8:11], s67 offen offset:3072 sc1 lds
    s_add_u32 s67, s66, 4096
    buffer_load_dwordx4 v[144:147], v1, s[8:11], s66 offen offset:2048 sc1
    buffer_load_dwordx4 v[148:151], v1, s[8:11], s66 offen offset:3072 sc1
    buffer_load_dwordx4 v[152:155], v1, s[8:11], s67 offen offset:2048 sc1
    buffer_load_dwordx4 v[156:159], v1, s[8:11], s67 offen offset:3072 sc1
    s_waitcnt vmcnt(0)
Wat_top:
    s_barrier
    ds_read_b128 v[16:19], v7 offset:0
    ds_read_b128 v[48:51], v6 offset:0
    ds_read_b128 v[20:23], v7 offset:1024
    ds_read_b128 v[52:55], v6 offset:32
    ds_read_b128 v[24:27], v7 offset:2048
    ds_read_b128 v[56:59], v6 offset:2048
    ds_read_b128 v[28:31], v7 offset:3072
    ds_read_b128 v[60:63], v6 offset:2080
    ds_read_b128 v[32:35], v7 offset:4096
    ds_read_b128 v[64:67], v6 offset:4096
    ds_read_b128 v[36:39], v7 offset:5120
    ds_read_b128 v[68:71], v6 offset:4128
    ds_read_b128 v[40:43], v7 offset:6144
    ds_read_b128 v[72:75], v6 offset:6144
    ds_read_b128 v[44:47], v7 offset:7168
    ds_read_b128 v[76:79], v6 offset:6176
    s_add_u32 s59, s20, 10
    s_cmp_ge_u32 s59, 59
    s_cselect_b32 s59, s63, s59
    s_waitcnt lgkmcnt(14)
    v_mfma_f32_32x32x16_bf16 v[80:95], v[48:51], v[16:19], v[192:207]
    s_waitcnt lgkmcnt(12)
    v_mfma_f32_32x32x16_bf16 v[80:95], v[52:55], v[20:23], v[80:95]
    s_waitcnt lgkmcnt(10)
    v_mfma_f32_32x32x16_bf16 v[80:95], v[56:59], v[24:27], v[80:95]
    s_waitcnt lgkmcnt(8)
    v_mfma_f32_32x32x16_bf16 v[80:95], v[60:63], v[28:31], v[80:95]
    s_waitcnt lgkmcnt(6)
    v_mfma_f32_32x32x16_bf16 v[80:95], v[64:67], v[32:35], v[80:95]
    s_waitcnt lgkmcnt(4)
    v_mfma_f32_32x32x16_bf16 v[80:95], v[68:71], v[36:39], v[80:95]
    s_waitcnt lgkmcnt(2)
    v_mfma_f32_32x32x16_bf16 v[80:95], v[72:75], v[40:43], v[80:95]
    s_waitcnt lgkmcnt(0)
    v_mfma_f32_32x32x16_bf16 v[80:95], v[76:79], v[44:47], v[80:95]
    s_add_u32 s56, s59, 1
    s_and_b32 s30, s56, 60
    s_lshl_b32 s30, s30, 10
    s_lshl_b32 s23, s18, 7
    s_add_u32 s30, s30, s23
    s_add_u32 s30, s30, 58720264
    s_mul_i32 s65, s20, 1048576
    s_add_u32 s65, s65, 67108864
    s_and_b32 s23, s16, 12
    s_add_u32 s23, s23, s16
    s_lshl_b32 s23, s23, 15
    s_add_u32 s65, s65, s23
    s_lshl_b32 s67, s20, 15
    s_waitcnt vmcnt(0)
    s_barrier
    s_lshr_b32 s22, s27, 31
    s_or_b32 s22, s22, s17
    s_cbranch_scc1 Wf_19
    s_lshl_b32 s22, s27, 12
    s_lshl_b32 s23, s16, 7
    s_add_u32 s22, s22, s23
    s_add_u32 s22, s22, 58720256
    v_mov_b32 v10, 1
    s_mov_b64 exec, 1
    buffer_store_dword v10, off, s[8:11], s22 sc1
    s_mov_b64 exec, -1
Wf_19:
    v_max3_f32 v13, v80, v81, v82
    v_max3_f32 v13, v13, v83, v84
    v_max3_f32 v13, v13, v85, v86
    v_max3_f32 v13, v13, v87, v88
    v_max3_f32 v13, v13, v89, v90
    v_max3_f32 v13, v13, v91, v92
    v_max3_f32 v13, v13, v93, v94
    v_max_f32 v13, v13, v95
    s_cmp_eq_u32 s64, 0
    s_cbranch_scc1 Wat_k1
    v_mfma_f32_32x32x16_bf16 v[96:111], v[112:115], v[16:19], 0
    s_add_u32 s23, s65, 16384
    buffer_load_dwordx4 v[160:163], v4, s[8:11], s23 offen sc1
    buffer_load_dword v248, v8, s[40:43], s67 offen offset:0
    v_mfma_f32_32x32x16_bf16 v[96:111], v[116:119], v[20:23], v[96:111]
    s_add_u32 s23, s65, 20480
    buffer_load_dwordx4 v[164:167], v4, s[8:11], s23 offen sc1
    buffer_load_dword v249, v8, s[40:43], s67 offen offset:128
    v_mfma_f32_32x32x16_bf16 v[96:111], v[120:123], v[24:27], v[96:111]
    s_add_u32 s23, s65, 24576
    buffer_load_dwordx4 v[168:171], v4, s[8:11], s23 offen sc1
    buffer_load_dword v250, off, s[8:11], s30 sc1
    v_mfma_f32_32x32x16_bf16 v[96:111], v[124:127], v[28:31], v[96:111]
    s_add_u32 s23, s65, 28672
    buffer_load_dwordx4 v[172:175], v5, s[8:11], s23 offen sc1
    v_mfma_f32_32x32x16_bf16 v[96:111], v[128:131], v[32:35], v[96:111]
    s_add_u32 s23, s65, 147456
    buffer_load_dwordx4 v[176:179], v4, s[8:11], s23 offen sc1
    v_mfma_f32_32x32x16_bf16 v[96:111], v[132:135], v[36:39], v[96:111]
    s_add_u32 s23, s65, 151552
    buffer_load_dwordx4 v[180:183], v4, s[8:11], s23 offen sc1
    v_mfma_f32_32x32x16_bf16 v[96:111], v[136:139], v[40:43], v[96:111]
    s_add_u32 s23, s65, 155648
    buffer_load_dwordx4 v[184:187], v4, s[8:11], s23 offen sc1
    v_mfma_f32_32x32x16_bf16 v[96:111], v[140:143], v[44:47], v[96:111]
    s_add_u32 s23, s65, 159744
    buffer_load_dwordx4 v[188:191], v5, s[8:11], s23 offen sc1
    s_branch Wat_k2
Wat_k1:
    s_add_u32 s23, s65, 16384
    buffer_load_dwordx4 v[160:163], v4, s[8:11], s23 offen sc1
    s_add_u32 s23, s65, 20480
    buffer_load_dwordx4 v[164:167], v4, s[8:11], s23 offen sc1
    s_add_u32 s23, s65, 24576
    buffer_load_dwordx4 v[168:171], v4, s[8:11], s23 offen sc1
    s_add_u32 s23, s65, 28672
    buffer_load_dwordx4 v[172:175], v5, s[8:11], s23 offen sc1
    s_add_u32 s23, s65, 147456
    buffer_load_dwordx4 v[176:179], v4, s[8:11], s23 offen sc1
    s_add_u32 s23, s65, 151552
    buffer_load_dwordx4 v[180:183], v4, s[8:11], s23 offen sc1
    s_add_u32 s23, s65, 155648
    buffer_load_dwordx4 v[184:187], v4, s[8:11], s23 offen sc1
    s_add_u32 s23, s65, 159744
    buffer_load_dwordx4 v[188:191], v5, s[8:11], s23 offen sc1
    buffer_load_dword v248, v8, s[40:43], s67 offen offset:0
    buffer_load_dword v249, v8, s[40:43], s67 offen offset:128
    buffer_load_dword v250, off, s[8:11], s30 sc1
    s_waitcnt vmcnt(10)
    v_mfma_f32_16x16x32_bf16 v[212:215], v[208:211], v[160:163], 0
    s_waitcnt vmcnt(9)
    v_mfma_f32_16x16x32_bf16 v[212:215], v[208:211], v[164:167], v[212:215]
    s_waitcnt vmcnt(8)
    v_mfma_f32_16x16x32_bf16 v[212:215], v[208:211], v[168:171], v[212:215]
    s_waitcnt vmcnt(7)
    v_mfma_f32_16x16x32_bf16 v[212:215], v[208:211], v[172:175], v[212:215]
    s_waitcnt vmcnt(6)
    v_mfma_f32_16x16x32_bf16 v[216:219], v[208:211], v[176:179], 0
    s_waitcnt vmcnt(5)
    v_mfma_f32_16x16x32_bf16 v[216:219], v[208:211], v[180:183], v[216:219]
    s_waitcnt vmcnt(4)
    v_mfma_f32_16x16x32_bf16 v[216:219], v[208:211], v[184:187], v[216:219]
    s_waitcnt vmcnt(3)
    v_mfma_f32_16x16x32_bf16 v[216:219], v[208:211], v[188:191], v[216:219]
    v_add_f32 v212, v212, v244
    v_add_f32 v213, v213, v245
    s_nop 5
    v_add_f32 v216, v216, v246
    v_add_f32 v217, v217, v247
    v_mul_f32 v214, 0xbfb8aa3b, v212
    v_mul_f32 v215, 0xbfb8aa3b, v213
    v_mul_f32 v218, 0xbfb8aa3b, v216
    v_mul_f32 v219, 0xbfb8aa3b, v217
    v_exp_f32 v214, v214
    v_exp_f32 v215, v215
    v_exp_f32 v218, v218
    v_exp_f32 v219, v219
    v_add_f32 v214, 1.0, v214
    v_add_f32 v215, 1.0, v215
    v_add_f32 v218, 1.0, v218
    v_add_f32 v219, 1.0, v219
    v_rcp_f32 v214, v214
    v_rcp_f32 v215, v215
    v_rcp_f32 v218, v218
    v_rcp_f32 v219, v219
    v_mul_f32 v212, v212, v214
    v_mul_f32 v213, v213, v215
    v_mul_f32 v216, v216, v218
    v_mul_f32 v217, v217, v219
    s_waitcnt vmcnt(2)
    v_lshlrev_b32 v214, 16, v248
    v_and_b32 v215, 0xffff0000, v248
    s_waitcnt vmcnt(1)
    v_lshlrev_b32 v218, 16, v249
    v_and_b32 v219, 0xffff0000, v249
    s_cmp_lt_i32 s27, 0
    s_cbranch_scc1 Wat_k3
    s_lshl_b32 s22, s27, 12
    s_add_u32 s22, s22, 58720256
Wp_20:
    buffer_load_dword v10, v3, s[8:11], s22 offen sc1
    s_waitcnt vmcnt(0)
    v_cmp_ne_u32 vcc, 1, v10
    s_cbranch_vccz Wp_20_ok
    s_mov_b64 exec, vcc
    s_add_u32 s21, s21, 1
    s_cmp_lt_u32 s21, 400000
    s_cbranch_scc1 Wp_20
Wp_20_ok:
    s_mov_b64 exec, -1
    s_mul_i32 s65, s27, 1048576
    s_add_u32 s65, s65, 67108864
    s_and_b32 s23, s16, 12
    s_add_u32 s23, s23, s16
    s_lshl_b32 s23, s23, 15
    s_add_u32 s65, s65, s23
    s_add_u32 s23, s65, 0
    buffer_load_dwordx4 v[48:51], v4, s[8:11], s23 offen sc1
    s_add_u32 s23, s65, 4096
    buffer_load_dwordx4 v[52:55], v4, s[8:11], s23 offen sc1
    s_add_u32 s23, s65, 8192
    buffer_load_dwordx4 v[56:59], v4, s[8:11], s23 offen sc1
    s_add_u32 s23, s65, 12288
    buffer_load_dwordx4 v[60:63], v4, s[8:11], s23 offen sc1
    s_add_u32 s23, s65, 131072
    buffer_load_dwordx4 v[64:67], v4, s[8:11], s23 offen sc1
    s_add_u32 s23, s65, 135168
    buffer_load_dwordx4 v[68:71], v4, s[8:11], s23 offen sc1
    s_add_u32 s23, s65, 139264
    buffer_load_dwordx4 v[72:75], v4, s[8:11], s23 offen sc1
    s_add_u32 s23, s65, 143360
    buffer_load_dwordx4 v[76:79], v4, s[8:11], s23 offen sc1
    s_lshl_b32 s22, s27, 15
    s_waitcnt vmcnt(7)
    v_mfma_f32_16x16x32_bf16 v[228:231], v[208:211], v[48:51], 0
    s_waitcnt vmcnt(6)
    v_mfma_f32_16x16x32_bf16 v[228:231], v[208:211], v[52:55], v[228:231]
    s_waitcnt vmcnt(5)
    v_mfma_f32_16x16x32_bf16 v[228:231], v[208:211], v[56:59], v[228:231]
    s_waitcnt vmcnt(4)
    v_mfma_f32_16x16x32_bf16 v[228:231], v[208:211], v[60:63], v[228:231]
    s_nop 0
    s_nop 6
    v_fmac_f32 v222, v228, v220
    v_fmac_f32 v223, v229, v221
    v_cvt_pk_bf16_f32 v222, v222, v223
    buffer_store_dword v222, v8, s[44:47], s22 offen offset:0 sc1
    s_waitcnt vmcnt(4)
    v_mfma_f32_16x16x32_bf16 v[228:231], v[208:211], v[64:67], 0
    s_waitcnt vmcnt(3)
    v_mfma_f32_16x16x32_bf16 v[228:231], v[208:211], v[68:71], v[228:231]
    s_waitcnt vmcnt(2)
    v_mfma_f32_16x16x32_bf16 v[228:231], v[208:211], v[72:75], v[228:231]
    s_waitcnt vmcnt(1)
    v_mfma_f32_16x16x32_bf16 v[228:231], v[208:211], v[76:79], v[228:231]
    s_nop 0
    s_nop 6
    v_fmac_f32 v226, v228, v224
    v_fmac_f32 v227, v229, v225
    v_cvt_pk_bf16_f32 v226, v226, v227
    buffer_store_dword v226, v8, s[44:47], s22 offen offset:128 sc1
    s_mov_b32 s27, -1
Wat_k3:
    s_getpc_b64 s[4:5]
Wat_pc:
    v_lshlrev_b32 v10, 7, v0
    v_min_u32 v10, Wend-Wat_pc, v10
    global_load_dword v251, v10, s[4:5]
    s_cmp_lt_u32 s20, 62
    s_cbranch_scc1 Wat_k4
    v_mov_b32 v14, 49152
    v_bfe_u32 v10, v0, 5, 1
    v_lshl_add_u32 v14, v10, 8, v14
    v_bfe_u32 v10, v0, 1, 2
    v_lshl_add_u32 v14, v10, 6, v14
    v_bfe_u32 v10, v0, 0, 1
    v_lshl_add_u32 v14, v10, 4, v14
    v_mov_b32 v15, 49160
    v_bfe_u32 v10, v0, 5, 1
    v_lshl_add_u32 v15, v10, 9, v15
    v_bfe_u32 v10, v0, 4, 1
    v_lshl_add_u32 v15, v10, 7, v15
    v_bfe_u32 v10, v0, 0, 3
    v_lshl_add_u32 v15, v10, 4, v15
    v_bfe_u32 v10, v0, 3, 1
    v_lshl_add_u32 v15, v10, 2, v15
    s_and_b32 s22, s17, 2
    s_lshl_b32 s22, s22, 11
    v_add_u32 v14, s22, v14
    s_and_b32 s22, s20, 1
    s_lshl_b32 s22, s22, 4
    s_add_u32 s22, s22, s16
    s_lshl_b32 s22, s22, 13
    s_lshl_b32 s23, s17, 11
    s_add_u32 s22, s22, s23
    s_add_u32 s22, s22, 61865984
    v_add_u32 v15, s23, v15
    v_add_u32 v11, 1024, v15
    s_add_u32 s23, s23, 49152
    v_add_u32 v12, s23, v1
Wat_km:
    buffer_load_dwordx4 v[112:115], v1, s[8:11], s22 offen offset:0 sc1
    buffer_load_dwordx4 v[116:119], v1, s[8:11], s22 offen offset:1024 sc1
    s_waitcnt vmcnt(1)
    ds_write_b128 v12, v[112:115] offset:0
    s_waitcnt vmcnt(0)
    ds_write_b128 v12, v[116:119] offset:1024
    v_max3_u32 v10, v112, v113, v114
    v_max3_u32 v10, v10, v115, v116
    v_max3_u32 v10, v10, v117, v118
    v_max_u32 v10, v10, v119
    v_cmp_eq_u32 vcc, -1, v10
    s_cbranch_vccz Wat_km_ok
    s_add_u32 s21, s21, 1
    s_cmp_lt_u32 s21, 400000
    s_cbranch_scc1 Wat_km
Wat_km_ok:
    s_waitcnt lgkmcnt(0)
    s_barrier
    ds_read_b64 v[112:113], v14 offset:0
    ds_read_b64 v[114:115], v14 offset:1024
    ds_read_b64 v[116:117], v14 offset:32
    ds_read_b64 v[118:119], v14 offset:1056
    ds_read_b64 v[120:121], v14 offset:512
    ds_read_b64 v[122:123], v14 offset:1536
    ds_read_b64 v[124:125], v14 offset:544
    ds_read_b64 v[126:127], v14 offset:1568
    s_waitcnt lgkmcnt(6)
    v_mfma_f32_32x32x16_bf16 v[96:111], v[112:115], v[16:19], 0
    ds_read_b64 v[128:129], v14 offset:2048
    ds_read_b64 v[130:131], v14 offset:3072
    s_waitcnt lgkmcnt(6)
    v_mfma_f32_32x32x16_bf16 v[96:111], v[116:119], v[20:23], v[96:111]
    ds_read_b64 v[132:133], v14 offset:2080
    ds_read_b64 v[134:135], v14 offset:3104
    s_waitcnt lgkmcnt(6)
    v_mfma_f32_32x32x16_bf16 v[96:111], v[120:123], v[24:27], v[96:111]
    ds_read_b64 v[136:137], v14 offset:2560
    ds_read_b64 v[138:139], v14 offset:3584
    s_waitcnt lgkmcnt(6)
    v_mfma_f32_32x32x16_bf16 v[96:111], v[124:127], v[28:31], v[96:111]
    ds_read_b64 v[140:141], v14 offset:2592
    ds_read_b64 v[142:143], v14 offset:3616
    s_waitcnt lgkmcnt(6)
    v_mfma_f32_32x32x16_bf16 v[96:111], v[128:131], v[32:35], v[96:111]
    ds_read2_b32 v[232:233], v15 offset0:0 offset1:64
    ds_read2_b32 v[236:237], v11 offset0:0 offset1:64
    s_waitcnt lgkmcnt(6)
    v_mfma_f32_32x32x16_bf16 v[96:111], v[132:135], v[36:39], v[96:111]
    s_waitcnt lgkmcnt(4)
    v_mfma_f32_32x32x16_bf16 v[96:111], v[136:139], v[40:43], v[96:111]
    s_waitcnt lgkmcnt(0)
    s_branch Wat_k5
Wat_k4:
    s_add_u32 s56, s20, 1
    s_and_b32 s30, s56, 60
    s_lshl_b32 s30, s30, 10
    s_lshl_b32 s23, s18, 7
    s_add_u32 s30, s30, s23
    s_add_u32 s30, s30, 58720264
    s_mov_b64 exec, 1
Wp_21:
    buffer_load_dword v10, off, s[8:11], s30 sc1
    s_waitcnt vmcnt(0)
    v_cmp_ne_u32 vcc, 1, v10
    s_cbranch_vccz Wp_21_ok
    s_mov_b64 exec, vcc
    s_add_u32 s21, s21, 1
    s_cmp_lt_u32 s21, 400000
    s_cbranch_scc1 Wp_21
Wp_21_ok:
    s_mov_b64 exec, -1
    s_add_u32 s56, s20, 1
    s_lshr_b32 s24, s56, 2
    s_lshl_b32 s22, s24, 19
    s_lshl_b32 s23, s18, 14
    s_add_u32 s31, s22, s23
    s_add_u32 s31, s31, 34603008
    s_and_b32 s23, s17, 1
    s_lshl_b32 s23, s23, 13
    s_add_u32 s24, s31, s23
    s_and_b32 s23, s56, 2
    s_lshl_b32 s23, s23, 9
    s_add_u32 s24, s24, s23
    s_and_b32 s23, s56, 1
    s_lshl_b32 s23, s23, 3
    s_add_u32 s24, s24, s23
    s_and_b32 s23, s56, 3
    s_lshl_b32 s23, s23, 7
    s_add_u32 s31, s31, s23
    s_mov_b32 exec_lo, 0xff
    s_mov_b32 exec_hi, 0xff
    buffer_load_dwordx4 v[112:115], v14, s[8:11], s31 offen offset:0 sc1
    buffer_load_dwordx4 v[116:119], v14, s[8:11], s31 offen offset:1024 sc1
    s_add_u32 s31, s31, 4096
    buffer_load_dwordx4 v[120:123], v14, s[8:11], s31 offen offset:0 sc1
    buffer_load_dwordx4 v[124:127], v14, s[8:11], s31 offen offset:1024 sc1
    s_add_u32 s31, s31, 4096
    buffer_load_dwordx4 v[128:131], v14, s[8:11], s31 offen offset:0 sc1
    buffer_load_dwordx4 v[132:135], v14, s[8:11], s31 offen offset:1024 sc1
    s_add_u32 s31, s31, 4096
    buffer_load_dwordx4 v[136:139], v14, s[8:11], s31 offen offset:0 sc1
    buffer_load_dwordx4 v[140:143], v14, s[8:11], s31 offen offset:1024 sc1
    s_add_u32 s31, s31, 4096
    s_mov_b64 exec, -1
    buffer_load_dwordx2 v[232:233], v1, s[8:11], s24 offen offset:2048 sc1
    s_add_u32 s24, s24, 4096
    buffer_load_dwordx2 v[236:237], v1, s[8:11], s24 offen offset:2048 sc1
    s_add_u32 s24, s24, 4096
    s_waitcnt vmcnt(9)
    v_mfma_f32_32x32x16_bf16 v[96:111], v[112:115], v[16:19], 0
    s_waitcnt vmcnt(8)
    v_mfma_f32_32x32x16_bf16 v[96:111], v[116:119], v[20:23], v[96:111]
    s_waitcnt vmcnt(7)
    v_mfma_f32_32x32x16_bf16 v[96:111], v[120:123], v[24:27], v[96:111]
    s_waitcnt vmcnt(6)
    v_mfma_f32_32x32x16_bf16 v[96:111], v[124:127], v[28:31], v[96:111]
    s_waitcnt vmcnt(5)
    v_mfma_f32_32x32x16_bf16 v[96:111], v[128:131], v[32:35], v[96:111]
    s_waitcnt vmcnt(4)
    v_mfma_f32_32x32x16_bf16 v[96:111], v[132:135], v[36:39], v[96:111]
    s_waitcnt vmcnt(3)
    v_mfma_f32_32x32x16_bf16 v[96:111], v[136:139], v[40:43], v[96:111]
    s_waitcnt vmcnt(0)
Wat_k5:
    v_mfma_f32_32x32x16_bf16 v[96:111], v[140:143], v[44:47], v[96:111]
Wat_k2:
    s_nop 0
    s_nop 10
    v_max3_f32 v13, v13, v96, v97
    v_max3_f32 v13, v13, v98, v99
    v_mov_b32 v10, v13
    s_nop 1
    v_permlane32_swap_b32 v13, v10
    v_max_f32 v13, v13, v10
    v_sub_f32 v80, v80, v13
    v_sub_f32 v81, v81, v13
    v_sub_f32 v82, v82, v13
    v_sub_f32 v83, v83, v13
    v_sub_f32 v84, v84, v13
    v_sub_f32 v85, v85, v13
    v_sub_f32 v86, v86, v13
    v_sub_f32 v87, v87, v13
    v_sub_f32 v88, v88, v13
    v_sub_f32 v89, v89, v13
    v_sub_f32 v90, v90, v13
    v_sub_f32 v91, v91, v13
    v_sub_f32 v92, v92, v13
    v_sub_f32 v93, v93, v13
    v_sub_f32 v94, v94, v13
    v_sub_f32 v95, v95, v13
    v_sub_f32 v96, v96, v13
    v_sub_f32 v97, v97, v13
    v_sub_f32 v98, v98, v13
    v_sub_f32 v99, v99, v13
    v_exp_f32 v80, v80
    v_exp_f32 v81, v81
    v_exp_f32 v82, v82
    v_exp_f32 v83, v83
    v_exp_f32 v84, v84
    v_exp_f32 v85, v85
    v_exp_f32 v86, v86
    v_exp_f32 v87, v87
    v_exp_f32 v88, v88
    v_exp_f32 v89, v89
    v_exp_f32 v90, v90
    v_exp_f32 v91, v91
    v_exp_f32 v92, v92
    v_exp_f32 v93, v93
    v_exp_f32 v94, v94
    v_exp_f32 v95, v95
    v_exp_f32 v96, v96
    v_exp_f32 v97, v97
    v_exp_f32 v98, v98
    v_exp_f32 v99, v99
    v_cvt_pk_bf16_f32 v104, v80, v81
    v_cvt_pk_bf16_f32 v105, v82, v83
    v_cvt_pk_bf16_f32 v106, v84, v85
    v_cvt_pk_bf16_f32 v107, v86, v87
    v_cvt_pk_bf16_f32 v108, v88, v89
    v_cvt_pk_bf16_f32 v109, v90, v91
    v_cvt_pk_bf16_f32 v110, v92, v93
    v_cvt_pk_bf16_f32 v111, v94, v95
    v_cvt_pk_bf16_f32 v240, v96, v97
    v_cvt_pk_bf16_f32 v241, v98, v99
    s_cmp_eq_u32 s64, 0
    s_cbranch_scc1 Wat_k6
    s_waitcnt vmcnt(10)
    v_mfma_f32_16x16x32_bf16 v[212:215], v[208:211], v[160:163], 0
    s_waitcnt vmcnt(8)
    v_mfma_f32_16x16x32_bf16 v[212:215], v[208:211], v[164:167], v[212:215]
    s_waitcnt vmcnt(6)
    v_mfma_f32_16x16x32_bf16 v[212:215], v[208:211], v[168:171], v[212:215]
    s_waitcnt vmcnt(4)
    v_mfma_f32_16x16x32_bf16 v[212:215], v[208:211], v[172:175], v[212:215]
    s_waitcnt vmcnt(3)
    v_mfma_f32_16x16x32_bf16 v[216:219], v[208:211], v[176:179], 0
    s_waitcnt vmcnt(2)
    v_mfma_f32_16x16x32_bf16 v[216:219], v[208:211], v[180:183], v[216:219]
    s_waitcnt vmcnt(1)
    v_mfma_f32_16x16x32_bf16 v[216:219], v[208:211], v[184:187], v[216:219]
    s_waitcnt vmcnt(0)
    v_mfma_f32_16x16x32_bf16 v[216:219], v[208:211], v[188:191], v[216:219]
    v_add_f32 v212, v212, v244
    v_add_f32 v213, v213, v245
    s_nop 5
    v_add_f32 v216, v216, v246
    v_add_f32 v217, v217, v247
    v_mul_f32 v214, 0xbfb8aa3b, v212
    v_mul_f32 v215, 0xbfb8aa3b, v213
    v_mul_f32 v218, 0xbfb8aa3b, v216
    v_mul_f32 v219, 0xbfb8aa3b, v217
    v_exp_f32 v214, v214
    v_exp_f32 v215, v215
    v_exp_f32 v218, v218
    v_exp_f32 v219, v219
    v_add_f32 v214, 1.0, v214
    v_add_f32 v215, 1.0, v215
    v_add_f32 v218, 1.0, v218
    v_add_f32 v219, 1.0, v219
    v_rcp_f32 v214, v214
    v_rcp_f32 v215, v215
    v_rcp_f32 v218, v218
    v_rcp_f32 v219, v219
    v_mul_f32 v212, v212, v214
    v_mul_f32 v213, v213, v215
    v_mul_f32 v216, v216, v218
    v_mul_f32 v217, v217, v219
    v_lshlrev_b32 v214, 16, v248
    v_and_b32 v215, 0xffff0000, v248
    v_lshlrev_b32 v218, 16, v249
    v_and_b32 v219, 0xffff0000, v249
Wat_k6:
    s_waitcnt vmcnt(0)
    v_mfma_f32_32x32x16_bf16 v[160:175], v[144:147], v[104:107], 0
    v_add_f32 v80, v80, v81
    v_add_f32 v82, v82, v83
    v_add_f32 v84, v84, v85
    v_add_f32 v86, v86, v87
    v_add_f32 v88, v88, v89
    v_mfma_f32_32x32x16_bf16 v[160:175], v[148:151], v[108:111], v[160:175]
    v_add_f32 v90, v90, v91
    v_add_f32 v92, v92, v93
    v_add_f32 v94, v94, v95
    v_add_f32 v96, v96, v97
    v_add_f32 v98, v98, v99
    v_mfma_f32_32x32x16_bf16 v[160:175], v[232:235], v[240:243], v[160:175]
    v_add_f32 v80, v80, v82
    v_add_f32 v80, v80, v84
    v_add_f32 v80, v80, v86
    v_add_f32 v80, v80, v88
    v_add_f32 v80, v80, v90
    v_mfma_f32_32x32x16_bf16 v[176:191], v[152:155], v[104:107], 0
    v_add_f32 v80, v80, v92
    v_add_f32 v80, v80, v94
    v_add_f32 v80, v80, v96
    v_add_f32 v80, v80, v98
    v_mov_b32 v10, v80
    v_mfma_f32_32x32x16_bf16 v[176:191], v[156:159], v[108:111], v[176:191]
    s_nop 0
    v_permlane32_swap_b32 v80, v10
    v_add_f32 v10, v80, v10
    v_rcp_f32 v10, v10
    v_mfma_f32_32x32x16_bf16 v[176:191], v[236:239], v[240:243], v[176:191]
    s_lshl_b32 s22, s27, 12
    s_add_u32 s22, s22, 58720256
    buffer_load_dword v251, v3, s[8:11], s22 offen sc1
    s_lshl_b32 s22, s17, 12
    v_add_u32 v12, s22, v1
    v_pk_mul_f32 v[160:161], v[160:161], v[10:11] op_sel_hi:[1,0]
    v_pk_mul_f32 v[162:163], v[162:163], v[10:11] op_sel_hi:[1,0]
    v_pk_mul_f32 v[164:165], v[164:165], v[10:11] op_sel_hi:[1,0]
    v_pk_mul_f32 v[166:167], v[166:167], v[10:11] op_sel_hi:[1,0]
    v_pk_mul_f32 v[168:169], v[168:169], v[10:11] op_sel_hi:[1,0]
    v_pk_mul_f32 v[170:171], v[170:171], v[10:11] op_sel_hi:[1,0]
    v_pk_mul_f32 v[172:173], v[172:173], v[10:11] op_sel_hi:[1,0]
    v_pk_mul_f32 v[174:175], v[174:175], v[10:11] op_sel_hi:[1,0]
    v_cvt_pk_bf16_f32 v160, v160, v161
    v_cvt_pk_bf16_f32 v161, v162, v163
    v_cvt_pk_bf16_f32 v162, v164, v165
    v_cvt_pk_bf16_f32 v163, v166, v167
    v_cvt_pk_bf16_f32 v164, v168, v169
    v_cvt_pk_bf16_f32 v165, v170, v171
    v_cvt_pk_bf16_f32 v166, v172, v173
    v_cvt_pk_bf16_f32 v167, v174, v175
    ds_write_b128 v12, v[160:163] offset:32768
    ds_write_b128 v12, v[164:167] offset:33792
    v_pk_mul_f32 v[176:177], v[176:177], v[10:11] op_sel_hi:[1,0]
    v_pk_mul_f32 v[178:179], v[178:179], v[10:11] op_sel_hi:[1,0]
    v_pk_mul_f32 v[180:181], v[180:181], v[10:11] op_sel_hi:[1,0]
    v_pk_mul_f32 v[182:183], v[182:183], v[10:11] op_sel_hi:[1,0]
    v_pk_mul_f32 v[184:185], v[184:185], v[10:11] op_sel_hi:[1,0]
    v_pk_mul_f32 v[186:187], v[186:187], v[10:11] op_sel_hi:[1,0]
    v_pk_mul_f32 v[188:189], v[188:189], v[10:11] op_sel_hi:[1,0]
    v_pk_mul_f32 v[190:191], v[190:191], v[10:11] op_sel_hi:[1,0]
    v_cvt_pk_bf16_f32 v176, v176, v177
    v_cvt_pk_bf16_f32 v177, v178, v179
    v_cvt_pk_bf16_f32 v178, v180, v181
    v_cvt_pk_bf16_f32 v179, v182, v183
    v_cvt_pk_bf16_f32 v180, v184, v185
    v_cvt_pk_bf16_f32 v181, v186, v187
    v_cvt_pk_bf16_f32 v182, v188, v189
    v_cvt_pk_bf16_f32 v183, v190, v191
    ds_write_b128 v12, v[176:179] offset:34816
    ds_write_b128 v12, v[180:183] offset:35840
    s_waitcnt lgkmcnt(0)
    s_barrier
    ds_read_b128 v[16:19], v1 offset:32768
    ds_read_b128 v[20:23], v1 offset:33792
    ds_read_b128 v[24:27], v1 offset:34816
    ds_read_b128 v[28:31], v1 offset:35840
    ds_read_b128 v[32:35], v1 offset:36864
    ds_read_b128 v[36:39], v1 offset:37888
    ds_read_b128 v[40:43], v1 offset:38912
    ds_read_b128 v[44:47], v1 offset:39936
    ds_read_b128 v[48:51], v1 offset:40960
    ds_read_b128 v[52:55], v1 offset:41984
    ds_read_b128 v[56:59], v1 offset:43008
    ds_read_b128 v[60:63], v1 offset:44032
    ds_read_b128 v[64:67], v1 offset:45056
    ds_read_b128 v[68:71], v1 offset:46080
    ds_read_b128 v[72:75], v1 offset:47104
    ds_read_b128 v[76:79], v1 offset:48128
    s_cmp_ge_u32 s20, 59
    s_cbranch_scc1 Wat_last
    v_readfirstlane_b32 s64, v250
    s_nop 3
    s_cmp_lt_u32 s59, 62
    s_cselect_b32 s64, s64, 0
    s_cmp_eq_u32 s64, 0
    s_cbranch_scc1 Wat_g3
    s_add_u32 s56, s59, 1
    s_lshr_b32 s24, s56, 2
    s_lshl_b32 s22, s24, 19
    s_lshl_b32 s23, s18, 14
    s_add_u32 s31, s22, s23
    s_add_u32 s31, s31, 34603008
    s_and_b32 s23, s17, 1
    s_lshl_b32 s23, s23, 13
    s_add_u32 s24, s31, s23
    s_and_b32 s23, s56, 2
    s_lshl_b32 s23, s23, 9
    s_add_u32 s24, s24, s23
    s_and_b32 s23, s56, 1
    s_lshl_b32 s23, s23, 3
    s_add_u32 s24, s24, s23
    s_and_b32 s23, s56, 3
    s_lshl_b32 s23, s23, 7
    s_add_u32 s31, s31, s23
    s_mov_b32 exec_lo, 0xff
    s_mov_b32 exec_hi, 0xff
    buffer_load_dwordx4 v[112:115], v14, s[8:11], s31 offen offset:0 sc1
    buffer_load_dwordx4 v[116:119], v14, s[8:11], s31 offen offset:1024 sc1
    s_add_u32 s31, s31, 4096
    buffer_load_dwordx4 v[120:123], v14, s[8:11], s31 offen offset:0 sc1
    buffer_load_dwordx4 v[124:127], v14, s[8:11], s31 offen offset:1024 sc1
    s_add_u32 s31, s31, 4096
    buffer_load_dwordx4 v[128:131], v14, s[8:11], s31 offen offset:0 sc1
    buffer_load_dwordx4 v[132:135], v14, s[8:11], s31 offen offset:1024 sc1
    s_add_u32 s31, s31, 4096
    buffer_load_dwordx4 v[136:139], v14, s[8:11], s31 offen offset:0 sc1
    buffer_load_dwordx4 v[140:143], v14, s[8:11], s31 offen offset:1024 sc1
    s_add_u32 s31, s31, 4096
    s_mov_b64 exec, -1
    buffer_load_dwordx2 v[232:233], v1, s[8:11], s24 offen offset:2048 sc1
    s_add_u32 s24, s24, 4096
    buffer_load_dwordx2 v[236:237], v1, s[8:11], s24 offen offset:2048 sc1
    s_add_u32 s24, s24, 4096
Wat_g3:
    s_lshl_b32 s22, s59, 18
    s_lshl_b32 s23, s16, 14
    s_add_u32 s22, s22, s23
    s_lshl_b32 s57, s17, 12
    s_add_u32 s22, s22, s57
    s_add_u32 s67, s22, 134217728
    s_lshl_b32 s66, s22, 1
    s_add_u32 s66, s66, 4096
    s_add_u32 m0, s57, 0
    s_mul_i32 s61, s20, 1048576
    s_add_u32 s61, s61, 67108864
    s_mul_i32 s23, s17, 262144
    s_add_u32 s61, s61, s23
    s_lshl_b32 s23, s28, 10
    s_add_u32 s61, s61, s23
    s_waitcnt lgkmcnt(15)
    v_mfma_f32_32x32x16_bf16 v[160:175], a[0:3], v[16:19], 0
    buffer_load_dwordx4 v1, s[8:11], s67 offen offset:0 sc1 lds
    s_waitcnt lgkmcnt(14)
    v_mfma_f32_32x32x16_bf16 v[160:175], a[4:7], v[20:23], v[160:175]
    s_waitcnt lgkmcnt(13)
    v_mfma_f32_32x32x16_bf16 v[160:175], a[8:11], v[24:27], v[160:175]
    buffer_load_dwordx4 v1, s[8:11], s67 offen offset:1024 sc1 lds
    s_waitcnt lgkmcnt(12)
    v_mfma_f32_32x32x16_bf16 v[160:175], a[12:15], v[28:31], v[160:175]
    s_waitcnt lgkmcnt(11)
    v_mfma_f32_32x32x16_bf16 v[160:175], a[16:19], v[32:35], v[160:175]
    buffer_load_dwordx4 v1, s[8:11], s67 offen offset:2048 sc1 lds
    s_waitcnt lgkmcnt(10)
    v_mfma_f32_32x32x16_bf16 v[160:175], a[20:23], v[36:39], v[160:175]
    s_waitcnt lgkmcnt(9)
    v_mfma_f32_32x32x16_bf16 v[160:175], a[24:27], v[40:43], v[160:175]
    buffer_load_dwordx4 v1, s[8:11], s67 offen offset:3072 sc1 lds
    s_add_u32 m0, s57, 16384
    s_add_u32 s67, s66, 2048
    s_waitcnt lgkmcnt(8)
    v_mfma_f32_32x32x16_bf16 v[160:175], a[28:31], v[44:47], v[160:175]
    s_waitcnt lgkmcnt(7)
    v_mfma_f32_32x32x16_bf16 v[160:175], a[32:35], v[48:51], v[160:175]
    buffer_load_dwordx4 v1, s[8:11], s66 offen offset:0 sc1 lds
    s_waitcnt lgkmcnt(6)
    v_mfma_f32_32x32x16_bf16 v[160:175], a[36:39], v[52:55], v[160:175]
    s_waitcnt lgkmcnt(5)
    v_mfma_f32_32x32x16_bf16 v[160:175], a[40:43], v[56:59], v[160:175]
    buffer_load_dwordx4 v1, s[8:11], s66 offen offset:1024 sc1 lds
    s_waitcnt lgkmcnt(4)
    v_mfma_f32_32x32x16_bf16 v[160:175], a[44:47], v[60:63], v[160:175]
    s_waitcnt lgkmcnt(3)
    v_mfma_f32_32x32x16_bf16 v[160:175], a[48:51], v[64:67], v[160:175]
    buffer_load_dwordx4 v1, s[8:11], s67 offen offset:2048 sc1 lds
    s_waitcnt lgkmcnt(2)
    v_mfma_f32_32x32x16_bf16 v[160:175], a[52:55], v[68:71], v[160:175]
    s_waitcnt lgkmcnt(1)
    v_mfma_f32_32x32x16_bf16 v[160:175], a[56:59], v[72:75], v[160:175]
    buffer_load_dwordx4 v1, s[8:11], s67 offen offset:3072 sc1 lds
    s_add_u32 s67, s66, 4096
    s_waitcnt lgkmcnt(0)
    v_mfma_f32_32x32x16_bf16 v[160:175], a[60:63], v[76:79], v[160:175]
    s_nop 6
    v_mfma_f32_32x32x16_bf16 v[176:191], a[64:67], v[16:19], 0
    buffer_load_dwordx4 v[144:147], v1, s[8:11], s66 offen offset:2048 sc1
    v_mfma_f32_32x32x16_bf16 v[176:191], a[68:71], v[20:23], v[176:191]
    v_mfma_f32_32x32x16_bf16 v[176:191], a[72:75], v[24:27], v[176:191]
    s_nop 0
    v_cvt_pk_bf16_f32 v160, v160, v161
    v_cvt_pk_bf16_f32 v161, v162, v163
    v_cvt_pk_bf16_f32 v162, v164, v165
    v_cvt_pk_bf16_f32 v163, v166, v167
    buffer_store_dwordx4 v[160:163], v2, s[8:11], s61 offen offset:0 sc1
    v_mfma_f32_32x32x16_bf16 v[176:191], a[76:79], v[28:31], v[176:191]
    v_mfma_f32_32x32x16_bf16 v[176:191], a[80:83], v[32:35], v[176:191]
    v_cvt_pk_bf16_f32 v168, v168, v169
    v_cvt_pk_bf16_f32 v169, v170, v171
    v_cvt_pk_bf16_f32 v170, v172, v173
    v_cvt_pk_bf16_f32 v171, v174, v175
    buffer_store_dwordx4 v[168:171], v2, s[8:11], s61 offen offset:256 sc1
    v_mfma_f32_32x32x16_bf16 v[176:191], a[84:87], v[36:39], v[176:191]
    v_mfma_f32_32x32x16_bf16 v[176:191], a[88:91], v[40:43], v[176:191]
    buffer_load_dwordx4 v[148:151], v1, s[8:11], s66 offen offset:3072 sc1
    v_mfma_f32_32x32x16_bf16 v[176:191], a[92:95], v[44:47], v[176:191]
    v_mfma_f32_32x32x16_bf16 v[176:191], a[96:99], v[48:51], v[176:191]
    buffer_load_dwordx4 v[152:155], v1, s[8:11], s67 offen offset:2048 sc1
    v_mfma_f32_32x32x16_bf16 v[176:191], a[100:103], v[52:55], v[176:191]
    v_mfma_f32_32x32x16_bf16 v[176:191], a[104:107], v[56:59], v[176:191]
    buffer_load_dwordx4 v[156:159], v1, s[8:11], s67 offen offset:3072 sc1
    v_mfma_f32_32x32x16_bf16 v[176:191], a[108:111], v[60:63], v[176:191]
    v_mfma_f32_32x32x16_bf16 v[176:191], a[112:115], v[64:67], v[176:191]
    s_waitcnt vmcnt(14)
    s_mov_b32 s65, 1073741824
    s_cmp_lt_i32 s27, 0
    s_cbranch_scc1 Wpr_22
    v_cmp_ne_u32 vcc, 1, v251
    s_cbranch_vccz Wpr_22a
    s_lshl_b32 s22, s27, 12
    s_add_u32 s22, s22, 58720256
Wp_23:
    buffer_load_dword v10, v3, s[8:11], s22 offen sc1
    s_waitcnt vmcnt(0)
    v_cmp_ne_u32 vcc, 1, v10
    s_cbranch_vccz Wp_23_ok
    s_mov_b64 exec, vcc
    s_add_u32 s21, s21, 1
    s_cmp_lt_u32 s21, 400000
    s_cbranch_scc1 Wp_23
Wp_23_ok:
    s_mov_b64 exec, -1
Wpr_22a:
    s_mul_i32 s65, s27, 1048576
    s_add_u32 s65, s65, 67108864
    s_and_b32 s23, s16, 12
    s_add_u32 s23, s23, s16
    s_lshl_b32 s23, s23, 15
    s_add_u32 s65, s65, s23
Wpr_22:
    v_mfma_f32_32x32x16_bf16 v[176:191], a[116:119], v[68:71], v[176:191]
    v_mfma_f32_32x32x16_bf16 v[176:191], a[120:123], v[72:75], v[176:191]
    s_add_u32 s23, s65, 0
    buffer_load_dwordx4 v[80:83], v4, s[8:11], s23 offen sc1
    v_mfma_f32_32x32x16_bf16 v[176:191], a[124:127], v[76:79], v[176:191]
    s_nop 5
    v_mfma_f32_32x32x16_bf16 v[160:175], a[128:131], v[16:19], 0
    s_add_u32 s23, s65, 4096
    buffer_load_dwordx4 v[84:87], v4, s[8:11], s23 offen sc1
    v_mfma_f32_32x32x16_bf16 v[160:175], a[132:135], v[20:23], v[160:175]
    v_mfma_f32_32x32x16_bf16 v[160:175], a[136:139], v[24:27], v[160:175]
    s_nop 0
    v_cvt_pk_bf16_f32 v176, v176, v177
    v_cvt_pk_bf16_f32 v177, v178, v179
    v_cvt_pk_bf16_f32 v178, v180, v181
    v_cvt_pk_bf16_f32 v179, v182, v183
    buffer_store_dwordx4 v[176:179], v2, s[8:11], s61 offen offset:512 sc1
    v_mfma_f32_32x32x16_bf16 v[160:175], a[140:143], v[28:31], v[160:175]
    v_mfma_f32_32x32x16_bf16 v[160:175], a[144:147], v[32:35], v[160:175]
    v_cvt_pk_bf16_f32 v184, v184, v185
    v_cvt_pk_bf16_f32 v185, v186, v187
    v_cvt_pk_bf16_f32 v186, v188, v189
    v_cvt_pk_bf16_f32 v187, v190, v191
    buffer_store_dwordx4 v[184:187], v2, s[8:11], s61 offen offset:768 sc1
    s_add_u32 s61, s61, 131072
    v_mfma_f32_32x32x16_bf16 v[160:175], a[148:151], v[36:39], v[160:175]
    v_mfma_f32_32x32x16_bf16 v[160:175], a[152:155], v[40:43], v[160:175]
    s_add_u32 s23, s65, 8192
    buffer_load_dwordx4 v[88:91], v4, s[8:11], s23 offen sc1
    v_mfma_f32_32x32x16_bf16 v[160:175], a[156:159], v[44:47], v[160:175]
    v_mfma_f32_32x32x16_bf16 v[160:175], a[160:163], v[48:51], v[160:175]
    s_add_u32 s23, s65, 12288
    buffer_load_dwordx4 v[92:95], v4, s[8:11], s23 offen sc1
    v_mfma_f32_32x32x16_bf16 v[160:175], a[164:167], v[52:55], v[160:175]
    v_mfma_f32_32x32x16_bf16 v[160:175], a[168:171], v[56:59], v[160:175]
    s_add_u32 s23, s65, 131072
    buffer_load_dwordx4 v[96:99], v4, s[8:11], s23 offen sc1
    v_mfma_f32_32x32x16_bf16 v[160:175], a[172:175], v[60:63], v[160:175]
    v_mfma_f32_32x32x16_bf16 v[160:175], a[176:179], v[64:67], v[160:175]
    s_add_u32 s23, s65, 135168
    buffer_load_dwordx4 v[100:103], v4, s[8:11], s23 offen sc1
    v_mfma_f32_32x32x16_bf16 v[160:175], a[180:183], v[68:71], v[160:175]
    v_mfma_f32_32x32x16_bf16 v[160:175], a[184:187], v[72:75], v[160:175]
    s_add_u32 s23, s65, 139264
    buffer_load_dwordx4 v[104:107], v4, s[8:11], s23 offen sc1
    v_mfma_f32_32x32x16_bf16 v[160:175], a[188:191], v[76:79], v[160:175]
    s_nop 5
    v_mfma_f32_32x32x16_bf16 v[176:191], a[192:195], v[16:19], 0
    s_add_u32 s23, s65, 143360
    buffer_load_dwordx4 v[108:111], v4, s[8:11], s23 offen sc1
    v_mfma_f32_32x32x16_bf16 v[176:191], a[196:199], v[20:23], v[176:191]
    v_mfma_f32_32x32x16_bf16 v[176:191], a[200:203], v[24:27], v[176:191]
    s_nop 0
    v_cvt_pk_bf16_f32 v160, v160, v161
    v_cvt_pk_bf16_f32 v161, v162, v163
    v_cvt_pk_bf16_f32 v162, v164, v165
    v_cvt_pk_bf16_f32 v163, v166, v167
    buffer_store_dwordx4 v[160:163], v2, s[8:11], s61 offen offset:0 sc1
    v_mfma_f32_32x32x16_bf16 v[176:191], a[204:207], v[28:31], v[176:191]
    v_mfma_f32_32x32x16_bf16 v[176:191], a[208:211], v[32:35], v[176:191]
    v_cvt_pk_bf16_f32 v168, v168, v169
    v_cvt_pk_bf16_f32 v169, v170, v171
    v_cvt_pk_bf16_f32 v170, v172, v173
    v_cvt_pk_bf16_f32 v171, v174, v175
    buffer_store_dwordx4 v[168:171], v2, s[8:11], s61 offen offset:256 sc1
    v_mfma_f32_32x32x16_bf16 v[176:191], a[212:215], v[36:39], v[176:191]
    v_mfma_f32_32x32x16_bf16 v[176:191], a[216:219], v[40:43], v[176:191]
    v_mfma_f32_32x32x16_bf16 v[176:191], a[220:223], v[44:47], v[176:191]
    v_mfma_f32_32x32x16_bf16 v[176:191], a[224:227], v[48:51], v[176:191]
    v_mfma_f32_32x32x16_bf16 v[176:191], a[228:231], v[52:55], v[176:191]
    v_mfma_f32_32x32x16_bf16 v[176:191], a[232:235], v[56:59], v[176:191]
    v_mfma_f32_32x32x16_bf16 v[176:191], a[236:239], v[60:63], v[176:191]
    v_mfma_f32_32x32x16_bf16 v[176:191], a[240:243], v[64:67], v[176:191]
    v_mfma_f32_32x32x16_bf16 v[176:191], a[244:247], v[68:71], v[176:191]
    v_mfma_f32_32x32x16_bf16 v[176:191], a[248:251], v[72:75], v[176:191]
    v_mfma_f32_32x32x16_bf16 v[176:191], a[252:255], v[76:79], v[176:191]
    s_nop 0
    s_nop 10
    v_cvt_pk_bf16_f32 v176, v176, v177
    v_cvt_pk_bf16_f32 v177, v178, v179
    v_cvt_pk_bf16_f32 v178, v180, v181
    v_cvt_pk_bf16_f32 v179, v182, v183
    buffer_store_dwordx4 v[176:179], v2, s[8:11], s61 offen offset:512 sc1
    v_cvt_pk_bf16_f32 v184, v184, v185
    v_cvt_pk_bf16_f32 v185, v186, v187
    v_cvt_pk_bf16_f32 v186, v188, v189
    v_cvt_pk_bf16_f32 v187, v190, v191
    buffer_store_dwordx4 v[184:187], v2, s[8:11], s61 offen offset:768 sc1
    s_cmp_lt_i32 s27, 0
    s_cbranch_scc1 Wfp_24
    s_lshl_b32 s22, s27, 15
    s_waitcnt vmcnt(13)
    v_mfma_f32_16x16x32_bf16 v[228:231], v[208:211], v[80:83], 0
    s_waitcnt vmcnt(12)
    v_mfma_f32_16x16x32_bf16 v[228:231], v[208:211], v[84:87], v[228:231]
    s_waitcnt vmcnt(9)
    v_mfma_f32_16x16x32_bf16 v[228:231], v[208:211], v[88:91], v[228:231]
    s_waitcnt vmcnt(8)
    v_mfma_f32_16x16x32_bf16 v[228:231], v[208:211], v[92:95], v[228:231]
    s_nop 0
    s_nop 6
    v_fmac_f32 v222, v228, v220
    v_fmac_f32 v223, v229, v221
    v_cvt_pk_bf16_f32 v222, v222, v223
    buffer_store_dword v222, v8, s[44:47], s22 offen offset:0 sc1
    s_waitcnt vmcnt(8)
    v_mfma_f32_16x16x32_bf16 v[228:231], v[208:211], v[96:99], 0
    s_waitcnt vmcnt(7)
    v_mfma_f32_16x16x32_bf16 v[228:231], v[208:211], v[100:103], v[228:231]
    s_waitcnt vmcnt(6)
    v_mfma_f32_16x16x32_bf16 v[228:231], v[208:211], v[104:107], v[228:231]
    s_waitcnt vmcnt(5)
    v_mfma_f32_16x16x32_bf16 v[228:231], v[208:211], v[108:111], v[228:231]
    s_nop 0
    s_nop 6
    v_fmac_f32 v226, v228, v224
    v_fmac_f32 v227, v229, v225
    v_cvt_pk_bf16_f32 v226, v226, v227
    buffer_store_dword v226, v8, s[44:47], s22 offen offset:128 sc1
Wfp_24:
    s_nop 1
    v_mov_b64 v[220:221], v[212:213]
    v_mov_b64 v[222:223], v[214:215]
    v_mov_b64 v[224:225], v[216:217]
    v_mov_b64 v[226:227], v[218:219]
    s_mov_b32 s27, s20
    s_waitcnt vmcnt(4)
    s_mov_b32 s20, s59
    s_branch Wat_top
Wat_last:
    s_cmp_lt_i32 s27, 0
    s_cbranch_scc1 Wat_lastp
    s_waitcnt vmcnt(0)
    s_mov_b32 s65, 1073741824
    s_cmp_lt_i32 s27, 0
    s_cbranch_scc1 Wpr_25
    v_cmp_ne_u32 vcc, 1, v251
    s_cbranch_vccz Wpr_25a
    s_lshl_b32 s22, s27, 12
    s_add_u32 s22, s22, 58720256
Wp_26:
    buffer_load_dword v10, v3, s[8:11], s22 offen sc1
    s_waitcnt vmcnt(0)
    v_cmp_ne_u32 vcc, 1, v10
    s_cbranch_vccz Wp_26_ok
    s_mov_b64 exec, vcc
    s_add_u32 s21, s21, 1
    s_cmp_lt_u32 s21, 400000
    s_cbranch_scc1 Wp_26
Wp_26_ok:
    s_mov_b64 exec, -1
Wpr_25a:
    s_mul_i32 s65, s27, 1048576
    s_add_u32 s65, s65, 67108864
    s_and_b32 s23, s16, 12
    s_add_u32 s23, s23, s16
    s_lshl_b32 s23, s23, 15
    s_add_u32 s65, s65, s23
Wpr_25:
    s_add_u32 s23, s65, 0
    buffer_load_dwordx4 v[80:83], v4, s[8:11], s23 offen sc1
    s_add_u32 s23, s65, 4096
    buffer_load_dwordx4 v[84:87], v4, s[8:11], s23 offen sc1
    s_add_u32 s23, s65, 8192
    buffer_load_dwordx4 v[88:91], v4, s[8:11], s23 offen sc1
    s_add_u32 s23, s65, 12288
    buffer_load_dwordx4 v[92:95], v4, s[8:11], s23 offen sc1
    s_add_u32 s23, s65, 131072
    buffer_load_dwordx4 v[96:99], v4, s[8:11], s23 offen sc1
    s_add_u32 s23, s65, 135168
    buffer_load_dwordx4 v[100:103], v4, s[8:11], s23 offen sc1
    s_add_u32 s23, s65, 139264
    buffer_load_dwordx4 v[104:107], v4, s[8:11], s23 offen sc1
    s_add_u32 s23, s65, 143360
    buffer_load_dwordx4 v[108:111], v4, s[8:11], s23 offen sc1
Wat_lastp:
    s_bitcmp1_b32 s19, 0
    s_cbranch_scc1 Wat_last1
Wat_last0:
    s_mul_i32 s61, s20, 1048576
    s_add_u32 s61, s61, 67108864
    s_mul_i32 s23, s17, 262144
    s_add_u32 s61, s61, s23
    s_lshl_b32 s23, s28, 10
    s_add_u32 s61, s61, s23
    s_waitcnt lgkmcnt(15)
    v_mfma_f32_32x32x16_bf16 v[160:175], a[0:3], v[16:19], 0
    s_waitcnt lgkmcnt(14)
    v_mfma_f32_32x32x16_bf16 v[160:175], a[4:7], v[20:23], v[160:175]
    s_waitcnt lgkmcnt(13)
    v_mfma_f32_32x32x16_bf16 v[160:175], a[8:11], v[24:27], v[160:175]
    s_waitcnt lgkmcnt(12)
    v_mfma_f32_32x32x16_bf16 v[160:175], a[12:15], v[28:31], v[160:175]
    s_waitcnt lgkmcnt(11)
    v_mfma_f32_32x32x16_bf16 v[160:175], a[16:19], v[32:35], v[160:175]
    s_waitcnt lgkmcnt(10)
    v_mfma_f32_32x32x16_bf16 v[160:175], a[20:23], v[36:39], v[160:175]
    s_waitcnt lgkmcnt(9)
    v_mfma_f32_32x32x16_bf16 v[160:175], a[24:27], v[40:43], v[160:175]
    s_waitcnt lgkmcnt(8)
    v_mfma_f32_32x32x16_bf16 v[160:175], a[28:31], v[44:47], v[160:175]
    s_waitcnt lgkmcnt(7)
    v_mfma_f32_32x32x16_bf16 v[160:175], a[32:35], v[48:51], v[160:175]
    s_waitcnt lgkmcnt(6)
    v_mfma_f32_32x32x16_bf16 v[160:175], a[36:39], v[52:55], v[160:175]
    s_waitcnt lgkmcnt(5)
    v_mfma_f32_32x32x16_bf16 v[160:175], a[40:43], v[56:59], v[160:175]
    s_waitcnt lgkmcnt(4)
    v_mfma_f32_32x32x16_bf16 v[160:175], a[44:47], v[60:63], v[160:175]
    s_waitcnt lgkmcnt(3)
    v_mfma_f32_32x32x16_bf16 v[160:175], a[48:51], v[64:67], v[160:175]
    s_waitcnt lgkmcnt(2)
    v_mfma_f32_32x32x16_bf16 v[160:175], a[52:55], v[68:71], v[160:175]
    s_waitcnt lgkmcnt(1)
    v_mfma_f32_32x32x16_bf16 v[160:175], a[56:59], v[72:75], v[160:175]
    s_waitcnt lgkmcnt(0)
    v_mfma_f32_32x32x16_bf16 v[160:175], a[60:63], v[76:79], v[160:175]
    s_nop 6
    v_mfma_f32_32x32x16_bf16 v[176:191], a[64:67], v[16:19], 0
    s_nop 0
    v_mfma_f32_32x32x16_bf16 v[176:191], a[68:71], v[20:23], v[176:191]
    v_mfma_f32_32x32x16_bf16 v[176:191], a[72:75], v[24:27], v[176:191]
    s_nop 0
    v_cvt_pk_bf16_f32 v160, v160, v161
    v_cvt_pk_bf16_f32 v161, v162, v163
    v_cvt_pk_bf16_f32 v162, v164, v165
    v_cvt_pk_bf16_f32 v163, v166, v167
    buffer_store_dwordx4 v[160:163], v2, s[8:11], s61 offen offset:0 sc1
    v_mfma_f32_32x32x16_bf16 v[176:191], a[76:79], v[28:31], v[176:191]
    v_mfma_f32_32x32x16_bf16 v[176:191], a[80:83], v[32:35], v[176:191]
    v_cvt_pk_bf16_f32 v168, v168, v169
    v_cvt_pk_bf16_f32 v169, v170, v171
    v_cvt_pk_bf16_f32 v170, v172, v173
    v_cvt_pk_bf16_f32 v171, v174, v175
    buffer_store_dwordx4 v[168:171], v2, s[8:11], s61 offen offset:256 sc1
    v_mfma_f32_32x32x16_bf16 v[176:191], a[84:87], v[36:39], v[176:191]
    v_mfma_f32_32x32x16_bf16 v[176:191], a[88:91], v[40:43], v[176:191]
    v_mfma_f32_32x32x16_bf16 v[176:191], a[92:95], v[44:47], v[176:191]
    v_mfma_f32_32x32x16_bf16 v[176:191], a[96:99], v[48:51], v[176:191]
    v_mfma_f32_32x32x16_bf16 v[176:191], a[100:103], v[52:55], v[176:191]
    v_mfma_f32_32x32x16_bf16 v[176:191], a[104:107], v[56:59], v[176:191]
    v_mfma_f32_32x32x16_bf16 v[176:191], a[108:111], v[60:63], v[176:191]
    v_mfma_f32_32x32x16_bf16 v[176:191], a[112:115], v[64:67], v[176:191]
    v_mfma_f32_32x32x16_bf16 v[176:191], a[116:119], v[68:71], v[176:191]
    v_mfma_f32_32x32x16_bf16 v[176:191], a[120:123], v[72:75], v[176:191]
    v_mfma_f32_32x32x16_bf16 v[176:191], a[124:127], v[76:79], v[176:191]
    s_nop 0
    s_nop 10
    v_cvt_pk_bf16_f32 v176, v176, v177
    v_cvt_pk_bf16_f32 v177, v178, v179
    v_cvt_pk_bf16_f32 v178, v180, v181
    v_cvt_pk_bf16_f32 v179, v182, v183
    buffer_store_dwordx4 v[176:179], v2, s[8:11], s61 offen offset:512 sc1
    v_cvt_pk_bf16_f32 v184, v184, v185
    v_cvt_pk_bf16_f32 v185, v186, v187
    v_cvt_pk_bf16_f32 v186, v188, v189
    v_cvt_pk_bf16_f32 v187, v190, v191
    buffer_store_dwordx4 v[184:187], v2, s[8:11], s61 offen offset:768 sc1
    s_add_u32 s61, s61, 131072
    s_cmp_lt_i32 s27, 0
    s_cbranch_scc1 Wfp_27
    s_lshl_b32 s22, s27, 15
    s_waitcnt vmcnt(11)
    v_mfma_f32_16x16x32_bf16 v[228:231], v[208:211], v[80:83], 0
    s_waitcnt vmcnt(10)
    v_mfma_f32_16x16x32_bf16 v[228:231], v[208:211], v[84:87], v[228:231]
    s_waitcnt vmcnt(9)
    v_mfma_f32_16x16x32_bf16 v[228:231], v[208:211], v[88:91], v[228:231]
    s_waitcnt vmcnt(8)
    v_mfma_f32_16x16x32_bf16 v[228:231], v[208:211], v[92:95], v[228:231]
    s_nop 0
    s_nop 6
    v_fmac_f32 v222, v228, v220
    v_fmac_f32 v223, v229, v221
    v_cvt_pk_bf16_f32 v222, v222, v223
    buffer_store_dword v222, v8, s[44:47], s22 offen offset:0 sc1
    s_waitcnt vmcnt(8)
    v_mfma_f32_16x16x32_bf16 v[228:231], v[208:211], v[96:99], 0
    s_waitcnt vmcnt(7)
    v_mfma_f32_16x16x32_bf16 v[228:231], v[208:211], v[100:103], v[228:231]
    s_waitcnt vmcnt(6)
    v_mfma_f32_16x16x32_bf16 v[228:231], v[208:211], v[104:107], v[228:231]
    s_waitcnt vmcnt(5)
    v_mfma_f32_16x16x32_bf16 v[228:231], v[208:211], v[108:111], v[228:231]
    s_nop 0
    s_nop 6
    v_fmac_f32 v226, v228, v224
    v_fmac_f32 v227, v229, v225
    v_cvt_pk_bf16_f32 v226, v226, v227
    buffer_store_dword v226, v8, s[44:47], s22 offen offset:128 sc1
Wfp_27:
    s_nop 1
    v_mov_b64 v[220:221], v[212:213]
    v_mov_b64 v[222:223], v[214:215]
    v_mov_b64 v[224:225], v[216:217]
    v_mov_b64 v[226:227], v[218:219]
    s_mov_b32 s27, s20
    s_mul_i32 s65, s27, 1048576
    s_add_u32 s65, s65, 67108864
    s_and_b32 s23, s16, 12
    s_add_u32 s23, s23, s16
    s_lshl_b32 s23, s23, 15
    s_add_u32 s65, s65, s23
    s_waitcnt vmcnt(0)
Wat_lp0:
    s_add_u32 s23, s65, 0
    buffer_load_dwordx4 v[80:83], v4, s[8:11], s23 offen sc1
    s_add_u32 s23, s65, 4096
    buffer_load_dwordx4 v[84:87], v4, s[8:11], s23 offen sc1
    s_add_u32 s23, s65, 8192
    buffer_load_dwordx4 v[88:91], v4, s[8:11], s23 offen sc1
    s_add_u32 s23, s65, 12288
    buffer_load_dwordx4 v[92:95], v4, s[8:11], s23 offen sc1
    v_mov_b32 v10, 0
    s_waitcnt vmcnt(3)
    v_max3_u32 v10, v10, v80, v81
    v_max3_u32 v10, v10, v82, v83
    s_waitcnt vmcnt(2)
    v_max3_u32 v10, v10, v84, v85
    v_max3_u32 v10, v10, v86, v87
    s_waitcnt vmcnt(1)
    v_max3_u32 v10, v10, v88, v89
    v_max3_u32 v10, v10, v90, v91
    s_waitcnt vmcnt(0)
    v_max3_u32 v10, v10, v92, v93
    v_max3_u32 v10, v10, v94, v95
    v_cmp_eq_u32 vcc, -1, v10
    s_cbranch_vccz Wat_lp0_ok
    s_add_u32 s21, s21, 1
    s_cmp_lt_u32 s21, 400000
    s_cbranch_scc1 Wat_lp0
Wat_lp0_ok:
    s_lshl_b32 s22, s27, 15
    v_mfma_f32_16x16x32_bf16 v[228:231], v[208:211], v[80:83], 0
    v_mfma_f32_16x16x32_bf16 v[228:231], v[208:211], v[84:87], v[228:231]
    v_mfma_f32_16x16x32_bf16 v[228:231], v[208:211], v[88:91], v[228:231]
    v_mfma_f32_16x16x32_bf16 v[228:231], v[208:211], v[92:95], v[228:231]
    s_nop 0
    s_nop 6
    v_fmac_f32 v222, v228, v220
    v_fmac_f32 v223, v229, v221
    v_cvt_pk_bf16_f32 v222, v222, v223
    buffer_store_dword v222, v8, s[44:47], s22 offen offset:0 sc1
    s_branch Wend
Wat_last1:
    s_mul_i32 s61, s20, 1048576
    s_add_u32 s61, s61, 67108864
    s_mul_i32 s23, s17, 262144
    s_add_u32 s61, s61, s23
    s_lshl_b32 s23, s28, 10
    s_add_u32 s61, s61, s23
    s_add_u32 s61, s61, 131072
    s_waitcnt lgkmcnt(15)
    v_mfma_f32_32x32x16_bf16 v[160:175], a[128:131], v[16:19], 0
    s_waitcnt lgkmcnt(14)
    v_mfma_f32_32x32x16_bf16 v[160:175], a[132:135], v[20:23], v[160:175]
    s_waitcnt lgkmcnt(13)
    v_mfma_f32_32x32x16_bf16 v[160:175], a[136:139], v[24:27], v[160:175]
    s_waitcnt lgkmcnt(12)
    v_mfma_f32_32x32x16_bf16 v[160:175], a[140:143], v[28:31], v[160:175]
    s_waitcnt lgkmcnt(11)
    v_mfma_f32_32x32x16_bf16 v[160:175], a[144:147], v[32:35], v[160:175]
    s_waitcnt lgkmcnt(10)
    v_mfma_f32_32x32x16_bf16 v[160:175], a[148:151], v[36:39], v[160:175]
    s_waitcnt lgkmcnt(9)
    v_mfma_f32_32x32x16_bf16 v[160:175], a[152:155], v[40:43], v[160:175]
    s_waitcnt lgkmcnt(8)
    v_mfma_f32_32x32x16_bf16 v[160:175], a[156:159], v[44:47], v[160:175]
    s_waitcnt lgkmcnt(7)
    v_mfma_f32_32x32x16_bf16 v[160:175], a[160:163], v[48:51], v[160:175]
    s_waitcnt lgkmcnt(6)
    v_mfma_f32_32x32x16_bf16 v[160:175], a[164:167], v[52:55], v[160:175]
    s_waitcnt lgkmcnt(5)
    v_mfma_f32_32x32x16_bf16 v[160:175], a[168:171], v[56:59], v[160:175]
    s_waitcnt lgkmcnt(4)
    v_mfma_f32_32x32x16_bf16 v[160:175], a[172:175], v[60:63], v[160:175]
    s_waitcnt lgkmcnt(3)
    v_mfma_f32_32x32x16_bf16 v[160:175], a[176:179], v[64:67], v[160:175]
    s_waitcnt lgkmcnt(2)
    v_mfma_f32_32x32x16_bf16 v[160:175], a[180:183], v[68:71], v[160:175]
    s_waitcnt lgkmcnt(1)
    v_mfma_f32_32x32x16_bf16 v[160:175], a[184:187], v[72:75], v[160:175]
    s_waitcnt lgkmcnt(0)
    v_mfma_f32_32x32x16_bf16 v[160:175], a[188:191], v[76:79], v[160:175]
    s_nop 6
    v_mfma_f32_32x32x16_bf16 v[176:191], a[192:195], v[16:19], 0
    s_nop 0
    v_mfma_f32_32x32x16_bf16 v[176:191], a[196:199], v[20:23], v[176:191]
    v_mfma_f32_32x32x16_bf16 v[176:191], a[200:203], v[24:27], v[176:191]
    s_nop 0
    v_cvt_pk_bf16_f32 v160, v160, v161
    v_cvt_pk_bf16_f32 v161, v162, v163
    v_cvt_pk_bf16_f32 v162, v164, v165
    v_cvt_pk_bf16_f32 v163, v166, v167
    buffer_store_dwordx4 v[160:163], v2, s[8:11], s61 offen offset:0 sc1
    v_mfma_f32_32x32x16_bf16 v[176:191], a[204:207], v[28:31], v[176:191]
    v_mfma_f32_32x32x16_bf16 v[176:191], a[208:211], v[32:35], v[176:191]
    v_cvt_pk_bf16_f32 v168, v168, v169
    v_cvt_pk_bf16_f32 v169, v170, v171
    v_cvt_pk_bf16_f32 v170, v172, v173
    v_cvt_pk_bf16_f32 v171, v174, v175
    buffer_store_dwordx4 v[168:171], v2, s[8:11], s61 offen offset:256 sc1
    v_mfma_f32_32x32x16_bf16 v[176:191], a[212:215], v[36:39], v[176:191]
    v_mfma_f32_32x32x16_bf16 v[176:191], a[216:219], v[40:43], v[176:191]
    v_mfma_f32_32x32x16_bf16 v[176:191], a[220:223], v[44:47], v[176:191]
    v_mfma_f32_32x32x16_bf16 v[176:191], a[224:227], v[48:51], v[176:191]
    v_mfma_f32_32x32x16_bf16 v[176:191], a[228:231], v[52:55], v[176:191]
    v_mfma_f32_32x32x16_bf16 v[176:191], a[232:235], v[56:59], v[176:191]
    v_mfma_f32_32x32x16_bf16 v[176:191], a[236:239], v[60:63], v[176:191]
    v_mfma_f32_32x32x16_bf16 v[176:191], a[240:243], v[64:67], v[176:191]
    v_mfma_f32_32x32x16_bf16 v[176:191], a[244:247], v[68:71], v[176:191]
    v_mfma_f32_32x32x16_bf16 v[176:191], a[248:251], v[72:75], v[176:191]
    v_mfma_f32_32x32x16_bf16 v[176:191], a[252:255], v[76:79], v[176:191]
    s_nop 0
    s_nop 10
    v_cvt_pk_bf16_f32 v176, v176, v177
    v_cvt_pk_bf16_f32 v177, v178, v179
    v_cvt_pk_bf16_f32 v178, v180, v181
    v_cvt_pk_bf16_f32 v179, v182, v183
    buffer_store_dwordx4 v[176:179], v2, s[8:11], s61 offen offset:512 sc1
    v_cvt_pk_bf16_f32 v184, v184, v185
    v_cvt_pk_bf16_f32 v185, v186, v187
    v_cvt_pk_bf16_f32 v186, v188, v189
    v_cvt_pk_bf16_f32 v187, v190, v191
    buffer_store_dwordx4 v[184:187], v2, s[8:11], s61 offen offset:768 sc1
    s_cmp_lt_i32 s27, 0
    s_cbranch_scc1 Wfp_28
    s_lshl_b32 s22, s27, 15
    s_waitcnt vmcnt(11)
    v_mfma_f32_16x16x32_bf16 v[228:231], v[208:211], v[80:83], 0
    s_waitcnt vmcnt(10)
    v_mfma_f32_16x16x32_bf16 v[228:231], v[208:211], v[84:87], v[228:231]
    s_waitcnt vmcnt(9)
    v_mfma_f32_16x16x32_bf16 v[228:231], v[208:211], v[88:91], v[228:231]
    s_waitcnt vmcnt(8)
    v_mfma_f32_16x16x32_bf16 v[228:231], v[208:211], v[92:95], v[228:231]
    s_nop 0
    s_nop 6
    v_fmac_f32 v222, v228, v220
    v_fmac_f32 v223, v229, v221
    v_cvt_pk_bf16_f32 v222, v222, v223
    buffer_store_dword v222, v8, s[44:47], s22 offen offset:0 sc1
    s_waitcnt vmcnt(8)
    v_mfma_f32_16x16x32_bf16 v[228:231], v[208:211], v[96:99], 0
    s_waitcnt vmcnt(7)
    v_mfma_f32_16x16x32_bf16 v[228:231], v[208:211], v[100:103], v[228:231]
    s_waitcnt vmcnt(6)
    v_mfma_f32_16x16x32_bf16 v[228:231], v[208:211], v[104:107], v[228:231]
    s_waitcnt vmcnt(5)
    v_mfma_f32_16x16x32_bf16 v[228:231], v[208:211], v[108:111], v[228:231]
    s_nop 0
    s_nop 6
    v_fmac_f32 v226, v228, v224
    v_fmac_f32 v227, v229, v225
    v_cvt_pk_bf16_f32 v226, v226, v227
    buffer_store_dword v226, v8, s[44:47], s22 offen offset:128 sc1
Wfp_28:
    s_nop 1
    v_mov_b64 v[220:221], v[212:213]
    v_mov_b64 v[222:223], v[214:215]
    v_mov_b64 v[224:225], v[216:217]
    v_mov_b64 v[226:227], v[218:219]
    s_mov_b32 s27, s20
    s_mul_i32 s65, s27, 1048576
    s_add_u32 s65, s65, 67108864
    s_and_b32 s23, s16, 12
    s_add_u32 s23, s23, s16
    s_lshl_b32 s23, s23, 15
    s_add_u32 s65, s65, s23
    s_waitcnt vmcnt(0)
Wat_lp1:
    s_add_u32 s23, s65, 131072
    buffer_load_dwordx4 v[96:99], v4, s[8:11], s23 offen sc1
    s_add_u32 s23, s65, 135168
    buffer_load_dwordx4 v[100:103], v4, s[8:11], s23 offen sc1
    s_add_u32 s23, s65, 139264
    buffer_load_dwordx4 v[104:107], v4, s[8:11], s23 offen sc1
    s_add_u32 s23, s65, 143360
    buffer_load_dwordx4 v[108:111], v4, s[8:11], s23 offen sc1
    v_mov_b32 v10, 0
    s_waitcnt vmcnt(3)
    v_max3_u32 v10, v10, v96, v97
    v_max3_u32 v10, v10, v98, v99
    s_waitcnt vmcnt(2)
    v_max3_u32 v10, v10, v100, v101
    v_max3_u32 v10, v10, v102, v103
    s_waitcnt vmcnt(1)
    v_max3_u32 v10, v10, v104, v105
    v_max3_u32 v10, v10, v106, v107
    s_waitcnt vmcnt(0)
    v_max3_u32 v10, v10, v108, v109
    v_max3_u32 v10, v10, v110, v111
    v_cmp_eq_u32 vcc, -1, v10
    s_cbranch_vccz Wat_lp1_ok
    s_add_u32 s21, s21, 1
    s_cmp_lt_u32 s21, 400000
    s_cbranch_scc1 Wat_lp1
Wat_lp1_ok:
    s_lshl_b32 s22, s27, 15
    v_mfma_f32_16x16x32_bf16 v[228:231], v[208:211], v[96:99], 0
    v_mfma_f32_16x16x32_bf16 v[228:231], v[208:211], v[100:103], v[228:231]
    v_mfma_f32_16x16x32_bf16 v[228:231], v[208:211], v[104:107], v[228:231]
    v_mfma_f32_16x16x32_bf16 v[228:231], v[208:211], v[108:111], v[228:231]
    s_nop 0
    s_nop 6
    v_fmac_f32 v226, v228, v224
    v_fmac_f32 v227, v229, v225
    v_cvt_pk_bf16_f32 v226, v226, v227
    buffer_store_dword v226, v8, s[44:47], s22 offen offset:128 sc1
Wend:
    s_endpgm
Lcode_end:
.section .rodata,"a"
.p2align 6
.amdhsa_kernel recurrent_scan__memory_aug_recurrent_mem_tr__mixer_channel_mlp__prompt_kernel
  .amdhsa_next_free_vgpr 512
  .amdhsa_next_free_sgpr 102
  .amdhsa_accum_offset 256
  .amdhsa_group_segment_fixed_size 0
  .amdhsa_kernarg_size 120
  .amdhsa_user_sgpr_count 2
  .amdhsa_user_sgpr_kernarg_segment_ptr 1
  .amdhsa_system_sgpr_workgroup_id_x 1
.end_amdhsa_kernel
```
